```python
import torch

def _softmax(x, axis=-1):
    return torch.softmax(x, dim=axis)
def _gelu(x):
    return torch.nn.functional.gelu(x, approximate="tanh")
def _silu(x):
    return torch.nn.functional.silu(x)
def _sigmoid(x):
    return torch.sigmoid(x)
def _layernorm(x, axis=-1, eps=1e-5):
    m = x.mean(dim=axis, keepdim=True)
    v = x.var(dim=axis, keepdim=True, unbiased=False)
    return (x - m) / torch.sqrt(v + eps)
def _scatter_add(tgt, idx, src, axis=0):
    return tgt.clone().index_add_(axis, idx, src)
def _segment_sum(src, seg, n):
    out = torch.zeros((n,) + src.shape[1:], dtype=src.dtype)
    return out.index_add_(0, seg, src)
def _pad(x, pw):
    flat = tuple(v for pair in reversed(pw) for v in pair)
    return torch.nn.functional.pad(x, flat)

kernel_name = 'sequential_preLN__sliding_block__glu_gated_bilinear__prompt'

def setup_inputs():

    _w = (lambda a: (lambda t: t.to(torch.bfloat16) if t.is_floating_point() else t)(torch.as_tensor(a)))
    def _A_setup():
        B, S, D = 1, 2048, 576
        return {
            "x": _w((lambda *s: torch.randn(*s, dtype=torch.bfloat16) * 0.05)(B, S, D)),
            "wqkv": _w((lambda *s: torch.randn(*s, dtype=torch.bfloat16) * 0.05)(D, 3 * D)),
            "wo": _w((lambda *s: torch.randn(*s, dtype=torch.bfloat16) * 0.05)(D, D)),
        }
    _A_in = _A_setup()

    def _B_setup():
        B, S, D, F = 1, 2048, 576, 4608
        return {
            "x": _w((lambda *s: torch.randn(*s, dtype=torch.bfloat16) * 0.05)(B, S, D)),
            "w_gate": _w((lambda *s: torch.randn(*s, dtype=torch.bfloat16) * 0.8)(D, F) * (D ** -0.5)),
            "w_up": _w((lambda *s: torch.randn(*s, dtype=torch.bfloat16) * 0.8)(D, F) * (D ** -0.5)),
            "w_down": _w((lambda *s: torch.randn(*s, dtype=torch.bfloat16) * 0.8)(F, D) * (F ** -0.5)),
        }
    _B_in = _B_setup()

    return {
        "A_x": _A_in["x"],
        "A_wqkv": _A_in["wqkv"],
        "A_wo": _A_in["wo"],
        "B_x": _B_in["x"],
        "B_w_gate": _B_in["w_gate"],
        "B_w_up": _B_in["w_up"],
        "B_w_down": _B_in["w_down"],
    }

def reference(A_x, A_wqkv, A_wo, B_x, B_w_gate, B_w_up, B_w_down):
    def _A_ref(x, wqkv, wo):
        B, S, D = x.shape
        H = 32; Dh = D // H; W = 256
        qkv = (lambda x, *d: x.permute(*d))((x @ wqkv).reshape(B, S, 3, H, Dh), 2, 0, 3, 1, 4)
        q, k, v = qkv[0], qkv[1], qkv[2]
        scores = torch.einsum("bhqd,bhkd->bhqk", q, k) * (Dh ** -0.5)
        idx = torch.arange(S)
        mask = (idx[:, None] - idx[None, :] >= 0) & (idx[:, None] - idx[None, :] < W)
        scores = torch.where(mask[None, None], scores, -1e9)
        p = _softmax(scores, axis=-1)
        o = torch.einsum("bhqk,bhkd->bhqd", p, v)
        return (lambda x, *d: x.permute(*d))(o, 0, 2, 1, 3).reshape(B, S, D) @ wo

    def _B_ref(x, w_gate, w_up, w_down):
        g = torch.einsum("bsd,df->bsf", x, w_gate)
        u = torch.einsum("bsd,df->bsf", x, w_up)
        h = g * u
        return torch.einsum("bsf,fd->bsd", h, w_down)

    x = A_x
    h = x + _A_ref(_layernorm(x, axis=-1), A_wqkv, A_wo)
    h2 = h + _B_ref(_layernorm(h, axis=-1), B_w_gate, B_w_up, B_w_down)
    return h2
```

```asm
; @launch kernel=k1_kernel grid=(256,1,1) block=(256,1,1) lds=163840
.amdgcn_target "amdgcn-amd-amdhsa--gfx950"
.text
.p2align 12
.globl k1_kernel
.p2align 8
.type k1_kernel,@function
k1_kernel:
  s_cmp_ge_u32 s2, 256
  s_cbranch_scc1 k1_kernel_end
  s_load_dwordx4 s[4:7], s[0:1], 0
  s_load_dwordx4 s[76:79], s[0:1], 64
  s_load_dwordx2 s[16:17], s[0:1], 16
  s_load_dwordx4 s[20:23], s[0:1], 32
  v_lshrrev_b32 v18, 6, v0
  v_and_b32 v1, 63, v0
  v_readfirstlane_b32 s24, v18
  s_getpc_b64 s[44:45]
  s_and_b32 s40, s2, 0xf8
  v_lshrrev_b32 v30, 5, v0
  v_add_lshl_u32 v30, v30, s40, 7
  v_mov_b32 v31, s45
  v_add_co_u32 v30, vcc, s44, v30
  s_nop 1
  v_addc_co_u32 v31, vcc, 0, v31, vcc
  global_load_dword v29, v[30:31], off
  s_and_b32 s25, s2, 3
  s_lshl_b32 s25, s25, 2
  s_bfe_u32 s40, s2, 0x20003
  s_add_u32 s25, s25, s40
  s_and_b32 s26, s2, 4
  s_lshl_b32 s26, s26, 1
  s_lshr_b32 s27, s2, 5
  s_add_u32 s26, s26, s27
  s_and_b32 s29, s27, 1
  s_lshl_b32 s40, s40, 1
  s_add_u32 s40, s40, s27
  s_lshr_b32 s27, s27, 2
  s_add_u32 s40, s40, s27
  s_sub_u32 s27, s40, 9
  s_cselect_b32 s40, s40, s27
  s_lshl_b32 s41, s25, 2
  s_add_u32 s41, s41, s24
  s_mul_i32 s33, s41, 36864
  s_add_u32 s34, s33, 1152
  s_lshl_b32 s27, s40, 7
  s_add_u32 s32, s33, s27
  v_lshrrev_b32 v243, 4, v1
  v_lshrrev_b32 v20, 3, v1
  v_mul_u32_u24 v20, 1152, v20
  v_and_b32 v21, 7, v1
  v_xor_b32 v21, v21, v243
  v_lshl_add_u32 v224, v21, 4, v20
  v_xor_b32 v225, 64, v224
  v_add_u32 v225, 8192, v225
  v_add_u32 v226, 16384, v224
  v_add_u32 v227, 16384, v225
  s_mul_i32 s31, s26, 72
  s_mul_i32 s27, s29, 1080
  s_add_u32 s31, s31, s27
  s_mul_i32 s27, s24, 55296
  s_add_u32 s31, s31, s27
  s_add_u32 s31, s31, 1152
  s_mul_i32 s27, s40, 221184
  s_add_u32 s30, s31, s27
  s_mul_i32 s27, s29, 1088
  s_add_u32 s27, s27, 1152
  s_sub_u32 s100, s30, s27
  s_sub_u32 s3, s31, s27
  s_lshl_b32 s35, s24, 12
  s_mul_i32 s36, s24, 2304
  s_add_u32 s36, s36, 16384
  s_movk_i32 s42, 3456
  s_movk_i32 s43, -144
  v_lshlrev_b32 v245, 4, v1
  s_mov_b32 s14, 1990656
  s_mov_b32 s15, 0x00020000
  s_mov_b32 m0, s35
  v_mul_u32_u24 v20, 7282, v1
  v_lshrrev_b32 v20, 16, v20
  v_and_b32 v21, 0x78, v20
  v_and_b32 v22, 1, v20
  v_lshl_or_b32 v21, v22, 2, v21
  v_bfe_u32 v22, v20, 1, 2
  v_mad_i32_i24 v20, v20, s43, v245
  v_or_b32 v21, v21, v22
  v_mad_u32_u24 v228, v21, s42, v20
  v_add_u32 v20, 64, v1
  v_mul_u32_u24 v20, 7282, v20
  v_lshrrev_b32 v20, 16, v20
  v_and_b32 v21, 0x78, v20
  v_and_b32 v22, 1, v20
  v_lshl_or_b32 v21, v22, 2, v21
  v_bfe_u32 v22, v20, 1, 2
  v_mad_i32_i24 v20, v20, s43, v245
  v_or_b32 v21, v21, v22
  v_mad_u32_u24 v229, v21, s42, v20
  v_add_u32 v20, 128, v1
  v_mul_u32_u24 v20, 7282, v20
  v_lshrrev_b32 v20, 16, v20
  v_and_b32 v21, 0x78, v20
  v_and_b32 v22, 1, v20
  v_lshl_or_b32 v21, v22, 2, v21
  v_bfe_u32 v22, v20, 1, 2
  v_mad_i32_i24 v20, v20, s43, v245
  v_or_b32 v21, v21, v22
  v_mad_u32_u24 v230, v21, s42, v20
  s_waitcnt lgkmcnt(0)
  s_mov_b32 s12, s6
  s_mov_b32 s13, s7
  s_mov_b32 s6, 2359296
  s_mov_b32 s7, 0x00020000
  buffer_load_dwordx4 v224, s[4:7], s32 offen offset:0 lds
  buffer_load_dwordx4 v225, s[4:7], s32 offen offset:1024 lds
  buffer_load_dwordx4 v226, s[4:7], s32 offen offset:2048 lds
  buffer_load_dwordx4 v227, s[4:7], s32 offen offset:3072 lds
  s_add_u32 m0, s36, 0
  s_add_u32 s32, s32, 128
  buffer_load_dwordx4 v228, s[12:15], s30 offen offset:0 lds
  buffer_load_dwordx4 v229, s[12:15], s30 offen offset:1024 lds
  s_mov_b64 exec, 0xffff
  buffer_load_dwordx4 v230, s[12:15], s30 offen offset:2048 lds
  s_mov_b64 exec, -1
  s_add_u32 s30, s30, 221184
  s_cmp_eq_u32 s32, s34
  s_cselect_b32 s32, s33, s32
  s_cselect_b32 s30, s31, s30
  s_add_u32 m0, s35, 25600
  s_nop 0
  buffer_load_dwordx4 v224, s[4:7], s32 offen offset:0 lds
  buffer_load_dwordx4 v225, s[4:7], s32 offen offset:1024 lds
  buffer_load_dwordx4 v226, s[4:7], s32 offen offset:2048 lds
  buffer_load_dwordx4 v227, s[4:7], s32 offen offset:3072 lds
  s_add_u32 m0, s36, 25600
  s_add_u32 s32, s32, 128
  buffer_load_dwordx4 v228, s[12:15], s30 offen offset:0 lds
  buffer_load_dwordx4 v229, s[12:15], s30 offen offset:1024 lds
  s_mov_b64 exec, 0xffff
  buffer_load_dwordx4 v230, s[12:15], s30 offen offset:2048 lds
  s_mov_b64 exec, -1
  s_add_u32 s30, s30, 221184
  s_cmp_eq_u32 s32, s34
  s_cselect_b32 s32, s33, s32
  s_cselect_b32 s30, s31, s30
  s_mov_b64 exec, 0
  s_cmp_eq_u32 s24, 0
  s_cbranch_scc1 k1_kernel_w0
  s_cmp_eq_u32 s24, 1
  s_cbranch_scc1 k1_kernel_w1
  s_cmp_eq_u32 s24, 2
  s_cbranch_scc1 k1_kernel_w2
  s_branch k1_kernel_w3
k1_kernel_wr:
  s_mov_b64 exec, -1
  v_lshlrev_b32 v249, 4, v0
  v_mov_b32 v252, 0
  s_mov_b32 s42, 0x3f803f80
  s_lshl_b32 s27, s25, 2
  s_sub_u32 s27, 8, s27
  v_lshrrev_b32 v20, 5, v0
  v_cmp_gt_i32 vcc, s27, v20
  v_mov_b32 v21, 0xf149
  v_and_b32 v20, 31, v0
  v_cndmask_b32 v21, 0, v21, vcc
  v_cmp_eq_u32 vcc, 1, v20
  v_mov_b32 v22, s42
  v_add_u32 v20, 155648, v249
  v_cndmask_b32 v64, v22, v21, vcc
  v_cndmask_b32 v65, v22, v252, vcc
  v_cndmask_b32 v66, v22, v252, vcc
  v_cndmask_b32 v67, v22, v252, vcc
  v_cndmask_b32 v68, v22, v252, vcc
  v_cndmask_b32 v69, v22, v252, vcc
  ds_write_b128 v20, v[64:67]
  ds_write_b128 v20, v[66:69] offset:4096
  v_accvgpr_write_b32 a232, v22
  v_accvgpr_write_b32 a233, v22
  v_accvgpr_write_b32 a234, v22
  v_accvgpr_write_b32 a235, v22
  v_and_b32 v18, 15, v1
  v_lshrrev_b32 v20, 1, v18
  v_xor_b32 v20, v20, v243
  v_lshlrev_b32 v20, 4, v20
  v_lshl_add_u32 v237, v18, 7, v20
  v_add_u32 v237, s35, v237
  v_xor_b32 v238, 64, v237
  v_lshlrev_b32 v250, 4, v18
  v_lshrrev_b32 v248, 2, v1
  v_and_b32 v246, 3, v1
  v_mul_u32_u24 v21, 288, v248
  v_add_u32 v21, 16384, v21
  v_lshl_add_u32 v23, v246, 3, v21
  s_mov_b32 s40, 0x70482800
  s_lshl_b32 s41, s24, 3
  s_xor_b32 s27, s41, 524288
  s_bfe_u32 s27, s40, s27
  v_add_u32 v232, s27, v23
  s_xor_b32 s27, s41, 524296
  s_bfe_u32 s27, s40, s27
  v_add_u32 v233, s27, v23
  s_xor_b32 s27, s41, 524304
  s_bfe_u32 s27, s40, s27
  v_add_u32 v234, s27, v23
  s_xor_b32 s27, s41, 524312
  s_bfe_u32 s27, s40, s27
  v_add_u32 v235, s27, v23
  v_mul_u32_u24 v23, 72, v246
  v_add3_u32 v236, v23, v21, 32
  v_cmp_lt_u32 vcc, 1, v246
  v_mov_b32 v24, 155712
  s_movk_i32 s38, 25600
  v_cndmask_b32 v236, v236, v24, vcc
  v_cndmask_b32 v241, 1, 0, vcc
  s_mov_b32 s39, -76800
  s_mov_b32 s8, s78
  s_mov_b32 s9, s79
  s_mov_b32 s10, 67108864
  s_mov_b32 s11, 0x00020000
  s_movk_i32 s78, 256
  s_mov_b32 s79, 0x00020000
  s_mov_b32 s89, 0x7fffff00
  v_mov_b32 v30, 1
  s_sub_u32 s40, s2, 192
  s_lshl_b32 s41, s40, 2
  s_add_u32 s41, s41, s24
  s_lshl_b32 s90, s40, 13
  s_add_u32 s90, s90, 18522112
  s_cmp_lt_u32 s40, 6
  s_cselect_b32 s41, s41, 256
  s_cselect_b32 s91, s90, s89
  v_lshl_add_u32 v31, v1, 8, s41
  s_lshl_b32 s90, s40, 12
  s_add_u32 s90, s90, 17035264
  s_cmp_lt_u32 s40, 3
  s_cselect_b32 s91, s90, s91
  s_cselect_b32 s41, 0, 0xfc0
  s_cmp_eq_u32 s40, 0
  s_cselect_b32 s91, 18481152, s91
  s_cselect_b32 s90, 7, 4
  v_and_b32 v28, s41, v249
  v_lshl_add_u32 v28, v0, s90, v28
  v_mov_b32 v253, 0
  v_mov_b32 v254, 0
  v_mov_b32 v255, 0
  v_lshrrev_b32 v244, 5, v1
  s_sub_u32 s101, s2, 64
  s_lshl_b32 s40, s101, 3
  v_lshrrev_b32 v172, 5, v0
  v_add_u32 v172, s40, v172
  v_lshrrev_b32 v173, 6, v172
  v_lshl_add_u32 v173, v173, 3, v172
  v_bfe_u32 v174, v172, 3, 1
  v_mad_u32_u24 v173, v174, 28, v173
  v_bfe_u32 v174, v172, 4, 1
  v_mad_i32_i24 v173, v174, -8, v173
  v_bfe_u32 v175, v172, 5, 1
  v_mad_i32_i24 v173, v175, -12, v173
  v_and_b32 v174, 31, v172
  v_lshl_add_u32 v174, v175, 1, v174
  v_bfe_u32 v175, v172, 1, 4
  v_mad_u32_u24 v174, v175, 34, v174
  v_add_u32 v174, 16, v174
  v_cmp_gt_u32 vcc, 512, v172
  v_and_b32 v175, 31, v0
  v_mul_u32_u24 v175, 12, v175
  v_cndmask_b32 v173, v174, v173, vcc
  v_mul_u32_u24 v173, 1152, v173
  s_cmp_lt_u32 s101, 72
  s_cselect_b32 s40, 0, s89
  v_add3_u32 v44, v173, v175, s40
  v_lshl_add_u32 v45, v172, 3, s40
  s_mov_b32 s18, 663552
  s_mov_b32 s19, 0x00020000
  buffer_load_dwordx3 v[32:34], v44, s[16:19], 0 offen offset:0
  buffer_load_dwordx3 v[36:38], v44, s[16:19], 0 offen offset:384
  buffer_load_dwordx3 v[40:42], v44, s[16:19], 0 offen offset:768
  s_lshl_b32 s44, s24, 9
  s_movk_i32 s43, 6208
  v_and_b32 v175, 31, v1
  v_lshl_add_u32 v172, v175, 4, s44
  v_mad_u32_u24 v2, v244, s43, v172
  v_add_u32 v3, 12416, v2
  s_add_u32 s45, s44, 155664
  v_mov_b32 v4, s45
  v_add_u32 v172, 24832, v172
  v_cmp_lt_u32 vcc, 31, v1
  v_lshlrev_b32 v9, 2, v1
  v_mov_b32 v173, 0x3f80
  v_cndmask_b32 v4, v172, v4, vcc
  v_cndmask_b32 v173, 0, v173, vcc
  v_accvgpr_write_b32 a244, v173
  v_accvgpr_write_b32 a252, v173
  v_and_b32 v172, 16, v1
  v_lshl_add_u32 v8, v172, 6, v250
  v_lshl_add_u32 v8, v244, 8, v8
  v_lshlrev_b32 v172, 2, v244
  v_and_b32 v174, 3, v248
  v_add_u32 v174, v174, v172
  v_lshl_add_u32 v174, v174, 4, s44
  v_lshrrev_b32 v172, 1, v246
  v_mad_u32_u24 v172, v172, s43, v174
  v_and_b32 v173, 1, v246
  v_lshl_add_u32 v172, v173, 3, v172
  v_add_u32 v6, 31040, v172
  v_add_u32 v7, 43456, v172
  s_lshl_b32 s45, s29, 3
  s_add_u32 s45, s45, 55872
  v_add_u32 v174, s45, v174
  v_and_b32 v173, 19, v1
  s_movk_i32 s45, 9740
  v_lshl_add_u32 v172, v244, 2, s45
  v_lshlrev_b32 v172, 4, v172
  v_cmp_lt_u32 vcc, 16, v173
  s_nop 1
  v_cndmask_b32 v174, v174, v172, vcc
  v_cmp_lt_u32 vcc, 15, v173
  s_nop 1
  v_cndmask_b32 v6, v6, v174, vcc
  v_cndmask_b32 v7, v7, v174, vcc
  s_lshl_b32 s27, s25, 1
  s_lshr_b32 s28, s24, 1
  s_add_u32 s27, s27, s28
  s_mul_i32 s87, s27, 73728
  s_and_b32 s27, s24, 1
  s_lshl_b32 s27, s27, 11
  s_add_u32 s87, s87, s27
  s_lshl_b32 s27, s26, 12
  s_add_u32 s87, s87, s27
  s_add_u32 s87, s87, 8388608
  s_mul_i32 s27, s29, 3584
  s_sub_u32 s87, s87, s27
  s_lshl_b32 s88, s25, 2
  s_add_u32 s88, s88, s24
  s_lshl_b32 s88, s88, 12
  s_lshl_b32 s27, s26, 8
  s_add_u32 s88, s88, s27
  s_add_u32 s88, s88, 17563648
  s_sub_u32 s96, s29, 1
  v_mov_b32 v173, 0x3f003f00
  v_mov_b32 v16, 0
  v_mov_b32 v17, 0
  v_accvgpr_write_b32 a236, v173
  v_accvgpr_write_b32 a237, v173
  v_accvgpr_write_b32 a238, 0
  v_accvgpr_write_b32 a239, 0
  v_accvgpr_write_b32 a245, 0
  v_accvgpr_write_b32 a246, 0
  v_accvgpr_write_b32 a247, 0
  v_accvgpr_write_b32 a253, 0
  v_accvgpr_write_b32 a254, 0
  v_accvgpr_write_b32 a255, 0
  s_add_u32 m0, s35, 51200
  s_nop 0
  buffer_load_dwordx4 v224, s[4:7], s32 offen offset:0 lds
  buffer_load_dwordx4 v225, s[4:7], s32 offen offset:1024 lds
  buffer_load_dwordx4 v226, s[4:7], s32 offen offset:2048 lds
  buffer_load_dwordx4 v227, s[4:7], s32 offen offset:3072 lds
  s_add_u32 m0, s36, 51200
  s_add_u32 s32, s32, 128
  buffer_load_dwordx4 v228, s[12:15], s30 offen offset:0 lds
  buffer_load_dwordx4 v229, s[12:15], s30 offen offset:1024 lds
  s_mov_b64 exec, 0xffff
  buffer_load_dwordx4 v230, s[12:15], s30 offen offset:2048 lds
  s_mov_b64 exec, -1
  s_add_u32 s30, s30, 221184
  s_cmp_eq_u32 s32, s34
  s_cselect_b32 s32, s33, s32
  s_cselect_b32 s30, s31, s30
  buffer_store_dwordx4 v[252:255], v28, s[8:11], s91 offen sc1
  s_waitcnt vmcnt(18) lgkmcnt(0)
  s_barrier
  ds_read_b128 a[0:3], v237 offset:0
  ds_read_b128 a[4:7], v237 offset:2048
  ds_read_b64_tr_b16 a[144:145], v232 offset:0
  ds_read_b64_tr_b16 a[146:147], v232 offset:144
  ds_read_b64_tr_b16 a[148:149], v233 offset:0
  ds_read_b64_tr_b16 a[150:151], v233 offset:144
  ds_read_b64_tr_b16 a[152:153], v234 offset:0
  ds_read_b64_tr_b16 a[154:155], v234 offset:144
  ds_read_b64_tr_b16 a[156:157], v235 offset:0
  ds_read_b64_tr_b16 a[158:159], v235 offset:144
  ds_read_b128 a[8:11], v238 offset:0
  ds_read_b128 a[12:15], v238 offset:2048
  ds_read_b64_tr_b16 a[160:161], v236 offset:0
  ds_read_b64_tr_b16 a[162:163], v236 offset:144
  s_waitcnt lgkmcnt(12)
  v_mfma_f32_16x16x32_bf16 v[112:115], a[0:3], a[0:3], 0
  s_add_u32 m0, s35, 76800
  s_add_u32 s95, s3, 1990656
  v_mfma_f32_16x16x32_bf16 v[116:119], a[4:7], a[4:7], 0
  buffer_load_dwordx4 v224, s[4:7], s32 offen offset:0 lds
  s_mul_i32 s37, s24, 1280
  s_waitcnt lgkmcnt(8)
  v_mfma_f32_16x16x32_bf16 v[104:107], a[144:147], a[232:235], 0
  ds_read_b64_tr_b16 a[164:165], v232 offset:4608
  buffer_load_dwordx4 v225, s[4:7], s32 offen offset:1024 lds
  v_mfma_f32_16x16x32_bf16 v[64:67], a[144:147], a[0:3], 0
  ds_read_b64_tr_b16 a[166:167], v232 offset:4752
  buffer_load_dwordx4 v226, s[4:7], s32 offen offset:2048 lds
  v_mfma_f32_16x16x32_bf16 v[68:71], a[144:147], a[4:7], 0
  buffer_load_dwordx4 v227, s[4:7], s32 offen offset:3072 lds
  s_add_u32 s37, s37, 102400
  v_mfma_f32_16x16x32_bf16 v[72:75], a[148:151], a[0:3], 0
  ds_read_b64_tr_b16 a[168:169], v233 offset:4608
  s_add_u32 m0, s36, 76800
  s_add_u32 s32, s32, 128
  v_mfma_f32_16x16x32_bf16 v[76:79], a[148:151], a[4:7], 0
  ds_read_b64_tr_b16 a[170:171], v233 offset:4752
  buffer_load_dwordx4 v228, s[12:15], s30 offen offset:0 lds
  s_waitcnt lgkmcnt(8)
  v_mfma_f32_16x16x32_bf16 v[80:83], a[152:155], a[0:3], 0
  ds_read_b64_tr_b16 a[172:173], v234 offset:4608
  buffer_load_dwordx4 v229, s[12:15], s30 offen offset:1024 lds
  v_mfma_f32_16x16x32_bf16 v[84:87], a[152:155], a[4:7], 0
  ds_read_b64_tr_b16 a[174:175], v234 offset:4752
  s_mov_b64 exec, 0xffff
  buffer_load_dwordx4 v230, s[12:15], s30 offen offset:2048 lds
  s_mov_b64 exec, -1
  v_mfma_f32_16x16x32_bf16 v[88:91], a[156:159], a[0:3], 0
  ds_read_b64_tr_b16 a[144:145], v235 offset:4608
  s_add_u32 s30, s30, 221184
  v_mfma_f32_16x16x32_bf16 v[92:95], a[156:159], a[4:7], 0
  ds_read_b64_tr_b16 a[146:147], v235 offset:4752
  s_cmp_eq_u32 s32, s34
  s_cselect_b32 s32, s33, s32
  s_cselect_b32 s30, s31, s30
  s_waitcnt lgkmcnt(6)
  v_mfma_f32_16x16x32_bf16 v[108:111], a[160:163], a[232:235], 0
  ds_read_b64_tr_b16 a[148:149], v236 offset:4608
  s_movk_i32 s40, -80
  v_mfma_f32_16x16x32_bf16 v[96:99], a[160:163], a[0:3], 0
  ds_read_b64_tr_b16 a[150:151], v236 offset:4752
  s_movk_i32 s41, 3456
  v_mfma_f32_16x16x32_bf16 v[100:103], a[160:163], a[4:7], 0
  v_mul_u32_u24 v172, 13108, v1
  v_lshrrev_b32 v172, 16, v172
  s_waitcnt lgkmcnt(12)
  v_mfma_f32_16x16x32_bf16 v[112:115], a[8:11], a[8:11], v[112:115]
  v_and_b32 v173, 0x78, v172
  v_and_b32 v174, 1, v172
  v_mfma_f32_16x16x32_bf16 v[116:119], a[12:15], a[12:15], v[116:119]
  v_lshl_or_b32 v173, v174, 2, v173
  v_bfe_u32 v174, v172, 1, 2
  v_mfma_f32_16x16x32_bf16 v[104:107], a[164:167], a[232:235], v[104:107]
  s_waitcnt vmcnt(18)
  s_barrier
  ds_read_b128 a[16:19], v237 offset:25600
  ds_read_b128 a[20:23], v237 offset:27648
  ds_read_b64_tr_b16 a[152:153], v232 offset:25600
  v_mad_i32_i24 v172, v172, s40, v245
  v_mfma_f32_16x16x32_bf16 v[64:67], a[164:167], a[8:11], v[64:67]
  ds_read_b64_tr_b16 a[154:155], v232 offset:25744
  v_or_b32 v173, v173, v174
  v_mfma_f32_16x16x32_bf16 v[68:71], a[164:167], a[12:15], v[68:71]
  s_add_u32 m0, s35, 0
  v_mad_u32_u24 v231, v173, s41, v172
  s_waitcnt lgkmcnt(8)
  v_mfma_f32_16x16x32_bf16 v[72:75], a[168:171], a[8:11], v[72:75]
  ds_read_b64_tr_b16 a[156:157], v233 offset:25600
  v_add_u32 v172, 64, v1
  v_mfma_f32_16x16x32_bf16 v[76:79], a[168:171], a[12:15], v[76:79]
  ds_read_b64_tr_b16 a[158:159], v233 offset:25744
  buffer_load_dwordx4 v224, s[4:7], s32 offen offset:0 lds
  v_mfma_f32_16x16x32_bf16 v[80:83], a[172:175], a[8:11], v[80:83]
  ds_read_b64_tr_b16 a[160:161], v234 offset:25600
  v_mul_u32_u24 v172, 13108, v172
  v_mfma_f32_16x16x32_bf16 v[84:87], a[172:175], a[12:15], v[84:87]
  ds_read_b64_tr_b16 a[162:163], v234 offset:25744
  buffer_load_dwordx4 v225, s[4:7], s32 offen offset:1024 lds
  s_waitcnt lgkmcnt(8)
  v_mfma_f32_16x16x32_bf16 v[88:91], a[144:147], a[8:11], v[88:91]
  ds_read_b64_tr_b16 a[164:165], v235 offset:25600
  v_lshrrev_b32 v172, 16, v172
  v_mfma_f32_16x16x32_bf16 v[92:95], a[144:147], a[12:15], v[92:95]
  ds_read_b64_tr_b16 a[166:167], v235 offset:25744
  buffer_load_dwordx4 v226, s[4:7], s32 offen offset:2048 lds
  v_mfma_f32_16x16x32_bf16 v[108:111], a[148:151], a[232:235], v[108:111]
  ds_read_b128 a[24:27], v238 offset:25600
  ds_read_b128 a[28:31], v238 offset:27648
  v_mad_i32_i24 v236, v241, s38, v236
  ds_read_b64_tr_b16 a[168:169], v236 offset:0
  v_and_b32 v173, 0x78, v172
  v_mfma_f32_16x16x32_bf16 v[96:99], a[148:151], a[8:11], v[96:99]
  ds_read_b64_tr_b16 a[170:171], v236 offset:144
  buffer_load_dwordx4 v227, s[4:7], s32 offen offset:3072 lds
  v_mfma_f32_16x16x32_bf16 v[100:103], a[148:151], a[12:15], v[100:103]
  v_and_b32 v174, 1, v172
  v_lshl_or_b32 v173, v174, 2, v173
  s_waitcnt lgkmcnt(12)
  v_mfma_f32_16x16x32_bf16 v[112:115], a[16:19], a[16:19], v[112:115]
  s_add_u32 m0, s36, 0
  s_add_u32 s32, s32, 128
  v_bfe_u32 v174, v172, 1, 2
  v_mfma_f32_16x16x32_bf16 v[116:119], a[20:23], a[20:23], v[116:119]
  v_mad_i32_i24 v172, v172, s40, v245
  v_or_b32 v173, v173, v174
  s_waitcnt lgkmcnt(8)
  v_mfma_f32_16x16x32_bf16 v[104:107], a[152:155], a[232:235], v[104:107]
  ds_read_b64_tr_b16 a[172:173], v232 offset:30208
  buffer_load_dwordx4 v228, s[12:15], s30 offen offset:0 lds
  v_mfma_f32_16x16x32_bf16 v[64:67], a[152:155], a[16:19], v[64:67]
  ds_read_b64_tr_b16 a[174:175], v232 offset:30352
  v_mad_u32_u24 v239, v173, s41, v172
  v_mfma_f32_16x16x32_bf16 v[68:71], a[152:155], a[20:23], v[68:71]
  buffer_load_dwordx4 v229, s[12:15], s30 offen offset:1024 lds
  s_lshl_b32 s27, s29, 3
  v_mfma_f32_16x16x32_bf16 v[72:75], a[156:159], a[16:19], v[72:75]
  ds_read_b64_tr_b16 a[144:145], v233 offset:30208
  s_add_u32 s27, s27, 102400
  v_mfma_f32_16x16x32_bf16 v[76:79], a[156:159], a[20:23], v[76:79]
  ds_read_b64_tr_b16 a[146:147], v233 offset:30352
  s_mov_b64 exec, 0xffff
  buffer_load_dwordx4 v230, s[12:15], s30 offen offset:2048 lds
  s_mov_b64 exec, -1
  s_waitcnt lgkmcnt(8)
  v_mfma_f32_16x16x32_bf16 v[80:83], a[160:163], a[16:19], v[80:83]
  ds_read_b64_tr_b16 a[148:149], v234 offset:30208
  v_mul_u32_u24 v240, 160, v248
  v_mfma_f32_16x16x32_bf16 v[84:87], a[160:163], a[20:23], v[84:87]
  ds_read_b64_tr_b16 a[150:151], v234 offset:30352
  s_add_u32 s30, s30, 221184
  v_mfma_f32_16x16x32_bf16 v[88:91], a[164:167], a[16:19], v[88:91]
  ds_read_b64_tr_b16 a[152:153], v235 offset:30208
  v_lshl_add_u32 v240, v246, 3, v240
  v_mfma_f32_16x16x32_bf16 v[92:95], a[164:167], a[20:23], v[92:95]
  ds_read_b64_tr_b16 a[154:155], v235 offset:30352
  s_cmp_eq_u32 s32, s34
  s_cselect_b32 s32, s33, s32
  s_cselect_b32 s30, s31, s30
  s_waitcnt lgkmcnt(6)
  v_mfma_f32_16x16x32_bf16 v[108:111], a[168:171], a[232:235], v[108:111]
  ds_read_b64_tr_b16 a[156:157], v236 offset:4608
  v_add_u32 v240, s27, v240
  v_mfma_f32_16x16x32_bf16 v[96:99], a[168:171], a[16:19], v[96:99]
  ds_read_b64_tr_b16 a[158:159], v236 offset:4752
  s_and_b32 s27, s24, 1
  v_mfma_f32_16x16x32_bf16 v[100:103], a[168:171], a[20:23], v[100:103]
  v_and_b32 v172, 1, v243
  v_xor_b32 v172, s27, v172
  s_waitcnt lgkmcnt(12)
  v_mfma_f32_16x16x32_bf16 v[112:115], a[24:27], a[24:27], v[112:115]
  v_lshl_add_u32 v172, v172, 1, v244
  s_mov_b32 s40, 32896
  v_mfma_f32_16x16x32_bf16 v[116:119], a[28:31], a[28:31], v[116:119]
  v_mad_u32_u24 v242, v172, s40, v250
  s_mul_i32 s40, s26, 296064
  v_mfma_f32_16x16x32_bf16 v[104:107], a[172:175], a[232:235], v[104:107]
  s_waitcnt vmcnt(15)
  s_barrier
  v_add_u32 v237, 51200, v237
  ds_read_b128 a[32:35], v237 offset:0
  ds_read_b128 a[36:39], v237 offset:2048
  v_add_u32 v232, 51200, v232
  ds_read_b64_tr_b16 a[160:161], v232 offset:0
  s_add_u32 s40, s40, 4096
  v_mfma_f32_16x16x32_bf16 v[64:67], a[172:175], a[24:27], v[64:67]
  ds_read_b64_tr_b16 a[162:163], v232 offset:144
  s_lshl_b32 s41, s25, 11
  v_mfma_f32_16x16x32_bf16 v[68:71], a[172:175], a[28:31], v[68:71]
  s_add_u32 m0, s35, 25600
  s_add_u32 s82, s40, s41
  s_waitcnt lgkmcnt(8)
  v_mfma_f32_16x16x32_bf16 v[72:75], a[144:147], a[24:27], v[72:75]
  v_add_u32 v233, 51200, v233
  ds_read_b64_tr_b16 a[164:165], v233 offset:0
  s_lshl_b32 s41, s24, 9
  v_mfma_f32_16x16x32_bf16 v[76:79], a[144:147], a[28:31], v[76:79]
  ds_read_b64_tr_b16 a[166:167], v233 offset:144
  buffer_load_dwordx4 v224, s[4:7], s32 offen offset:0 lds
  v_mfma_f32_16x16x32_bf16 v[80:83], a[148:151], a[24:27], v[80:83]
  v_add_u32 v234, 51200, v234
  ds_read_b64_tr_b16 a[168:169], v234 offset:0
  s_add_u32 s82, s82, s41
  v_mfma_f32_16x16x32_bf16 v[84:87], a[148:151], a[28:31], v[84:87]
  ds_read_b64_tr_b16 a[170:171], v234 offset:144
  buffer_load_dwordx4 v225, s[4:7], s32 offen offset:1024 lds
  s_waitcnt lgkmcnt(8)
  v_mfma_f32_16x16x32_bf16 v[88:91], a[152:155], a[24:27], v[88:91]
  v_add_u32 v235, 51200, v235
  ds_read_b64_tr_b16 a[172:173], v235 offset:0
  s_lshr_b32 s27, s24, 1
  v_mfma_f32_16x16x32_bf16 v[92:95], a[152:155], a[28:31], v[92:95]
  ds_read_b64_tr_b16 a[174:175], v235 offset:144
  buffer_load_dwordx4 v226, s[4:7], s32 offen offset:2048 lds
  v_mfma_f32_16x16x32_bf16 v[108:111], a[156:159], a[232:235], v[108:111]
  v_add_u32 v238, 51200, v238
  ds_read_b128 a[40:43], v238 offset:0
  ds_read_b128 a[44:47], v238 offset:2048
  v_mad_i32_i24 v236, v241, s38, v236
  ds_read_b64_tr_b16 a[144:145], v236 offset:0
  s_mul_i32 s28, s27, 131584
  v_mfma_f32_16x16x32_bf16 v[96:99], a[156:159], a[24:27], v[96:99]
  ds_read_b64_tr_b16 a[146:147], v236 offset:144
  buffer_load_dwordx4 v227, s[4:7], s32 offen offset:3072 lds
  v_mfma_f32_16x16x32_bf16 v[100:103], a[156:159], a[28:31], v[100:103]
  s_add_u32 s80, s82, s28
  s_sub_u32 s81, s82, s28
  s_waitcnt lgkmcnt(12)
  v_mfma_f32_16x16x32_bf16 v[112:115], a[32:35], a[32:35], v[112:115]
  s_add_u32 m0, s36, 25600
  s_add_u32 s32, s32, 128
  s_add_u32 s81, s81, 131584
  v_mfma_f32_16x16x32_bf16 v[116:119], a[36:39], a[36:39], v[116:119]
  s_add_u32 s82, s82, 263168
  s_add_u32 s40, s40, 32768
  s_waitcnt lgkmcnt(8)
  v_mfma_f32_16x16x32_bf16 v[104:107], a[160:163], a[232:235], v[104:107]
  ds_read_b64_tr_b16 a[148:149], v232 offset:4608
  buffer_load_dwordx4 v228, s[12:15], s30 offen offset:0 lds
  v_mfma_f32_16x16x32_bf16 v[64:67], a[160:163], a[32:35], v[64:67]
  ds_read_b64_tr_b16 a[150:151], v232 offset:4752
  buffer_load_dword v28, off, s[8:11], s40
  v_mfma_f32_16x16x32_bf16 v[68:71], a[160:163], a[36:39], v[68:71]
  buffer_load_dwordx4 v229, s[12:15], s30 offen offset:1024 lds
  s_lshl_b32 s27, s24, 6
  v_mfma_f32_16x16x32_bf16 v[72:75], a[164:167], a[32:35], v[72:75]
  ds_read_b64_tr_b16 a[152:153], v233 offset:4608
  s_add_u32 s27, s27, 155136
  v_mfma_f32_16x16x32_bf16 v[76:79], a[164:167], a[36:39], v[76:79]
  ds_read_b64_tr_b16 a[154:155], v233 offset:4752
  s_mov_b64 exec, 0xffff
  buffer_load_dwordx4 v230, s[12:15], s30 offen offset:2048 lds
  s_mov_b64 exec, -1
  s_waitcnt lgkmcnt(8)
  v_mfma_f32_16x16x32_bf16 v[80:83], a[168:171], a[32:35], v[80:83]
  ds_read_b64_tr_b16 a[156:157], v234 offset:4608
  v_lshl_add_u32 v247, v243, 4, s27
  v_mfma_f32_16x16x32_bf16 v[84:87], a[168:171], a[36:39], v[84:87]
  ds_read_b64_tr_b16 a[158:159], v234 offset:4752
  s_add_u32 s30, s30, 221184
  v_mfma_f32_16x16x32_bf16 v[88:91], a[172:175], a[32:35], v[88:91]
  ds_read_b64_tr_b16 a[160:161], v235 offset:4608
  s_lshl_b32 s40, s25, 4
  v_mfma_f32_16x16x32_bf16 v[92:95], a[172:175], a[36:39], v[92:95]
  ds_read_b64_tr_b16 a[162:163], v235 offset:4752
  s_cmp_eq_u32 s32, s34
  s_cselect_b32 s32, s33, s32
  s_cselect_b32 s30, s31, s30
  s_waitcnt lgkmcnt(6)
  v_mfma_f32_16x16x32_bf16 v[108:111], a[144:147], a[232:235], v[108:111]
  ds_read_b64_tr_b16 a[164:165], v236 offset:4608
  s_add_u32 s40, s40, s26
  v_mfma_f32_16x16x32_bf16 v[96:99], a[144:147], a[32:35], v[96:99]
  ds_read_b64_tr_b16 a[166:167], v236 offset:4752
  s_lshl_b32 s40, s40, 7
  v_mfma_f32_16x16x32_bf16 v[100:103], a[144:147], a[36:39], v[100:103]
  s_lshl_b32 s41, s24, 2
  s_add_u32 s40, s40, s41
  s_waitcnt lgkmcnt(12)
k1_kernel_w0:
  s_cbranch_execz k1_kernel_w4
  v_mfma_f32_16x16x32_bf16 v[112:115], a[40:43], a[40:43], v[112:115]
  s_add_u32 s83, s40, 18481152
  s_mov_b32 s86, 20000
  v_mfma_f32_16x16x32_bf16 v[116:119], a[44:47], a[44:47], v[116:119]
  s_mov_b32 s98, 1051597459
  v_mfma_f32_16x16x32_bf16 v[104:107], a[148:151], a[232:235], v[104:107]
  s_waitcnt vmcnt(15)
  s_barrier
  ds_read_b128 a[48:51], v237 offset:25600
  ds_read_b128 a[52:55], v237 offset:27648
  ds_read_b64_tr_b16 a[168:169], v232 offset:25600
  s_lshr_b32 s27, s24, 1
  v_mfma_f32_16x16x32_bf16 v[64:67], a[148:151], a[40:43], v[64:67]
  ds_read_b64_tr_b16 a[170:171], v232 offset:25744
  s_mul_i32 s28, s27, 3
  v_mfma_f32_16x16x32_bf16 v[68:71], a[148:151], a[44:47], v[68:71]
  s_add_u32 m0, s35, 51200
  s_lshl_b32 s40, s25, 1
  s_waitcnt lgkmcnt(8)
  v_mfma_f32_16x16x32_bf16 v[72:75], a[152:155], a[40:43], v[72:75]
  ds_read_b64_tr_b16 a[172:173], v233 offset:25600
  s_add_u32 s28, s28, s40
  v_mfma_f32_16x16x32_bf16 v[76:79], a[152:155], a[44:47], v[76:79]
  ds_read_b64_tr_b16 a[174:175], v233 offset:25744
  buffer_load_dwordx4 v224, s[4:7], s32 offen offset:0 lds
  v_mfma_f32_16x16x32_bf16 v[80:83], a[156:159], a[40:43], v[80:83]
  ds_read_b64_tr_b16 a[144:145], v234 offset:25600
  s_sub_u32 s28, s28, 4
  v_mfma_f32_16x16x32_bf16 v[84:87], a[156:159], a[44:47], v[84:87]
  ds_read_b64_tr_b16 a[146:147], v234 offset:25744
  buffer_load_dwordx4 v225, s[4:7], s32 offen offset:1024 lds
  s_waitcnt lgkmcnt(8)
  v_mfma_f32_16x16x32_bf16 v[88:91], a[160:163], a[40:43], v[88:91]
  ds_read_b64_tr_b16 a[148:149], v235 offset:25600
  s_and_b32 s40, s26, 14
  v_mfma_f32_16x16x32_bf16 v[92:95], a[160:163], a[44:47], v[92:95]
  ds_read_b64_tr_b16 a[150:151], v235 offset:25744
  buffer_load_dwordx4 v226, s[4:7], s32 offen offset:2048 lds
  v_mfma_f32_16x16x32_bf16 v[108:111], a[164:167], a[232:235], v[108:111]
  ds_read_b128 a[56:59], v238 offset:25600
  ds_read_b128 a[60:63], v238 offset:27648
  v_mad_i32_i24 v236, v241, s38, v236
  ds_read_b64_tr_b16 a[152:153], v236 offset:0
  s_and_b32 s41, s24, 1
  v_mfma_f32_16x16x32_bf16 v[96:99], a[164:167], a[40:43], v[96:99]
  ds_read_b64_tr_b16 a[154:155], v236 offset:144
  buffer_load_dwordx4 v227, s[4:7], s32 offen offset:3072 lds
  v_mfma_f32_16x16x32_bf16 v[100:103], a[164:167], a[44:47], v[100:103]
  s_lshl_b32 s84, s40, 7
  s_add_u32 s84, s84, 18481152
  s_waitcnt lgkmcnt(12)
  v_mfma_f32_16x16x32_bf16 v[112:115], a[48:51], a[48:51], v[112:115]
  s_add_u32 m0, s36, 51200
  s_add_u32 s32, s32, 128
  v_lshrrev_b32 v172, 1, v1
  v_mfma_f32_16x16x32_bf16 v[116:119], a[52:55], a[52:55], v[116:119]
  v_min_u32 v172, 5, v172
  s_lshl_b32 s85, s28, 1
  s_waitcnt lgkmcnt(8)
  v_mfma_f32_16x16x32_bf16 v[104:107], a[168:171], a[232:235], v[104:107]
  ds_read_b64_tr_b16 a[156:157], v232 offset:30208
  buffer_load_dwordx4 v228, s[12:15], s30 offen offset:0 lds
  v_mfma_f32_16x16x32_bf16 v[64:67], a[168:171], a[48:51], v[64:67]
  ds_read_b64_tr_b16 a[158:159], v232 offset:30352
  v_add_u32 v172, s85, v172
  v_mfma_f32_16x16x32_bf16 v[68:71], a[168:171], a[52:55], v[68:71]
  buffer_load_dwordx4 v229, s[12:15], s30 offen offset:1024 lds
  v_max_i32 v172, 0, v172
  v_mfma_f32_16x16x32_bf16 v[72:75], a[172:175], a[48:51], v[72:75]
  ds_read_b64_tr_b16 a[160:161], v233 offset:30208
  v_lshrrev_b32 v173, 2, v172
  v_mfma_f32_16x16x32_bf16 v[76:79], a[172:175], a[52:55], v[76:79]
  ds_read_b64_tr_b16 a[162:163], v233 offset:30352
  s_mov_b64 exec, 0xffff
  buffer_load_dwordx4 v230, s[12:15], s30 offen offset:2048 lds
  s_mov_b64 exec, -1
  s_waitcnt lgkmcnt(8)
  v_mfma_f32_16x16x32_bf16 v[80:83], a[144:147], a[48:51], v[80:83]
  ds_read_b64_tr_b16 a[164:165], v234 offset:30208
  v_and_b32 v172, 3, v172
  v_mfma_f32_16x16x32_bf16 v[84:87], a[144:147], a[52:55], v[84:87]
  ds_read_b64_tr_b16 a[166:167], v234 offset:30352
  s_add_u32 s30, s30, 221184
  v_mfma_f32_16x16x32_bf16 v[88:91], a[148:151], a[48:51], v[88:91]
  ds_read_b64_tr_b16 a[168:169], v235 offset:30208
  v_lshlrev_b32 v172, 2, v172
  v_mfma_f32_16x16x32_bf16 v[92:95], a[148:151], a[52:55], v[92:95]
  ds_read_b64_tr_b16 a[170:171], v235 offset:30352
  s_cmp_eq_u32 s32, s34
  s_cselect_b32 s32, s33, s32
  s_cselect_b32 s30, s31, s30
  s_waitcnt lgkmcnt(6)
  v_mfma_f32_16x16x32_bf16 v[108:111], a[152:155], a[232:235], v[108:111]
  ds_read_b64_tr_b16 a[172:173], v236 offset:4608
  v_lshl_add_u32 v5, v173, 11, v172
  v_mfma_f32_16x16x32_bf16 v[96:99], a[152:155], a[48:51], v[96:99]
  ds_read_b64_tr_b16 a[174:175], v236 offset:4752
  s_add_u32 m0, s37, 0
  v_mfma_f32_16x16x32_bf16 v[100:103], a[152:155], a[52:55], v[100:103]
  v_and_b32 v172, 1, v1
  v_lshl_add_u32 v5, v172, 7, v5
  s_waitcnt lgkmcnt(12)
  v_mfma_f32_16x16x32_bf16 v[112:115], a[56:59], a[56:59], v[112:115]
  buffer_load_dwordx4 v231, s[12:15], s100 offen offset:0 lds
  s_mul_i32 s40, s40, 296064
  v_mfma_f32_16x16x32_bf16 v[116:119], a[60:63], a[60:63], v[116:119]
  s_lshl_b32 s85, s28, 10
  s_add_u32 s85, s85, s40
  v_mfma_f32_16x16x32_bf16 v[104:107], a[156:159], a[232:235], v[104:107]
  s_waitcnt vmcnt(16)
  s_barrier
  v_add_u32 v237, -51200, v237
  ds_read_b128 a[64:67], v237 offset:0
  ds_read_b128 a[68:71], v237 offset:2048
  v_add_u32 v232, -51200, v232
  ds_read_b64_tr_b16 a[144:145], v232 offset:0
  s_mov_b64 exec, 0xffff
  buffer_load_dwordx4 v239, s[12:15], s100 offen offset:1024 lds
  s_mov_b64 exec, -1
  s_waitcnt vmcnt(31)
  buffer_store_byte v30, v31, s[76:79], 0 offen sc1
  v_mfma_f32_16x16x32_bf16 v[64:67], a[156:159], a[56:59], v[64:67]
  ds_read_b64_tr_b16 a[146:147], v232 offset:144
  s_add_u32 s85, s85, 4096
  v_mfma_f32_16x16x32_bf16 v[68:71], a[156:159], a[60:63], v[68:71]
  s_add_u32 s100, s100, 221184
  s_mul_i32 s40, s41, 296064
  v_min_u32 v31, 5, v1
  s_waitcnt lgkmcnt(8)
  v_mfma_f32_16x16x32_bf16 v[72:75], a[160:163], a[56:59], v[72:75]
  v_add_u32 v233, -51200, v233
  ds_read_b64_tr_b16 a[148:149], v233 offset:0
  s_add_u32 s97, s85, s40
  v_lshlrev_b32 v31, 2, v31
  v_mfma_f32_16x16x32_bf16 v[76:79], a[160:163], a[60:63], v[76:79]
  ds_read_b64_tr_b16 a[150:151], v233 offset:144
  s_cmp_eq_u32 s100, s95
  s_cselect_b32 s100, s3, s100
  v_mfma_f32_16x16x32_bf16 v[80:83], a[164:167], a[56:59], v[80:83]
  v_add_u32 v234, -51200, v234
  ds_read_b64_tr_b16 a[152:153], v234 offset:0
  s_add_u32 s97, s97, 263168
  v_mfma_f32_16x16x32_bf16 v[84:87], a[164:167], a[60:63], v[84:87]
  ds_read_b64_tr_b16 a[154:155], v234 offset:144
  s_add_u32 m0, s35, 76800
  s_waitcnt lgkmcnt(8)
  v_mfma_f32_16x16x32_bf16 v[88:91], a[168:171], a[56:59], v[88:91]
  v_add_u32 v235, -51200, v235
  ds_read_b64_tr_b16 a[156:157], v235 offset:0
  s_lshl_b32 s40, s29, 1
  v_mfma_f32_16x16x32_bf16 v[92:95], a[168:171], a[60:63], v[92:95]
  ds_read_b64_tr_b16 a[158:159], v235 offset:144
  buffer_load_dwordx4 v224, s[4:7], s32 offen offset:0 lds
  v_mfma_f32_16x16x32_bf16 v[108:111], a[172:175], a[232:235], v[108:111]
  v_add_u32 v238, -51200, v238
  ds_read_b128 a[72:75], v238 offset:0
  ds_read_b128 a[76:79], v238 offset:2048
  v_mad_i32_i24 v236, v241, s39, v236
  ds_read_b64_tr_b16 a[160:161], v236 offset:0
  s_add_u32 s40, s40, s41
  v_mfma_f32_16x16x32_bf16 v[96:99], a[172:175], a[56:59], v[96:99]
  ds_read_b64_tr_b16 a[162:163], v236 offset:144
  buffer_load_dwordx4 v225, s[4:7], s32 offen offset:1024 lds
  v_mfma_f32_16x16x32_bf16 v[100:103], a[172:175], a[60:63], v[100:103]
  s_mul_i32 s40, s40, 65792
  s_add_u32 s85, s85, s40
  s_waitcnt lgkmcnt(12)
  v_mfma_f32_16x16x32_bf16 v[112:115], a[64:67], a[64:67], v[112:115]
  buffer_load_dwordx4 v226, s[4:7], s32 offen offset:2048 lds
  s_mul_i32 s27, s27, 3072
  v_mfma_f32_16x16x32_bf16 v[116:119], a[68:71], a[68:71], v[116:119]
  s_mul_i32 s99, s41, 12416
  s_add_u32 s99, s99, s27
  s_waitcnt lgkmcnt(8)
  v_mfma_f32_16x16x32_bf16 v[104:107], a[144:147], a[232:235], v[104:107]
  ds_read_b64_tr_b16 a[164:165], v232 offset:4608
  buffer_load_dwordx4 v227, s[4:7], s32 offen offset:3072 lds
  v_mfma_f32_16x16x32_bf16 v[64:67], a[144:147], a[64:67], v[64:67]
  ds_read_b64_tr_b16 a[166:167], v232 offset:4752
  s_mul_i32 s94, s41, 31040
  v_mfma_f32_16x16x32_bf16 v[68:71], a[144:147], a[68:71], v[68:71]
  s_add_u32 m0, s36, 76800
  s_add_u32 s32, s32, 128
  s_add_u32 s94, s94, s27
  v_mfma_f32_16x16x32_bf16 v[72:75], a[148:151], a[64:67], v[72:75]
  ds_read_b64_tr_b16 a[168:169], v233 offset:4608
  s_cmp_lt_i32 s28, 0
  s_cselect_b32 s40, s89, 0
  v_mfma_f32_16x16x32_bf16 v[76:79], a[148:151], a[68:71], v[76:79]
  ds_read_b64_tr_b16 a[170:171], v233 offset:4752
  buffer_load_dwordx4 v228, s[12:15], s30 offen offset:0 lds
  s_waitcnt lgkmcnt(8)
  v_mfma_f32_16x16x32_bf16 v[80:83], a[152:155], a[64:67], v[80:83]
  ds_read_b64_tr_b16 a[172:173], v234 offset:4608
  v_or_b32 v140, s40, v245
  v_mfma_f32_16x16x32_bf16 v[84:87], a[152:155], a[68:71], v[84:87]
  ds_read_b64_tr_b16 a[174:175], v234 offset:4752
  buffer_load_dwordx4 v229, s[12:15], s30 offen offset:1024 lds
  v_mfma_f32_16x16x32_bf16 v[88:91], a[156:159], a[64:67], v[88:91]
  ds_read_b64_tr_b16 a[144:145], v235 offset:4608
  s_cmp_lt_i32 s28, -1
  s_cselect_b32 s40, s89, 0
  v_mfma_f32_16x16x32_bf16 v[92:95], a[156:159], a[68:71], v[92:95]
  ds_read_b64_tr_b16 a[146:147], v235 offset:4752
  s_mov_b64 exec, 0xffff
  buffer_load_dwordx4 v230, s[12:15], s30 offen offset:2048 lds
  s_mov_b64 exec, -1
  s_waitcnt lgkmcnt(6)
  v_mfma_f32_16x16x32_bf16 v[108:111], a[160:163], a[232:235], v[108:111]
  ds_read_b64_tr_b16 a[148:149], v236 offset:4608
  v_or_b32 v141, s40, v245
  v_mfma_f32_16x16x32_bf16 v[96:99], a[160:163], a[64:67], v[96:99]
  ds_read_b64_tr_b16 a[150:151], v236 offset:4752
  s_add_u32 s30, s30, 221184
  v_mfma_f32_16x16x32_bf16 v[100:103], a[160:163], a[68:71], v[100:103]
  s_cmp_lt_i32 s28, -2
  s_cselect_b32 s40, s89, 0
  v_or_b32 v142, s40, v245
  s_waitcnt lgkmcnt(12)
  v_mfma_f32_16x16x32_bf16 v[112:115], a[72:75], a[72:75], v[112:115]
  s_cmp_eq_u32 s32, s34
  s_cselect_b32 s32, s33, s32
  s_cselect_b32 s30, s31, s30
  s_movk_i32 s40, -12
  v_mfma_f32_16x16x32_bf16 v[116:119], a[76:79], a[76:79], v[116:119]
  s_movk_i32 s41, 1152
  v_add_u32 v172, 0, v1
  v_mfma_f32_16x16x32_bf16 v[104:107], a[164:167], a[232:235], v[104:107]
  s_waitcnt vmcnt(17)
  s_barrier
  ds_read_b128 a[80:83], v237 offset:25600
  ds_read_b128 a[84:87], v237 offset:27648
  ds_read_b64_tr_b16 a[152:153], v232 offset:25600
  s_add_u32 m0, s37, 5120
  v_mfma_f32_16x16x32_bf16 v[64:67], a[164:167], a[72:75], v[64:67]
  ds_read_b64_tr_b16 a[154:155], v232 offset:25744
  v_mul_u32_u24 v173, 5462, v172
  v_mfma_f32_16x16x32_bf16 v[68:71], a[164:167], a[76:79], v[68:71]
  buffer_load_dwordx4 v231, s[12:15], s100 offen offset:0 lds
  v_lshrrev_b32 v173, 16, v173
  s_waitcnt lgkmcnt(8)
  v_mfma_f32_16x16x32_bf16 v[72:75], a[168:171], a[72:75], v[72:75]
  ds_read_b64_tr_b16 a[156:157], v233 offset:25600
  v_mad_i32_i24 v172, v173, s40, v172
  v_mfma_f32_16x16x32_bf16 v[76:79], a[168:171], a[76:79], v[76:79]
  ds_read_b64_tr_b16 a[158:159], v233 offset:25744
  s_mov_b64 exec, 0xffff
  buffer_load_dwordx4 v239, s[12:15], s100 offen offset:1024 lds
  s_mov_b64 exec, -1
  v_mfma_f32_16x16x32_bf16 v[80:83], a[172:175], a[72:75], v[80:83]
  ds_read_b64_tr_b16 a[160:161], v234 offset:25600
  v_lshrrev_b32 v174, 1, v173
  v_mfma_f32_16x16x32_bf16 v[84:87], a[172:175], a[76:79], v[84:87]
  ds_read_b64_tr_b16 a[162:163], v234 offset:25744
  s_add_u32 s100, s100, 221184
  s_waitcnt lgkmcnt(8)
  v_mfma_f32_16x16x32_bf16 v[88:91], a[144:147], a[72:75], v[88:91]
  ds_read_b64_tr_b16 a[164:165], v235 offset:25600
  v_and_b32 v174, 2, v174
  v_mfma_f32_16x16x32_bf16 v[92:95], a[144:147], a[76:79], v[92:95]
  ds_read_b64_tr_b16 a[166:167], v235 offset:25744
  s_cmp_eq_u32 s100, s95
  s_cselect_b32 s100, s3, s100
  v_mfma_f32_16x16x32_bf16 v[108:111], a[148:151], a[232:235], v[108:111]
  ds_read_b128 a[88:91], v238 offset:25600
  ds_read_b128 a[92:95], v238 offset:27648
  v_mad_i32_i24 v236, v241, s38, v236
  ds_read_b64_tr_b16 a[168:169], v236 offset:0
  v_xor_b32 v172, v172, v174
  v_mfma_f32_16x16x32_bf16 v[96:99], a[148:151], a[72:75], v[96:99]
  ds_read_b64_tr_b16 a[170:171], v236 offset:144
  s_add_u32 m0, s37, 10240
  v_mfma_f32_16x16x32_bf16 v[100:103], a[148:151], a[76:79], v[100:103]
  v_lshlrev_b32 v172, 4, v172
  v_lshrrev_b32 v174, 3, v173
  s_waitcnt lgkmcnt(12)
  v_mfma_f32_16x16x32_bf16 v[112:115], a[80:83], a[80:83], v[112:115]
  buffer_load_dwordx4 v231, s[12:15], s100 offen offset:0 lds
  v_mad_u32_u24 v174, v174, 28, v173
  v_mfma_f32_16x16x32_bf16 v[116:119], a[84:87], a[84:87], v[116:119]
  v_mad_u32_u24 v175, v174, s41, v172
  v_lshrrev_b32 v174, 1, v173
  s_waitcnt lgkmcnt(8)
  v_mfma_f32_16x16x32_bf16 v[104:107], a[152:155], a[232:235], v[104:107]
  ds_read_b64_tr_b16 a[172:173], v232 offset:30208
  s_mov_b64 exec, 0xffff
  buffer_load_dwordx4 v239, s[12:15], s100 offen offset:1024 lds
  s_mov_b64 exec, -1
  v_mfma_f32_16x16x32_bf16 v[64:67], a[152:155], a[80:83], v[64:67]
  ds_read_b64_tr_b16 a[174:175], v232 offset:30352
  v_accvgpr_write_b32 a224, v175
  v_mfma_f32_16x16x32_bf16 v[68:71], a[152:155], a[84:87], v[68:71]
  s_add_u32 s100, s100, 221184
  v_mad_u32_u24 v173, v174, 34, v173
  v_mfma_f32_16x16x32_bf16 v[72:75], a[156:159], a[80:83], v[72:75]
  ds_read_b64_tr_b16 a[144:145], v233 offset:30208
  v_mad_u32_u24 v175, v173, s41, v172
  v_mfma_f32_16x16x32_bf16 v[76:79], a[156:159], a[84:87], v[76:79]
  ds_read_b64_tr_b16 a[146:147], v233 offset:30352
  s_cmp_eq_u32 s100, s95
  s_cselect_b32 s100, s3, s100
  s_waitcnt lgkmcnt(8)
  v_mfma_f32_16x16x32_bf16 v[80:83], a[160:163], a[80:83], v[80:83]
  ds_read_b64_tr_b16 a[148:149], v234 offset:30208
  v_accvgpr_write_b32 a227, v175
  v_mfma_f32_16x16x32_bf16 v[84:87], a[160:163], a[84:87], v[84:87]
  ds_read_b64_tr_b16 a[150:151], v234 offset:30352
  s_add_u32 m0, s35, 0
  v_mfma_f32_16x16x32_bf16 v[88:91], a[164:167], a[80:83], v[88:91]
  ds_read_b64_tr_b16 a[152:153], v235 offset:30208
  v_add_u32 v172, 64, v1
  v_mfma_f32_16x16x32_bf16 v[92:95], a[164:167], a[84:87], v[92:95]
  ds_read_b64_tr_b16 a[154:155], v235 offset:30352
  buffer_load_dwordx4 v224, s[4:7], s32 offen offset:0 lds
  s_waitcnt lgkmcnt(6)
  v_mfma_f32_16x16x32_bf16 v[108:111], a[168:171], a[232:235], v[108:111]
  ds_read_b64_tr_b16 a[156:157], v236 offset:4608
  v_mul_u32_u24 v173, 5462, v172
  v_mfma_f32_16x16x32_bf16 v[96:99], a[168:171], a[80:83], v[96:99]
  ds_read_b64_tr_b16 a[158:159], v236 offset:4752
  buffer_load_dwordx4 v225, s[4:7], s32 offen offset:1024 lds
  v_mfma_f32_16x16x32_bf16 v[100:103], a[168:171], a[84:87], v[100:103]
  v_lshrrev_b32 v173, 16, v173
  v_mad_i32_i24 v172, v173, s40, v172
  s_waitcnt lgkmcnt(12)
  v_mfma_f32_16x16x32_bf16 v[112:115], a[88:91], a[88:91], v[112:115]
  buffer_load_dwordx4 v226, s[4:7], s32 offen offset:2048 lds
  v_lshrrev_b32 v174, 1, v173
  v_mfma_f32_16x16x32_bf16 v[116:119], a[92:95], a[92:95], v[116:119]
  v_and_b32 v174, 2, v174
  v_xor_b32 v172, v172, v174
  v_mfma_f32_16x16x32_bf16 v[104:107], a[172:175], a[232:235], v[104:107]
  s_waitcnt vmcnt(17)
  s_barrier
  v_add_u32 v237, 51200, v237
  ds_read_b128 a[96:99], v237 offset:0
  ds_read_b128 a[100:103], v237 offset:2048
  v_add_u32 v232, 51200, v232
  ds_read_b64_tr_b16 a[160:161], v232 offset:0
  buffer_load_dwordx4 v227, s[4:7], s32 offen offset:3072 lds
  v_mfma_f32_16x16x32_bf16 v[64:67], a[172:175], a[88:91], v[64:67]
  ds_read_b64_tr_b16 a[162:163], v232 offset:144
  v_lshlrev_b32 v172, 4, v172
  v_mfma_f32_16x16x32_bf16 v[68:71], a[172:175], a[92:95], v[68:71]
  s_add_u32 m0, s36, 0
  s_add_u32 s32, s32, 128
  v_lshrrev_b32 v174, 3, v173
  s_waitcnt lgkmcnt(8)
  v_mfma_f32_16x16x32_bf16 v[72:75], a[144:147], a[88:91], v[72:75]
  v_add_u32 v233, 51200, v233
  ds_read_b64_tr_b16 a[164:165], v233 offset:0
  v_mad_u32_u24 v174, v174, 28, v173
  v_mfma_f32_16x16x32_bf16 v[76:79], a[144:147], a[92:95], v[76:79]
  ds_read_b64_tr_b16 a[166:167], v233 offset:144
  buffer_load_dwordx4 v228, s[12:15], s30 offen offset:0 lds
  v_mfma_f32_16x16x32_bf16 v[80:83], a[148:151], a[88:91], v[80:83]
  v_add_u32 v234, 51200, v234
  ds_read_b64_tr_b16 a[168:169], v234 offset:0
  v_mad_u32_u24 v175, v174, s41, v172
  v_mfma_f32_16x16x32_bf16 v[84:87], a[148:151], a[92:95], v[84:87]
  ds_read_b64_tr_b16 a[170:171], v234 offset:144
  buffer_load_dwordx4 v229, s[12:15], s30 offen offset:1024 lds
  s_waitcnt lgkmcnt(8)
  v_mfma_f32_16x16x32_bf16 v[88:91], a[152:155], a[88:91], v[88:91]
  v_add_u32 v235, 51200, v235
  ds_read_b64_tr_b16 a[172:173], v235 offset:0
  v_lshrrev_b32 v174, 1, v173
  v_mfma_f32_16x16x32_bf16 v[92:95], a[152:155], a[92:95], v[92:95]
  ds_read_b64_tr_b16 a[174:175], v235 offset:144
  s_mov_b64 exec, 0xffff
  buffer_load_dwordx4 v230, s[12:15], s30 offen offset:2048 lds
  s_mov_b64 exec, -1
  v_mfma_f32_16x16x32_bf16 v[108:111], a[156:159], a[232:235], v[108:111]
  v_add_u32 v238, 51200, v238
  ds_read_b128 a[104:107], v238 offset:0
  ds_read_b128 a[108:111], v238 offset:2048
  v_mad_i32_i24 v236, v241, s38, v236
  ds_read_b64_tr_b16 a[144:145], v236 offset:0
  v_accvgpr_write_b32 a225, v175
  v_mfma_f32_16x16x32_bf16 v[96:99], a[156:159], a[88:91], v[96:99]
  ds_read_b64_tr_b16 a[146:147], v236 offset:144
  s_add_u32 s30, s30, 221184
  v_mfma_f32_16x16x32_bf16 v[100:103], a[156:159], a[92:95], v[100:103]
  v_mad_u32_u24 v173, v174, 34, v173
  v_mad_u32_u24 v175, v173, s41, v172
  s_waitcnt lgkmcnt(12)
  v_mfma_f32_16x16x32_bf16 v[112:115], a[96:99], a[96:99], v[112:115]
  s_cmp_eq_u32 s32, s34
  s_cselect_b32 s32, s33, s32
  s_cselect_b32 s30, s31, s30
  v_accvgpr_write_b32 a228, v175
  v_mfma_f32_16x16x32_bf16 v[116:119], a[100:103], a[100:103], v[116:119]
  v_add_u32 v172, 128, v1
  v_mul_u32_u24 v173, 5462, v172
  s_waitcnt lgkmcnt(8)
  v_mfma_f32_16x16x32_bf16 v[104:107], a[160:163], a[232:235], v[104:107]
  ds_read_b64_tr_b16 a[148:149], v232 offset:4608
  s_add_u32 m0, s37, 15360
  v_mfma_f32_16x16x32_bf16 v[64:67], a[160:163], a[96:99], v[64:67]
  ds_read_b64_tr_b16 a[150:151], v232 offset:4752
  v_lshrrev_b32 v173, 16, v173
  v_mfma_f32_16x16x32_bf16 v[68:71], a[160:163], a[100:103], v[68:71]
  buffer_load_dwordx4 v231, s[12:15], s100 offen offset:0 lds
  v_mad_i32_i24 v172, v173, s40, v172
  v_mfma_f32_16x16x32_bf16 v[72:75], a[164:167], a[96:99], v[72:75]
  ds_read_b64_tr_b16 a[152:153], v233 offset:4608
  v_lshrrev_b32 v174, 1, v173
  v_mfma_f32_16x16x32_bf16 v[76:79], a[164:167], a[100:103], v[76:79]
  ds_read_b64_tr_b16 a[154:155], v233 offset:4752
  s_mov_b64 exec, 0xffff
  buffer_load_dwordx4 v239, s[12:15], s100 offen offset:1024 lds
  s_mov_b64 exec, -1
  s_waitcnt lgkmcnt(8)
  v_mfma_f32_16x16x32_bf16 v[80:83], a[168:171], a[96:99], v[80:83]
  ds_read_b64_tr_b16 a[156:157], v234 offset:4608
  v_and_b32 v174, 2, v174
  v_mfma_f32_16x16x32_bf16 v[84:87], a[168:171], a[100:103], v[84:87]
  ds_read_b64_tr_b16 a[158:159], v234 offset:4752
  s_add_u32 s100, s100, 221184
  v_mfma_f32_16x16x32_bf16 v[88:91], a[172:175], a[96:99], v[88:91]
  ds_read_b64_tr_b16 a[160:161], v235 offset:4608
  v_xor_b32 v172, v172, v174
  v_mfma_f32_16x16x32_bf16 v[92:95], a[172:175], a[100:103], v[92:95]
  ds_read_b64_tr_b16 a[162:163], v235 offset:4752
  s_cmp_eq_u32 s100, s95
  s_cselect_b32 s100, s3, s100
  s_waitcnt lgkmcnt(6)
  v_mfma_f32_16x16x32_bf16 v[108:111], a[144:147], a[232:235], v[108:111]
  ds_read_b64_tr_b16 a[164:165], v236 offset:4608
  v_lshlrev_b32 v172, 4, v172
  v_mfma_f32_16x16x32_bf16 v[96:99], a[144:147], a[96:99], v[96:99]
  ds_read_b64_tr_b16 a[166:167], v236 offset:4752
  s_add_u32 m0, s37, 20480
  v_mfma_f32_16x16x32_bf16 v[100:103], a[144:147], a[100:103], v[100:103]
  v_lshrrev_b32 v174, 3, v173
  v_mad_u32_u24 v174, v174, 28, v173
  s_waitcnt lgkmcnt(12)
  v_mfma_f32_16x16x32_bf16 v[112:115], a[104:107], a[104:107], v[112:115]
  buffer_load_dwordx4 v231, s[12:15], s100 offen offset:0 lds
  v_mad_u32_u24 v175, v174, s41, v172
  v_mfma_f32_16x16x32_bf16 v[116:119], a[108:111], a[108:111], v[116:119]
  v_lshrrev_b32 v174, 1, v173
  v_accvgpr_write_b32 a226, v175
  v_mfma_f32_16x16x32_bf16 v[104:107], a[148:151], a[232:235], v[104:107]
  s_waitcnt vmcnt(14)
  s_barrier
  ds_read_b128 a[112:115], v237 offset:25600
  ds_read_b128 a[116:119], v237 offset:27648
  ds_read_b64_tr_b16 a[168:169], v232 offset:25600
  s_mov_b64 exec, 0xffff
  buffer_load_dwordx4 v239, s[12:15], s100 offen offset:1024 lds
  s_mov_b64 exec, -1
  v_mfma_f32_16x16x32_bf16 v[64:67], a[148:151], a[104:107], v[64:67]
  ds_read_b64_tr_b16 a[170:171], v232 offset:25744
  v_mad_u32_u24 v173, v174, 34, v173
  v_mfma_f32_16x16x32_bf16 v[68:71], a[148:151], a[108:111], v[68:71]
  s_add_u32 s100, s100, 221184
  v_mad_u32_u24 v175, v173, s41, v172
  s_waitcnt lgkmcnt(8)
  v_mfma_f32_16x16x32_bf16 v[72:75], a[152:155], a[104:107], v[72:75]
  ds_read_b64_tr_b16 a[172:173], v233 offset:25600
  v_accvgpr_write_b32 a229, v175
  v_mfma_f32_16x16x32_bf16 v[76:79], a[152:155], a[108:111], v[76:79]
  ds_read_b64_tr_b16 a[174:175], v233 offset:25744
  s_cmp_eq_u32 s100, s95
  s_cselect_b32 s100, s3, s100
  v_mfma_f32_16x16x32_bf16 v[80:83], a[156:159], a[104:107], v[80:83]
  ds_read_b64_tr_b16 a[144:145], v234 offset:25600
  s_mov_b32 s42, 0x00100001
  v_mfma_f32_16x16x32_bf16 v[84:87], a[156:159], a[108:111], v[84:87]
  ds_read_b64_tr_b16 a[146:147], v234 offset:25744
  s_add_u32 m0, s37, 25600
  s_waitcnt lgkmcnt(8)
  v_mfma_f32_16x16x32_bf16 v[88:91], a[160:163], a[104:107], v[88:91]
  ds_read_b64_tr_b16 a[148:149], v235 offset:25600
  s_mov_b32 s43, 0x10000100
  v_mfma_f32_16x16x32_bf16 v[92:95], a[160:163], a[108:111], v[92:95]
  ds_read_b64_tr_b16 a[150:151], v235 offset:25744
  buffer_load_dwordx4 v231, s[12:15], s100 offen offset:0 lds
  v_mfma_f32_16x16x32_bf16 v[108:111], a[164:167], a[232:235], v[108:111]
  ds_read_b128 a[120:123], v238 offset:25600
  ds_read_b128 a[124:127], v238 offset:27648
  v_mad_i32_i24 v236, v241, s38, v236
  ds_read_b64_tr_b16 a[152:153], v236 offset:0
  s_lshl_b64 s[44:45], s[42:43], 1
  v_mfma_f32_16x16x32_bf16 v[96:99], a[164:167], a[104:107], v[96:99]
  ds_read_b64_tr_b16 a[154:155], v236 offset:144
  s_mov_b64 exec, 0xffff
  buffer_load_dwordx4 v239, s[12:15], s100 offen offset:1024 lds
  s_mov_b64 exec, -1
  v_mfma_f32_16x16x32_bf16 v[100:103], a[164:167], a[108:111], v[100:103]
  s_lshl_b64 s[46:47], s[42:43], 2
  s_lshl_b64 s[48:49], s[42:43], 3
  s_waitcnt lgkmcnt(12)
  v_mfma_f32_16x16x32_bf16 v[112:115], a[112:115], a[112:115], v[112:115]
  s_add_u32 s100, s100, 221184
  s_and_b32 s35, s26, 7
  v_mfma_f32_16x16x32_bf16 v[116:119], a[116:119], a[116:119], v[116:119]
  s_mul_i32 s36, s35, 192
  s_mul_i32 s30, s24, 11520
  s_waitcnt lgkmcnt(8)
  v_mfma_f32_16x16x32_bf16 v[104:107], a[168:171], a[232:235], v[104:107]
  ds_read_b64_tr_b16 a[156:157], v232 offset:30208
  s_cmp_eq_u32 s100, s95
  s_cselect_b32 s100, s3, s100
  v_mfma_f32_16x16x32_bf16 v[64:67], a[168:171], a[112:115], v[64:67]
  ds_read_b64_tr_b16 a[158:159], v232 offset:30352
  s_and_b32 s31, s24, 1
  v_mfma_f32_16x16x32_bf16 v[68:71], a[168:171], a[116:119], v[68:71]
  s_add_u32 m0, s37, 30720
  s_mul_i32 s31, s31, 2304
  v_mfma_f32_16x16x32_bf16 v[72:75], a[172:175], a[112:115], v[72:75]
  ds_read_b64_tr_b16 a[160:161], v233 offset:30208
  s_sub_u32 s30, s30, s31
  v_mfma_f32_16x16x32_bf16 v[76:79], a[172:175], a[116:119], v[76:79]
  ds_read_b64_tr_b16 a[162:163], v233 offset:30352
  buffer_load_dwordx4 v231, s[12:15], s100 offen offset:0 lds
  s_waitcnt lgkmcnt(8)
  v_mfma_f32_16x16x32_bf16 v[80:83], a[144:147], a[112:115], v[80:83]
  ds_read_b64_tr_b16 a[164:165], v234 offset:30208
  s_add_u32 s30, s30, s36
  v_mfma_f32_16x16x32_bf16 v[84:87], a[144:147], a[116:119], v[84:87]
  ds_read_b64_tr_b16 a[166:167], v234 offset:30352
  s_mov_b64 exec, 0xffff
  buffer_load_dwordx4 v239, s[12:15], s100 offen offset:1024 lds
  s_mov_b64 exec, -1
  v_mfma_f32_16x16x32_bf16 v[88:91], a[148:151], a[112:115], v[88:91]
  ds_read_b64_tr_b16 a[168:169], v235 offset:30208
  s_mul_i32 s31, s31, 144
  s_and_b32 s34, s24, 2
  s_mul_i32 s34, s34, 1152
  s_add_u32 s31, s31, s34
  v_mfma_f32_16x16x32_bf16 v[92:95], a[148:151], a[116:119], v[92:95]
  ds_read_b64_tr_b16 a[170:171], v235 offset:30352
  s_add_u32 s100, s100, 221184
  s_waitcnt lgkmcnt(6)
  v_mfma_f32_16x16x32_bf16 v[108:111], a[152:155], a[232:235], v[108:111]
  ds_read_b64_tr_b16 a[172:173], v236 offset:4608
  s_add_u32 s31, s31, 18432
  v_mfma_f32_16x16x32_bf16 v[96:99], a[152:155], a[112:115], v[96:99]
  ds_read_b64_tr_b16 a[174:175], v236 offset:4752
  s_cmp_eq_u32 s100, s95
  s_cselect_b32 s100, s3, s100
  v_mfma_f32_16x16x32_bf16 v[100:103], a[152:155], a[116:119], v[100:103]
  s_add_u32 s31, s31, s36
  s_lshl_b32 s91, s25, 1
  s_add_u32 s91, s91, s35
  s_and_b32 s91, s91, 7
  s_waitcnt lgkmcnt(12)
  v_mfma_f32_16x16x32_bf16 v[112:115], a[120:123], a[120:123], v[112:115]
  s_add_u32 m0, s37, 35840
  s_mul_i32 s36, s91, 82944
  s_add_u32 s30, s30, s36
  v_mfma_f32_16x16x32_bf16 v[116:119], a[124:127], a[124:127], v[116:119]
  s_mul_i32 s36, s24, 3072
  s_cmp_lt_u32 s35, 6
  s_cselect_b32 s18, s18, 0
  v_mfma_f32_16x16x32_bf16 v[104:107], a[156:159], a[232:235], v[104:107]
  s_waitcnt vmcnt(8)
  s_barrier
  v_add_u32 v237, -51200, v237
  ds_read_b128 a[128:131], v237 offset:0
  ds_read_b128 a[132:135], v237 offset:2048
  v_mad_i32_i24 v236, v241, s39, v236
  ds_read_b64_tr_b16 a[144:145], v236 offset:0
  buffer_load_dwordx4 v231, s[12:15], s100 offen offset:0 lds
  v_mfma_f32_16x16x32_bf16 v[64:67], a[156:159], a[120:123], v[64:67]
  ds_read_b64_tr_b16 a[146:147], v236 offset:144
  v_mfma_f32_16x16x32_bf16 v[68:71], a[156:159], a[124:127], v[68:71]
  s_mov_b64 exec, 0xffff
  buffer_load_dwordx4 v239, s[12:15], s100 offen offset:1024 lds
  s_mov_b64 exec, -1
  s_waitcnt lgkmcnt(8)
  v_mfma_f32_16x16x32_bf16 v[72:75], a[160:163], a[120:123], v[72:75]
  v_add_u32 v238, -51200, v238
  ds_read_b128 a[136:139], v238 offset:0
  ds_read_b128 a[140:143], v238 offset:2048
  ds_read_b64_tr_b16 a[148:149], v236 offset:4608
  v_mfma_f32_16x16x32_bf16 v[76:79], a[160:163], a[124:127], v[76:79]
  ds_read_b64_tr_b16 a[150:151], v236 offset:4752
  s_add_u32 s100, s100, 221184
  v_mfma_f32_16x16x32_bf16 v[80:83], a[164:167], a[120:123], v[80:83]
  v_add_u32 v232, -51200, v232
  ds_read_b64_tr_b16 a[152:153], v232 offset:0
  v_mfma_f32_16x16x32_bf16 v[84:87], a[164:167], a[124:127], v[84:87]
  ds_read_b64_tr_b16 a[154:155], v232 offset:144
  s_cmp_eq_u32 s100, s95
  s_cselect_b32 s100, s3, s100
  s_waitcnt lgkmcnt(10)
  v_mfma_f32_16x16x32_bf16 v[88:91], a[168:171], a[120:123], v[88:91]
  ds_read_b64_tr_b16 a[156:157], v232 offset:4608
  v_mfma_f32_16x16x32_bf16 v[92:95], a[168:171], a[124:127], v[92:95]
  ds_read_b64_tr_b16 a[158:159], v232 offset:4752
  s_add_u32 m0, s37, 40960
  v_mfma_f32_16x16x32_bf16 v[108:111], a[172:175], a[232:235], v[108:111]
k1_kernel_w1:
  s_cbranch_execz k1_kernel_w5
  v_add_u32 v233, -51200, v233
  ds_read_b64_tr_b16 a[160:161], v233 offset:0
  v_mfma_f32_16x16x32_bf16 v[96:99], a[172:175], a[120:123], v[96:99]
  ds_read_b64_tr_b16 a[162:163], v233 offset:144
  buffer_load_dwordx4 v231, s[12:15], s100 offen offset:0 lds
  buffer_load_dword v30, v31, s[76:79], 0 offen sc1
  v_mfma_f32_16x16x32_bf16 v[100:103], a[172:175], a[124:127], v[100:103]
  s_waitcnt lgkmcnt(12)
  v_mfma_f32_16x16x32_bf16 v[112:115], a[128:131], a[128:131], v[112:115]
  s_mov_b64 exec, 0xffff
  buffer_load_dwordx4 v239, s[12:15], s100 offen offset:1024 lds
  s_mov_b64 exec, -1
  v_mfma_f32_16x16x32_bf16 v[116:119], a[132:135], a[132:135], v[116:119]
  s_waitcnt lgkmcnt(8)
  v_mfma_f32_16x16x32_bf16 v[112:115], a[136:139], a[136:139], v[112:115]
  s_add_u32 s100, s100, 221184
  v_mfma_f32_16x16x32_bf16 v[116:119], a[140:143], a[140:143], v[116:119]
  s_waitcnt lgkmcnt(6)
  v_mfma_f32_16x16x32_bf16 v[108:111], a[144:147], a[232:235], v[108:111]
  ds_read_b64_tr_b16 a[164:165], v233 offset:4608
  s_cmp_eq_u32 s100, s95
  s_cselect_b32 s100, s3, s100
  v_mfma_f32_16x16x32_bf16 v[96:99], a[144:147], a[128:131], v[96:99]
  ds_read_b64_tr_b16 a[166:167], v233 offset:4752
  v_cndmask_b32 v164, 0, v112, s[42:43]
  v_cndmask_b32 v165, 0, v116, s[42:43]
  v_mfma_f32_16x16x32_bf16 v[100:103], a[144:147], a[132:135], v[100:103]
  v_cndmask_b32 v164, v164, v113, s[44:45]
  v_cndmask_b32 v165, v165, v117, s[44:45]
  v_cndmask_b32 v164, v164, v114, s[46:47]
  v_mfma_f32_16x16x32_bf16 v[108:111], a[148:151], a[232:235], v[108:111]
  v_add_u32 v234, -51200, v234
  ds_read_b64_tr_b16 a[168:169], v234 offset:0
  v_cndmask_b32 v165, v165, v118, s[46:47]
  v_cndmask_b32 v164, v164, v115, s[48:49]
  v_mfma_f32_16x16x32_bf16 v[96:99], a[148:151], a[136:139], v[96:99]
  ds_read_b64_tr_b16 a[170:171], v234 offset:144
  v_cndmask_b32 v165, v165, v119, s[48:49]
  v_mov_b32 v166, v164
  v_mfma_f32_16x16x32_bf16 v[100:103], a[148:151], a[140:143], v[100:103]
  v_mov_b32 v167, v165
  s_waitcnt lgkmcnt(6)
  v_mfma_f32_16x16x32_bf16 v[104:107], a[152:155], a[232:235], v[104:107]
  ds_read_b64_tr_b16 a[172:173], v234 offset:4608
  v_mfma_f32_16x16x32_bf16 v[64:67], a[152:155], a[128:131], v[64:67]
  ds_read_b64_tr_b16 a[174:175], v234 offset:4752
  v_mov_b32 v168, v96
  v_mov_b32 v169, v100
  v_mfma_f32_16x16x32_bf16 v[68:71], a[152:155], a[132:135], v[68:71]
  v_mov_b32 v170, v96
  v_mov_b32 v171, v100
  v_permlane32_swap_b32 v164, v166
  v_mfma_f32_16x16x32_bf16 v[104:107], a[156:159], a[232:235], v[104:107]
  v_add_u32 v235, -51200, v235
  ds_read_b64_tr_b16 a[144:145], v235 offset:0
  v_permlane32_swap_b32 v165, v167
  v_permlane32_swap_b32 v168, v170
  v_mfma_f32_16x16x32_bf16 v[64:67], a[156:159], a[136:139], v[64:67]
  ds_read_b64_tr_b16 a[146:147], v235 offset:144
  v_permlane32_swap_b32 v169, v171
  v_add_f32 v164, v164, v166
  v_mfma_f32_16x16x32_bf16 v[68:71], a[156:159], a[140:143], v[68:71]
  v_add_f32 v165, v165, v167
  v_mul_f32 v170, 0x3ae38e39, v170
  v_mul_f32 v171, 0x3ae38e39, v171
  s_waitcnt lgkmcnt(6)
  v_mfma_f32_16x16x32_bf16 v[72:75], a[160:163], a[128:131], v[72:75]
  ds_read_b64_tr_b16 a[148:149], v235 offset:4608
  s_mov_b32 exec_lo, 0x00010001
  s_mov_b32 exec_hi, 0x00010001
  ds_write_b128 v247, v[104:107]
  s_mov_b64 exec, -1
  v_mov_b32 v166, v164
  v_mfma_f32_16x16x32_bf16 v[76:79], a[160:163], a[132:135], v[76:79]
  ds_read_b64_tr_b16 a[150:151], v235 offset:4752
  v_mov_b32 v167, v165
  v_mov_b32 v156, 0x3727c5ac
  v_mfma_f32_16x16x32_bf16 v[72:75], a[164:167], a[136:139], v[72:75]
  v_mov_b32 v158, 0x3727c5ac
  v_permlane16_swap_b32 v164, v166
  v_permlane16_swap_b32 v165, v167
  v_mfma_f32_16x16x32_bf16 v[76:79], a[164:167], a[140:143], v[76:79]
  v_fma_f32 v156, -v170, v170, v156
  v_fma_f32 v158, -v171, v171, v158
  v_add_f32 v164, v164, v166
  s_waitcnt lgkmcnt(5)
  v_mfma_f32_16x16x32_bf16 v[80:83], a[168:171], a[128:131], v[80:83]
  v_add_f32 v165, v165, v167
  v_fmac_f32 v156, 0x3ae38e39, v164
  v_fmac_f32 v158, 0x3ae38e39, v165
  v_mfma_f32_16x16x32_bf16 v[84:87], a[168:171], a[132:135], v[84:87]
  v_rsq_f32 v156, v156
  v_rsq_f32 v158, v158
  s_nop 0
  v_mfma_f32_16x16x32_bf16 v[80:83], a[172:175], a[136:139], v[80:83]
  s_waitcnt lgkmcnt(0)
  s_barrier
  v_xor_b32 v19, 64, v247
  ds_read_b128 v[144:147], v19
  v_xor_b32 v20, 128, v247
  ds_read_b128 v[148:151], v20
  v_xor_b32 v21, 192, v247
  ds_read_b128 v[152:155], v21
  v_mul_f32 v160, -v170, v156
  v_mul_f32 v162, -v171, v158
  v_mfma_f32_16x16x32_bf16 v[84:87], a[172:175], a[140:143], v[84:87]
  s_waitcnt lgkmcnt(3)
  v_mfma_f32_16x16x32_bf16 v[88:91], a[144:147], a[128:131], v[88:91]
  v_mfma_f32_16x16x32_bf16 v[92:95], a[144:147], a[132:135], v[92:95]
  v_mfma_f32_16x16x32_bf16 v[88:91], a[148:151], a[136:139], v[88:91]
  v_mfma_f32_16x16x32_bf16 v[92:95], a[148:151], a[140:143], v[92:95]
  s_load_dwordx2 s[48:49], s[0:1], 48
  s_lshr_b32 s3, s2, 3
  s_lshl_b32 s42, s24, 5
  s_add_u32 s3, s3, s42
  s_lshl_b32 s42, s3, 13
  v_lshl_add_u32 v26, v1, 7, s42
  v_pk_mul_f32 v[96:97], v[96:97], v[156:157] op_sel_hi:[1,0]
  v_pk_mul_f32 v[98:99], v[98:99], v[156:157] op_sel_hi:[1,0]
  v_pk_fma_f32 v[96:97], v[108:109], v[160:161], v[96:97] op_sel_hi:[1,0,1]
  v_pk_fma_f32 v[98:99], v[110:111], v[160:161], v[98:99] op_sel_hi:[1,0,1]
  v_cvt_pk_bf16_f32 v96, v96, v97
  v_cvt_pk_bf16_f32 v97, v98, v99
  v_pk_mul_f32 v[100:101], v[100:101], v[158:159] op_sel_hi:[1,0]
  v_pk_mul_f32 v[102:103], v[102:103], v[158:159] op_sel_hi:[1,0]
  v_pk_fma_f32 v[100:101], v[108:109], v[162:163], v[100:101] op_sel_hi:[1,0,1]
  v_pk_fma_f32 v[102:103], v[110:111], v[162:163], v[102:103] op_sel_hi:[1,0,1]
  v_cvt_pk_bf16_f32 v98, v100, v101
  v_cvt_pk_bf16_f32 v99, v102, v103
  s_waitcnt lgkmcnt(2)
  v_pk_mul_f32 v[64:65], v[64:65], v[156:157] op_sel_hi:[1,0]
  v_pk_mul_f32 v[66:67], v[66:67], v[156:157] op_sel_hi:[1,0]
  v_pk_fma_f32 v[64:65], v[104:105], v[160:161], v[64:65] op_sel_hi:[1,0,1]
  v_pk_fma_f32 v[66:67], v[106:107], v[160:161], v[66:67] op_sel_hi:[1,0,1]
  v_cvt_pk_bf16_f32 v64, v64, v65
  v_cvt_pk_bf16_f32 v65, v66, v67
  v_pk_mul_f32 v[72:73], v[72:73], v[156:157] op_sel_hi:[1,0]
  v_pk_mul_f32 v[74:75], v[74:75], v[156:157] op_sel_hi:[1,0]
  v_pk_fma_f32 v[72:73], v[144:145], v[160:161], v[72:73] op_sel_hi:[1,0,1]
  v_pk_fma_f32 v[74:75], v[146:147], v[160:161], v[74:75] op_sel_hi:[1,0,1]
  v_cvt_pk_bf16_f32 v66, v72, v73
  v_cvt_pk_bf16_f32 v67, v74, v75
  v_permlane16_swap_b32 v96, v98
  v_permlane16_swap_b32 v97, v99
  s_mov_b32 exec_hi, 0
  buffer_store_dwordx4 v[96:99], v245, s[8:11], s82 offen sc1
  s_mov_b32 exec_hi, -1
  v_pk_mul_f32 v[68:69], v[68:69], v[158:159] op_sel_hi:[1,0]
  v_pk_mul_f32 v[70:71], v[70:71], v[158:159] op_sel_hi:[1,0]
  v_pk_fma_f32 v[68:69], v[104:105], v[162:163], v[68:69] op_sel_hi:[1,0,1]
  v_pk_fma_f32 v[70:71], v[106:107], v[162:163], v[70:71] op_sel_hi:[1,0,1]
  v_cvt_pk_bf16_f32 v68, v68, v69
  v_cvt_pk_bf16_f32 v69, v70, v71
  v_pk_mul_f32 v[76:77], v[76:77], v[158:159] op_sel_hi:[1,0]
  v_pk_mul_f32 v[78:79], v[78:79], v[158:159] op_sel_hi:[1,0]
  v_pk_fma_f32 v[76:77], v[144:145], v[162:163], v[76:77] op_sel_hi:[1,0,1]
  v_pk_fma_f32 v[78:79], v[146:147], v[162:163], v[78:79] op_sel_hi:[1,0,1]
  v_cvt_pk_bf16_f32 v70, v76, v77
  v_cvt_pk_bf16_f32 v71, v78, v79
  v_permlane16_swap_b32 v64, v66
  v_permlane16_swap_b32 v65, v67
  buffer_store_dwordx4 v[64:67], v242, s[8:11], s80 offen offset:0 sc1
  s_waitcnt lgkmcnt(0)
  v_pk_mul_f32 v[80:81], v[80:81], v[156:157] op_sel_hi:[1,0]
  v_pk_mul_f32 v[82:83], v[82:83], v[156:157] op_sel_hi:[1,0]
  v_pk_fma_f32 v[80:81], v[148:149], v[160:161], v[80:81] op_sel_hi:[1,0,1]
  v_pk_fma_f32 v[82:83], v[150:151], v[160:161], v[82:83] op_sel_hi:[1,0,1]
  v_cvt_pk_bf16_f32 v80, v80, v81
  v_cvt_pk_bf16_f32 v81, v82, v83
  v_pk_mul_f32 v[88:89], v[88:89], v[156:157] op_sel_hi:[1,0]
  v_pk_mul_f32 v[90:91], v[90:91], v[156:157] op_sel_hi:[1,0]
  v_pk_fma_f32 v[88:89], v[152:153], v[160:161], v[88:89] op_sel_hi:[1,0,1]
  v_pk_fma_f32 v[90:91], v[154:155], v[160:161], v[90:91] op_sel_hi:[1,0,1]
  v_cvt_pk_bf16_f32 v82, v88, v89
  v_cvt_pk_bf16_f32 v83, v90, v91
  v_permlane16_swap_b32 v68, v70
  v_permlane16_swap_b32 v69, v71
  buffer_store_dwordx4 v[68:71], v242, s[8:11], s80 offen offset:256 sc1
  v_pk_mul_f32 v[84:85], v[84:85], v[158:159] op_sel_hi:[1,0]
  v_pk_mul_f32 v[86:87], v[86:87], v[158:159] op_sel_hi:[1,0]
  v_pk_fma_f32 v[84:85], v[148:149], v[162:163], v[84:85] op_sel_hi:[1,0,1]
  v_pk_fma_f32 v[86:87], v[150:151], v[162:163], v[86:87] op_sel_hi:[1,0,1]
  v_cvt_pk_bf16_f32 v84, v84, v85
  v_cvt_pk_bf16_f32 v85, v86, v87
  v_pk_mul_f32 v[92:93], v[92:93], v[158:159] op_sel_hi:[1,0]
  v_pk_mul_f32 v[94:95], v[94:95], v[158:159] op_sel_hi:[1,0]
  v_pk_fma_f32 v[92:93], v[152:153], v[162:163], v[92:93] op_sel_hi:[1,0,1]
  v_pk_fma_f32 v[94:95], v[154:155], v[162:163], v[94:95] op_sel_hi:[1,0,1]
  v_cvt_pk_bf16_f32 v86, v92, v93
  v_cvt_pk_bf16_f32 v87, v94, v95
  v_permlane16_swap_b32 v80, v82
  v_permlane16_swap_b32 v81, v83
  buffer_store_dwordx4 v[80:83], v242, s[8:11], s81 offen offset:0 sc1
  s_nop 1
  v_permlane16_swap_b32 v84, v86
  v_permlane16_swap_b32 v85, v87
  buffer_store_dwordx4 v[84:87], v242, s[8:11], s81 offen offset:256 sc1
  s_waitcnt vmcnt(25)
  s_barrier
  ds_read_b64_tr_b16 a[152:153], v240 offset:0
  ds_read_b64_tr_b16 a[154:155], v240 offset:80
  ds_read_b64_tr_b16 a[156:157], v240 offset:40
  ds_read_b64_tr_b16 a[158:159], v240 offset:120
  ds_read_b64_tr_b16 a[160:161], v240 offset:32
  ds_read_b64_tr_b16 a[162:163], v240 offset:112
  ds_read_b64_tr_b16 a[164:165], v240 offset:2560
  ds_read_b64_tr_b16 a[166:167], v240 offset:2640
  ds_read_b64_tr_b16 a[168:169], v240 offset:2600
  ds_read_b64_tr_b16 a[170:171], v240 offset:2680
  s_waitcnt lgkmcnt(6)
  v_mfma_f32_16x16x32_bf16 v[128:131], a[152:155], a[232:235], 0
  ds_read_b64_tr_b16 a[172:173], v240 offset:2592
  s_mov_b64 s[32:33], s[4:5]
  v_mfma_f32_16x16x32_bf16 v[104:107], a[152:155], a[0:3], 0
  ds_read_b64_tr_b16 a[174:175], v240 offset:2672
  s_and_b32 s42, s2, 7
  v_mfma_f32_16x16x32_bf16 v[108:111], a[152:155], a[4:7], 0
  s_mul_i32 s45, s42, 1152
  s_movk_i32 s43, 8064
  v_mfma_f32_16x16x32_bf16 v[132:135], a[156:159], a[232:235], 0
  ds_read_b64_tr_b16 a[144:145], v240 offset:5120
  s_cmp_ge_u32 s3, 64
  s_cselect_b32 s12, s22, s20
  s_cselect_b32 s13, s23, s21
  v_mfma_f32_16x16x32_bf16 v[112:115], a[156:159], a[0:3], 0
  ds_read_b64_tr_b16 a[146:147], v240 offset:5200
  s_mov_b32 s14, 5308416
  v_mfma_f32_16x16x32_bf16 v[116:119], a[156:159], a[4:7], 0
  s_and_b32 s44, s3, 63
  s_mul_i32 s44, s44, 49
  s_waitcnt lgkmcnt(6)
  v_mfma_f32_16x16x32_bf16 v[136:139], a[160:163], a[232:235], 0
  ds_read_b64_tr_b16 a[148:149], v240 offset:5160
  v_min_u32 v172, 48, v1
  v_mfma_f32_16x16x32_bf16 v[120:123], a[160:163], a[0:3], 0
  ds_read_b64_tr_b16 a[150:151], v240 offset:5240
  v_add_u32 v172, s44, v172
  v_mfma_f32_16x16x32_bf16 v[124:127], a[160:163], a[4:7], 0
  v_mul_u32_u24 v173, 7282, v172
  v_lshrrev_b32 v173, 16, v173
  v_mfma_f32_16x16x32_bf16 v[128:131], a[164:167], a[232:235], v[128:131]
  ds_read_b64_tr_b16 a[152:153], v240 offset:5152
  v_lshl_add_u32 v172, v172, 7, s45
  v_mfma_f32_16x16x32_bf16 v[104:107], a[164:167], a[8:11], v[104:107]
  ds_read_b64_tr_b16 a[154:155], v240 offset:5232
  v_mad_u32_u24 v27, v173, s43, v172
  v_mfma_f32_16x16x32_bf16 v[108:111], a[164:167], a[12:15], v[108:111]
  s_bitcmp1_b32 s24, 1
  s_cselect_b32 s4, s22, s20
  s_cselect_b32 s5, s23, s21
  s_mov_b32 s20, s48
  s_waitcnt lgkmcnt(6)
  v_mfma_f32_16x16x32_bf16 v[132:135], a[168:171], a[232:235], v[132:135]
  ds_read_b64_tr_b16 a[156:157], v240 offset:7680
  s_mov_b32 s21, s49
  v_mfma_f32_16x16x32_bf16 v[112:115], a[168:171], a[8:11], v[112:115]
  ds_read_b64_tr_b16 a[158:159], v240 offset:7760
  s_mov_b32 s23, 0x00020000
  v_mfma_f32_16x16x32_bf16 v[116:119], a[168:171], a[12:15], v[116:119]
  s_sub_u32 s44, s3, 56
  s_cselect_b32 s22, 0, 5308416
  s_cselect_b32 s48, 0x40000000, 0
  s_cselect_b32 s44, 0, s44
  s_lshl_b32 s44, s44, 3
  v_mfma_f32_16x16x32_bf16 v[136:139], a[172:175], a[232:235], v[136:139]
  ds_read_b64_tr_b16 a[160:161], v240 offset:7720
  s_and_b32 s42, s2, 7
  v_mfma_f32_16x16x32_bf16 v[120:123], a[172:175], a[8:11], v[120:123]
  ds_read_b64_tr_b16 a[162:163], v240 offset:7800
  s_mul_i32 s45, s42, 576
  v_mfma_f32_16x16x32_bf16 v[124:127], a[172:175], a[12:15], v[124:127]
  s_add_u32 s45, s45, s44
  s_mul_i32 s45, s45, 1152
  s_waitcnt lgkmcnt(6)
  v_mfma_f32_16x16x32_bf16 v[128:131], a[144:147], a[232:235], v[128:131]
  ds_read_b64_tr_b16 a[164:165], v240 offset:7712
  s_and_b32 s43, s2, 4
  v_mfma_f32_16x16x32_bf16 v[104:107], a[144:147], a[16:19], v[104:107]
  ds_read_b64_tr_b16 a[166:167], v240 offset:7792
  s_lshl_b32 s43, s43, 5
  v_mfma_f32_16x16x32_bf16 v[108:111], a[144:147], a[20:23], v[108:111]
  s_add_u32 s45, s45, s43
  v_lshrrev_b32 v172, 3, v1
  v_mfma_f32_16x16x32_bf16 v[132:135], a[148:151], a[232:235], v[132:135]
  ds_read_b64_tr_b16 a[168:169], v240 offset:10240
  v_mul_u32_u24 v24, 1152, v172
  v_mfma_f32_16x16x32_bf16 v[112:115], a[148:151], a[16:19], v[112:115]
  ds_read_b64_tr_b16 a[170:171], v240 offset:10320
  v_and_b32 v173, 7, v1
  v_mfma_f32_16x16x32_bf16 v[116:119], a[148:151], a[20:23], v[116:119]
  v_lshl_add_u32 v24, v173, 4, v24
  v_add_u32 v24, s45, v24
  s_waitcnt lgkmcnt(6)
  v_mfma_f32_16x16x32_bf16 v[136:139], a[152:155], a[232:235], v[136:139]
  ds_read_b64_tr_b16 a[172:173], v240 offset:10280
  s_lshl_b32 s42, s42, 1
  v_mfma_f32_16x16x32_bf16 v[120:123], a[152:155], a[16:19], v[120:123]
  ds_read_b64_tr_b16 a[174:175], v240 offset:10360
  s_cmp_ge_u32 s44, 320
  s_cselect_b32 s45, 320, 0
  s_addc_u32 s42, s42, 0
  v_mfma_f32_16x16x32_bf16 v[124:127], a[152:155], a[20:23], v[124:127]
  s_sub_u32 s45, s44, s45
  s_lshr_b32 s43, 1320960, s42
  v_mfma_f32_16x16x32_bf16 v[128:131], a[156:159], a[232:235], v[128:131]
  ds_read_b64_tr_b16 a[144:145], v240 offset:10272
  s_and_b32 s43, s43, 128
  v_mfma_f32_16x16x32_bf16 v[104:107], a[156:159], a[24:27], v[104:107]
  ds_read_b64_tr_b16 a[146:147], v240 offset:10352
  s_xor_b32 s43, s43, s45
  v_mfma_f32_16x16x32_bf16 v[108:111], a[156:159], a[28:31], v[108:111]
  s_and_b32 s49, s42, 3
  s_lshl_b32 s44, s49, 8
  s_waitcnt lgkmcnt(6)
  v_mfma_f32_16x16x32_bf16 v[132:135], a[160:163], a[232:235], v[132:135]
  ds_read_b64_tr_b16 a[148:149], v240 offset:12800
  s_add_u32 s43, s43, s44
  v_mfma_f32_16x16x32_bf16 v[112:115], a[160:163], a[24:27], v[112:115]
  ds_read_b64_tr_b16 a[150:151], v240 offset:12880
  s_lshl_b32 s44, s49, 5
  v_mfma_f32_16x16x32_bf16 v[116:119], a[160:163], a[28:31], v[116:119]
  s_add_u32 s44, s44, s45
  s_add_u32 s44, s44, 768
  v_mfma_f32_16x16x32_bf16 v[136:139], a[164:167], a[232:235], v[136:139]
  ds_read_b64_tr_b16 a[152:153], v240 offset:12840
  s_cmp_ge_u32 s45, 256
  s_cselect_b32 s43, s44, s43
  v_mfma_f32_16x16x32_bf16 v[120:123], a[164:167], a[24:27], v[120:123]
  ds_read_b64_tr_b16 a[154:155], v240 offset:12920
  s_lshl_b32 s43, s43, 6
  v_mfma_f32_16x16x32_bf16 v[124:127], a[164:167], a[28:31], v[124:127]
  s_and_b32 s42, s42, 12
  s_mul_i32 s42, s42, 147456
  s_waitcnt lgkmcnt(6)
  v_mfma_f32_16x16x32_bf16 v[128:131], a[168:171], a[232:235], v[128:131]
  ds_read_b64_tr_b16 a[156:157], v240 offset:12832
  s_waitcnt vmcnt(0)
  v_cmp_ne_u32 vcc, 0x01010101, v30
  s_cbranch_vccz k1_kernel_bka
k1_kernel_sla:
  s_sleep 1
  buffer_load_dword v30, v31, s[76:79], 0 offen sc1
  s_sub_u32 s86, s86, 1
  s_max_i32 s86, s86, 0
  s_waitcnt vmcnt(0)
  s_cbranch_scc0 k1_kernel_bka
  v_cmp_ne_u32 vcc, 0x01010101, v30
  s_cbranch_vccnz k1_kernel_sla
k1_kernel_bka:
  s_mov_b64 exec, 1
  buffer_store_dword v30, off, s[8:11], s83 sc1
  s_mov_b64 exec, -1
  v_mfma_f32_16x16x32_bf16 v[104:107], a[168:171], a[32:35], v[104:107]
  ds_read_b64_tr_b16 a[158:159], v240 offset:12912
  s_add_u32 s43, s43, s42
  v_mfma_f32_16x16x32_bf16 v[108:111], a[168:171], a[36:39], v[108:111]
  s_add_u32 s43, s43, s48
  v_lshl_add_u32 v25, v172, 6, s43
  v_mfma_f32_16x16x32_bf16 v[132:135], a[172:175], a[232:235], v[132:135]
  s_waitcnt vmcnt(13)
  s_barrier
  ds_read_b64_tr_b16 a[160:161], v240 offset:15360
  v_and_b32 v172, 3, v1
  v_mfma_f32_16x16x32_bf16 v[112:115], a[172:175], a[32:35], v[112:115]
  ds_read_b64_tr_b16 a[162:163], v240 offset:15440
  v_lshl_add_u32 v25, v172, 4, v25
  v_mfma_f32_16x16x32_bf16 v[116:119], a[172:175], a[36:39], v[116:119]
  v_bfe_u32 v172, v1, 2, 1
  s_mov_b32 s43, 73728
  s_waitcnt lgkmcnt(6)
  v_mfma_f32_16x16x32_bf16 v[136:139], a[144:147], a[232:235], v[136:139]
  ds_read_b64_tr_b16 a[164:165], v240 offset:15400
  v_mad_u32_u24 v25, v172, s43, v25
  v_mfma_f32_16x16x32_bf16 v[120:123], a[144:147], a[32:35], v[120:123]
  ds_read_b64_tr_b16 a[166:167], v240 offset:15480
  s_mov_b32 s48, 58720256
  v_mfma_f32_16x16x32_bf16 v[124:127], a[144:147], a[36:39], v[124:127]
  s_waitcnt vmcnt(63)
  s_mov_b32 s40, 0x3f803f80
  v_mov_b32 v35, 0
  v_mov_b32 v39, 0
  v_dot2_f32_bf16 v35, v32, s40, v35
  v_mfma_f32_16x16x32_bf16 v[128:131], a[148:151], a[232:235], v[128:131]
  ds_read_b64_tr_b16 a[168:169], v240 offset:15392
  v_dot2_f32_bf16 v39, v33, s40, v39
  v_mfma_f32_16x16x32_bf16 v[104:107], a[148:151], a[40:43], v[104:107]
  ds_read_b64_tr_b16 a[170:171], v240 offset:15472
  v_dot2_f32_bf16 v35, v34, s40, v35
  v_mfma_f32_16x16x32_bf16 v[108:111], a[148:151], a[44:47], v[108:111]
  v_dot2_f32_bf16 v39, v36, s40, v39
  v_dot2_f32_bf16 v35, v37, s40, v35
  s_waitcnt lgkmcnt(6)
  v_mfma_f32_16x16x32_bf16 v[132:135], a[152:155], a[232:235], v[132:135]
  ds_read_b64_tr_b16 a[172:173], v240 offset:17920
  v_dot2_f32_bf16 v39, v38, s40, v39
  v_mfma_f32_16x16x32_bf16 v[112:115], a[152:155], a[40:43], v[112:115]
  ds_read_b64_tr_b16 a[174:175], v240 offset:18000
  v_dot2_f32_bf16 v35, v40, s40, v35
  v_mfma_f32_16x16x32_bf16 v[116:119], a[152:155], a[44:47], v[116:119]
  v_dot2_f32_bf16 v39, v41, s40, v39
  v_dot2_f32_bf16 v35, v42, s40, v35
  v_mfma_f32_16x16x32_bf16 v[136:139], a[156:159], a[232:235], v[136:139]
  ds_read_b64_tr_b16 a[144:145], v240 offset:17960
  s_nop 2
  v_mfma_f32_16x16x32_bf16 v[120:123], a[156:159], a[40:43], v[120:123]
  ds_read_b64_tr_b16 a[146:147], v240 offset:18040
  v_add_f32 v35, v35, v39
  s_nop 1
  v_mfma_f32_16x16x32_bf16 v[124:127], a[156:159], a[44:47], v[124:127]
  v_add_f32_dpp v35, v35, v35 quad_perm:[1,0,3,2] row_mask:0xf bank_mask:0xf
  s_nop 1
  v_add_f32_dpp v35, v35, v35 quad_perm:[2,3,0,1] row_mask:0xf bank_mask:0xf
  s_nop 1
  s_waitcnt lgkmcnt(6)
  v_mfma_f32_16x16x32_bf16 v[128:131], a[160:163], a[232:235], v[128:131]
  ds_read_b64_tr_b16 a[148:149], v240 offset:17952
  v_add_f32_dpp v35, v35, v35 row_half_mirror row_mask:0xf bank_mask:0xf
  s_nop 1
  v_mfma_f32_16x16x32_bf16 v[104:107], a[160:163], a[48:51], v[104:107]
  ds_read_b64_tr_b16 a[150:151], v240 offset:18032
  v_add_f32_dpp v35, v35, v35 row_mirror row_mask:0xf bank_mask:0xf
  v_mfma_f32_16x16x32_bf16 v[108:111], a[160:163], a[52:55], v[108:111]
  v_mov_b32 v39, v35
  s_nop 1
  v_permlane16_swap_b32 v35, v39
  v_mfma_f32_16x16x32_bf16 v[132:135], a[164:167], a[232:235], v[132:135]
  ds_read_b64_tr_b16 a[152:153], v240 offset:20480
  v_add_f32 v35, v35, v39
  v_mfma_f32_16x16x32_bf16 v[112:115], a[164:167], a[48:51], v[112:115]
  ds_read_b64_tr_b16 a[154:155], v240 offset:20560
  v_mul_f32 v35, 0x3ae38e39, v35
  v_mfma_f32_16x16x32_bf16 v[116:119], a[164:167], a[52:55], v[116:119]
  v_cvt_pk_bf16_f32 v32, v35, v35
  v_lshlrev_b32 v32, 16, v32
  s_waitcnt lgkmcnt(6)
  v_mfma_f32_16x16x32_bf16 v[136:139], a[168:171], a[232:235], v[136:139]
  ds_read_b64_tr_b16 a[156:157], v240 offset:20520
  v_sub_f32 v32, v35, v32
  v_mfma_f32_16x16x32_bf16 v[120:123], a[168:171], a[48:51], v[120:123]
  ds_read_b64_tr_b16 a[158:159], v240 offset:20600
  v_cvt_pk_bf16_f32 v32, v35, v32
  v_mfma_f32_16x16x32_bf16 v[124:127], a[168:171], a[52:55], v[124:127]
  v_mov_b32 v33, 1.0
  v_mul_f32 v156, s98, v156
  v_mfma_f32_16x16x32_bf16 v[128:131], a[172:175], a[232:235], v[128:131]
  ds_read_b64_tr_b16 a[160:161], v240 offset:20512
  v_mul_f32 v160, s98, v160
  v_mfma_f32_16x16x32_bf16 v[104:107], a[172:175], a[56:59], v[104:107]
  ds_read_b64_tr_b16 a[162:163], v240 offset:20592
  v_mul_f32 v158, s98, v158
  v_mfma_f32_16x16x32_bf16 v[108:111], a[172:175], a[60:63], v[108:111]
  v_mul_f32 v162, s98, v162
  s_lshl_b32 s27, s24, 7
  s_waitcnt lgkmcnt(6)
  v_mfma_f32_16x16x32_bf16 v[132:135], a[144:147], a[232:235], v[132:135]
  ds_read_b64_tr_b16 a[164:165], v240 offset:23040
  s_add_u32 s27, s27, 154624
  v_mfma_f32_16x16x32_bf16 v[112:115], a[144:147], a[56:59], v[112:115]
  ds_read_b64_tr_b16 a[166:167], v240 offset:23120
  v_add_u32 v172, s27, v9
  v_mfma_f32_16x16x32_bf16 v[116:119], a[144:147], a[60:63], v[116:119]
  s_mov_b64 exec, 0xffff
  ds_write_b32 v172, v170 offset:0
  ds_write_b32 v172, v171 offset:64
  s_mov_b64 exec, -1
  v_mov_b32 v172, 0xf149f2ca
  v_mfma_f32_16x16x32_bf16 v[136:139], a[148:151], a[232:235], v[136:139]
  ds_read_b64_tr_b16 a[168:169], v240 offset:23080
  v_and_b32 v175, 31, v1
  v_mfma_f32_16x16x32_bf16 v[120:123], a[148:151], a[56:59], v[120:123]
  ds_read_b64_tr_b16 a[170:171], v240 offset:23160
  v_mad_i32_i24 v175, v244, -4, v175
  v_mfma_f32_16x16x32_bf16 v[124:127], a[148:151], a[60:63], v[124:127]
  v_cmp_gt_i32 s[44:45], 0, v175
  v_cmp_gt_i32 s[46:47], 1, v175
  s_waitcnt lgkmcnt(8)
  v_mfma_f32_16x16x32_bf16 v[128:131], a[152:155], a[232:235], v[128:131]
  ds_read_b64_tr_b16 a[172:173], v240 offset:23072
  s_nop 0
  v_mfma_f32_16x16x32_bf16 v[104:107], a[152:155], a[64:67], v[104:107]
  ds_read_b64_tr_b16 a[174:175], v240 offset:23152
  v_cndmask_b32 v48, v172, 0, s[44:45]
  v_mfma_f32_16x16x32_bf16 v[108:111], a[152:155], a[68:71], v[108:111]
  v_cndmask_b32 v176, 0, v172, s[44:45]
  v_cndmask_b32 v192, v172, 0, s[44:45]
  v_mfma_f32_16x16x32_bf16 v[132:135], a[156:159], a[232:235], v[132:135]
  ds_read_b64_tr_b16 a[144:145], v240 offset:25600
  v_cndmask_b32 v208, 0, v172, s[44:45]
  v_mfma_f32_16x16x32_bf16 v[112:115], a[156:159], a[64:67], v[112:115]
  ds_read_b64_tr_b16 a[146:147], v240 offset:25680
  v_cmp_gt_i32 s[44:45], 2, v175
  v_mfma_f32_16x16x32_bf16 v[116:119], a[156:159], a[68:71], v[116:119]
  v_cndmask_b32 v49, v172, 0, s[46:47]
  v_cndmask_b32 v177, 0, v172, s[46:47]
  s_waitcnt lgkmcnt(8)
  v_mfma_f32_16x16x32_bf16 v[136:139], a[160:163], a[232:235], v[136:139]
  ds_read_b64_tr_b16 a[148:149], v240 offset:25640
  v_cndmask_b32 v193, v172, 0, s[46:47]
  v_mfma_f32_16x16x32_bf16 v[120:123], a[160:163], a[64:67], v[120:123]
  ds_read_b64_tr_b16 a[150:151], v240 offset:25720
  v_cndmask_b32 v209, 0, v172, s[46:47]
  v_mfma_f32_16x16x32_bf16 v[124:127], a[160:163], a[68:71], v[124:127]
  v_cmp_gt_i32 s[46:47], 3, v175
  v_cndmask_b32 v50, v172, 0, s[44:45]
  v_mfma_f32_16x16x32_bf16 v[128:131], a[164:167], a[232:235], v[128:131]
  ds_read_b64_tr_b16 a[152:153], v240 offset:25632
  v_cndmask_b32 v178, 0, v172, s[44:45]
  v_mfma_f32_16x16x32_bf16 v[104:107], a[164:167], a[72:75], v[104:107]
  ds_read_b64_tr_b16 a[154:155], v240 offset:25712
  v_cndmask_b32 v194, v172, 0, s[44:45]
  v_mfma_f32_16x16x32_bf16 v[108:111], a[164:167], a[76:79], v[108:111]
  v_cndmask_b32 v210, 0, v172, s[44:45]
  v_cmp_gt_i32 s[44:45], 8, v175
  s_waitcnt lgkmcnt(6)
  v_mfma_f32_16x16x32_bf16 v[132:135], a[168:171], a[232:235], v[132:135]
  ds_read_b64_tr_b16 a[156:157], v240 offset:28160
  v_cndmask_b32 v51, v172, 0, s[46:47]
  v_mfma_f32_16x16x32_bf16 v[112:115], a[168:171], a[72:75], v[112:115]
  ds_read_b64_tr_b16 a[158:159], v240 offset:28240
  v_cndmask_b32 v179, 0, v172, s[46:47]
  v_mfma_f32_16x16x32_bf16 v[116:119], a[168:171], a[76:79], v[116:119]
  v_cndmask_b32 v195, v172, 0, s[46:47]
  v_cndmask_b32 v211, 0, v172, s[46:47]
  v_mfma_f32_16x16x32_bf16 v[136:139], a[172:175], a[232:235], v[136:139]
  ds_read_b64_tr_b16 a[160:161], v240 offset:28200
  v_cmp_gt_i32 s[46:47], 9, v175
  v_mfma_f32_16x16x32_bf16 v[120:123], a[172:175], a[72:75], v[120:123]
  ds_read_b64_tr_b16 a[162:163], v240 offset:28280
  v_cndmask_b32 v52, v172, 0, s[44:45]
  v_mfma_f32_16x16x32_bf16 v[124:127], a[172:175], a[76:79], v[124:127]
  v_cndmask_b32 v180, 0, v172, s[44:45]
  v_cndmask_b32 v196, v172, 0, s[44:45]
  s_waitcnt lgkmcnt(6)
  v_mfma_f32_16x16x32_bf16 v[128:131], a[144:147], a[232:235], v[128:131]
  ds_read_b64_tr_b16 a[164:165], v240 offset:28192
  v_cndmask_b32 v212, 0, v172, s[44:45]
  v_mfma_f32_16x16x32_bf16 v[104:107], a[144:147], a[80:83], v[104:107]
  ds_read_b64_tr_b16 a[166:167], v240 offset:28272
  v_cmp_gt_i32 s[44:45], 10, v175
  v_mfma_f32_16x16x32_bf16 v[108:111], a[144:147], a[84:87], v[108:111]
  buffer_load_dword v28, v5, s[8:11], s84 offen sc1
  v_cndmask_b32 v53, v172, 0, s[46:47]
  v_mfma_f32_16x16x32_bf16 v[132:135], a[148:151], a[232:235], v[132:135]
  s_waitcnt vmcnt(7)
  s_barrier
  ds_read_b64_tr_b16 a[168:169], v240 offset:30720
  v_cndmask_b32 v181, 0, v172, s[46:47]
  v_mfma_f32_16x16x32_bf16 v[112:115], a[148:151], a[80:83], v[112:115]
  ds_read_b64_tr_b16 a[170:171], v240 offset:30800
  v_cndmask_b32 v197, v172, 0, s[46:47]
  v_mfma_f32_16x16x32_bf16 v[116:119], a[148:151], a[84:87], v[116:119]
  v_cndmask_b32 v213, 0, v172, s[46:47]
  v_cmp_gt_i32 s[46:47], 11, v175
  s_waitcnt lgkmcnt(6)
  v_mfma_f32_16x16x32_bf16 v[136:139], a[152:155], a[232:235], v[136:139]
  ds_read_b64_tr_b16 a[172:173], v240 offset:30760
  v_cndmask_b32 v54, v172, 0, s[44:45]
  v_mfma_f32_16x16x32_bf16 v[120:123], a[152:155], a[80:83], v[120:123]
  ds_read_b64_tr_b16 a[174:175], v240 offset:30840
  v_cndmask_b32 v182, 0, v172, s[44:45]
  v_mfma_f32_16x16x32_bf16 v[124:127], a[152:155], a[84:87], v[124:127]
  v_cndmask_b32 v198, v172, 0, s[44:45]
  v_cndmask_b32 v214, 0, v172, s[44:45]
  v_mfma_f32_16x16x32_bf16 v[128:131], a[156:159], a[232:235], v[128:131]
  ds_read_b64_tr_b16 a[144:145], v240 offset:30752
  v_cmp_gt_i32 s[44:45], 16, v175
  v_mfma_f32_16x16x32_bf16 v[104:107], a[156:159], a[88:91], v[104:107]
  ds_read_b64_tr_b16 a[146:147], v240 offset:30832
  v_cndmask_b32 v55, v172, 0, s[46:47]
  v_mfma_f32_16x16x32_bf16 v[108:111], a[156:159], a[92:95], v[108:111]
  v_cndmask_b32 v183, 0, v172, s[46:47]
  v_cndmask_b32 v199, v172, 0, s[46:47]
  s_waitcnt lgkmcnt(6)
  v_mfma_f32_16x16x32_bf16 v[132:135], a[160:163], a[232:235], v[132:135]
  ds_read_b64_tr_b16 a[148:149], v240 offset:33280
  v_cndmask_b32 v215, 0, v172, s[46:47]
  v_mfma_f32_16x16x32_bf16 v[112:115], a[160:163], a[88:91], v[112:115]
  ds_read_b64_tr_b16 a[150:151], v240 offset:33360
  v_cmp_gt_i32 s[46:47], 17, v175
  v_mfma_f32_16x16x32_bf16 v[116:119], a[160:163], a[92:95], v[116:119]
  v_cndmask_b32 v56, v172, 0, s[44:45]
  v_cndmask_b32 v184, 0, v172, s[44:45]
  v_mfma_f32_16x16x32_bf16 v[136:139], a[164:167], a[232:235], v[136:139]
  ds_read_b64_tr_b16 a[152:153], v240 offset:33320
  v_cndmask_b32 v200, v172, 0, s[44:45]
  v_mfma_f32_16x16x32_bf16 v[120:123], a[164:167], a[88:91], v[120:123]
  ds_read_b64_tr_b16 a[154:155], v240 offset:33400
  v_cndmask_b32 v216, 0, v172, s[44:45]
  v_mfma_f32_16x16x32_bf16 v[124:127], a[164:167], a[92:95], v[124:127]
  v_cmp_gt_i32 s[44:45], 18, v175
  v_cndmask_b32 v57, v172, 0, s[46:47]
k1_kernel_w2:
  s_cbranch_execz k1_kernel_w6
  s_waitcnt lgkmcnt(6)
  v_mfma_f32_16x16x32_bf16 v[128:131], a[168:171], a[232:235], v[128:131]
  ds_read_b64_tr_b16 a[156:157], v240 offset:33312
  v_cndmask_b32 v185, 0, v172, s[46:47]
  v_mfma_f32_16x16x32_bf16 v[104:107], a[168:171], a[96:99], v[104:107]
  ds_read_b64_tr_b16 a[158:159], v240 offset:33392
  v_cndmask_b32 v201, v172, 0, s[46:47]
  v_mfma_f32_16x16x32_bf16 v[108:111], a[168:171], a[100:103], v[108:111]
  v_cndmask_b32 v217, 0, v172, s[46:47]
  v_cmp_gt_i32 s[46:47], 19, v175
  v_mfma_f32_16x16x32_bf16 v[132:135], a[172:175], a[232:235], v[132:135]
  ds_read_b64_tr_b16 a[160:161], v240 offset:35840
  v_cndmask_b32 v58, v172, 0, s[44:45]
  v_mfma_f32_16x16x32_bf16 v[112:115], a[172:175], a[96:99], v[112:115]
  ds_read_b64_tr_b16 a[162:163], v240 offset:35920
  v_cndmask_b32 v186, 0, v172, s[44:45]
  v_mfma_f32_16x16x32_bf16 v[116:119], a[172:175], a[100:103], v[116:119]
  v_cndmask_b32 v202, v172, 0, s[44:45]
  v_cndmask_b32 v218, 0, v172, s[44:45]
  s_waitcnt lgkmcnt(6)
  v_mfma_f32_16x16x32_bf16 v[136:139], a[144:147], a[232:235], v[136:139]
  ds_read_b64_tr_b16 a[164:165], v240 offset:35880
  v_cmp_gt_i32 s[44:45], 24, v175
  v_mfma_f32_16x16x32_bf16 v[120:123], a[144:147], a[96:99], v[120:123]
  ds_read_b64_tr_b16 a[166:167], v240 offset:35960
  v_cndmask_b32 v59, v172, 0, s[46:47]
  v_mfma_f32_16x16x32_bf16 v[124:127], a[144:147], a[100:103], v[124:127]
  v_cndmask_b32 v187, 0, v172, s[46:47]
  v_cndmask_b32 v203, v172, 0, s[46:47]
  v_mfma_f32_16x16x32_bf16 v[128:131], a[148:151], a[232:235], v[128:131]
  ds_read_b64_tr_b16 a[168:169], v240 offset:35872
  v_cndmask_b32 v219, 0, v172, s[46:47]
  v_mfma_f32_16x16x32_bf16 v[104:107], a[148:151], a[104:107], v[104:107]
  ds_read_b64_tr_b16 a[170:171], v240 offset:35952
  v_cmp_gt_i32 s[46:47], 25, v175
  v_mfma_f32_16x16x32_bf16 v[108:111], a[148:151], a[108:111], v[108:111]
  v_cndmask_b32 v60, v172, 0, s[44:45]
  v_cndmask_b32 v188, 0, v172, s[44:45]
  s_waitcnt lgkmcnt(6)
  v_mfma_f32_16x16x32_bf16 v[132:135], a[152:155], a[232:235], v[132:135]
  ds_read_b64_tr_b16 a[172:173], v240 offset:38400
  v_cndmask_b32 v204, v172, 0, s[44:45]
  v_mfma_f32_16x16x32_bf16 v[112:115], a[152:155], a[104:107], v[112:115]
  ds_read_b64_tr_b16 a[174:175], v240 offset:38480
  v_cndmask_b32 v220, 0, v172, s[44:45]
  v_mfma_f32_16x16x32_bf16 v[116:119], a[152:155], a[108:111], v[116:119]
  v_cmp_gt_i32 s[44:45], 26, v175
  v_cndmask_b32 v61, v172, 0, s[46:47]
  v_mfma_f32_16x16x32_bf16 v[136:139], a[156:159], a[232:235], v[136:139]
  ds_read_b64_tr_b16 a[144:145], v240 offset:38440
  v_cndmask_b32 v189, 0, v172, s[46:47]
  v_mfma_f32_16x16x32_bf16 v[120:123], a[156:159], a[104:107], v[120:123]
  ds_read_b64_tr_b16 a[146:147], v240 offset:38520
  v_cndmask_b32 v205, v172, 0, s[46:47]
  v_mfma_f32_16x16x32_bf16 v[124:127], a[156:159], a[108:111], v[124:127]
  v_cndmask_b32 v221, 0, v172, s[46:47]
  v_cmp_gt_i32 s[46:47], 27, v175
  s_waitcnt lgkmcnt(6)
  v_mfma_f32_16x16x32_bf16 v[128:131], a[160:163], a[232:235], v[128:131]
  ds_read_b64_tr_b16 a[148:149], v240 offset:38432
  v_cndmask_b32 v62, v172, 0, s[44:45]
  v_mfma_f32_16x16x32_bf16 v[104:107], a[160:163], a[112:115], v[104:107]
  ds_read_b64_tr_b16 a[150:151], v240 offset:38512
  v_cndmask_b32 v190, 0, v172, s[44:45]
  v_mfma_f32_16x16x32_bf16 v[108:111], a[160:163], a[116:119], v[108:111]
  v_cndmask_b32 v206, v172, 0, s[44:45]
  v_cndmask_b32 v222, 0, v172, s[44:45]
  v_mfma_f32_16x16x32_bf16 v[132:135], a[164:167], a[232:235], v[132:135]
  ds_read_b64_tr_b16 a[152:153], v240 offset:40960
  v_cndmask_b32 v63, v172, 0, s[46:47]
  v_mfma_f32_16x16x32_bf16 v[112:115], a[164:167], a[112:115], v[112:115]
  ds_read_b64_tr_b16 a[154:155], v240 offset:41040
  v_cndmask_b32 v191, 0, v172, s[46:47]
  v_mfma_f32_16x16x32_bf16 v[116:119], a[164:167], a[116:119], v[116:119]
  v_cndmask_b32 v207, v172, 0, s[46:47]
  v_cndmask_b32 v223, 0, v172, s[46:47]
  s_waitcnt lgkmcnt(6)
  v_mfma_f32_16x16x32_bf16 v[136:139], a[168:171], a[232:235], v[136:139]
  ds_read_b64_tr_b16 a[156:157], v240 offset:41000
  s_waitcnt vmcnt(0)
  v_cmp_eq_u32 vcc, 0, v28
  s_cbranch_vccz k1_kernel_bkb
k1_kernel_slb:
  s_sleep 1
  buffer_load_dword v28, v5, s[8:11], s84 offen sc1
  s_sub_u32 s86, s86, 1
  s_max_i32 s86, s86, 0
  s_waitcnt vmcnt(0)
  s_cbranch_scc0 k1_kernel_bkb
  v_cmp_eq_u32 vcc, 0, v28
  s_cbranch_vccnz k1_kernel_slb
k1_kernel_bkb:
  s_add_u32 m0, s99, 0
  s_nop 0
  v_mfma_f32_16x16x32_bf16 v[120:123], a[168:171], a[112:115], v[120:123]
  ds_read_b64_tr_b16 a[158:159], v240 offset:41080
  buffer_load_dwordx4 v140, s[8:11], s85 offen offset:0 lds
  buffer_load_dwordx4 v141, s[8:11], s85 offen offset:1024 lds
  v_mfma_f32_16x16x32_bf16 v[124:127], a[168:171], a[116:119], v[124:127]
  buffer_load_dwordx4 v142, s[8:11], s85 offen offset:2048 lds
  s_add_u32 m0, s99, 6208
  s_add_u32 s85, s85, 32896
  buffer_load_dwordx4 v140, s[8:11], s85 offen offset:0 lds
  v_mfma_f32_16x16x32_bf16 v[128:131], a[172:175], a[232:235], v[128:131]
  ds_read_b64_tr_b16 a[160:161], v240 offset:40992
  buffer_load_dwordx4 v141, s[8:11], s85 offen offset:1024 lds
  buffer_load_dwordx4 v142, s[8:11], s85 offen offset:2048 lds
  v_mfma_f32_16x16x32_bf16 v[104:107], a[172:175], a[120:123], v[104:107]
  ds_read_b64_tr_b16 a[162:163], v240 offset:41072
  s_add_u32 m0, s94, 24832
  s_nop 0
  buffer_load_dwordx4 v140, s[8:11], s97 offen offset:0 lds
  v_mfma_f32_16x16x32_bf16 v[108:111], a[172:175], a[124:127], v[108:111]
  buffer_load_dwordx4 v141, s[8:11], s97 offen offset:1024 lds
  buffer_load_dwordx4 v142, s[8:11], s97 offen offset:2048 lds
  s_add_u32 m0, s99, 31040
  s_add_u32 s85, s85, 263168
  s_waitcnt lgkmcnt(6)
  v_mfma_f32_16x16x32_bf16 v[132:135], a[144:147], a[232:235], v[132:135]
  ds_read_b64_tr_b16 a[164:165], v240 offset:43520
  buffer_load_dwordx4 v140, s[8:11], s85 offen offset:0 lds
  buffer_load_dwordx4 v141, s[8:11], s85 offen offset:1024 lds
  v_mfma_f32_16x16x32_bf16 v[112:115], a[144:147], a[120:123], v[112:115]
  ds_read_b64_tr_b16 a[166:167], v240 offset:43600
  buffer_load_dwordx4 v142, s[8:11], s85 offen offset:2048 lds
  s_add_u32 m0, s99, 37248
  s_add_u32 s85, s85, 32896
  v_mfma_f32_16x16x32_bf16 v[116:119], a[144:147], a[124:127], v[116:119]
  buffer_load_dwordx4 v140, s[8:11], s85 offen offset:0 lds
  buffer_load_dwordx4 v141, s[8:11], s85 offen offset:1024 lds
  buffer_load_dwordx4 v142, s[8:11], s85 offen offset:2048 lds
  v_mfma_f32_16x16x32_bf16 v[136:139], a[148:151], a[232:235], v[136:139]
  ds_read_b64_tr_b16 a[168:169], v240 offset:43560
  v_mfma_f32_16x16x32_bf16 v[120:123], a[148:151], a[120:123], v[120:123]
  ds_read_b64_tr_b16 a[170:171], v240 offset:43640
  s_mov_b32 s40, 17039360
  s_mov_b32 exec_lo, 1
  s_mov_b32 exec_hi, 1
  buffer_store_dwordx2 v[32:33], v45, s[8:11], s40 offen sc1
  s_mov_b64 exec, -1
  v_mfma_f32_16x16x32_bf16 v[124:127], a[148:151], a[124:127], v[124:127]
k1_kernel_w3:
  s_cbranch_execz k1_kernel_w7
  s_lshl_b32 s40, s25, 13
  s_lshl_b32 s41, s26, 9
  s_waitcnt lgkmcnt(6)
  v_mfma_f32_16x16x32_bf16 v[128:131], a[152:155], a[232:235], v[128:131]
  ds_read_b64_tr_b16 a[172:173], v240 offset:43552
  s_add_u32 s40, s40, s41
  v_mfma_f32_16x16x32_bf16 v[104:107], a[152:155], a[128:131], v[104:107]
  ds_read_b64_tr_b16 a[174:175], v240 offset:43632
  s_add_u32 s40, s40, 18350080
  v_mfma_f32_16x16x32_bf16 v[108:111], a[152:155], a[132:135], v[108:111]
  s_and_b32 s41, s26, 7
  s_cselect_b32 s40, s89, s40
  v_mov_b32 v253, 0
  v_mfma_f32_16x16x32_bf16 v[132:135], a[156:159], a[232:235], v[132:135]
  v_mov_b32 v254, 0
  v_mov_b32 v255, 0
  v_mfma_f32_16x16x32_bf16 v[112:115], a[156:159], a[128:131], v[112:115]
  buffer_store_dwordx4 v[252:255], v249, s[8:11], s40 offen sc1
  s_and_b32 s37, s26, 7
  v_mfma_f32_16x16x32_bf16 v[116:119], a[156:159], a[132:135], v[116:119]
  s_mov_b32 s34, 2359296
  s_mov_b32 s35, 0x00020000
  s_waitcnt lgkmcnt(4)
  v_mfma_f32_16x16x32_bf16 v[136:139], a[160:163], a[232:235], v[136:139]
  s_lshr_b32 s38, s26, 3
  s_lshl_b32 s27, s25, 1
  v_mfma_f32_16x16x32_bf16 v[120:123], a[160:163], a[128:131], v[120:123]
  s_add_u32 s38, s38, s27
  s_lshl_b32 s38, s38, 2
  v_mfma_f32_16x16x32_bf16 v[124:127], a[160:163], a[132:135], v[124:127]
  s_add_u32 s38, s38, s24
  s_lshl_b32 s39, s24, 10
  v_mfma_f32_16x16x32_bf16 v[128:131], a[164:167], a[232:235], v[128:131]
  v_lshl_add_u32 v23, v1, 4, s39
  s_lshl_b32 s90, s91, 9
  v_add_u32 v23, s90, v23
  v_and_b32 v23, 0xfff, v23
  s_add_u32 s39, s39, 148480
  v_mfma_f32_16x16x32_bf16 v[104:107], a[164:167], a[136:139], v[104:107]
  s_lshl_b32 s47, s25, 2
  s_add_u32 s47, s47, s24
  s_lshl_b32 s47, s47, 6
  s_add_u32 s47, s47, s26
  v_mfma_f32_16x16x32_bf16 v[108:111], a[164:167], a[140:143], v[108:111]
  s_waitcnt lgkmcnt(0)
  v_mfma_f32_16x16x32_bf16 v[132:135], a[168:171], a[232:235], v[132:135]
  v_mfma_f32_16x16x32_bf16 v[112:115], a[168:171], a[136:139], v[112:115]
  v_mfma_f32_16x16x32_bf16 v[116:119], a[168:171], a[140:143], v[116:119]
  v_mfma_f32_16x16x32_bf16 v[136:139], a[172:175], a[232:235], v[136:139]
  v_mfma_f32_16x16x32_bf16 v[120:123], a[172:175], a[136:139], v[120:123]
  v_mfma_f32_16x16x32_bf16 v[124:127], a[172:175], a[140:143], v[124:127]
  s_nop 2
  v_pk_mul_f32 v[104:105], v[104:105], v[156:157] op_sel_hi:[1,0]
  v_pk_mul_f32 v[106:107], v[106:107], v[156:157] op_sel_hi:[1,0]
  v_pk_fma_f32 v[104:105], v[128:129], v[160:161], v[104:105] op_sel_hi:[1,0,1]
  v_pk_fma_f32 v[106:107], v[130:131], v[160:161], v[106:107] op_sel_hi:[1,0,1]
  v_cvt_pk_bf16_f32 v104, v104, v105
  v_cvt_pk_bf16_f32 v105, v106, v107
  v_pk_mul_f32 v[108:109], v[108:109], v[158:159] op_sel_hi:[1,0]
  v_pk_mul_f32 v[110:111], v[110:111], v[158:159] op_sel_hi:[1,0]
  v_pk_fma_f32 v[108:109], v[128:129], v[162:163], v[108:109] op_sel_hi:[1,0,1]
  v_pk_fma_f32 v[110:111], v[130:131], v[162:163], v[110:111] op_sel_hi:[1,0,1]
  v_cvt_pk_bf16_f32 v106, v108, v109
  v_cvt_pk_bf16_f32 v107, v110, v111
  v_pk_mul_f32 v[112:113], v[112:113], v[156:157] op_sel_hi:[1,0]
  v_pk_mul_f32 v[114:115], v[114:115], v[156:157] op_sel_hi:[1,0]
  v_pk_fma_f32 v[112:113], v[132:133], v[160:161], v[112:113] op_sel_hi:[1,0,1]
  v_pk_fma_f32 v[114:115], v[134:135], v[160:161], v[114:115] op_sel_hi:[1,0,1]
  v_cvt_pk_bf16_f32 v112, v112, v113
  v_cvt_pk_bf16_f32 v113, v114, v115
  v_pk_mul_f32 v[116:117], v[116:117], v[158:159] op_sel_hi:[1,0]
  v_pk_mul_f32 v[118:119], v[118:119], v[158:159] op_sel_hi:[1,0]
  v_pk_fma_f32 v[116:117], v[132:133], v[162:163], v[116:117] op_sel_hi:[1,0,1]
  v_pk_fma_f32 v[118:119], v[134:135], v[162:163], v[118:119] op_sel_hi:[1,0,1]
  v_cvt_pk_bf16_f32 v114, v116, v117
  v_cvt_pk_bf16_f32 v115, v118, v119
  v_pk_mul_f32 v[120:121], v[120:121], v[156:157] op_sel_hi:[1,0]
  v_pk_mul_f32 v[122:123], v[122:123], v[156:157] op_sel_hi:[1,0]
  v_pk_fma_f32 v[120:121], v[136:137], v[160:161], v[120:121] op_sel_hi:[1,0,1]
  v_pk_fma_f32 v[122:123], v[138:139], v[160:161], v[122:123] op_sel_hi:[1,0,1]
  v_cvt_pk_bf16_f32 v120, v120, v121
  v_cvt_pk_bf16_f32 v121, v122, v123
  v_pk_mul_f32 v[124:125], v[124:125], v[158:159] op_sel_hi:[1,0]
  v_pk_mul_f32 v[126:127], v[126:127], v[158:159] op_sel_hi:[1,0]
  v_pk_fma_f32 v[124:125], v[136:137], v[162:163], v[124:125] op_sel_hi:[1,0,1]
  v_pk_fma_f32 v[126:127], v[138:139], v[162:163], v[126:127] op_sel_hi:[1,0,1]
  v_cvt_pk_bf16_f32 v122, v124, v125
  v_cvt_pk_bf16_f32 v123, v126, v127
  v_permlane16_swap_b32 v104, v106
  v_permlane16_swap_b32 v105, v107
  v_permlane16_swap_b32 v112, v114
  v_permlane16_swap_b32 v113, v115
  v_permlane16_swap_b32 v120, v122
  v_permlane16_swap_b32 v121, v123
  v_accvgpr_write_b32 a240, v104
  v_accvgpr_write_b32 a241, v105
  v_accvgpr_write_b32 a242, v106
  v_accvgpr_write_b32 a243, v107
  v_accvgpr_write_b32 a248, v112
  v_accvgpr_write_b32 a249, v113
  v_accvgpr_write_b32 a250, v114
  v_accvgpr_write_b32 a251, v115
  s_mov_b32 exec_hi, 0
  s_mov_b32 exec_lo, s96
  v_accvgpr_write_b32 a244, v120
  v_accvgpr_write_b32 a253, v121
  s_not_b32 exec_lo, exec_lo
  v_accvgpr_write_b32 a246, v120
  v_accvgpr_write_b32 a255, v121
  s_mov_b64 exec, -1
  s_mov_b32 s46, 0x07060302
  s_waitcnt vmcnt(8)
  s_barrier
  ds_read_b128 a[0:3], v2 offset:0
  ds_read_b128 a[36:39], v4 offset:0
  ds_read_b128 a[4:7], v2 offset:512
  ds_read_b128 a[40:43], v4 offset:512
  ds_read_b128 a[8:11], v2 offset:1024
  ds_read_b128 a[44:47], v4 offset:1024
  ds_read_b128 a[12:15], v2 offset:1536
  ds_read_b128 a[48:51], v4 offset:1536
  ds_read_b128 a[16:19], v2 offset:2048
  ds_read_b128 a[52:55], v4 offset:2048
  ds_read_b128 a[20:23], v2 offset:2560
  ds_read_b128 a[56:59], v4 offset:2560
  v_accvgpr_read_b32 v0, a224
  v_accvgpr_read_b32 v5, a225
  v_accvgpr_read_b32 v22, a226
  s_mov_b32 s41, s3
  s_cmp_lt_u32 s41, 115
  s_cbranch_scc1 k1_kernel_nc
  s_getpc_b64 s[44:45]
k1_kernel_pc:
  s_add_u32 s44, s44, k4_part-k1_kernel_pc
  s_addc_u32 s45, s45, 0
  s_sub_u32 s41, s41, 115
  s_lshl_b32 s41, s41, 13
  v_lshl_add_u32 v30, v1, 7, s41
  v_min_u32 v30, code_end-k4_part-4, v30
  v_mov_b32 v31, s45
  v_add_co_u32 v30, vcc, s44, v30
  s_nop 1
  v_addc_co_u32 v31, vcc, 0, v31, vcc
  global_load_dword v30, v[30:31], off
k1_kernel_nc:
  s_waitcnt lgkmcnt(11)
  v_mfma_f32_32x32x16_bf16 v[48:63], a[0:3], a[240:243], v[48:63]
  ds_read_b128 a[24:27], v2 offset:3072
  buffer_load_dwordx4 a[108:111], v24, s[20:23], 0 offen offset:0
  s_lshl_b32 s47, s47, 2
  s_add_u32 s47, s47, 18546688
  s_waitcnt lgkmcnt(11)
  v_mfma_f32_32x32x16_bf16 v[48:63], a[36:39], a[244:247], v[48:63]
  ds_read_b128 a[60:63], v4 offset:3072
k1_kernel_w4:
  s_cbranch_execz k1_kernel_w8
  buffer_load_dwordx4 a[112:115], v24, s[20:23], 0 offen offset:256
  s_waitcnt lgkmcnt(11)
  v_mfma_f32_32x32x16_bf16 v[64:79], a[4:7], a[240:243], 0
  ds_read_b128 a[28:31], v2 offset:3584
  buffer_load_dwordx4 a[116:119], v24, s[20:23], 0 offen offset:512
  s_waitcnt lgkmcnt(11)
  v_mfma_f32_32x32x16_bf16 v[64:79], a[40:43], a[244:247], v[64:79]
  ds_read_b128 a[64:67], v4 offset:3584
  buffer_load_dwordx4 a[120:123], v24, s[20:23], 0 offen offset:768
  v_max_f32 v10, v48, v49
  v_max_f32 v11, v50, v51
  v_max3_f32 v10, v52, v53, v10
  v_max3_f32 v11, v54, v55, v11
  s_waitcnt lgkmcnt(11)
  v_mfma_f32_32x32x16_bf16 v[80:95], a[8:11], a[240:243], 0
  ds_read_b128 a[32:35], v2 offset:4096
  buffer_load_dword v27, v27, s[12:15], 0 offen
  v_max3_f32 v10, v56, v57, v10
  v_max3_f32 v11, v58, v59, v11
  v_max3_f32 v10, v60, v61, v10
  v_max3_f32 v11, v62, v63, v11
  s_waitcnt lgkmcnt(11)
  v_mfma_f32_32x32x16_bf16 v[80:95], a[44:47], a[244:247], v[80:95]
  ds_read_b128 a[68:71], v4 offset:4096
  v_max3_f32 v10, v64, v65, v10
  v_max3_f32 v11, v66, v67, v11
  v_max3_f32 v10, v68, v69, v10
  v_max3_f32 v11, v70, v71, v11
  s_waitcnt lgkmcnt(11)
  v_mfma_f32_32x32x16_bf16 v[96:111], a[12:15], a[240:243], 0
  ds_read_b128 a[72:75], v3 offset:0
  v_max3_f32 v10, v72, v73, v10
  v_max3_f32 v11, v74, v75, v11
  v_max3_f32 v10, v76, v77, v10
  v_max3_f32 v11, v78, v79, v11
  s_waitcnt lgkmcnt(11)
  v_mfma_f32_32x32x16_bf16 v[96:111], a[48:51], a[244:247], v[96:111]
  ds_read_b128 a[104:107], v3 offset:4096
  v_max3_f32 v10, v80, v81, v10
  v_max3_f32 v11, v82, v83, v11
  v_max3_f32 v10, v84, v85, v10
  v_max3_f32 v11, v86, v87, v11
  s_waitcnt lgkmcnt(11)
  v_mfma_f32_32x32x16_bf16 v[112:127], a[16:19], a[240:243], 0
  ds_read_b128 a[76:79], v3 offset:512
  v_max3_f32 v10, v88, v89, v10
  v_max3_f32 v11, v90, v91, v11
  v_max3_f32 v10, v92, v93, v10
  v_max3_f32 v11, v94, v95, v11
  s_waitcnt lgkmcnt(11)
  v_mfma_f32_32x32x16_bf16 v[112:127], a[52:55], a[244:247], v[112:127]
  ds_read_b128 a[80:83], v3 offset:1024
  v_max3_f32 v10, v96, v97, v10
  v_max3_f32 v11, v98, v99, v11
  v_max3_f32 v10, v100, v101, v10
  v_max3_f32 v11, v102, v103, v11
  s_waitcnt lgkmcnt(11)
  v_mfma_f32_32x32x16_bf16 v[128:143], a[20:23], a[240:243], 0
  ds_read_b128 a[84:87], v3 offset:1536
  v_max3_f32 v10, v104, v105, v10
  v_max3_f32 v11, v106, v107, v11
  v_max3_f32 v10, v108, v109, v10
  v_max3_f32 v11, v110, v111, v11
  s_waitcnt lgkmcnt(11)
  v_mfma_f32_32x32x16_bf16 v[128:143], a[56:59], a[244:247], v[128:143]
  ds_read_b128 a[88:91], v3 offset:2048
  v_max3_f32 v10, v112, v113, v10
  v_max3_f32 v11, v114, v115, v11
  v_max3_f32 v10, v116, v117, v10
  v_max3_f32 v11, v118, v119, v11
  s_waitcnt lgkmcnt(11)
  v_mfma_f32_32x32x16_bf16 v[144:159], a[24:27], a[240:243], 0
  ds_read_b128 a[92:95], v3 offset:2560
  v_max3_f32 v10, v120, v121, v10
  v_max3_f32 v11, v122, v123, v11
  v_max3_f32 v10, v124, v125, v10
  v_max3_f32 v11, v126, v127, v11
  s_waitcnt lgkmcnt(11)
  v_mfma_f32_32x32x16_bf16 v[144:159], a[60:63], a[244:247], v[144:159]
  ds_read_b128 a[96:99], v3 offset:3072
  ds_read_b128 a[100:103], v3 offset:3584
  v_max3_f32 v10, v128, v129, v10
  v_max3_f32 v11, v130, v131, v11
  v_max3_f32 v10, v132, v133, v10
  v_max3_f32 v11, v134, v135, v11
  s_waitcnt lgkmcnt(12)
  v_mfma_f32_32x32x16_bf16 v[160:175], a[28:31], a[240:243], 0
  s_waitcnt vmcnt(7)
  s_barrier
  ds_read_b64_tr_b16 a[144:145], v6 offset:0
  ds_read_b64_tr_b16 a[146:147], v6 offset:256
  v_max3_f32 v10, v136, v137, v10
  v_max3_f32 v11, v138, v139, v11
  v_max3_f32 v10, v140, v141, v10
  v_max3_f32 v11, v142, v143, v11
  s_waitcnt lgkmcnt(13)
  v_mfma_f32_32x32x16_bf16 v[160:175], a[64:67], a[244:247], v[160:175]
  ds_read_b64_tr_b16 a[148:149], v6 offset:128
  ds_read_b64_tr_b16 a[150:151], v6 offset:384
  v_max3_f32 v10, v144, v145, v10
  v_max3_f32 v11, v146, v147, v11
  v_max3_f32 v10, v148, v149, v10
  v_max3_f32 v11, v150, v151, v11
  s_waitcnt lgkmcnt(14)
  v_mfma_f32_32x32x16_bf16 v[176:191], a[32:35], a[240:243], v[176:191]
  ds_read_b64_tr_b16 a[152:153], v6 offset:512
  ds_read_b64_tr_b16 a[154:155], v6 offset:768
  v_max3_f32 v10, v152, v153, v10
  v_max3_f32 v11, v154, v155, v11
  v_max3_f32 v10, v156, v157, v10
  v_max3_f32 v11, v158, v159, v11
  s_waitcnt lgkmcnt(15)
  v_mfma_f32_32x32x16_bf16 v[176:191], a[68:71], a[244:247], v[176:191]
  ds_read_b64_tr_b16 a[156:157], v6 offset:640
  ds_read_b64_tr_b16 a[158:159], v6 offset:896
  v_max3_f32 v10, v160, v161, v10
  v_max3_f32 v11, v162, v163, v11
  v_max3_f32 v10, v164, v165, v10
  v_max3_f32 v11, v166, v167, v11
  v_max3_f32 v10, v168, v169, v10
  v_max3_f32 v11, v170, v171, v11
  v_max3_f32 v10, v172, v173, v10
  v_max3_f32 v11, v174, v175, v11
  s_waitcnt lgkmcnt(15)
  v_mfma_f32_32x32x16_bf16 v[192:207], a[72:75], a[248:251], v[192:207]
  ds_read_b64_tr_b16 a[160:161], v6 offset:1024
  ds_read_b64_tr_b16 a[162:163], v6 offset:1280
  v_max3_f32 v10, v176, v177, v10
  v_max3_f32 v11, v178, v179, v11
  v_max3_f32 v10, v180, v181, v10
  v_max3_f32 v11, v182, v183, v11
  v_max3_f32 v10, v184, v185, v10
  v_mfma_f32_32x32x16_bf16 v[192:207], a[36:39], a[252:255], v[192:207]
  v_max3_f32 v11, v186, v187, v11
  v_max3_f32 v10, v188, v189, v10
  v_max3_f32 v11, v190, v191, v11
  v_max_f32 v10, v10, v11
  v_mov_b32 v11, v10
  s_waitcnt lgkmcnt(15)
k1_kernel_w5:
  s_cbranch_execz k1_kernel_w9
  v_mfma_f32_32x32x16_bf16 v[208:223], a[104:107], a[248:251], v[208:223]
  v_permlane32_swap_b32 v10, v11
  v_max_f32 v10, v10, v11
  v_and_b32 v18, 0xffff0000, v10
  v_sub_f32 v19, v18, v10
  v_and_b32 v20, 0xffff0000, v19
  v_mfma_f32_32x32x16_bf16 v[208:223], a[68:71], a[252:255], v[208:223]
  v_sub_f32 v19, v19, v20
  v_xor_b32 v18, 0x80000000, v18
  v_lshrrev_b32 v15, 16, v19
  v_perm_b32 v14, v20, v18, s46
  ds_read_b64_tr_b16 a[164:165], v6 offset:1152
  ds_read_b64_tr_b16 a[166:167], v6 offset:1408
  s_waitcnt lgkmcnt(12)
  s_barrier
  v_mfma_f32_32x32x16_bf16 v[48:63], a[236:239], v[14:17], v[48:63]
  v_max_f32 v12, v192, v193
  v_max_f32 v13, v194, v195
  v_max3_f32 v12, v196, v197, v12
  v_max3_f32 v13, v198, v199, v13
  v_max3_f32 v12, v200, v201, v12
  v_mfma_f32_32x32x16_bf16 v[64:79], a[236:239], v[14:17], v[64:79]
  v_max3_f32 v13, v202, v203, v13
  v_max3_f32 v12, v204, v205, v12
  v_max3_f32 v13, v206, v207, v13
  s_nop 0
  v_exp_f32 v48, v48
  v_exp_f32 v49, v49
  s_waitcnt lgkmcnt(15)
  v_mfma_f32_32x32x16_bf16 v[224:239], a[76:79], a[248:251], 0
  v_max3_f32 v12, v208, v209, v12
  v_exp_f32 v50, v50
  v_cvt_pk_bf16_f32 v48, v48, v49
  v_exp_f32 v51, v51
  v_max3_f32 v13, v210, v211, v13
  v_exp_f32 v56, v56
  v_cvt_pk_bf16_f32 v49, v50, v51
  v_mfma_f32_32x32x16_bf16 v[224:239], a[40:43], a[252:255], v[224:239]
  v_exp_f32 v57, v57
  v_max3_f32 v12, v212, v213, v12
  v_exp_f32 v58, v58
  v_cvt_pk_bf16_f32 v50, v56, v57
  v_mfma_f32_32x32x16_bf16 v[80:95], a[236:239], v[14:17], v[80:95]
  v_exp_f32 v59, v59
  v_max3_f32 v13, v214, v215, v13
  v_exp_f32 v52, v52
  v_cvt_pk_bf16_f32 v51, v58, v59
  v_exp_f32 v53, v53
  v_max3_f32 v12, v216, v217, v12
  v_exp_f32 v54, v54
  v_cvt_pk_bf16_f32 v52, v52, v53
  s_waitcnt lgkmcnt(10)
  v_mfma_f32_32x32x16_bf16 v[32:47], a[144:147], v[48:51], 0
  ds_read_b64_tr_b16 a[168:169], v6 offset:1536
  ds_read_b64_tr_b16 a[170:171], v6 offset:1792
  v_exp_f32 v55, v55
  v_max3_f32 v13, v218, v219, v13
  v_exp_f32 v60, v60
  v_cvt_pk_bf16_f32 v53, v54, v55
  v_exp_f32 v61, v61
  s_waitcnt lgkmcnt(15)
  v_mfma_f32_32x32x16_bf16 v[240:255], a[80:83], a[248:251], 0
  v_max3_f32 v12, v220, v221, v12
  v_exp_f32 v62, v62
  v_cvt_pk_bf16_f32 v54, v60, v61
  v_exp_f32 v63, v63
  v_max3_f32 v13, v222, v223, v13
  v_exp_f32 v64, v64
  v_cvt_pk_bf16_f32 v55, v62, v63
  v_lshrrev_b32 v2, 2, v1
  v_exp_f32 v65, v65
  v_max3_f32 v12, v224, v225, v12
  v_exp_f32 v66, v66
  v_cvt_pk_bf16_f32 v64, v64, v65
  s_waitcnt lgkmcnt(10)
  v_mfma_f32_32x32x16_bf16 v[32:47], a[148:151], v[52:55], v[32:47]
  ds_read_b64_tr_b16 a[172:173], v6 offset:1664
  ds_read_b64_tr_b16 a[174:175], v6 offset:1920
  v_and_b32 v4, 3, v1
  v_exp_f32 v67, v67
  v_max3_f32 v13, v226, v227, v13
  v_exp_f32 v72, v72
  v_cvt_pk_bf16_f32 v65, v66, v67
  v_mfma_f32_32x32x16_bf16 v[240:255], a[44:47], a[252:255], v[240:255]
  v_exp_f32 v73, v73
  v_max3_f32 v12, v228, v229, v12
  v_exp_f32 v74, v74
  v_cvt_pk_bf16_f32 v66, v72, v73
  v_mfma_f32_32x32x16_bf16 v[96:111], a[236:239], v[14:17], v[96:111]
  v_mul_u32_u24 v26, 1152, v2
  v_exp_f32 v75, v75
  v_max3_f32 v13, v230, v231, v13
  v_exp_f32 v68, v68
  v_cvt_pk_bf16_f32 v67, v74, v75
  v_mul_u32_u24 v3, 192, v2
  v_exp_f32 v69, v69
  v_max3_f32 v12, v232, v233, v12
  v_exp_f32 v70, v70
  v_cvt_pk_bf16_f32 v68, v68, v69
  s_waitcnt lgkmcnt(10)
  v_mfma_f32_32x32x16_bf16 v[32:47], a[152:155], v[64:67], v[32:47]
  ds_read_b64_tr_b16 a[176:177], v6 offset:2048
  ds_read_b64_tr_b16 a[178:179], v6 offset:2304
  v_lshl_add_u32 v26, v4, 4, v26
  v_exp_f32 v71, v71
  v_max3_f32 v13, v234, v235, v13
  v_exp_f32 v76, v76
  v_cvt_pk_bf16_f32 v69, v70, v71
  v_exp_f32 v77, v77
  s_waitcnt lgkmcnt(15)
  v_mfma_f32_32x32x16_bf16 v[48:63], a[84:87], a[248:251], 0
  v_max3_f32 v12, v236, v237, v12
  v_exp_f32 v78, v78
  v_cvt_pk_bf16_f32 v70, v76, v77
  v_lshl_add_u32 v3, v4, 3, v3
  v_exp_f32 v79, v79
  v_max3_f32 v13, v238, v239, v13
  v_exp_f32 v80, v80
  v_cvt_pk_bf16_f32 v71, v78, v79
  v_and_b32 v11, 16, v1
  v_exp_f32 v81, v81
  v_max3_f32 v12, v240, v241, v12
  v_exp_f32 v82, v82
  v_cvt_pk_bf16_f32 v80, v80, v81
  s_waitcnt lgkmcnt(10)
  v_mfma_f32_32x32x16_bf16 v[32:47], a[156:159], v[68:71], v[32:47]
  ds_read_b64_tr_b16 a[180:181], v6 offset:2176
  ds_read_b64_tr_b16 a[182:183], v6 offset:2432
  v_add_u32 v3, 62464, v3
  v_exp_f32 v83, v83
  v_max3_f32 v13, v242, v243, v13
  v_exp_f32 v88, v88
  v_cvt_pk_bf16_f32 v81, v82, v83
  v_mfma_f32_32x32x16_bf16 v[48:63], a[48:51], a[252:255], v[48:63]
  v_exp_f32 v89, v89
  v_max3_f32 v12, v244, v245, v12
  v_exp_f32 v90, v90
  v_cvt_pk_bf16_f32 v82, v88, v89
  v_mfma_f32_32x32x16_bf16 v[112:127], a[236:239], v[14:17], v[112:127]
  v_lshlrev_b32 v11, 1, v11
  v_exp_f32 v91, v91
  v_max3_f32 v13, v246, v247, v13
  v_exp_f32 v84, v84
  v_cvt_pk_bf16_f32 v83, v90, v91
  v_lshrrev_b32 v10, 4, v1
  v_exp_f32 v85, v85
  v_max3_f32 v12, v248, v249, v12
  v_exp_f32 v86, v86
  v_cvt_pk_bf16_f32 v84, v84, v85
  s_waitcnt lgkmcnt(10)
  v_mfma_f32_32x32x16_bf16 v[32:47], a[160:163], v[80:83], v[32:47]
  ds_read_b64_tr_b16 a[184:185], v6 offset:2560
  ds_read_b64_tr_b16 a[186:187], v6 offset:2816
  v_sub_u32 v4, v3, v11
  v_exp_f32 v87, v87
  v_max3_f32 v13, v250, v251, v13
  v_exp_f32 v92, v92
  v_cvt_pk_bf16_f32 v85, v86, v87
  v_exp_f32 v93, v93
  s_waitcnt lgkmcnt(15)
  v_mfma_f32_32x32x16_bf16 v[64:79], a[88:91], a[248:251], 0
  v_max3_f32 v12, v252, v253, v12
  v_exp_f32 v94, v94
  v_cvt_pk_bf16_f32 v86, v92, v93
k1_kernel_w6:
  s_cbranch_execz k1_kernel_w10
  v_add_u32 v3, v3, v11
  v_exp_f32 v95, v95
  v_max3_f32 v13, v254, v255, v13
  v_exp_f32 v96, v96
  v_cvt_pk_bf16_f32 v87, v94, v95
  s_add_u32 s44, s36, 31040
  v_exp_f32 v97, v97
  v_max3_f32 v12, v48, v49, v12
  v_exp_f32 v98, v98
  v_cvt_pk_bf16_f32 v96, v96, v97
  s_waitcnt lgkmcnt(10)
  v_mfma_f32_32x32x16_bf16 v[32:47], a[164:167], v[84:87], v[32:47]
  ds_read_b64_tr_b16 a[188:189], v6 offset:2688
  ds_read_b64_tr_b16 a[190:191], v6 offset:2944
  v_and_b32 v11, 15, v1
  v_exp_f32 v99, v99
  v_max3_f32 v13, v50, v51, v13
  v_exp_f32 v104, v104
  v_cvt_pk_bf16_f32 v97, v98, v99
  v_mfma_f32_32x32x16_bf16 v[64:79], a[52:55], a[252:255], v[64:79]
  v_exp_f32 v105, v105
  v_max3_f32 v12, v52, v53, v12
  v_exp_f32 v106, v106
  v_cvt_pk_bf16_f32 v98, v104, v105
  v_mfma_f32_32x32x16_bf16 v[128:143], a[236:239], v[14:17], v[128:143]
  v_lshl_add_u32 v31, v10, 3, s44
  v_exp_f32 v107, v107
  v_max3_f32 v13, v54, v55, v13
  v_exp_f32 v100, v100
  v_cvt_pk_bf16_f32 v99, v106, v107
  v_lshl_add_u32 v31, v11, 6, v31
  v_exp_f32 v101, v101
  v_max3_f32 v12, v56, v57, v12
  v_exp_f32 v102, v102
  v_cvt_pk_bf16_f32 v100, v100, v101
  s_waitcnt lgkmcnt(10)
  v_mfma_f32_32x32x16_bf16 v[32:47], a[168:171], v[96:99], v[32:47]
  ds_read_b64_tr_b16 a[192:193], v6 offset:3072
  ds_read_b64_tr_b16 a[194:195], v6 offset:3328
  v_lshlrev_b32 v11, 2, v11
  v_exp_f32 v103, v103
  v_max3_f32 v13, v58, v59, v13
  v_exp_f32 v108, v108
  v_cvt_pk_bf16_f32 v101, v102, v103
  v_exp_f32 v109, v109
  s_waitcnt lgkmcnt(15)
  v_mfma_f32_32x32x16_bf16 v[80:95], a[92:95], a[248:251], 0
  v_max3_f32 v12, v60, v61, v12
  v_exp_f32 v110, v110
  v_cvt_pk_bf16_f32 v102, v108, v109
  v_lshl_add_u32 v10, v10, 9, v11
  v_exp_f32 v111, v111
  v_max3_f32 v13, v62, v63, v13
  v_exp_f32 v112, v112
  v_cvt_pk_bf16_f32 v103, v110, v111
  v_lshlrev_b32 v2, 4, v1
  v_exp_f32 v113, v113
  v_max3_f32 v12, v64, v65, v12
  v_exp_f32 v114, v114
  v_cvt_pk_bf16_f32 v112, v112, v113
  s_waitcnt lgkmcnt(10)
  v_mfma_f32_32x32x16_bf16 v[32:47], a[172:175], v[100:103], v[32:47]
  ds_read_b64_tr_b16 a[196:197], v6 offset:3200
  ds_read_b64_tr_b16 a[198:199], v6 offset:3456
  s_mul_i32 s28, s38, 18432
  s_mul_i32 s41, s37, 192
  v_exp_f32 v115, v115
  v_max3_f32 v13, v66, v67, v13
  v_exp_f32 v120, v120
  v_cvt_pk_bf16_f32 v113, v114, v115
  v_mfma_f32_32x32x16_bf16 v[80:95], a[56:59], a[252:255], v[80:95]
  v_exp_f32 v121, v121
  v_max3_f32 v12, v68, v69, v12
  v_exp_f32 v122, v122
  v_cvt_pk_bf16_f32 v114, v120, v121
  v_mfma_f32_32x32x16_bf16 v[144:159], a[236:239], v[14:17], v[144:159]
  s_add_u32 s28, s28, s41
  s_lshr_b32 s45, s38, 1
  v_exp_f32 v123, v123
  v_max3_f32 v13, v70, v71, v13
  v_exp_f32 v116, v116
  v_cvt_pk_bf16_f32 v115, v122, v123
  s_lshl_b32 s42, s45, 8
  s_add_u32 s42, s42, 18546688
  v_exp_f32 v117, v117
  v_max3_f32 v12, v72, v73, v12
  v_exp_f32 v118, v118
  v_cvt_pk_bf16_f32 v116, v116, v117
  s_waitcnt lgkmcnt(10)
  v_mfma_f32_32x32x16_bf16 v[32:47], a[176:179], v[112:115], v[32:47]
  ds_read_b64_tr_b16 a[200:201], v6 offset:3584
  ds_read_b64_tr_b16 a[202:203], v6 offset:3840
  s_lshl_b32 s45, s45, 12
  s_and_b32 s41, s38, 1
  v_exp_f32 v119, v119
  v_max3_f32 v13, v74, v75, v13
  v_exp_f32 v124, v124
  v_cvt_pk_bf16_f32 v117, v118, v119
  v_exp_f32 v125, v125
  s_waitcnt lgkmcnt(15)
  v_mfma_f32_32x32x16_bf16 v[96:111], a[96:99], a[248:251], 0
  v_max3_f32 v12, v76, v77, v12
  v_exp_f32 v126, v126
  v_cvt_pk_bf16_f32 v118, v124, v125
  s_lshl_b32 s41, s41, 6
  s_add_u32 s45, s45, s41
  v_exp_f32 v127, v127
  v_max3_f32 v13, v78, v79, v13
  v_exp_f32 v128, v128
  v_cvt_pk_bf16_f32 v119, v126, v127
  s_add_u32 s45, s45, 17563648
  s_lshr_b32 s43, s38, 2
  v_exp_f32 v129, v129
  v_max3_f32 v12, v80, v81, v12
  v_exp_f32 v130, v130
  v_cvt_pk_bf16_f32 v128, v128, v129
  s_waitcnt lgkmcnt(10)
  v_mfma_f32_32x32x16_bf16 v[32:47], a[180:183], v[116:119], v[32:47]
  ds_read_b64_tr_b16 a[204:205], v6 offset:3712
  ds_read_b64_tr_b16 a[206:207], v6 offset:3968
  s_mul_i32 s43, s43, 73728
  s_lshl_b32 s41, s24, 10
  v_exp_f32 v131, v131
  v_max3_f32 v13, v82, v83, v13
  v_exp_f32 v136, v136
  v_cvt_pk_bf16_f32 v129, v130, v131
  v_mfma_f32_32x32x16_bf16 v[96:111], a[60:63], a[252:255], v[96:111]
  v_exp_f32 v137, v137
  v_max3_f32 v12, v84, v85, v12
  v_exp_f32 v138, v138
  v_cvt_pk_bf16_f32 v130, v136, v137
  v_mfma_f32_32x32x16_bf16 v[160:175], a[236:239], v[14:17], v[160:175]
  s_add_u32 s43, s43, s41
  s_add_u32 s40, s43, 8388608
  v_exp_f32 v139, v139
  v_max3_f32 v13, v86, v87, v13
  v_exp_f32 v132, v132
  v_cvt_pk_bf16_f32 v131, v138, v139
  s_mov_b32 m0, s39
  s_mov_b32 s27, 17039360
  v_lshlrev_b32 v28, 4, v1
  s_mov_b64 s[12:13], s[8:9]
  s_and_b32 s41, s38, 7
  v_exp_f32 v133, v133
  v_max3_f32 v12, v88, v89, v12
  buffer_load_dwordx4 v23, s[8:11], s27 offen lds
  v_exp_f32 v134, v134
  v_cvt_pk_bf16_f32 v132, v132, v133
  s_waitcnt lgkmcnt(10)
  v_mfma_f32_32x32x16_bf16 v[32:47], a[184:187], v[128:131], v[32:47]
  ds_read_b64_tr_b16 a[208:209], v6 offset:4096
  ds_read_b64_tr_b16 a[210:211], v6 offset:4352
  s_lshl_b32 s41, s41, 6
  s_add_u32 s41, s41, 154624
  v_exp_f32 v135, v135
  v_max3_f32 v13, v90, v91, v13
  s_mov_b32 m0, 152576
  s_mov_b32 s27, 17043456
  v_exp_f32 v140, v140
  v_cvt_pk_bf16_f32 v133, v134, v135
  buffer_load_dwordx4 v28, s[8:11], s27 offen lds
  v_exp_f32 v141, v141
  s_waitcnt lgkmcnt(15)
  v_mfma_f32_32x32x16_bf16 v[112:127], a[100:103], a[248:251], 0
  v_max3_f32 v12, v92, v93, v12
k1_kernel_w7:
  s_cbranch_execz k1_kernel_w11
  v_exp_f32 v142, v142
  v_cvt_pk_bf16_f32 v134, v140, v141
  s_cmp_lt_u32 s37, 6
  s_cselect_b32 s34, s34, 0
  s_cselect_b32 s42, s42, s89
  v_exp_f32 v143, v143
  v_max3_f32 v13, v94, v95, v13
  v_exp_f32 v144, v144
  v_cvt_pk_bf16_f32 v135, v142, v143
  s_add_u32 m0, s36, 62464
  v_exp_f32 v145, v145
  v_max3_f32 v12, v96, v97, v12
  buffer_load_dwordx4 v0, s[16:19], s30 offen lds
  v_exp_f32 v146, v146
  v_cvt_pk_bf16_f32 v144, v144, v145
  s_waitcnt lgkmcnt(10)
  v_mfma_f32_32x32x16_bf16 v[32:47], a[188:191], v[132:135], v[32:47]
  ds_read_b64_tr_b16 a[212:213], v6 offset:4224
  ds_read_b64_tr_b16 a[214:215], v6 offset:4480
  v_exp_f32 v147, v147
  v_max3_f32 v13, v98, v99, v13
  v_exp_f32 v152, v152
  v_cvt_pk_bf16_f32 v145, v146, v147
  v_mfma_f32_32x32x16_bf16 v[112:127], a[64:67], a[252:255], v[112:127]
  s_add_u32 m0, s36, 63488
  v_exp_f32 v153, v153
  v_max3_f32 v12, v100, v101, v12
  buffer_load_dwordx4 v5, s[16:19], s30 offen lds
  v_exp_f32 v154, v154
  v_cvt_pk_bf16_f32 v146, v152, v153
  v_mfma_f32_32x32x16_bf16 v[176:191], a[236:239], v[14:17], v[176:191]
  v_exp_f32 v155, v155
  v_max3_f32 v13, v102, v103, v13
  v_exp_f32 v148, v148
  v_cvt_pk_bf16_f32 v147, v154, v155
  s_add_u32 m0, s36, 64512
  v_exp_f32 v149, v149
  v_max3_f32 v12, v104, v105, v12
  buffer_load_dwordx4 v22, s[16:19], s30 offen lds
  v_exp_f32 v150, v150
  v_cvt_pk_bf16_f32 v148, v148, v149
  s_waitcnt lgkmcnt(10)
  v_mfma_f32_32x32x16_bf16 v[32:47], a[192:195], v[144:147], v[32:47]
  ds_read_b64_tr_b16 a[216:217], v7 offset:0
  ds_read_b64_tr_b16 a[218:219], v7 offset:256
  v_exp_f32 v151, v151
  v_max3_f32 v13, v106, v107, v13
  v_exp_f32 v156, v156
  v_cvt_pk_bf16_f32 v149, v150, v151
  v_exp_f32 v157, v157
  v_max3_f32 v12, v108, v109, v12
  v_exp_f32 v158, v158
  v_cvt_pk_bf16_f32 v150, v156, v157
  v_exp_f32 v159, v159
  v_max3_f32 v13, v110, v111, v13
  v_exp_f32 v160, v160
  v_cvt_pk_bf16_f32 v151, v158, v159
  s_add_u32 m0, s36, 74752
  s_add_u32 s30, s30, 82944
  s_sub_u32 s90, s30, 663552
  s_cselect_b32 s30, s30, s90
  v_exp_f32 v161, v161
  v_max3_f32 v12, v112, v113, v12
  buffer_load_dwordx4 v0, s[16:19], s30 offen lds
  v_exp_f32 v162, v162
  v_cvt_pk_bf16_f32 v160, v160, v161
  s_waitcnt lgkmcnt(10)
  v_mfma_f32_32x32x16_bf16 v[32:47], a[196:199], v[148:151], v[32:47]
  ds_read_b64_tr_b16 a[220:221], v7 offset:128
  ds_read_b64_tr_b16 a[222:223], v7 offset:384
  v_exp_f32 v163, v163
  v_max3_f32 v13, v114, v115, v13
  v_exp_f32 v168, v168
  v_cvt_pk_bf16_f32 v161, v162, v163
  s_add_u32 m0, s36, 75776
  v_exp_f32 v169, v169
  v_max3_f32 v12, v116, v117, v12
  buffer_load_dwordx4 v5, s[16:19], s30 offen lds
  v_exp_f32 v170, v170
  v_cvt_pk_bf16_f32 v162, v168, v169
  v_exp_f32 v171, v171
  v_max3_f32 v13, v118, v119, v13
  v_exp_f32 v164, v164
  v_cvt_pk_bf16_f32 v163, v170, v171
  s_add_u32 m0, s36, 76800
  v_exp_f32 v165, v165
  v_max3_f32 v12, v120, v121, v12
  buffer_load_dwordx4 v22, s[16:19], s30 offen lds
  v_exp_f32 v166, v166
  v_cvt_pk_bf16_f32 v164, v164, v165
  s_waitcnt lgkmcnt(10)
  v_mfma_f32_32x32x16_bf16 v[32:47], a[200:203], v[160:163], v[32:47]
  ds_read_b64_tr_b16 a[144:145], v7 offset:512
  ds_read_b64_tr_b16 a[146:147], v7 offset:768
  v_exp_f32 v167, v167
  v_max3_f32 v13, v122, v123, v13
  v_exp_f32 v172, v172
  v_cvt_pk_bf16_f32 v165, v166, v167
  v_exp_f32 v173, v173
  v_max3_f32 v12, v124, v125, v12
  v_exp_f32 v174, v174
  v_cvt_pk_bf16_f32 v166, v172, v173
  v_exp_f32 v175, v175
  v_max3_f32 v13, v126, v127, v13
  v_exp_f32 v176, v176
  v_cvt_pk_bf16_f32 v167, v174, v175
  v_max_f32 v12, v12, v13
  v_mov_b32 v13, v12
  s_add_u32 m0, s36, 87040
  s_add_u32 s30, s30, 82944
  s_sub_u32 s90, s30, 663552
  s_cselect_b32 s30, s30, s90
  v_exp_f32 v177, v177
  buffer_load_dwordx4 v0, s[16:19], s30 offen lds
  v_exp_f32 v178, v178
  v_cvt_pk_bf16_f32 v176, v176, v177
  s_waitcnt lgkmcnt(10)
  v_mfma_f32_32x32x16_bf16 v[32:47], a[204:207], v[164:167], v[32:47]
  ds_read_b64_tr_b16 a[148:149], v7 offset:640
  ds_read_b64_tr_b16 a[150:151], v7 offset:896
  v_permlane32_swap_b32 v12, v13
  v_exp_f32 v179, v179
  v_max_f32 v12, v12, v13
  v_and_b32 v18, 0xffff0000, v12
  v_exp_f32 v184, v184
  v_cvt_pk_bf16_f32 v177, v178, v179
  v_sub_f32 v19, v18, v12
  s_add_u32 m0, s36, 88064
  v_exp_f32 v185, v185
  v_and_b32 v20, 0xffff0000, v19
  v_sub_f32 v19, v19, v20
  buffer_load_dwordx4 v5, s[16:19], s30 offen lds
  v_exp_f32 v186, v186
  v_cvt_pk_bf16_f32 v178, v184, v185
  v_xor_b32 v18, 0x80000000, v18
  v_exp_f32 v187, v187
  v_lshrrev_b32 v15, 16, v19
  v_perm_b32 v14, v20, v18, s46
  v_exp_f32 v180, v180
  v_cvt_pk_bf16_f32 v179, v186, v187
  v_mfma_f32_32x32x16_bf16 v[192:207], a[236:239], v[14:17], v[192:207]
  s_add_u32 m0, s36, 89088
  v_exp_f32 v181, v181
  buffer_load_dwordx4 v22, s[16:19], s30 offen lds
  v_exp_f32 v182, v182
  v_cvt_pk_bf16_f32 v180, v180, v181
  s_waitcnt lgkmcnt(10)
  v_mfma_f32_32x32x16_bf16 v[32:47], a[208:211], v[176:179], v[32:47]
  ds_read_b64_tr_b16 a[152:153], v7 offset:1024
  ds_read_b64_tr_b16 a[154:155], v7 offset:1280
  v_exp_f32 v183, v183
  v_exp_f32 v188, v188
  v_cvt_pk_bf16_f32 v181, v182, v183
  v_exp_f32 v189, v189
  v_mfma_f32_32x32x16_bf16 v[224:239], a[236:239], v[14:17], v[224:239]
  v_exp_f32 v190, v190
  v_cvt_pk_bf16_f32 v182, v188, v189
  v_exp_f32 v191, v191
  v_exp_f32 v192, v192
  v_cvt_pk_bf16_f32 v183, v190, v191
  s_add_u32 m0, s36, 99328
  s_add_u32 s30, s30, 82944
k1_kernel_w8:
  s_cbranch_execz k1_kernel_w12
  s_sub_u32 s90, s30, 663552
  s_cselect_b32 s30, s30, s90
  v_exp_f32 v193, v193
  buffer_load_dwordx4 v0, s[16:19], s30 offen lds
  v_exp_f32 v194, v194
  v_cvt_pk_bf16_f32 v192, v192, v193
  s_waitcnt lgkmcnt(10)
  v_mfma_f32_32x32x16_bf16 v[32:47], a[212:215], v[180:183], v[32:47]
  ds_read_b64_tr_b16 a[156:157], v7 offset:1152
  ds_read_b64_tr_b16 a[158:159], v7 offset:1408
  v_exp_f32 v195, v195
  v_exp_f32 v200, v200
  v_cvt_pk_bf16_f32 v193, v194, v195
  s_add_u32 m0, s36, 100352
  v_exp_f32 v201, v201
  buffer_load_dwordx4 v5, s[16:19], s30 offen lds
  v_exp_f32 v202, v202
  v_cvt_pk_bf16_f32 v194, v200, v201
  v_mfma_f32_32x32x16_bf16 v[240:255], a[236:239], v[14:17], v[240:255]
  v_exp_f32 v203, v203
  v_exp_f32 v196, v196
  v_cvt_pk_bf16_f32 v195, v202, v203
  s_add_u32 m0, s36, 101376
  v_rcp_f32 v21, v44
  v_exp_f32 v197, v197
  buffer_load_dwordx4 v22, s[16:19], s30 offen lds
  v_mul_f32 v32, v32, v21
  v_exp_f32 v198, v198
  v_cvt_pk_bf16_f32 v196, v196, v197
  s_waitcnt lgkmcnt(10)
  v_mfma_f32_32x32x16_bf16 v[128:143], a[216:219], v[192:195], 0
  ds_read_b64_tr_b16 a[160:161], v7 offset:1536
  ds_read_b64_tr_b16 a[162:163], v7 offset:1792
  v_mul_f32 v33, v33, v21
  v_exp_f32 v199, v199
  v_mul_f32 v34, v34, v21
  v_exp_f32 v204, v204
  v_cvt_pk_bf16_f32 v197, v198, v199
  v_mul_f32 v35, v35, v21
  v_exp_f32 v205, v205
  v_mul_f32 v36, v36, v21
  v_exp_f32 v206, v206
  v_cvt_pk_bf16_f32 v198, v204, v205
  v_mul_f32 v37, v37, v21
  v_exp_f32 v207, v207
  v_mul_f32 v38, v38, v21
  v_exp_f32 v224, v224
  v_cvt_pk_bf16_f32 v199, v206, v207
  s_add_u32 m0, s36, 111616
  s_add_u32 s30, s30, 82944
  s_sub_u32 s90, s30, 663552
  s_cselect_b32 s30, s30, s90
  v_mul_f32 v39, v39, v21
  v_exp_f32 v225, v225
  buffer_load_dwordx4 v0, s[16:19], s30 offen lds
  v_mul_f32 v40, v40, v21
  v_exp_f32 v226, v226
  v_cvt_pk_bf16_f32 v224, v224, v225
  s_waitcnt lgkmcnt(10)
  v_mfma_f32_32x32x16_bf16 v[128:143], a[220:223], v[196:199], v[128:143]
  ds_read_b64_tr_b16 a[164:165], v7 offset:1664
  ds_read_b64_tr_b16 a[166:167], v7 offset:1920
  v_mul_f32 v41, v41, v21
  v_exp_f32 v227, v227
  v_cvt_pk_bf16_f32 v32, v32, v33
  v_exp_f32 v232, v232
  v_cvt_pk_bf16_f32 v225, v226, v227
  s_add_u32 m0, s36, 112640
  v_cvt_pk_bf16_f32 v33, v34, v35
  v_exp_f32 v233, v233
  buffer_load_dwordx4 v5, s[16:19], s30 offen lds
  v_cvt_pk_bf16_f32 v34, v36, v37
  v_exp_f32 v234, v234
  v_cvt_pk_bf16_f32 v226, v232, v233
  v_mfma_f32_32x32x16_bf16 v[48:63], a[236:239], v[14:17], v[48:63]
  v_cvt_pk_bf16_f32 v35, v38, v39
  v_exp_f32 v235, v235
  v_cvt_pk_bf16_f32 v36, v40, v41
  v_exp_f32 v228, v228
  v_cvt_pk_bf16_f32 v227, v234, v235
  s_add_u32 m0, s36, 113664
  buffer_store_dwordx4 v[32:35], v8, s[8:11], s87 offen offset:0 sc1
  v_exp_f32 v229, v229
  buffer_load_dwordx4 v22, s[16:19], s30 offen lds
  s_add_u32 s87, s87, 4096
  v_exp_f32 v230, v230
  v_cvt_pk_bf16_f32 v228, v228, v229
  s_waitcnt lgkmcnt(10)
  v_mfma_f32_32x32x16_bf16 v[128:143], a[144:147], v[224:227], v[128:143]
  ds_read_b64_tr_b16 a[168:169], v7 offset:2048
  ds_read_b64_tr_b16 a[170:171], v7 offset:2304
  s_mov_b32 exec_hi, 0
  buffer_store_dword v36, v9, s[8:11], s88 offen offset:0 sc1
  s_mov_b32 exec_hi, -1
  v_exp_f32 v231, v231
  v_exp_f32 v236, v236
  v_cvt_pk_bf16_f32 v229, v230, v231
  v_exp_f32 v237, v237
  v_exp_f32 v238, v238
  v_cvt_pk_bf16_f32 v230, v236, v237
  v_exp_f32 v239, v239
  v_exp_f32 v240, v240
  v_cvt_pk_bf16_f32 v231, v238, v239
  s_add_u32 m0, s36, 123904
  s_add_u32 s30, s30, 82944
  s_sub_u32 s90, s30, 663552
  s_cselect_b32 s30, s30, s90
  v_exp_f32 v241, v241
  buffer_load_dwordx4 v0, s[16:19], s30 offen lds
  v_exp_f32 v242, v242
  v_cvt_pk_bf16_f32 v240, v240, v241
  s_waitcnt lgkmcnt(10)
  v_mfma_f32_32x32x16_bf16 v[128:143], a[148:151], v[228:231], v[128:143]
  ds_read_b64_tr_b16 a[172:173], v7 offset:2176
  ds_read_b64_tr_b16 a[174:175], v7 offset:2432
  v_exp_f32 v243, v243
  v_lshl_add_u32 v144, v1, 4, s39
  v_lshlrev_b32 v148, 3, v1
  v_add_u32 v148, 152576, v148
  v_exp_f32 v248, v248
  v_cvt_pk_bf16_f32 v241, v242, v243
  s_add_u32 m0, s36, 124928
  v_exp_f32 v249, v249
  s_waitcnt vmcnt(18)
  ds_read_b128 v[144:147], v144
  ds_read_b64 v[148:149], v148
  buffer_load_dwordx4 v5, s[16:19], s30 offen lds
  v_exp_f32 v250, v250
  v_cvt_pk_bf16_f32 v242, v248, v249
  v_mfma_f32_32x32x16_bf16 v[64:79], a[236:239], v[14:17], v[64:79]
  v_exp_f32 v251, v251
  v_exp_f32 v244, v244
  v_cvt_pk_bf16_f32 v243, v250, v251
  s_add_u32 m0, s36, 125952
  v_exp_f32 v245, v245
  buffer_load_dwordx4 v22, s[16:19], s30 offen lds
  v_exp_f32 v246, v246
  v_cvt_pk_bf16_f32 v244, v244, v245
  s_waitcnt lgkmcnt(12)
  v_mfma_f32_32x32x16_bf16 v[128:143], a[152:155], v[240:243], v[128:143]
  ds_read_b64_tr_b16 a[176:177], v7 offset:2560
  ds_read_b64_tr_b16 a[178:179], v7 offset:2816
  v_exp_f32 v247, v247
  v_exp_f32 v252, v252
  v_cvt_pk_bf16_f32 v245, v246, v247
  v_exp_f32 v253, v253
  v_exp_f32 v254, v254
  v_cvt_pk_bf16_f32 v246, v252, v253
  v_exp_f32 v255, v255
  s_waitcnt lgkmcnt(2)
  v_and_b32 v145, v145, v147
  v_and_b32 v145, v145, v149
  v_cmp_ne_u32 vcc, 1.0, v145
  s_cbranch_vccz k1_kernel_bkr
k1_kernel_slr:
  s_sleep 1
  s_mov_b32 m0, s39
  s_mov_b32 s27, 17039360
  v_lshlrev_b32 v28, 4, v1
  buffer_load_dwordx4 v23, s[8:11], s27 offen sc1 lds
  s_mov_b32 m0, 152576
  s_mov_b32 s27, 17043456
  buffer_load_dwordx4 v28, s[8:11], s27 offen sc1 lds
  v_lshl_add_u32 v144, v1, 4, s39
  v_lshlrev_b32 v148, 3, v1
  v_add_u32 v148, 152576, v148
  s_waitcnt vmcnt(0)
  ds_read_b128 v[144:147], v144
  ds_read_b64 v[148:149], v148
k1_kernel_w9:
  s_cbranch_execz k1_kernel_w13
  s_waitcnt lgkmcnt(0)
  s_sub_u32 s86, s86, 1
  s_max_i32 s86, s86, 0
  s_waitcnt vmcnt(0)
  s_cbranch_scc0 k1_kernel_bkr
  v_and_b32 v145, v145, v147
  v_and_b32 v145, v145, v149
  v_cmp_ne_u32 vcc, 1.0, v145
  s_cbranch_vccnz k1_kernel_slr
k1_kernel_bkr:
  v_exp_f32 v48, v48
  v_cvt_pk_bf16_f32 v247, v254, v255
  s_add_u32 m0, s36, 136192
  s_add_u32 s30, s30, 82944
  s_sub_u32 s90, s30, 663552
  s_cselect_b32 s30, s30, s90
  v_exp_f32 v49, v49
  buffer_load_dwordx4 v0, s[16:19], s30 offen lds
  v_exp_f32 v50, v50
  v_cvt_pk_bf16_f32 v48, v48, v49
  s_waitcnt lgkmcnt(12)
  v_mfma_f32_32x32x16_bf16 v[128:143], a[156:159], v[244:247], v[128:143]
  ds_read_b64_tr_b16 a[180:181], v7 offset:2688
  ds_read_b64_tr_b16 a[182:183], v7 offset:2944
  v_exp_f32 v51, v51
  v_exp_f32 v56, v56
  v_cvt_pk_bf16_f32 v49, v50, v51
  s_add_u32 m0, s36, 137216
  v_exp_f32 v57, v57
  buffer_load_dwordx4 v5, s[16:19], s30 offen lds
  v_exp_f32 v58, v58
  v_cvt_pk_bf16_f32 v50, v56, v57
  v_mfma_f32_32x32x16_bf16 v[80:95], a[236:239], v[14:17], v[80:95]
  v_exp_f32 v59, v59
  v_exp_f32 v52, v52
  v_cvt_pk_bf16_f32 v51, v58, v59
  s_add_u32 m0, s36, 138240
  v_exp_f32 v53, v53
  buffer_load_dwordx4 v22, s[16:19], s30 offen lds
  v_exp_f32 v54, v54
  v_cvt_pk_bf16_f32 v52, v52, v53
  s_waitcnt lgkmcnt(12)
  v_mfma_f32_32x32x16_bf16 v[128:143], a[160:163], v[48:51], v[128:143]
  ds_read_b64_tr_b16 a[184:185], v7 offset:3072
  ds_read_b64_tr_b16 a[186:187], v7 offset:3328
  v_exp_f32 v55, v55
  v_exp_f32 v60, v60
  v_cvt_pk_bf16_f32 v53, v54, v55
  v_exp_f32 v61, v61
  v_exp_f32 v62, v62
  v_cvt_pk_bf16_f32 v54, v60, v61
  v_exp_f32 v63, v63
  v_exp_f32 v64, v64
  v_cvt_pk_bf16_f32 v55, v62, v63
  s_add_u32 m0, s36, 0
  s_add_u32 s30, s30, 82944
  s_sub_u32 s90, s30, 663552
  s_cselect_b32 s30, s30, s90
  v_exp_f32 v65, v65
  buffer_load_dwordx4 v0, s[16:19], s30 offen lds
  v_exp_f32 v66, v66
  v_cvt_pk_bf16_f32 v64, v64, v65
  s_waitcnt lgkmcnt(12)
  v_mfma_f32_32x32x16_bf16 v[128:143], a[164:167], v[52:55], v[128:143]
  ds_read_b64_tr_b16 a[188:189], v7 offset:3200
  ds_read_b64_tr_b16 a[190:191], v7 offset:3456
  v_exp_f32 v67, v67
  v_exp_f32 v72, v72
  v_cvt_pk_bf16_f32 v65, v66, v67
  s_add_u32 m0, s36, 1024
  v_exp_f32 v73, v73
  buffer_load_dwordx4 v5, s[16:19], s30 offen lds
  v_exp_f32 v74, v74
  v_cvt_pk_bf16_f32 v66, v72, v73
  v_mfma_f32_32x32x16_bf16 v[96:111], a[236:239], v[14:17], v[96:111]
  v_exp_f32 v75, v75
  v_exp_f32 v68, v68
  v_cvt_pk_bf16_f32 v67, v74, v75
  s_add_u32 m0, s36, 2048
  v_exp_f32 v69, v69
  buffer_load_dwordx4 v22, s[16:19], s30 offen lds
  v_exp_f32 v70, v70
  v_cvt_pk_bf16_f32 v68, v68, v69
  s_waitcnt lgkmcnt(12)
  v_mfma_f32_32x32x16_bf16 v[128:143], a[168:171], v[64:67], v[128:143]
  ds_read_b64_tr_b16 a[192:193], v7 offset:3584
  ds_read_b64_tr_b16 a[194:195], v7 offset:3840
  v_exp_f32 v71, v71
  s_waitcnt vmcnt(9)
  s_mov_b64 exec, 1
  buffer_store_dword v6, off, s[8:11], s47 offset:128 sc1
  s_mov_b64 exec, -1
  v_exp_f32 v76, v76
  v_cvt_pk_bf16_f32 v69, v70, v71
  v_exp_f32 v77, v77
  v_exp_f32 v78, v78
  v_cvt_pk_bf16_f32 v70, v76, v77
  v_exp_f32 v79, v79
  v_exp_f32 v80, v80
  v_cvt_pk_bf16_f32 v71, v78, v79
  s_add_u32 m0, s36, 12288
  v_accvgpr_read_b32 v0, a227
  v_exp_f32 v81, v81
  buffer_load_dwordx4 v0, s[16:19], s31 offen lds
  v_exp_f32 v82, v82
  v_cvt_pk_bf16_f32 v80, v80, v81
  s_waitcnt lgkmcnt(12)
  v_mfma_f32_32x32x16_bf16 v[128:143], a[172:175], v[68:71], v[128:143]
  ds_read_b64_tr_b16 a[196:197], v7 offset:3712
  ds_read_b64_tr_b16 a[198:199], v7 offset:3968
  v_exp_f32 v83, v83
  v_exp_f32 v88, v88
  v_cvt_pk_bf16_f32 v81, v82, v83
  s_add_u32 m0, s36, 13312
  v_accvgpr_read_b32 v5, a228
  v_exp_f32 v89, v89
  buffer_load_dwordx4 v5, s[16:19], s31 offen lds
  v_exp_f32 v90, v90
  v_cvt_pk_bf16_f32 v82, v88, v89
  v_mfma_f32_32x32x16_bf16 v[112:127], a[236:239], v[14:17], v[112:127]
  v_exp_f32 v91, v91
  v_exp_f32 v84, v84
  v_cvt_pk_bf16_f32 v83, v90, v91
  s_add_u32 m0, s36, 14336
  v_accvgpr_read_b32 v22, a229
  v_exp_f32 v85, v85
  buffer_load_dwordx4 v22, s[16:19], s31 offen lds
  v_exp_f32 v86, v86
  v_cvt_pk_bf16_f32 v84, v84, v85
  s_waitcnt lgkmcnt(10)
  v_mfma_f32_32x32x16_bf16 v[128:143], a[176:179], v[80:83], v[128:143]
  ds_read_b64_tr_b16 a[200:201], v7 offset:4096
  ds_read_b64_tr_b16 a[202:203], v7 offset:4352
  v_exp_f32 v87, v87
  v_exp_f32 v92, v92
  v_cvt_pk_bf16_f32 v85, v86, v87
  v_exp_f32 v93, v93
  v_exp_f32 v94, v94
  v_cvt_pk_bf16_f32 v86, v92, v93
  v_exp_f32 v95, v95
  v_exp_f32 v96, v96
  v_cvt_pk_bf16_f32 v87, v94, v95
  v_exp_f32 v97, v97
  v_exp_f32 v98, v98
  v_cvt_pk_bf16_f32 v96, v96, v97
  s_waitcnt lgkmcnt(10)
  v_mfma_f32_32x32x16_bf16 v[128:143], a[180:183], v[84:87], v[128:143]
  ds_read_b64_tr_b16 a[204:205], v7 offset:4224
  ds_read_b64_tr_b16 a[206:207], v7 offset:4480
  v_exp_f32 v99, v99
  v_exp_f32 v104, v104
  v_cvt_pk_bf16_f32 v97, v98, v99
  v_exp_f32 v105, v105
  v_exp_f32 v106, v106
  v_cvt_pk_bf16_f32 v98, v104, v105
  v_mfma_f32_32x32x16_bf16 v[208:223], a[236:239], v[14:17], v[208:223]
  v_exp_f32 v107, v107
  v_exp_f32 v100, v100
  v_cvt_pk_bf16_f32 v99, v106, v107
  v_exp_f32 v101, v101
  v_exp_f32 v102, v102
  v_cvt_pk_bf16_f32 v100, v100, v101
  s_waitcnt lgkmcnt(10)
  v_mfma_f32_32x32x16_bf16 v[128:143], a[184:187], v[96:99], v[128:143]
  v_exp_f32 v103, v103
  v_exp_f32 v108, v108
  v_cvt_pk_bf16_f32 v101, v102, v103
  v_exp_f32 v109, v109
  v_exp_f32 v110, v110
  v_cvt_pk_bf16_f32 v102, v108, v109
  v_exp_f32 v111, v111
  v_exp_f32 v112, v112
k1_kernel_w10:
  s_cbranch_execz k1_kernel_w14
  v_cvt_pk_bf16_f32 v103, v110, v111
  v_exp_f32 v113, v113
  v_exp_f32 v114, v114
  v_cvt_pk_bf16_f32 v112, v112, v113
  s_waitcnt lgkmcnt(8)
  v_mfma_f32_32x32x16_bf16 v[128:143], a[188:191], v[100:103], v[128:143]
  v_exp_f32 v115, v115
  s_waitcnt vmcnt(36)
  buffer_store_dwordx4 a[108:111], v25, s[8:11], s48 offen sc1
  s_add_u32 s48, s48, 147456
  v_exp_f32 v120, v120
  v_cvt_pk_bf16_f32 v113, v114, v115
  v_exp_f32 v121, v121
  v_exp_f32 v122, v122
  v_cvt_pk_bf16_f32 v114, v120, v121
  v_exp_f32 v123, v123
  v_exp_f32 v116, v116
  v_cvt_pk_bf16_f32 v115, v122, v123
  v_exp_f32 v117, v117
  v_exp_f32 v118, v118
  v_cvt_pk_bf16_f32 v116, v116, v117
  s_waitcnt lgkmcnt(6)
  v_mfma_f32_32x32x16_bf16 v[128:143], a[192:195], v[112:115], v[128:143]
  v_exp_f32 v119, v119
  s_waitcnt vmcnt(36)
  buffer_store_dwordx4 a[112:115], v25, s[8:11], s48 offen sc1
  s_add_u32 s48, s48, 147456
  v_exp_f32 v124, v124
  v_cvt_pk_bf16_f32 v117, v118, v119
  v_exp_f32 v125, v125
  v_exp_f32 v126, v126
  v_cvt_pk_bf16_f32 v118, v124, v125
  v_exp_f32 v127, v127
  v_exp_f32 v208, v208
  v_cvt_pk_bf16_f32 v119, v126, v127
  v_exp_f32 v209, v209
  v_exp_f32 v210, v210
  v_cvt_pk_bf16_f32 v208, v208, v209
  s_waitcnt lgkmcnt(4)
  v_mfma_f32_32x32x16_bf16 v[128:143], a[196:199], v[116:119], v[128:143]
  v_exp_f32 v211, v211
  s_waitcnt vmcnt(36)
  buffer_store_dwordx4 a[116:119], v25, s[8:11], s48 offen sc1
  s_add_u32 s48, s48, 147456
  v_exp_f32 v216, v216
  v_cvt_pk_bf16_f32 v209, v210, v211
  v_exp_f32 v217, v217
  v_exp_f32 v218, v218
  v_cvt_pk_bf16_f32 v210, v216, v217
  v_exp_f32 v219, v219
  v_exp_f32 v212, v212
  v_cvt_pk_bf16_f32 v211, v218, v219
  v_exp_f32 v213, v213
  v_exp_f32 v214, v214
  v_cvt_pk_bf16_f32 v212, v212, v213
  s_waitcnt lgkmcnt(2)
  v_mfma_f32_32x32x16_bf16 v[128:143], a[200:203], v[208:211], v[128:143]
  v_exp_f32 v215, v215
  s_waitcnt vmcnt(36)
  buffer_store_dwordx4 a[120:123], v25, s[8:11], s48 offen sc1
  s_add_u32 s48, s48, 147456
  v_exp_f32 v220, v220
  v_cvt_pk_bf16_f32 v213, v214, v215
  v_exp_f32 v221, v221
  v_exp_f32 v222, v222
  v_cvt_pk_bf16_f32 v214, v220, v221
  v_exp_f32 v223, v223
  s_waitcnt vmcnt(4)
  s_barrier
  s_nop 0
  v_cvt_pk_bf16_f32 v215, v222, v223
  s_nop 1
  s_waitcnt lgkmcnt(0)
  v_mfma_f32_32x32x16_bf16 v[128:143], a[204:207], v[212:215], v[128:143]
  s_nop 7
  s_nop 3
  v_rcp_f32 v21, v140
  s_nop 0
  v_mul_f32 v128, v128, v21
  v_mul_f32 v129, v129, v21
  v_mul_f32 v130, v130, v21
  v_mul_f32 v131, v131, v21
  v_mul_f32 v132, v132, v21
  v_mul_f32 v133, v133, v21
  v_mul_f32 v134, v134, v21
  v_mul_f32 v135, v135, v21
  v_mul_f32 v138, v138, v21
  v_mul_f32 v139, v139, v21
  v_cvt_pk_bf16_f32 v128, v128, v129
  v_cvt_pk_bf16_f32 v129, v130, v131
  v_cvt_pk_bf16_f32 v130, v132, v133
  v_cvt_pk_bf16_f32 v131, v134, v135
  v_cvt_pk_bf16_f32 v132, v138, v139
  buffer_store_dwordx4 v[128:131], v8, s[8:11], s87 offen offset:0 sc1
  s_mov_b32 exec_hi, 0
  buffer_store_dword v132, v9, s[8:11], s88 offen offset:128 sc1
  s_mov_b32 exec_hi, -1
  s_cmp_ge_u32 s37, 6
  s_cbranch_scc1 k1_kernel_idle
  v_lshrrev_b32 v30, 2, v1
  v_add_u32 v12, s41, v11
  v_lshlrev_b32 v30, 3, v30
  v_add_u32 v30, 148480, v30
  ds_read_b32 v12, v12
  s_add_u32 m0, s44, 0
  s_nop 0
  buffer_load_dwordx4 v26, s[32:35], s28 offen offset:0 lds
  s_add_u32 m0, s44, 960
  s_nop 0
  buffer_load_dwordx4 v26, s[32:35], s28 offen offset:64 lds
  s_add_u32 m0, s44, 1920
  s_nop 0
  buffer_load_dwordx4 v26, s[32:35], s28 offen offset:128 lds
  s_lshl_b32 s91, s91, 13
  ds_read_b64_tr_b16 a[0:1], v3 offset:0
  ds_read_b64_tr_b16 a[2:3], v3 offset:3072
  ds_read_b64_tr_b16 a[4:5], v4 offset:32
  ds_read_b64_tr_b16 a[6:7], v4 offset:3104
  ds_read_b64_tr_b16 a[8:9], v3 offset:64
  ds_read_b64_tr_b16 a[10:11], v3 offset:3136
  ds_read_b64_tr_b16 a[12:13], v4 offset:96
  ds_read_b64_tr_b16 a[14:15], v4 offset:3168
  buffer_load_dword v13, v11, s[8:11], s42 offen offset:128 sc1
  ds_read_b64_tr_b16 a[16:17], v3 offset:128
  ds_read_b64_tr_b16 a[18:19], v3 offset:3200
  ds_read_b64_tr_b16 a[20:21], v4 offset:160
  ds_read_b64_tr_b16 a[22:23], v4 offset:3232
  ds_read_b64_tr_b16 a[24:25], v30 offset:0
  ds_read_b64_tr_b16 a[26:27], v30 offset:128
  ds_read_b64_tr_b16 a[28:29], v3 offset:12288
  ds_read_b64_tr_b16 a[30:31], v3 offset:15360
  ds_read_b64_tr_b16 a[32:33], v4 offset:12320
  ds_read_b64_tr_b16 a[34:35], v4 offset:15392
  ds_read_b64_tr_b16 a[124:125], v3 offset:12352
  ds_read_b64_tr_b16 a[126:127], v3 offset:15424
  ds_read_b64_tr_b16 a[128:129], v4 offset:12384
  ds_read_b64_tr_b16 a[130:131], v4 offset:15456
  ds_read_b64_tr_b16 a[132:133], v3 offset:12416
  ds_read_b64_tr_b16 a[134:135], v3 offset:15488
  ds_read_b64_tr_b16 a[136:137], v4 offset:12448
  ds_read_b64_tr_b16 a[138:139], v4 offset:15520
  ds_read_b64_tr_b16 a[140:141], v30 offset:512
  ds_read_b64_tr_b16 a[142:143], v30 offset:640
  ds_read_b64_tr_b16 a[36:37], v3 offset:24576
  ds_read_b64_tr_b16 a[38:39], v3 offset:27648
  ds_read_b64_tr_b16 a[40:41], v4 offset:24608
  ds_read_b64_tr_b16 a[42:43], v4 offset:27680
  ds_read_b64_tr_b16 a[44:45], v3 offset:24640
  ds_read_b64_tr_b16 a[46:47], v3 offset:27712
  ds_read_b64_tr_b16 a[48:49], v4 offset:24672
  ds_read_b64_tr_b16 a[50:51], v4 offset:27744
  ds_read_b64_tr_b16 a[52:53], v3 offset:24704
  ds_read_b64_tr_b16 a[54:55], v3 offset:27776
  ds_read_b64_tr_b16 a[56:57], v4 offset:24736
  ds_read_b64_tr_b16 a[58:59], v4 offset:27808
  ds_read_b64_tr_b16 a[60:61], v30 offset:1024
  ds_read_b64_tr_b16 a[62:63], v30 offset:1152
  ds_read_b64_tr_b16 a[64:65], v3 offset:36864
  ds_read_b64_tr_b16 a[66:67], v3 offset:39936
  ds_read_b64_tr_b16 a[68:69], v4 offset:36896
  ds_read_b64_tr_b16 a[70:71], v4 offset:39968
  ds_read_b64_tr_b16 a[72:73], v3 offset:36928
  ds_read_b64_tr_b16 a[74:75], v3 offset:40000
k1_kernel_w11:
  s_cbranch_execz k1_kernel_w15
  ds_read_b64_tr_b16 a[76:77], v4 offset:36960
  ds_read_b64_tr_b16 a[78:79], v4 offset:40032
  ds_read_b64_tr_b16 a[80:81], v3 offset:36992
  ds_read_b64_tr_b16 a[82:83], v3 offset:40064
  ds_read_b64_tr_b16 a[84:85], v4 offset:37024
  ds_read_b64_tr_b16 a[86:87], v4 offset:40096
  ds_read_b64_tr_b16 a[88:89], v30 offset:1536
  ds_read_b64_tr_b16 a[90:91], v30 offset:1664
  s_waitcnt vmcnt(4)
  s_mov_b64 exec, 1
  buffer_store_dword v30, off, s[8:11], s47 sc1
  s_mov_b64 exec, -1
  s_waitcnt vmcnt(2)
  ds_read_b64 v[60:61], v31 offset:0
  ds_read_b64 v[62:63], v31 offset:32
  ds_read_b64 v[64:65], v31 offset:1024
  ds_read_b64 v[66:67], v31 offset:1056
  ds_read_b64 v[68:69], v31 offset:2048
  ds_read_b64 v[70:71], v31 offset:2080
  ds_read_b64_tr_b16 a[92:93], v3 offset:49152
  ds_read_b64_tr_b16 a[94:95], v3 offset:52224
  s_waitcnt vmcnt(1)
  v_cmp_eq_u32 vcc, 0, v13
  s_cmp_eq_u64 vcc, 0
  s_cselect_b32 s14, s10, 0
  s_add_u32 s90, s40, s91
  buffer_load_dwordx4 v[176:179], v2, s[12:15], s90 offen
  s_add_u32 s91, s91, 8192
  s_and_b32 s91, s91, 0xffff
  ds_read_b64_tr_b16 a[96:97], v4 offset:49184
  ds_read_b64_tr_b16 a[98:99], v4 offset:52256
  ds_read_b64_tr_b16 a[100:101], v3 offset:49216
  ds_read_b64_tr_b16 a[102:103], v3 offset:52288
  s_add_u32 s90, s40, s91
  buffer_load_dwordx4 v[184:187], v2, s[12:15], s90 offen
  s_add_u32 s91, s91, 8192
  s_and_b32 s91, s91, 0xffff
  ds_read_b64_tr_b16 a[104:105], v4 offset:49248
  ds_read_b64_tr_b16 a[106:107], v4 offset:52320
  ds_read_b64_tr_b16 a[108:109], v3 offset:49280
  ds_read_b64_tr_b16 a[110:111], v3 offset:52352
  s_add_u32 s90, s40, s91
  buffer_load_dwordx4 v[192:195], v2, s[12:15], s90 offen
  s_add_u32 s91, s91, 8192
  s_and_b32 s91, s91, 0xffff
  ds_read_b64_tr_b16 a[112:113], v4 offset:49312
  ds_read_b64_tr_b16 a[114:115], v4 offset:52384
  ds_read_b64_tr_b16 a[116:117], v30 offset:2048
  ds_read_b64_tr_b16 a[118:119], v30 offset:2176
  s_add_u32 s90, s40, s91
  buffer_load_dwordx4 v[200:203], v2, s[12:15], s90 offen
  s_add_u32 s91, s91, 8192
  s_and_b32 s91, s91, 0xffff
  v_add_u32 v3, 61440, v3
  v_add_u32 v4, 61440, v4
  ds_read_b64_tr_b16 a[120:121], v3 offset:0
  ds_read_b64_tr_b16 a[122:123], v3 offset:3072
  s_waitcnt lgkmcnt(15)
  v_lshlrev_b32 v32, 16, v60
  ds_read_b64_tr_b16 a[144:145], v4 offset:32
  ds_read_b64_tr_b16 a[146:147], v4 offset:3104
  v_and_b32 v33, 0xffff0000, v60
  v_lshlrev_b32 v34, 16, v61
  s_add_u32 s90, s40, s91
  buffer_load_dwordx4 v[208:211], v2, s[12:15], s90 offen
  s_add_u32 s91, s91, 8192
  s_and_b32 s91, s91, 0xffff
  ds_read_b64_tr_b16 a[148:149], v3 offset:64
  ds_read_b64_tr_b16 a[150:151], v3 offset:3136
  v_and_b32 v35, 0xffff0000, v61
  v_lshlrev_b32 v36, 16, v62
  ds_read_b64_tr_b16 a[152:153], v4 offset:96
  ds_read_b64_tr_b16 a[154:155], v4 offset:3168
  v_and_b32 v37, 0xffff0000, v62
  v_lshlrev_b32 v38, 16, v63
  s_add_u32 s90, s40, s91
  buffer_load_dwordx4 v[216:219], v2, s[12:15], s90 offen
  s_add_u32 s91, s91, 8192
  s_and_b32 s91, s91, 0xffff
  ds_read_b64_tr_b16 a[156:157], v3 offset:128
  ds_read_b64_tr_b16 a[158:159], v3 offset:3200
  v_and_b32 v39, 0xffff0000, v63
  v_lshlrev_b32 v40, 16, v64
  ds_read_b64_tr_b16 a[160:161], v4 offset:160
  ds_read_b64_tr_b16 a[162:163], v4 offset:3232
  v_and_b32 v41, 0xffff0000, v64
  v_lshlrev_b32 v42, 16, v65
  s_add_u32 s90, s40, s91
  buffer_load_dwordx4 v[224:227], v2, s[12:15], s90 offen
  s_add_u32 s91, s91, 8192
  s_and_b32 s91, s91, 0xffff
  ds_read_b64_tr_b16 a[164:165], v30 offset:2560
  ds_read_b64_tr_b16 a[166:167], v30 offset:2688
  v_and_b32 v43, 0xffff0000, v65
  v_lshlrev_b32 v44, 16, v66
  ds_read_b64_tr_b16 a[168:169], v3 offset:12288
  ds_read_b64_tr_b16 a[170:171], v3 offset:15360
  v_and_b32 v45, 0xffff0000, v66
  v_lshlrev_b32 v46, 16, v67
  s_add_u32 s90, s40, s91
  buffer_load_dwordx4 v[232:235], v2, s[12:15], s90 offen
  s_add_u32 s91, s91, 8192
  s_and_b32 s91, s91, 0xffff
  ds_read_b64_tr_b16 a[172:173], v4 offset:12320
  ds_read_b64_tr_b16 a[174:175], v4 offset:15392
  v_and_b32 v47, 0xffff0000, v67
  v_lshlrev_b32 v48, 16, v68
  ds_read_b64_tr_b16 a[176:177], v3 offset:12352
  ds_read_b64_tr_b16 a[178:179], v3 offset:15424
  v_and_b32 v49, 0xffff0000, v68
  v_lshlrev_b32 v50, 16, v69
  buffer_load_dword v240, v10, s[12:15], s45 offen offset:0
  ds_read_b64_tr_b16 a[180:181], v4 offset:12384
  ds_read_b64_tr_b16 a[182:183], v4 offset:15456
  v_and_b32 v51, 0xffff0000, v69
  v_lshlrev_b32 v52, 16, v70
  ds_read_b64_tr_b16 a[184:185], v3 offset:12416
  ds_read_b64_tr_b16 a[186:187], v3 offset:15488
  v_and_b32 v53, 0xffff0000, v70
  v_lshlrev_b32 v54, 16, v71
  buffer_load_dword v241, v10, s[12:15], s45 offen offset:256
  ds_read_b64_tr_b16 a[188:189], v4 offset:12448
  ds_read_b64_tr_b16 a[190:191], v4 offset:15520
  v_and_b32 v55, 0xffff0000, v71
  s_mul_i32 s27, s37, 12288
  s_add_u32 s4, s43, s27
  ds_read_b64_tr_b16 a[192:193], v30 offset:3072
  ds_read_b64_tr_b16 a[194:195], v30 offset:3200
  s_add_u32 s4, s4, 12582912
  s_add_u32 s5, s4, 4096
  s_add_u32 s6, s4, 8192
  s_lshl_b32 s44, s38, 10
  buffer_load_dword v242, v10, s[12:15], s45 offen offset:2048
  v_add_u32 v3, -123904, v3
  v_add_u32 v4, -123904, v4
  ds_read_b64_tr_b16 a[196:197], v3 offset:0
  ds_read_b64_tr_b16 a[198:199], v3 offset:3072
  s_lshl_b32 s27, s37, 7
  s_add_u32 s44, s44, s27
  s_add_u32 s44, s44, 17301504
  v_lshlrev_b32 v18, 2, v1
  ds_read_b64_tr_b16 a[200:201], v4 offset:32
  ds_read_b64_tr_b16 a[202:203], v4 offset:3104
  s_lshl_b32 s46, s38, 6
  s_and_b32 s27, s38, 1
k1_kernel_w12:
  s_cbranch_execz k1_kernel_wr
  s_lshl_b32 s27, s27, 5
  s_sub_u32 s46, s46, s27
  buffer_load_dword v243, v10, s[12:15], s45 offen offset:2304
  ds_read_b64_tr_b16 a[204:205], v3 offset:64
  ds_read_b64_tr_b16 a[206:207], v3 offset:3136
  s_lshl_b32 s27, s37, 2
  s_add_u32 s46, s46, s27
  s_add_u32 s46, s46, 18563072
  ds_read_b64_tr_b16 a[208:209], v4 offset:96
  ds_read_b64_tr_b16 a[210:211], v4 offset:3168
  ds_read_b64_tr_b16 a[212:213], v3 offset:128
  ds_read_b64_tr_b16 a[214:215], v3 offset:3200
  ds_read_b64_tr_b16 a[216:217], v4 offset:160
  ds_read_b64_tr_b16 a[218:219], v4 offset:3232
  ds_read_b64_tr_b16 a[220:221], v30 offset:3584
  ds_read_b64_tr_b16 a[222:223], v30 offset:3712
  ds_read_b64_tr_b16 a[224:225], v3 offset:12288
  ds_read_b64_tr_b16 a[226:227], v3 offset:15360
  ds_read_b64_tr_b16 a[228:229], v4 offset:12320
  ds_read_b64_tr_b16 a[230:231], v4 offset:15392
  ds_read_b64_tr_b16 a[232:233], v3 offset:12352
  ds_read_b64_tr_b16 a[234:235], v3 offset:15424
  ds_read_b64_tr_b16 a[236:237], v4 offset:12384
  ds_read_b64_tr_b16 a[238:239], v4 offset:15456
  s_cmp_lg_u32 s14, 0
  s_cbranch_scc1 k1_kernel_bkd
k1_kernel_sld:
  buffer_load_dword v13, v11, s[8:11], s42 offen offset:128 sc1
  s_sub_u32 s86, s86, 1
  s_max_i32 s86, s86, 0
  s_waitcnt vmcnt(0)
  s_cbranch_scc0 k1_kernel_sle
  v_cmp_eq_u32 vcc, 0, v13
  s_cbranch_vccnz k1_kernel_sld
k1_kernel_sle:
  s_mov_b32 s14, s10
  s_add_u32 s90, s40, s91
  buffer_load_dwordx4 v[176:179], v2, s[12:15], s90 offen
  s_add_u32 s91, s91, 8192
  s_and_b32 s91, s91, 0xffff
  s_add_u32 s90, s40, s91
  buffer_load_dwordx4 v[184:187], v2, s[12:15], s90 offen
  s_add_u32 s91, s91, 8192
  s_and_b32 s91, s91, 0xffff
  s_add_u32 s90, s40, s91
  buffer_load_dwordx4 v[192:195], v2, s[12:15], s90 offen
  s_add_u32 s91, s91, 8192
  s_and_b32 s91, s91, 0xffff
  s_add_u32 s90, s40, s91
  buffer_load_dwordx4 v[200:203], v2, s[12:15], s90 offen
  s_add_u32 s91, s91, 8192
  s_and_b32 s91, s91, 0xffff
  s_add_u32 s90, s40, s91
  buffer_load_dwordx4 v[208:211], v2, s[12:15], s90 offen
  s_add_u32 s91, s91, 8192
  s_and_b32 s91, s91, 0xffff
  s_add_u32 s90, s40, s91
  buffer_load_dwordx4 v[216:219], v2, s[12:15], s90 offen
  s_add_u32 s91, s91, 8192
  s_and_b32 s91, s91, 0xffff
  s_add_u32 s90, s40, s91
  buffer_load_dwordx4 v[224:227], v2, s[12:15], s90 offen
  s_add_u32 s91, s91, 8192
  s_and_b32 s91, s91, 0xffff
  s_add_u32 s90, s40, s91
  buffer_load_dwordx4 v[232:235], v2, s[12:15], s90 offen
  s_add_u32 s91, s91, 8192
  s_and_b32 s91, s91, 0xffff
  buffer_load_dword v240, v10, s[12:15], s45 offen offset:0
  buffer_load_dword v241, v10, s[12:15], s45 offen offset:256
  buffer_load_dword v242, v10, s[12:15], s45 offen offset:2048
  buffer_load_dword v243, v10, s[12:15], s45 offen offset:2304
  s_waitcnt vmcnt(0)
k1_kernel_bkd:
  ds_read_b64_tr_b16 a[240:241], v3 offset:12416
  ds_read_b64_tr_b16 a[242:243], v3 offset:15488
  ds_read_b64_tr_b16 a[244:245], v4 offset:12448
  ds_read_b64_tr_b16 a[246:247], v4 offset:15520
  ds_read_b64_tr_b16 a[248:249], v30 offset:4096
  ds_read_b64_tr_b16 a[250:251], v30 offset:4224
  v_add_u32 v3, 62464, v3
  v_add_u32 v4, 62464, v4
  ds_read_b64_tr_b16 a[252:253], v3 offset:6144
  ds_read_b64_tr_b16 a[254:255], v3 offset:9216
  ds_read_b64_tr_b16 v[72:73], v4 offset:6176
  ds_read_b64_tr_b16 v[74:75], v4 offset:9248
  ds_read_b64_tr_b16 v[76:77], v3 offset:6208
  ds_read_b64_tr_b16 v[78:79], v3 offset:9280
  ds_read_b64_tr_b16 v[80:81], v4 offset:6240
  ds_read_b64_tr_b16 v[82:83], v4 offset:9312
  ds_read_b64_tr_b16 v[84:85], v3 offset:6272
  ds_read_b64_tr_b16 v[86:87], v3 offset:9344
  ds_read_b64_tr_b16 v[88:89], v4 offset:6304
  ds_read_b64_tr_b16 v[90:91], v4 offset:9376
  ds_read_b64_tr_b16 v[92:93], v30 offset:256
  ds_read_b64_tr_b16 v[94:95], v30 offset:384
  ds_read_b64_tr_b16 v[96:97], v3 offset:18432
  ds_read_b64_tr_b16 v[98:99], v3 offset:21504
  ds_read_b64_tr_b16 v[100:101], v4 offset:18464
  ds_read_b64_tr_b16 v[102:103], v4 offset:21536
  ds_read_b64_tr_b16 v[104:105], v3 offset:18496
  ds_read_b64_tr_b16 v[106:107], v3 offset:21568
  ds_read_b64_tr_b16 v[108:109], v4 offset:18528
  ds_read_b64_tr_b16 v[110:111], v4 offset:21600
  ds_read_b64_tr_b16 v[112:113], v3 offset:18560
  ds_read_b64_tr_b16 v[114:115], v3 offset:21632
  buffer_load_dword v16, v11, s[8:11], s42 offen sc1
  s_waitcnt vmcnt(12) lgkmcnt(15)
  v_mfma_f32_16x16x32_bf16 v[32:35], a[0:3], v[176:179], v[32:35]
  ds_read_b64_tr_b16 v[116:117], v4 offset:18592
  ds_read_b64_tr_b16 v[118:119], v4 offset:21664
  ds_read_b64_tr_b16 v[120:121], v30 offset:768
  ds_read_b64_tr_b16 v[122:123], v30 offset:896
  v_mfma_f32_16x16x32_bf16 v[36:39], a[4:7], v[176:179], v[36:39]
  ds_read_b64_tr_b16 v[124:125], v3 offset:30720
  ds_read_b64_tr_b16 v[126:127], v3 offset:33792
  ds_read_b64_tr_b16 v[144:145], v4 offset:30752
  ds_read_b64_tr_b16 v[146:147], v4 offset:33824
  v_mfma_f32_16x16x32_bf16 v[40:43], a[8:11], v[176:179], v[40:43]
  ds_read_b64_tr_b16 v[148:149], v3 offset:30784
  ds_read_b64_tr_b16 v[150:151], v3 offset:33856
  ds_read_b64_tr_b16 v[152:153], v4 offset:30816
  ds_read_b64_tr_b16 v[154:155], v4 offset:33888
  v_mfma_f32_16x16x32_bf16 v[44:47], a[12:15], v[176:179], v[44:47]
  ds_read_b64_tr_b16 v[156:157], v3 offset:30848
  ds_read_b64_tr_b16 v[158:159], v3 offset:33920
  ds_read_b64_tr_b16 v[160:161], v4 offset:30880
  ds_read_b64_tr_b16 v[162:163], v4 offset:33952
  s_waitcnt lgkmcnt(15)
  v_mfma_f32_16x16x32_bf16 v[48:51], a[16:19], v[176:179], v[48:51]
  ds_read_b64_tr_b16 v[164:165], v30 offset:1280
  ds_read_b64_tr_b16 v[166:167], v30 offset:1408
  ds_read_b64_tr_b16 v[168:169], v3 offset:43008
  ds_read_b64_tr_b16 v[170:171], v3 offset:46080
  v_mfma_f32_16x16x32_bf16 v[52:55], a[20:23], v[176:179], v[52:55]
  ds_read_b64_tr_b16 v[172:173], v4 offset:43040
  ds_read_b64_tr_b16 v[174:175], v4 offset:46112
  ds_read_b64_tr_b16 v[248:249], v3 offset:43072
  ds_read_b64_tr_b16 v[250:251], v3 offset:46144
  v_mfma_f32_16x16x32_bf16 v[56:59], a[24:27], v[176:179], 0
  ds_read_b64_tr_b16 v[252:253], v4 offset:43104
  ds_read_b64_tr_b16 v[254:255], v4 offset:46176
  ds_read_b64_tr_b16 v[128:129], v3 offset:43136
k1_kernel_w13:
  s_cbranch_execz k1_kernel_wr
  ds_read_b64_tr_b16 v[130:131], v3 offset:46208
  s_waitcnt vmcnt(11)
  v_mfma_f32_16x16x32_bf16 v[32:35], a[28:31], v[184:187], v[32:35]
  ds_read_b64_tr_b16 v[132:133], v4 offset:43168
  ds_read_b64_tr_b16 v[134:135], v4 offset:46240
  ds_read_b64_tr_b16 v[136:137], v30 offset:1792
  ds_read_b64_tr_b16 v[138:139], v30 offset:1920
  s_waitcnt lgkmcnt(15)
  v_mfma_f32_16x16x32_bf16 v[36:39], a[32:35], v[184:187], v[36:39]
  ds_read_b64_tr_b16 v[140:141], v3 offset:55296
  ds_read_b64_tr_b16 v[142:143], v3 offset:58368
  ds_read_b64_tr_b16 a[0:1], v4 offset:55328
  ds_read_b64_tr_b16 a[2:3], v4 offset:58400
  v_mfma_f32_16x16x32_bf16 v[40:43], a[124:127], v[184:187], v[40:43]
  ds_read_b64_tr_b16 a[4:5], v3 offset:55360
  ds_read_b64_tr_b16 a[6:7], v3 offset:58432
  ds_read_b64_tr_b16 a[8:9], v4 offset:55392
  ds_read_b64_tr_b16 a[10:11], v4 offset:58464
  v_mfma_f32_16x16x32_bf16 v[44:47], a[128:131], v[184:187], v[44:47]
  ds_read_b64_tr_b16 a[12:13], v3 offset:55424
  ds_read_b64_tr_b16 a[14:15], v3 offset:58496
  ds_read_b64_tr_b16 a[16:17], v4 offset:55456
  ds_read_b64_tr_b16 a[18:19], v4 offset:58528
  v_mfma_f32_16x16x32_bf16 v[48:51], a[132:135], v[184:187], v[48:51]
  ds_read_b64_tr_b16 a[20:21], v30 offset:2304
  ds_read_b64_tr_b16 a[22:23], v30 offset:2432
  ds_read_b64_tr_b16 a[24:25], v30 offset:2816
  ds_read_b64_tr_b16 a[26:27], v30 offset:2944
  s_waitcnt lgkmcnt(15)
  v_mfma_f32_16x16x32_bf16 v[52:55], a[136:139], v[184:187], v[52:55]
  v_add_u32 v3, 61440, v3
  v_add_u32 v4, 61440, v4
  ds_read_b64_tr_b16 a[28:29], v3 offset:6144
  ds_read_b64_tr_b16 a[30:31], v3 offset:9216
  ds_read_b64_tr_b16 a[32:33], v4 offset:6176
  ds_read_b64_tr_b16 a[34:35], v4 offset:9248
  v_mfma_f32_16x16x32_bf16 v[56:59], a[140:143], v[184:187], v[56:59]
  ds_read_b64_tr_b16 a[124:125], v30 offset:3328
  ds_read_b64_tr_b16 a[126:127], v30 offset:3456
  ds_read_b64_tr_b16 a[128:129], v3 offset:18432
  ds_read_b64_tr_b16 a[130:131], v3 offset:21504
  s_waitcnt vmcnt(10)
  v_mfma_f32_16x16x32_bf16 v[32:35], a[36:39], v[192:195], v[32:35]
  ds_read_b64_tr_b16 a[132:133], v4 offset:18464
  ds_read_b64_tr_b16 a[134:135], v4 offset:21536
  ds_read_b64_tr_b16 a[136:137], v30 offset:3840
  ds_read_b64_tr_b16 a[138:139], v30 offset:3968
  v_mfma_f32_16x16x32_bf16 v[36:39], a[40:43], v[192:195], v[36:39]
  v_add_u32 v3, -123904, v3
  v_add_u32 v4, -123904, v4
  ds_read_b64_tr_b16 a[140:141], v3 offset:6144
  ds_read_b64_tr_b16 a[142:143], v3 offset:9216
  ds_read_b64_tr_b16 a[36:37], v4 offset:6176
  ds_read_b64_tr_b16 a[38:39], v4 offset:9248
  s_waitcnt lgkmcnt(15)
  v_mfma_f32_16x16x32_bf16 v[40:43], a[44:47], v[192:195], v[40:43]
  ds_read_b64_tr_b16 a[40:41], v30 offset:4352
  ds_read_b64_tr_b16 a[42:43], v30 offset:4480
  v_mfma_f32_16x16x32_bf16 v[44:47], a[48:51], v[192:195], v[44:47]
  ds_read_b64_tr_b16 a[44:45], v3 offset:18432
  ds_read_b64_tr_b16 a[46:47], v3 offset:21504
  v_mfma_f32_16x16x32_bf16 v[48:51], a[52:55], v[192:195], v[48:51]
  ds_read_b64_tr_b16 a[48:49], v4 offset:18464
  ds_read_b64_tr_b16 a[50:51], v4 offset:21536
  v_mfma_f32_16x16x32_bf16 v[52:55], a[56:59], v[192:195], v[52:55]
  v_add_u32 v3, 123904, v3
  v_add_u32 v4, 123904, v4
  ds_read_b64_tr_b16 a[52:53], v3 offset:6208
  ds_read_b64_tr_b16 a[54:55], v3 offset:9280
  s_waitcnt lgkmcnt(15)
  v_mfma_f32_16x16x32_bf16 v[56:59], a[60:63], v[192:195], v[56:59]
  ds_read_b64_tr_b16 a[56:57], v4 offset:6240
  ds_read_b64_tr_b16 a[58:59], v4 offset:9312
  s_waitcnt vmcnt(9)
  v_mfma_f32_16x16x32_bf16 v[32:35], a[64:67], v[200:203], v[32:35]
  ds_read_b64_tr_b16 a[60:61], v3 offset:18496
  ds_read_b64_tr_b16 a[62:63], v3 offset:21568
  v_mfma_f32_16x16x32_bf16 v[36:39], a[68:71], v[200:203], v[36:39]
  ds_read_b64_tr_b16 a[64:65], v4 offset:18528
  ds_read_b64_tr_b16 a[66:67], v4 offset:21600
  v_mfma_f32_16x16x32_bf16 v[40:43], a[72:75], v[200:203], v[40:43]
  v_add_u32 v3, -123904, v3
  v_add_u32 v4, -123904, v4
  ds_read_b64_tr_b16 a[68:69], v3 offset:6208
  ds_read_b64_tr_b16 a[70:71], v3 offset:9280
  s_waitcnt lgkmcnt(15)
  v_mfma_f32_16x16x32_bf16 v[44:47], a[76:79], v[200:203], v[44:47]
  ds_read_b64_tr_b16 a[72:73], v4 offset:6240
  ds_read_b64_tr_b16 a[74:75], v4 offset:9312
  v_mfma_f32_16x16x32_bf16 v[48:51], a[80:83], v[200:203], v[48:51]
  ds_read_b64_tr_b16 a[76:77], v3 offset:18496
  ds_read_b64_tr_b16 a[78:79], v3 offset:21568
  v_mfma_f32_16x16x32_bf16 v[52:55], a[84:87], v[200:203], v[52:55]
  ds_read_b64_tr_b16 a[80:81], v4 offset:18528
  ds_read_b64_tr_b16 a[82:83], v4 offset:21600
  v_mfma_f32_16x16x32_bf16 v[56:59], a[88:91], v[200:203], v[56:59]
  v_add_u32 v3, 123904, v3
  v_add_u32 v4, 123904, v4
  ds_read_b64_tr_b16 a[84:85], v3 offset:6272
  ds_read_b64_tr_b16 a[86:87], v3 offset:9344
  s_waitcnt vmcnt(8) lgkmcnt(15)
  v_mfma_f32_16x16x32_bf16 v[32:35], a[92:95], v[208:211], v[32:35]
  ds_read_b64_tr_b16 a[88:89], v4 offset:6304
  ds_read_b64_tr_b16 a[90:91], v4 offset:9376
  v_mfma_f32_16x16x32_bf16 v[36:39], a[96:99], v[208:211], v[36:39]
  ds_read_b64_tr_b16 a[92:93], v3 offset:18560
  ds_read_b64_tr_b16 a[94:95], v3 offset:21632
  s_waitcnt vmcnt(0)
  v_cmp_eq_u32 vcc, 0, v16
  s_cbranch_vccz k1_kernel_bkc
k1_kernel_slc:
  s_sleep 1
  buffer_load_dword v16, v11, s[8:11], s42 offen sc1
  s_sub_u32 s86, s86, 1
  s_max_i32 s86, s86, 0
  s_waitcnt vmcnt(0)
  s_cbranch_scc0 k1_kernel_bkc
  v_cmp_eq_u32 vcc, 0, v16
  s_cbranch_vccnz k1_kernel_slc
k1_kernel_bkc:
  s_add_u32 s40, s40, 4096
  s_add_u32 s90, s40, s91
  buffer_load_dwordx4 v[180:183], v2, s[12:15], s90 offen
  s_add_u32 s91, s91, 8192
  s_and_b32 s91, s91, 0xffff
  v_mfma_f32_16x16x32_bf16 v[40:43], a[100:103], v[208:211], v[40:43]
  ds_read_b64_tr_b16 a[96:97], v4 offset:18592
  ds_read_b64_tr_b16 a[98:99], v4 offset:21664
  v_mfma_f32_16x16x32_bf16 v[44:47], a[104:107], v[208:211], v[44:47]
  v_add_u32 v3, -123904, v3
  v_add_u32 v4, -123904, v4
  ds_read_b64_tr_b16 a[100:101], v3 offset:6272
  ds_read_b64_tr_b16 a[102:103], v3 offset:9344
  s_add_u32 s90, s40, s91
  buffer_load_dwordx4 v[188:191], v2, s[12:15], s90 offen
  s_add_u32 s91, s91, 8192
  s_and_b32 s91, s91, 0xffff
  s_waitcnt lgkmcnt(15)
  v_mfma_f32_16x16x32_bf16 v[48:51], a[108:111], v[208:211], v[48:51]
  ds_read_b64_tr_b16 a[104:105], v4 offset:6304
k1_kernel_w14:
  s_cbranch_execz k1_kernel_wr
  ds_read_b64_tr_b16 a[106:107], v4 offset:9376
  v_mfma_f32_16x16x32_bf16 v[52:55], a[112:115], v[208:211], v[52:55]
  ds_read_b64_tr_b16 a[108:109], v3 offset:18560
  ds_read_b64_tr_b16 a[110:111], v3 offset:21632
  s_add_u32 s90, s40, s91
  buffer_load_dwordx4 v[196:199], v2, s[12:15], s90 offen
  s_add_u32 s91, s91, 8192
  s_and_b32 s91, s91, 0xffff
  v_mfma_f32_16x16x32_bf16 v[56:59], a[116:119], v[208:211], v[56:59]
  ds_read_b64_tr_b16 a[112:113], v4 offset:18592
  ds_read_b64_tr_b16 a[114:115], v4 offset:21664
  s_waitcnt vmcnt(10)
  v_mfma_f32_16x16x32_bf16 v[32:35], a[120:123], v[216:219], v[32:35]
  s_add_u32 s90, s40, s91
  buffer_load_dwordx4 v[204:207], v2, s[12:15], s90 offen
  s_add_u32 s91, s91, 8192
  s_and_b32 s91, s91, 0xffff
  s_waitcnt lgkmcnt(15)
  v_mfma_f32_16x16x32_bf16 v[36:39], a[144:147], v[216:219], v[36:39]
  v_mfma_f32_16x16x32_bf16 v[40:43], a[148:151], v[216:219], v[40:43]
  s_add_u32 s90, s40, s91
  buffer_load_dwordx4 v[212:215], v2, s[12:15], s90 offen
  s_add_u32 s91, s91, 8192
  s_and_b32 s91, s91, 0xffff
  v_mfma_f32_16x16x32_bf16 v[44:47], a[152:155], v[216:219], v[44:47]
  v_mfma_f32_16x16x32_bf16 v[48:51], a[156:159], v[216:219], v[48:51]
  s_add_u32 s90, s40, s91
  buffer_load_dwordx4 v[220:223], v2, s[12:15], s90 offen
  s_add_u32 s91, s91, 8192
  s_and_b32 s91, s91, 0xffff
  s_waitcnt lgkmcnt(15)
  v_mfma_f32_16x16x32_bf16 v[52:55], a[160:163], v[216:219], v[52:55]
  v_mfma_f32_16x16x32_bf16 v[56:59], a[164:167], v[216:219], v[56:59]
  s_add_u32 s90, s40, s91
  buffer_load_dwordx4 v[228:231], v2, s[12:15], s90 offen
  s_add_u32 s91, s91, 8192
  s_and_b32 s91, s91, 0xffff
  s_waitcnt vmcnt(13)
  v_mfma_f32_16x16x32_bf16 v[32:35], a[168:171], v[224:227], v[32:35]
  v_mfma_f32_16x16x32_bf16 v[36:39], a[172:175], v[224:227], v[36:39]
  s_add_u32 s90, s40, s91
  buffer_load_dwordx4 v[236:239], v2, s[12:15], s90 offen
  s_add_u32 s91, s91, 8192
  s_and_b32 s91, s91, 0xffff
  s_waitcnt lgkmcnt(15)
  v_mfma_f32_16x16x32_bf16 v[40:43], a[176:179], v[224:227], v[40:43]
  v_mfma_f32_16x16x32_bf16 v[44:47], a[180:183], v[224:227], v[44:47]
  buffer_load_dword v244, v10, s[12:15], s45 offen offset:128
  v_mfma_f32_16x16x32_bf16 v[48:51], a[184:187], v[224:227], v[48:51]
  v_mfma_f32_16x16x32_bf16 v[52:55], a[188:191], v[224:227], v[52:55]
  buffer_load_dword v245, v10, s[12:15], s45 offen offset:384
  s_waitcnt lgkmcnt(15)
  v_mfma_f32_16x16x32_bf16 v[56:59], a[192:195], v[224:227], v[56:59]
  s_waitcnt vmcnt(15)
  v_mfma_f32_16x16x32_bf16 v[32:35], a[196:199], v[232:235], v[32:35]
  buffer_load_dword v246, v10, s[12:15], s45 offen offset:2176
  v_mfma_f32_16x16x32_bf16 v[36:39], a[200:203], v[232:235], v[36:39]
  v_mfma_f32_16x16x32_bf16 v[40:43], a[204:207], v[232:235], v[40:43]
  buffer_load_dword v247, v10, s[12:15], s45 offen offset:2432
  s_waitcnt lgkmcnt(15)
  v_mfma_f32_16x16x32_bf16 v[44:47], a[208:211], v[232:235], v[44:47]
  v_mfma_f32_16x16x32_bf16 v[48:51], a[212:215], v[232:235], v[48:51]
  v_mfma_f32_16x16x32_bf16 v[52:55], a[216:219], v[232:235], v[52:55]
  v_mfma_f32_16x16x32_bf16 v[56:59], a[220:223], v[232:235], v[56:59]
  s_waitcnt vmcnt(13) lgkmcnt(15)
  v_mfma_f32_16x16x32_bf16 v[32:35], a[224:227], v[240:243], v[32:35]
  v_mfma_f32_16x16x32_bf16 v[36:39], a[228:231], v[240:243], v[36:39]
  v_mfma_f32_16x16x32_bf16 v[40:43], a[232:235], v[240:243], v[40:43]
  v_mfma_f32_16x16x32_bf16 v[44:47], a[236:239], v[240:243], v[44:47]
  s_waitcnt lgkmcnt(15)
  v_mfma_f32_16x16x32_bf16 v[48:51], a[240:243], v[240:243], v[48:51]
  v_mfma_f32_16x16x32_bf16 v[52:55], a[244:247], v[240:243], v[52:55]
  v_mfma_f32_16x16x32_bf16 v[56:59], a[248:251], v[240:243], v[56:59]
  s_waitcnt vmcnt(11)
  v_mfma_f32_16x16x32_bf16 v[32:35], a[252:255], v[180:183], v[32:35]
  s_waitcnt lgkmcnt(15)
  v_mfma_f32_16x16x32_bf16 v[36:39], v[72:75], v[180:183], v[36:39]
  v_mfma_f32_16x16x32_bf16 v[40:43], v[76:79], v[180:183], v[40:43]
  v_mfma_f32_16x16x32_bf16 v[44:47], v[80:83], v[180:183], v[44:47]
  v_mfma_f32_16x16x32_bf16 v[48:51], v[84:87], v[180:183], v[48:51]
  s_waitcnt lgkmcnt(15)
  v_mfma_f32_16x16x32_bf16 v[52:55], v[88:91], v[180:183], v[52:55]
  v_mfma_f32_16x16x32_bf16 v[56:59], v[92:95], v[180:183], v[56:59]
  s_waitcnt vmcnt(10)
  v_mfma_f32_16x16x32_bf16 v[32:35], v[96:99], v[188:191], v[32:35]
  v_mfma_f32_16x16x32_bf16 v[36:39], v[100:103], v[188:191], v[36:39]
  s_waitcnt lgkmcnt(15)
  v_mfma_f32_16x16x32_bf16 v[40:43], v[104:107], v[188:191], v[40:43]
  v_mfma_f32_16x16x32_bf16 v[44:47], v[108:111], v[188:191], v[44:47]
  v_mfma_f32_16x16x32_bf16 v[48:51], v[112:115], v[188:191], v[48:51]
  v_mfma_f32_16x16x32_bf16 v[52:55], v[116:119], v[188:191], v[52:55]
  s_waitcnt lgkmcnt(15)
  v_mfma_f32_16x16x32_bf16 v[56:59], v[120:123], v[188:191], v[56:59]
  s_waitcnt vmcnt(9)
  v_mfma_f32_16x16x32_bf16 v[32:35], v[124:127], v[196:199], v[32:35]
  v_mfma_f32_16x16x32_bf16 v[36:39], v[144:147], v[196:199], v[36:39]
  v_mfma_f32_16x16x32_bf16 v[40:43], v[148:151], v[196:199], v[40:43]
  s_waitcnt lgkmcnt(15)
  v_mfma_f32_16x16x32_bf16 v[44:47], v[152:155], v[196:199], v[44:47]
  v_mfma_f32_16x16x32_bf16 v[48:51], v[156:159], v[196:199], v[48:51]
  v_mfma_f32_16x16x32_bf16 v[52:55], v[160:163], v[196:199], v[52:55]
  v_mfma_f32_16x16x32_bf16 v[56:59], v[164:167], v[196:199], v[56:59]
  s_waitcnt vmcnt(8) lgkmcnt(15)
  v_mfma_f32_16x16x32_bf16 v[32:35], v[168:171], v[204:207], v[32:35]
  v_mfma_f32_16x16x32_bf16 v[36:39], v[172:175], v[204:207], v[36:39]
  v_mfma_f32_16x16x32_bf16 v[40:43], v[248:251], v[204:207], v[40:43]
  v_mfma_f32_16x16x32_bf16 v[44:47], v[252:255], v[204:207], v[44:47]
  s_waitcnt lgkmcnt(15)
  v_mfma_f32_16x16x32_bf16 v[48:51], v[128:131], v[204:207], v[48:51]
  v_mfma_f32_16x16x32_bf16 v[52:55], v[132:135], v[204:207], v[52:55]
  v_mfma_f32_16x16x32_bf16 v[56:59], v[136:139], v[204:207], v[56:59]
  s_waitcnt vmcnt(7)
  v_mfma_f32_16x16x32_bf16 v[32:35], v[140:143], v[212:215], v[32:35]
  s_waitcnt lgkmcnt(15)
  v_mfma_f32_16x16x32_bf16 v[36:39], a[0:3], v[212:215], v[36:39]
  v_mfma_f32_16x16x32_bf16 v[40:43], a[4:7], v[212:215], v[40:43]
  v_mfma_f32_16x16x32_bf16 v[44:47], a[8:11], v[212:215], v[44:47]
  v_mfma_f32_16x16x32_bf16 v[48:51], a[12:15], v[212:215], v[48:51]
  s_waitcnt lgkmcnt(15)
  v_mfma_f32_16x16x32_bf16 v[52:55], a[16:19], v[212:215], v[52:55]
  v_mfma_f32_16x16x32_bf16 v[56:59], a[20:23], v[212:215], v[56:59]
  s_waitcnt vmcnt(6)
  v_mfma_f32_16x16x32_bf16 v[56:59], a[24:27], v[220:223], v[56:59]
  v_mfma_f32_16x16x32_bf16 v[32:35], a[28:31], v[220:223], v[32:35]
  s_waitcnt lgkmcnt(15)
  v_mfma_f32_16x16x32_bf16 v[36:39], a[32:35], v[220:223], v[36:39]
  s_waitcnt vmcnt(5)
  v_mfma_f32_16x16x32_bf16 v[56:59], a[124:127], v[228:231], v[56:59]
  v_mfma_f32_16x16x32_bf16 v[32:35], a[128:131], v[228:231], v[32:35]
  v_mfma_f32_16x16x32_bf16 v[36:39], a[132:135], v[228:231], v[36:39]
  s_waitcnt vmcnt(4) lgkmcnt(15)
  v_mfma_f32_16x16x32_bf16 v[56:59], a[136:139], v[236:239], v[56:59]
  v_mfma_f32_16x16x32_bf16 v[32:35], a[140:143], v[236:239], v[32:35]
  v_mfma_f32_16x16x32_bf16 v[36:39], a[36:39], v[236:239], v[36:39]
  s_waitcnt vmcnt(0)
  v_mfma_f32_16x16x32_bf16 v[56:59], a[40:43], v[244:247], v[56:59]
  s_waitcnt lgkmcnt(15)
  v_mfma_f32_16x16x32_bf16 v[32:35], a[44:47], v[244:247], v[32:35]
  v_mfma_f32_16x16x32_bf16 v[36:39], a[48:51], v[244:247], v[36:39]
  v_mfma_f32_16x16x32_bf16 v[40:43], a[52:55], v[220:223], v[40:43]
  v_mfma_f32_16x16x32_bf16 v[44:47], a[56:59], v[220:223], v[44:47]
  v_add_f32 v14, v56, v57
  v_add_f32 v14, v14, v12
  v_sub_f32 v32, v32, v14
  s_waitcnt lgkmcnt(15)
  v_mfma_f32_16x16x32_bf16 v[40:43], a[60:63], v[228:231], v[40:43]
  v_sub_f32 v33, v33, v14
  v_sub_f32 v34, v34, v14
k1_kernel_w15:
  s_cbranch_execz k1_kernel_wr
  v_sub_f32 v35, v35, v14
  v_mfma_f32_16x16x32_bf16 v[44:47], a[64:67], v[228:231], v[44:47]
  v_sub_f32 v36, v36, v14
  v_sub_f32 v37, v37, v14
  v_sub_f32 v38, v38, v14
  v_mfma_f32_16x16x32_bf16 v[40:43], a[68:71], v[236:239], v[40:43]
  v_sub_f32 v39, v39, v14
  v_cvt_pk_bf16_f32 v20, v32, v33
  v_cvt_pk_bf16_f32 v21, v34, v35
  v_mfma_f32_16x16x32_bf16 v[44:47], a[72:75], v[236:239], v[44:47]
  v_cvt_pk_bf16_f32 v22, v36, v37
  v_cvt_pk_bf16_f32 v23, v38, v39
  buffer_store_dwordx4 v[20:23], v2, s[8:11], s4 offen sc1
  s_waitcnt lgkmcnt(12)
  v_mfma_f32_16x16x32_bf16 v[40:43], a[76:79], v[244:247], v[40:43]
  v_mul_f32 v17, v32, v32
  v_mul_f32 v15, v33, v33
  v_fmac_f32 v17, v34, v34
  v_mfma_f32_16x16x32_bf16 v[44:47], a[80:83], v[244:247], v[44:47]
  v_fmac_f32 v15, v35, v35
  v_fmac_f32 v17, v36, v36
  v_fmac_f32 v15, v37, v37
  v_mfma_f32_16x16x32_bf16 v[48:51], a[84:87], v[220:223], v[48:51]
  v_fmac_f32 v17, v38, v38
  v_fmac_f32 v15, v39, v39
  v_mfma_f32_16x16x32_bf16 v[52:55], a[88:91], v[220:223], v[52:55]
  v_sub_f32 v40, v40, v14
  v_sub_f32 v41, v41, v14
  v_sub_f32 v42, v42, v14
  s_waitcnt lgkmcnt(4)
  v_mfma_f32_16x16x32_bf16 v[48:51], a[92:95], v[228:231], v[48:51]
  v_sub_f32 v43, v43, v14
  v_sub_f32 v44, v44, v14
  v_sub_f32 v45, v45, v14
  v_mfma_f32_16x16x32_bf16 v[52:55], a[96:99], v[228:231], v[52:55]
  v_sub_f32 v46, v46, v14
  v_sub_f32 v47, v47, v14
  v_cvt_pk_bf16_f32 v24, v40, v41
  v_mfma_f32_16x16x32_bf16 v[48:51], a[100:103], v[236:239], v[48:51]
  v_cvt_pk_bf16_f32 v25, v42, v43
  v_cvt_pk_bf16_f32 v26, v44, v45
  v_cvt_pk_bf16_f32 v27, v46, v47
  v_mfma_f32_16x16x32_bf16 v[52:55], a[104:107], v[236:239], v[52:55]
  buffer_store_dwordx4 v[24:27], v2, s[8:11], s5 offen sc1
  v_fmac_f32 v17, v40, v40
  v_fmac_f32 v15, v41, v41
  s_waitcnt lgkmcnt(0)
  v_mfma_f32_16x16x32_bf16 v[48:51], a[108:111], v[244:247], v[48:51]
  v_fmac_f32 v17, v42, v42
  v_fmac_f32 v15, v43, v43
  v_fmac_f32 v17, v44, v44
  v_mfma_f32_16x16x32_bf16 v[52:55], a[112:115], v[244:247], v[52:55]
  v_fmac_f32 v15, v45, v45
  v_fmac_f32 v17, v46, v46
  v_fmac_f32 v15, v47, v47
  s_mov_b32 vcc_lo, 0xffff
  s_nop 7
  v_pk_add_f32 v[48:49], v[48:49], v[14:15] op_sel_hi:[1,0] neg_lo:[0,1] neg_hi:[0,1]
  v_pk_add_f32 v[50:51], v[50:51], v[14:15] op_sel_hi:[1,0] neg_lo:[0,1] neg_hi:[0,1]
  v_pk_add_f32 v[52:53], v[52:53], v[14:15] op_sel_hi:[1,0] neg_lo:[0,1] neg_hi:[0,1]
  v_pk_add_f32 v[54:55], v[54:55], v[14:15] op_sel_hi:[1,0] neg_lo:[0,1] neg_hi:[0,1]
  v_cvt_pk_bf16_f32 v20, v48, v49
  v_cvt_pk_bf16_f32 v21, v50, v51
  v_cvt_pk_bf16_f32 v22, v52, v53
  v_cvt_pk_bf16_f32 v23, v54, v55
  buffer_store_dwordx4 v[20:23], v2, s[8:11], s6 offen sc1
  v_fmac_f32 v17, v48, v48
  v_fmac_f32 v15, v49, v49
  v_fmac_f32 v17, v50, v50
  v_fmac_f32 v15, v51, v51
  v_fmac_f32 v17, v52, v52
  v_fmac_f32 v15, v53, v53
  v_fmac_f32 v17, v54, v54
  v_fmac_f32 v15, v55, v55
  v_add_f32 v15, v15, v17
  v_mov_b32 v17, v15
  s_nop 1
  v_permlane32_swap_b32 v15, v17
  v_add_f32 v15, v15, v17
  v_mov_b32 v17, v15
  s_nop 1
  v_permlane16_swap_b32 v15, v17
  v_add_f32 v15, v15, v17
  s_mov_b32 exec_hi, 0
  v_cndmask_b32 v15, v14, v15, vcc
  buffer_store_dword v15, v18, s[8:11], s44 offen sc1
  s_mov_b32 exec_hi, -1
k1_kernel_fin:
  s_branch k4_part
k1_kernel_end:
  s_endpgm
k1_kernel_idle:
  s_waitcnt vmcnt(0)
  s_mov_b64 exec, 1
  buffer_store_dword v6, off, s[8:11], s47 sc1
  s_mov_b64 exec, -1
  s_and_b32 s3, s2, 7
  s_mul_i32 s3, s3, 663552
  s_add_u32 s20, s20, s3
  s_addc_u32 s21, s21, 0
  s_mov_b32 s22, 663552
  s_lshr_b32 s3, s2, 3
  s_and_b32 s3, s3, 7
  s_lshl_b32 s3, s3, 2
  s_add_u32 s3, s3, s24
  s_lshl_b32 s3, s3, 13
  v_lshlrev_b32 v2, 7, v1
  s_mov_b32 s6, 5308416
  s_and_b32 s40, s2, 7
  s_mul_i32 s40, s40, 1152
  s_movk_i32 s43, 8064
  s_bfe_u32 s41, s2, 0x30003
  s_and_b32 s42, s24, 1
  s_lshl_b32 s42, s42, 3
  s_add_u32 s41, s41, s42
  s_mul_i32 s41, s41, 64
  s_add_u32 s41, s41, 3136
  v_min_u32 v10, 63, v1
  v_add_u32 v10, s41, v10
  v_mul_u32_u24 v11, 7282, v10
  v_lshrrev_b32 v11, 16, v11
  v_lshlrev_b32 v12, 7, v10
  v_mad_u32_u24 v12, v11, s43, v12
  buffer_load_dword v240, v12, s[4:7], s40 offen
  v_add_u32 v10, 1024, v10
  v_mul_u32_u24 v11, 7282, v10
  v_lshrrev_b32 v11, 16, v11
  v_lshlrev_b32 v13, 7, v10
  v_mad_u32_u24 v13, v11, s43, v13
  buffer_load_dword v241, v13, s[4:7], s40 offen
  v_add_u32 v10, 1024, v10
  s_lshr_b32 s3, s3, 13
  s_mul_i32 s3, s3, 20736
  s_and_b32 s44, s2, 4
  s_xor_b32 s44, s44, 4
  s_lshl_b32 s44, s44, 5
  v_min_u32 v2, 44, v1
  v_mul_u32_u24 v3, 52, v2
  v_lshrrev_b32 v3, 8, v3
  v_mad_i32_i24 v2, v3, -5, v2
  v_lshl_add_u32 v2, v2, 8, s44
  v_min_u32 v2, 1024, v2
  v_mul_u32_u24 v3, 1152, v3
  v_add_u32 v2, v2, v3
  buffer_load_dword v250, v2, s[20:23], s3 offen
  s_add_u32 s3, s3, 10368
  buffer_load_dword v251, v2, s[20:23], s3 offen
  s_mov_b32 s46, s89
  s_branch k4_part
.p2align 12
.p2align 8
k4_part:
  s_nop 0
  s_load_dwordx4 s[4:7], s[0:1], 32
  s_load_dwordx2 s[22:23], s[0:1], 48
  s_load_dwordx2 s[76:77], s[0:1], 56
  s_bfe_u32 s20, s2, 0x20001
  s_bfe_u32 s21, s2, 0x20003
  s_lshl_b32 s25, s20, 2
  s_add_u32 s25, s25, s21
  s_and_b32 s27, s21, 1
  s_mul_i32 s28, s25, 576
  s_lshl_b32 s30, s27, 6
  s_add_u32 s29, s28, s30
  s_lshr_b32 s35, 2641920, s25
  s_and_b32 s35, s35, 256
  s_sub_u32 s29, s29, s35
  s_lshl_b32 s35, s35, 1
  s_lshl_b32 s30, s27, 9
  s_sub_u32 s28, s28, s30
  s_add_u32 s28, s28, 512
  s_and_b32 s26, s2, 1
  s_lshl_b32 s26, s26, 3
  s_lshr_b32 s32, s2, 5
  s_add_u32 s26, s26, s32
  s_lshr_b32 s32, s24, 1
  s_lshl_b32 s31, s26, 1
  s_add_u32 s31, s31, s32
  s_and_b32 s33, s24, 1
  s_mul_i32 s30, s33, 147456
  s_lshl_b32 s33, s33, 11
  s_lshl_b32 s32, s24, 11
  s_add_u32 s32, s32, 1024
  v_lshl_add_u32 v2, v1, 4, s33
  s_movk_i32 s34, 9216
  v_lshrrev_b32 v14, 3, v1
  v_and_b32 v15, 6, v14
  v_and_b32 v16, 7, v1
  v_xor_b32 v15, v15, v16
  v_lshl_add_u32 v16, v15, 4, s29
  v_mad_u32_u24 v3, v14, s34, v16
  v_add_u32 v4, 73728, v3
  v_lshrrev_b32 v16, 2, v1
  v_and_b32 v18, 3, v1
  v_and_b32 v17, 2, v14
  v_xor_b32 v17, v17, v18
  v_lshl_add_u32 v17, v17, 4, s28
  v_mad_u32_u24 v5, v16, s34, v17
  s_mov_b32 s90, s30
  s_add_u32 s30, s30, s35
  s_lshl_b32 s27, s24, 10
  s_mul_i32 s29, s31, 73728
  s_add_u32 s29, s29, 12582912
  s_mov_b32 s14, 5308416
  s_mov_b32 s15, 0x00020000
  s_mov_b32 s18, 73728
  s_mov_b32 s19, 0x00020000
  s_mov_b32 s31, 0
  s_add_u32 m0, s27, 33792
  s_bitcmp1_b32 s24, 1
  s_waitcnt lgkmcnt(0)
  s_cselect_b32 s12, s6, s4
  s_cselect_b32 s13, s7, s5
  s_add_u32 s16, s8, s29
  s_addc_u32 s17, s9, 0
  v_lshlrev_b32 v17, 3, v18
  v_add_u32 v17, 1024, v17
  v_lshl_add_u32 v19, v16, 7, v17
  v_and_b32 v13, 3, v14
  v_lshl_add_u32 v7, v13, 5, v19
  v_xor_b32 v8, 32, v7
  v_xor_b32 v9, 64, v7
  v_xor_b32 v10, 96, v7
  v_lshl_add_u32 v19, v16, 6, v17
  v_and_b32 v13, 16, v1
  v_lshl_add_u32 v11, v13, 1, v19
  v_xor_b32 v12, 32, v11
  s_lshl_b32 s94, s26, 2
  v_and_b32 v22, 7, v1
  s_add_u32 s94, s94, s24
  v_min_u32 v22, 5, v22
  s_lshl_b32 s94, s94, 7
  v_and_or_b32 v22, v1, 8, v22
  s_add_u32 s94, s94, 18563072
  v_lshlrev_b32 v23, 2, v22
  s_mov_b32 s87, 20000
  s_cmp_ge_u32 s2, 192
  s_cbranch_scc1 k4_part_np
  s_waitcnt vmcnt(0)
  s_mov_b64 exec, 1
  buffer_store_dword v7, off, s[8:11], s46 sc1
  s_mov_b64 exec, -1
k4_part_np:
  s_barrier
  buffer_load_dwordx4 v5, s[12:15], s90 offen lds
  s_add_u32 m0, s32, 0
  s_nop 0
  buffer_load_dwordx4 v3, s[12:15], s30 offen offset:0 lds
  s_add_u32 m0, s32, 1024
  s_nop 0
  buffer_load_dwordx4 v4, s[12:15], s30 offen offset:0 lds
  s_add_u32 m0, s32, 8064
  s_nop 0
  buffer_load_dwordx4 v3, s[12:15], s30 offen offset:128 lds
  s_add_u32 m0, s32, 9088
  s_nop 0
  buffer_load_dwordx4 v4, s[12:15], s30 offen offset:128 lds
  s_add_u32 m0, s32, 16384
  s_add_u32 s30, s30, 294912
  s_nop 0
  buffer_load_dwordx4 v3, s[12:15], s30 offen offset:0 lds
  s_add_u32 m0, s32, 17408
  s_nop 0
  buffer_load_dwordx4 v4, s[12:15], s30 offen offset:0 lds
  s_add_u32 m0, s32, 24448
  s_nop 0
  buffer_load_dwordx4 v3, s[12:15], s30 offen offset:128 lds
  s_add_u32 m0, s32, 25472
  s_nop 0
  buffer_load_dwordx4 v4, s[12:15], s30 offen offset:128 lds
  s_add_u32 m0, s27, 70656
  s_add_u32 s90, s90, 294912
  s_nop 0
  buffer_load_dwordx4 v5, s[12:15], s90 offen lds
  s_add_u32 m0, s32, 36864
  s_add_u32 s30, s30, 294912
  s_nop 0
  buffer_load_dwordx4 v3, s[12:15], s30 offen offset:0 lds
  s_add_u32 m0, s32, 37888
  s_nop 0
  buffer_load_dwordx4 v4, s[12:15], s30 offen offset:0 lds
  s_add_u32 m0, s32, 44928
  s_nop 0
  buffer_load_dwordx4 v3, s[12:15], s30 offen offset:128 lds
  s_add_u32 m0, s32, 45952
  s_nop 0
  buffer_load_dwordx4 v4, s[12:15], s30 offen offset:128 lds
  s_add_u32 m0, s32, 53248
  s_add_u32 s30, s30, 294912
  s_nop 0
  buffer_load_dwordx4 v3, s[12:15], s30 offen offset:0 lds
  s_add_u32 m0, s32, 54272
  s_nop 0
  buffer_load_dwordx4 v4, s[12:15], s30 offen offset:0 lds
  s_add_u32 m0, s32, 61312
  s_nop 0
  buffer_load_dwordx4 v3, s[12:15], s30 offen offset:128 lds
  s_add_u32 m0, s32, 62336
  s_nop 0
  buffer_load_dwordx4 v4, s[12:15], s30 offen offset:128 lds
  s_add_u32 s35, s35, 5013504
  s_lshl_b32 s99, s26, 4
  s_add_u32 s99, s99, s25
  s_lshl_b32 s98, s99, 2
  s_add_u32 s98, s98, s24
  s_sub_u32 s101, 20971520, s33
  s_mul_i32 s47, s98, 18432
  s_add_u32 s47, s47, s101
  s_mul_i32 s49, s98, 12288
  s_add_u32 s49, s49, 41943040
  s_sub_u32 s49, s49, s33
  s_xor_b32 s80, s98, 4
  s_mul_i32 s80, s80, 18432
  s_add_u32 s80, s80, s101
  s_xor_b32 s81, s98, 8
  s_mul_i32 s81, s81, 18432
  s_add_u32 s81, s81, s101
  s_xor_b32 s82, s98, 12
  s_mul_i32 s82, s82, 18432
  s_add_u32 s82, s82, s101
  s_mul_i32 s28, s24, 9216
  s_lshl_b32 s98, s21, 8
  s_and_b32 s99, s20, 2
  s_xor_b32 s99, s99, 2
  s_lshl_b32 s99, s99, 6
  s_add_u32 s98, s98, s99
  s_add_u32 s28, s28, s98
  s_sub_u32 s44, 1024, s98
  v_mul_u32_u24 v6, 1152, v14
  v_lshl_add_u32 v6, v15, 4, v6
  v_add_u32 v6, s28, v6
  s_mov_b32 s4, s22
  s_mov_b32 s5, s23
  s_mov_b32 s6, 5308416
  s_mov_b32 s7, 0x00020000
  s_mov_b32 s10, 134217728
  s_mov_b32 s11, 0x00020000
  s_mov_b32 s78, 2359296
  s_mov_b32 s79, 0x00020000
  v_lshlrev_b32 v13, 2, v18
  s_lshl_b32 s86, s26, 13
  s_add_u32 s86, s86, 18350080
  s_lshl_b32 s99, s24, 11
  s_add_u32 s86, s86, s99
  s_lshl_b32 s99, s25, 2
  s_add_u32 s83, s86, s99
  s_lshl_b32 s99, s20, 4
  s_add_u32 s84, s86, s99
  s_lshl_b32 s99, s21, 4
  s_add_u32 s97, s86, s99
  s_lshl_b32 s99, s20, 2
  s_add_u32 s85, s97, s99
  s_mov_b32 s87, 20000
  s_lshl_b32 s45, s21, 14
  s_lshr_b32 s98, s24, 1
  s_xor_b32 s99, s21, s98
  s_sub_u32 s98, 32, s98
  s_add_u32 s0, s99, s98
  s_lshl_b32 s0, s0, 11
  s_xor_b32 s99, s99, 2
  s_add_u32 s1, s99, s98
  s_lshl_b32 s1, s1, 11
  s_lshl_b32 s98, s25, 1
  s_and_b32 s99, s20, 1
  s_sub_u32 s98, s98, s99
  s_add_u32 s98, s98, 1
  s_mul_i32 s98, s98, 73728
  s_add_u32 s98, s98, s27
  s_add_u32 s98, s98, 58720256
  v_and_b32 v0, 2, v14
  v_xor_b32 v0, v0, v1
  v_lshl_add_u32 v0, v0, 4, s98
  buffer_load_dword v22, v23, s[8:11], s94 offen sc1
  s_mov_b64 exec, 0
  s_cmp_eq_u32 s24, 0
  s_cbranch_scc1 k4_part_w0
  s_cmp_eq_u32 s24, 1
  s_cbranch_scc1 k4_part_w1
  s_cmp_eq_u32 s24, 2
  s_cbranch_scc1 k4_part_w2
  s_branch k4_part_w3
k4_part_wr:
  s_mov_b64 exec, -1
  s_waitcnt vmcnt(10)
  s_barrier
  ds_read_b64_tr_b16 a[144:145], v11 offset:32768
  ds_read_b64_tr_b16 a[146:147], v11 offset:33792
  ds_read_b64_tr_b16 a[148:149], v11 offset:34816
  ds_read_b64_tr_b16 a[150:151], v11 offset:35840
  ds_read_b64_tr_b16 a[152:153], v12 offset:32768
  ds_read_b64_tr_b16 a[154:155], v12 offset:33792
  ds_read_b64_tr_b16 a[156:157], v12 offset:34816
  ds_read_b64_tr_b16 a[158:159], v12 offset:35840
  ds_read_b64_tr_b16 a[160:161], v7 offset:0
  ds_read_b64_tr_b16 a[162:163], v7 offset:2048
  ds_read_b64_tr_b16 a[164:165], v7 offset:4096
  ds_read_b64_tr_b16 a[166:167], v7 offset:6144
  s_waitcnt vmcnt(0)
  v_cmp_eq_u32 vcc, 0, v22
  s_cbranch_vccz k4_part_bkx
k4_part_slx:
  s_sleep 6
  buffer_load_dword v22, v23, s[8:11], s94 offen sc1
  s_sub_u32 s87, s87, 1
  s_max_i32 s87, s87, 0
  s_waitcnt vmcnt(0)
  s_cbranch_scc0 k4_part_bkx
  v_cmp_eq_u32 vcc, 0, v22
  s_cbranch_vccnz k4_part_slx
k4_part_bkx:
  buffer_load_dwordx4 a[0:3], v2, s[16:19], s31 offen
  buffer_load_dwordx4 a[4:7], v2, s[16:19], s31 offen offset:1024
  s_add_u32 s31, s31, 4096
  buffer_load_dwordx4 a[8:11], v2, s[16:19], s31 offen
  buffer_load_dwordx4 a[12:15], v2, s[16:19], s31 offen offset:1024
  s_add_u32 s31, s31, 4096
  buffer_load_dwordx4 a[16:19], v2, s[16:19], s31 offen
  buffer_load_dwordx4 a[20:23], v2, s[16:19], s31 offen offset:1024
  s_add_u32 s31, s31, 4096
  buffer_load_dwordx4 a[24:27], v2, s[16:19], s31 offen
  buffer_load_dwordx4 a[28:31], v2, s[16:19], s31 offen offset:1024
  s_add_u32 s31, s31, 4096
  s_waitcnt vmcnt(7) lgkmcnt(8)
  v_mfma_f32_16x16x32_bf16 v[152:155], a[144:147], a[0:3], 0
  ds_read_b64_tr_b16 a[168:169], v8 offset:0
  s_add_u32 m0, s27, 107520
  s_add_u32 s90, s90, 294912
  s_waitcnt vmcnt(6)
  v_mfma_f32_16x16x32_bf16 v[156:159], a[144:147], a[4:7], 0
  ds_read_b64_tr_b16 a[170:171], v8 offset:2048
  buffer_load_dwordx4 v5, s[12:15], s90 offen lds
  v_mfma_f32_16x16x32_bf16 v[168:171], a[148:151], a[0:3], 0
  ds_read_b64_tr_b16 a[172:173], v8 offset:4096
  v_mfma_f32_16x16x32_bf16 v[172:175], a[148:151], a[4:7], 0
  ds_read_b64_tr_b16 a[174:175], v8 offset:6144
  s_waitcnt lgkmcnt(8)
  v_mfma_f32_16x16x32_bf16 v[160:163], a[152:155], a[0:3], 0
  ds_read_b64_tr_b16 a[144:145], v9 offset:0
  v_mfma_f32_16x16x32_bf16 v[164:167], a[152:155], a[4:7], 0
  ds_read_b64_tr_b16 a[146:147], v9 offset:2048
  v_mfma_f32_16x16x32_bf16 v[176:179], a[156:159], a[0:3], 0
  ds_read_b64_tr_b16 a[148:149], v9 offset:4096
  v_mfma_f32_16x16x32_bf16 v[180:183], a[156:159], a[4:7], 0
  ds_read_b64_tr_b16 a[150:151], v9 offset:6144
  s_add_u32 m0, s32, 73728
  s_add_u32 s30, s30, 294912
  s_waitcnt lgkmcnt(8)
  v_mfma_f32_16x16x32_bf16 v[24:27], a[160:163], a[0:3], 0
  ds_read_b64_tr_b16 a[152:153], v10 offset:0
  buffer_load_dwordx4 v3, s[12:15], s30 offen offset:0 lds
  v_mfma_f32_16x16x32_bf16 v[28:31], a[160:163], a[4:7], 0
  ds_read_b64_tr_b16 a[154:155], v10 offset:2048
  v_mfma_f32_16x16x32_bf16 v[88:91], a[164:167], a[0:3], 0
  ds_read_b64_tr_b16 a[156:157], v10 offset:4096
  s_add_u32 m0, s32, 74752
  v_mfma_f32_16x16x32_bf16 v[92:95], a[164:167], a[4:7], 0
  ds_read_b64_tr_b16 a[158:159], v10 offset:6144
  buffer_load_dwordx4 v4, s[12:15], s30 offen offset:0 lds
  s_waitcnt lgkmcnt(8)
  v_mfma_f32_16x16x32_bf16 v[32:35], a[168:171], a[0:3], 0
  ds_read_b64_tr_b16 a[160:161], v7 offset:8192
  v_mfma_f32_16x16x32_bf16 v[36:39], a[168:171], a[4:7], 0
  ds_read_b64_tr_b16 a[162:163], v7 offset:10240
  v_mfma_f32_16x16x32_bf16 v[96:99], a[172:175], a[0:3], 0
  ds_read_b64_tr_b16 a[164:165], v7 offset:12288
  s_add_u32 m0, s32, 81792
  v_mfma_f32_16x16x32_bf16 v[100:103], a[172:175], a[4:7], 0
  ds_read_b64_tr_b16 a[166:167], v7 offset:14336
  buffer_load_dwordx4 v3, s[12:15], s30 offen offset:128 lds
  s_waitcnt lgkmcnt(8)
  v_mfma_f32_16x16x32_bf16 v[40:43], a[144:147], a[0:3], 0
  ds_read_b64_tr_b16 a[168:169], v8 offset:8192
  v_mfma_f32_16x16x32_bf16 v[44:47], a[144:147], a[4:7], 0
  ds_read_b64_tr_b16 a[170:171], v8 offset:10240
  s_add_u32 m0, s32, 82816
  v_mfma_f32_16x16x32_bf16 v[104:107], a[148:151], a[0:3], 0
  ds_read_b64_tr_b16 a[172:173], v8 offset:12288
  buffer_load_dwordx4 v4, s[12:15], s30 offen offset:128 lds
  v_mfma_f32_16x16x32_bf16 v[108:111], a[148:151], a[4:7], 0
  ds_read_b64_tr_b16 a[174:175], v8 offset:14336
  s_waitcnt lgkmcnt(8)
  v_mfma_f32_16x16x32_bf16 v[48:51], a[152:155], a[0:3], 0
  ds_read_b64_tr_b16 a[144:145], v9 offset:8192
  v_mfma_f32_16x16x32_bf16 v[52:55], a[152:155], a[4:7], 0
  ds_read_b64_tr_b16 a[146:147], v9 offset:10240
  s_add_u32 m0, s32, 90112
  s_add_u32 s30, s30, 294912
  v_mfma_f32_16x16x32_bf16 v[112:115], a[156:159], a[0:3], 0
  ds_read_b64_tr_b16 a[148:149], v9 offset:12288
  buffer_load_dwordx4 v3, s[12:15], s30 offen offset:0 lds
  v_mfma_f32_16x16x32_bf16 v[116:119], a[156:159], a[4:7], 0
  ds_read_b64_tr_b16 a[150:151], v9 offset:14336
  s_waitcnt lgkmcnt(8)
  v_mfma_f32_16x16x32_bf16 v[56:59], a[160:163], a[0:3], 0
  ds_read_b64_tr_b16 a[152:153], v10 offset:8192
  s_add_u32 m0, s32, 91136
  v_mfma_f32_16x16x32_bf16 v[60:63], a[160:163], a[4:7], 0
  ds_read_b64_tr_b16 a[154:155], v10 offset:10240
  buffer_load_dwordx4 v4, s[12:15], s30 offen offset:0 lds
  v_mfma_f32_16x16x32_bf16 v[120:123], a[164:167], a[0:3], 0
  ds_read_b64_tr_b16 a[156:157], v10 offset:12288
  v_mfma_f32_16x16x32_bf16 v[124:127], a[164:167], a[4:7], 0
  ds_read_b64_tr_b16 a[158:159], v10 offset:14336
  s_waitcnt lgkmcnt(8)
  v_mfma_f32_16x16x32_bf16 v[64:67], a[168:171], a[0:3], 0
  ds_read_b64_tr_b16 a[160:161], v7 offset:16384
  s_add_u32 m0, s32, 98176
  v_mfma_f32_16x16x32_bf16 v[68:71], a[168:171], a[4:7], 0
  ds_read_b64_tr_b16 a[162:163], v7 offset:18432
  buffer_load_dwordx4 v3, s[12:15], s30 offen offset:128 lds
  v_mfma_f32_16x16x32_bf16 v[128:131], a[172:175], a[0:3], 0
  ds_read_b64_tr_b16 a[164:165], v7 offset:20480
  v_mfma_f32_16x16x32_bf16 v[132:135], a[172:175], a[4:7], 0
  ds_read_b64_tr_b16 a[166:167], v7 offset:22528
  s_add_u32 m0, s32, 99200
  s_waitcnt lgkmcnt(8)
  v_mfma_f32_16x16x32_bf16 v[72:75], a[144:147], a[0:3], 0
  ds_read_b64_tr_b16 a[168:169], v8 offset:16384
  buffer_load_dwordx4 v4, s[12:15], s30 offen offset:128 lds
  v_mfma_f32_16x16x32_bf16 v[76:79], a[144:147], a[4:7], 0
  ds_read_b64_tr_b16 a[170:171], v8 offset:18432
  v_mfma_f32_16x16x32_bf16 v[136:139], a[148:151], a[0:3], 0
  ds_read_b64_tr_b16 a[172:173], v8 offset:20480
  v_mfma_f32_16x16x32_bf16 v[140:143], a[148:151], a[4:7], 0
  ds_read_b64_tr_b16 a[174:175], v8 offset:22528
  s_waitcnt lgkmcnt(8)
  v_mfma_f32_16x16x32_bf16 v[80:83], a[152:155], a[0:3], 0
  ds_read_b64_tr_b16 a[144:145], v9 offset:16384
  buffer_load_dwordx4 a[32:35], v2, s[16:19], s31 offen
  v_mfma_f32_16x16x32_bf16 v[84:87], a[152:155], a[4:7], 0
  ds_read_b64_tr_b16 a[146:147], v9 offset:18432
  v_mfma_f32_16x16x32_bf16 v[144:147], a[156:159], a[0:3], 0
  ds_read_b64_tr_b16 a[148:149], v9 offset:20480
  v_mfma_f32_16x16x32_bf16 v[148:151], a[156:159], a[4:7], 0
  ds_read_b64_tr_b16 a[150:151], v9 offset:22528
  buffer_load_dwordx4 a[36:39], v2, s[16:19], s31 offen offset:1024
  s_add_u32 s31, s31, 4096
  s_waitcnt vmcnt(16) lgkmcnt(8)
  v_mfma_f32_16x16x32_bf16 v[24:27], a[160:163], a[8:11], v[24:27]
  ds_read_b64_tr_b16 a[152:153], v10 offset:16384
  s_waitcnt vmcnt(15)
  v_mfma_f32_16x16x32_bf16 v[28:31], a[160:163], a[12:15], v[28:31]
  ds_read_b64_tr_b16 a[154:155], v10 offset:18432
  v_mfma_f32_16x16x32_bf16 v[88:91], a[164:167], a[8:11], v[88:91]
  ds_read_b64_tr_b16 a[156:157], v10 offset:20480
  s_add_u32 m0, s27, 144384
  s_add_u32 s90, s90, 294912
  v_mfma_f32_16x16x32_bf16 v[92:95], a[164:167], a[12:15], v[92:95]
  ds_read_b64_tr_b16 a[158:159], v10 offset:22528
  buffer_load_dwordx4 v5, s[12:15], s90 offen lds
  s_waitcnt lgkmcnt(8)
  v_mfma_f32_16x16x32_bf16 v[32:35], a[168:171], a[8:11], v[32:35]
  ds_read_b64_tr_b16 a[160:161], v7 offset:24576
  v_mfma_f32_16x16x32_bf16 v[36:39], a[168:171], a[12:15], v[36:39]
  ds_read_b64_tr_b16 a[162:163], v7 offset:26624
  v_mfma_f32_16x16x32_bf16 v[96:99], a[172:175], a[8:11], v[96:99]
  ds_read_b64_tr_b16 a[164:165], v7 offset:28672
  v_mfma_f32_16x16x32_bf16 v[100:103], a[172:175], a[12:15], v[100:103]
  ds_read_b64_tr_b16 a[166:167], v7 offset:30720
  s_waitcnt lgkmcnt(8)
  v_mfma_f32_16x16x32_bf16 v[40:43], a[144:147], a[8:11], v[40:43]
  ds_read_b64_tr_b16 a[168:169], v8 offset:24576
  v_mfma_f32_16x16x32_bf16 v[44:47], a[144:147], a[12:15], v[44:47]
  ds_read_b64_tr_b16 a[170:171], v8 offset:26624
  s_add_u32 m0, s32, 110592
  s_add_u32 s30, s30, 294912
  v_mfma_f32_16x16x32_bf16 v[104:107], a[148:151], a[8:11], v[104:107]
  ds_read_b64_tr_b16 a[172:173], v8 offset:28672
  buffer_load_dwordx4 v3, s[12:15], s30 offen offset:0 lds
  v_mfma_f32_16x16x32_bf16 v[108:111], a[148:151], a[12:15], v[108:111]
  ds_read_b64_tr_b16 a[174:175], v8 offset:30720
  s_waitcnt lgkmcnt(8)
  v_mfma_f32_16x16x32_bf16 v[48:51], a[152:155], a[8:11], v[48:51]
  ds_read_b64_tr_b16 a[144:145], v9 offset:24576
  s_add_u32 m0, s32, 111616
  v_mfma_f32_16x16x32_bf16 v[52:55], a[152:155], a[12:15], v[52:55]
  ds_read_b64_tr_b16 a[146:147], v9 offset:26624
  buffer_load_dwordx4 v4, s[12:15], s30 offen offset:0 lds
  v_mfma_f32_16x16x32_bf16 v[112:115], a[156:159], a[8:11], v[112:115]
  ds_read_b64_tr_b16 a[148:149], v9 offset:28672
  v_mfma_f32_16x16x32_bf16 v[116:119], a[156:159], a[12:15], v[116:119]
  ds_read_b64_tr_b16 a[150:151], v9 offset:30720
  s_waitcnt lgkmcnt(8)
  v_mfma_f32_16x16x32_bf16 v[56:59], a[160:163], a[8:11], v[56:59]
  ds_read_b64_tr_b16 a[152:153], v10 offset:24576
  v_mfma_f32_16x16x32_bf16 v[60:63], a[160:163], a[12:15], v[60:63]
  ds_read_b64_tr_b16 a[154:155], v10 offset:26624
  buffer_load_dwordx4 a[40:43], v2, s[16:19], s31 offen
  v_mfma_f32_16x16x32_bf16 v[120:123], a[164:167], a[8:11], v[120:123]
  ds_read_b64_tr_b16 a[156:157], v10 offset:28672
  v_mfma_f32_16x16x32_bf16 v[124:127], a[164:167], a[12:15], v[124:127]
  ds_read_b64_tr_b16 a[158:159], v10 offset:30720
  s_add_u32 m0, s32, 118656
  s_waitcnt lgkmcnt(8)
  v_mfma_f32_16x16x32_bf16 v[64:67], a[168:171], a[8:11], v[64:67]
  s_waitcnt vmcnt(24)
  s_barrier
  v_add_u32 v11, 69632, v11
  ds_read_b64_tr_b16 a[160:161], v11 offset:0
  buffer_load_dwordx4 v3, s[12:15], s30 offen offset:128 lds
  v_mfma_f32_16x16x32_bf16 v[68:71], a[168:171], a[12:15], v[68:71]
  ds_read_b64_tr_b16 a[162:163], v11 offset:1024
  v_mfma_f32_16x16x32_bf16 v[128:131], a[172:175], a[8:11], v[128:131]
  ds_read_b64_tr_b16 a[164:165], v11 offset:2048
  v_mfma_f32_16x16x32_bf16 v[132:135], a[172:175], a[12:15], v[132:135]
  ds_read_b64_tr_b16 a[166:167], v11 offset:3072
  s_waitcnt lgkmcnt(8)
  v_mfma_f32_16x16x32_bf16 v[72:75], a[144:147], a[8:11], v[72:75]
  v_add_u32 v12, 69632, v12
  ds_read_b64_tr_b16 a[168:169], v12 offset:0
  buffer_load_dwordx4 a[44:47], v2, s[16:19], s31 offen offset:1024
  s_add_u32 s31, s31, 4096
  v_mfma_f32_16x16x32_bf16 v[76:79], a[144:147], a[12:15], v[76:79]
  ds_read_b64_tr_b16 a[170:171], v12 offset:1024
  v_mfma_f32_16x16x32_bf16 v[136:139], a[148:151], a[8:11], v[136:139]
  ds_read_b64_tr_b16 a[172:173], v12 offset:2048
  s_add_u32 m0, s32, 119680
  v_mfma_f32_16x16x32_bf16 v[140:143], a[148:151], a[12:15], v[140:143]
  ds_read_b64_tr_b16 a[174:175], v12 offset:3072
  buffer_load_dwordx4 v4, s[12:15], s30 offen offset:128 lds
  s_waitcnt lgkmcnt(8)
  v_mfma_f32_16x16x32_bf16 v[80:83], a[152:155], a[8:11], v[80:83]
  ds_read_b64_tr_b16 a[144:145], v7 offset:36864
  v_mfma_f32_16x16x32_bf16 v[84:87], a[152:155], a[12:15], v[84:87]
  ds_read_b64_tr_b16 a[146:147], v7 offset:38912
  v_mfma_f32_16x16x32_bf16 v[144:147], a[156:159], a[8:11], v[144:147]
  ds_read_b64_tr_b16 a[148:149], v7 offset:40960
  s_add_u32 m0, s32, 126976
  s_add_u32 s30, s30, 294912
  v_mfma_f32_16x16x32_bf16 v[148:151], a[156:159], a[12:15], v[148:151]
  ds_read_b64_tr_b16 a[150:151], v7 offset:43008
  buffer_load_dwordx4 v3, s[12:15], s30 offen offset:0 lds
  s_waitcnt lgkmcnt(8)
  v_mfma_f32_16x16x32_bf16 v[152:155], a[160:163], a[8:11], v[152:155]
  ds_read_b64_tr_b16 a[152:153], v8 offset:36864
  v_mfma_f32_16x16x32_bf16 v[156:159], a[160:163], a[12:15], v[156:159]
  ds_read_b64_tr_b16 a[154:155], v8 offset:38912
  s_add_u32 m0, s32, 128000
  v_mfma_f32_16x16x32_bf16 v[168:171], a[164:167], a[8:11], v[168:171]
  ds_read_b64_tr_b16 a[156:157], v8 offset:40960
  buffer_load_dwordx4 v4, s[12:15], s30 offen offset:0 lds
  v_mfma_f32_16x16x32_bf16 v[172:175], a[164:167], a[12:15], v[172:175]
  ds_read_b64_tr_b16 a[158:159], v8 offset:43008
  s_waitcnt lgkmcnt(8)
  v_mfma_f32_16x16x32_bf16 v[160:163], a[168:171], a[8:11], v[160:163]
  ds_read_b64_tr_b16 a[160:161], v9 offset:36864
  v_mfma_f32_16x16x32_bf16 v[164:167], a[168:171], a[12:15], v[164:167]
  ds_read_b64_tr_b16 a[162:163], v9 offset:38912
  s_add_u32 m0, s32, 135040
  v_mfma_f32_16x16x32_bf16 v[176:179], a[172:175], a[8:11], v[176:179]
  ds_read_b64_tr_b16 a[164:165], v9 offset:40960
  buffer_load_dwordx4 v3, s[12:15], s30 offen offset:128 lds
  v_mfma_f32_16x16x32_bf16 v[180:183], a[172:175], a[12:15], v[180:183]
  ds_read_b64_tr_b16 a[166:167], v9 offset:43008
  s_waitcnt vmcnt(24) lgkmcnt(8)
  v_mfma_f32_16x16x32_bf16 v[24:27], a[144:147], a[16:19], v[24:27]
  ds_read_b64_tr_b16 a[168:169], v10 offset:36864
  s_add_u32 m0, s32, 136064
  s_waitcnt vmcnt(23)
  v_mfma_f32_16x16x32_bf16 v[28:31], a[144:147], a[20:23], v[28:31]
  ds_read_b64_tr_b16 a[170:171], v10 offset:38912
  buffer_load_dwordx4 v4, s[12:15], s30 offen offset:128 lds
  v_mfma_f32_16x16x32_bf16 v[88:91], a[148:151], a[16:19], v[88:91]
  ds_read_b64_tr_b16 a[172:173], v10 offset:40960
  v_mfma_f32_16x16x32_bf16 v[92:95], a[148:151], a[20:23], v[92:95]
  ds_read_b64_tr_b16 a[174:175], v10 offset:43008
  s_waitcnt lgkmcnt(8)
  v_mfma_f32_16x16x32_bf16 v[32:35], a[152:155], a[16:19], v[32:35]
  ds_read_b64_tr_b16 a[144:145], v7 offset:45056
  v_mfma_f32_16x16x32_bf16 v[36:39], a[152:155], a[20:23], v[36:39]
  ds_read_b64_tr_b16 a[146:147], v7 offset:47104
  buffer_load_dwordx4 a[48:51], v2, s[16:19], s31 offen
  v_mfma_f32_16x16x32_bf16 v[96:99], a[156:159], a[16:19], v[96:99]
  ds_read_b64_tr_b16 a[148:149], v7 offset:49152
  v_mfma_f32_16x16x32_bf16 v[100:103], a[156:159], a[20:23], v[100:103]
  ds_read_b64_tr_b16 a[150:151], v7 offset:51200
  s_waitcnt lgkmcnt(8)
  v_mfma_f32_16x16x32_bf16 v[40:43], a[160:163], a[16:19], v[40:43]
  ds_read_b64_tr_b16 a[152:153], v8 offset:45056
  buffer_load_dwordx4 a[52:55], v2, s[16:19], s31 offen offset:1024
  s_add_u32 s31, s31, 4096
  v_mfma_f32_16x16x32_bf16 v[44:47], a[160:163], a[20:23], v[44:47]
  ds_read_b64_tr_b16 a[154:155], v8 offset:47104
  v_mfma_f32_16x16x32_bf16 v[104:107], a[164:167], a[16:19], v[104:107]
  ds_read_b64_tr_b16 a[156:157], v8 offset:49152
  v_mfma_f32_16x16x32_bf16 v[108:111], a[164:167], a[20:23], v[108:111]
  ds_read_b64_tr_b16 a[158:159], v8 offset:51200
  s_add_u32 m0, s27, 33792
  s_add_u32 s90, s90, 294912
  s_waitcnt lgkmcnt(8)
  v_mfma_f32_16x16x32_bf16 v[48:51], a[168:171], a[16:19], v[48:51]
  ds_read_b64_tr_b16 a[160:161], v9 offset:45056
  buffer_load_dwordx4 v5, s[12:15], s90 offen lds
  v_mfma_f32_16x16x32_bf16 v[52:55], a[168:171], a[20:23], v[52:55]
  ds_read_b64_tr_b16 a[162:163], v9 offset:47104
  v_mfma_f32_16x16x32_bf16 v[112:115], a[172:175], a[16:19], v[112:115]
  ds_read_b64_tr_b16 a[164:165], v9 offset:49152
  v_mfma_f32_16x16x32_bf16 v[116:119], a[172:175], a[20:23], v[116:119]
  ds_read_b64_tr_b16 a[166:167], v9 offset:51200
  s_waitcnt lgkmcnt(8)
  v_mfma_f32_16x16x32_bf16 v[56:59], a[144:147], a[16:19], v[56:59]
  ds_read_b64_tr_b16 a[168:169], v10 offset:45056
  v_mfma_f32_16x16x32_bf16 v[60:63], a[144:147], a[20:23], v[60:63]
  ds_read_b64_tr_b16 a[170:171], v10 offset:47104
  v_mfma_f32_16x16x32_bf16 v[120:123], a[148:151], a[16:19], v[120:123]
  ds_read_b64_tr_b16 a[172:173], v10 offset:49152
  s_add_u32 m0, s32, 0
  s_add_u32 s30, s30, 294912
  v_mfma_f32_16x16x32_bf16 v[124:127], a[148:151], a[20:23], v[124:127]
  ds_read_b64_tr_b16 a[174:175], v10 offset:51200
  buffer_load_dwordx4 v3, s[12:15], s30 offen offset:0 lds
  s_waitcnt lgkmcnt(8)
  v_mfma_f32_16x16x32_bf16 v[64:67], a[152:155], a[16:19], v[64:67]
  ds_read_b64_tr_b16 a[144:145], v7 offset:53248
  v_mfma_f32_16x16x32_bf16 v[68:71], a[152:155], a[20:23], v[68:71]
  ds_read_b64_tr_b16 a[146:147], v7 offset:55296
  s_add_u32 m0, s32, 1024
  v_mfma_f32_16x16x32_bf16 v[128:131], a[156:159], a[16:19], v[128:131]
  ds_read_b64_tr_b16 a[148:149], v7 offset:57344
  buffer_load_dwordx4 v4, s[12:15], s30 offen offset:0 lds
  v_mfma_f32_16x16x32_bf16 v[132:135], a[156:159], a[20:23], v[132:135]
  ds_read_b64_tr_b16 a[150:151], v7 offset:59392
  s_waitcnt lgkmcnt(8)
  v_mfma_f32_16x16x32_bf16 v[72:75], a[160:163], a[16:19], v[72:75]
  ds_read_b64_tr_b16 a[152:153], v8 offset:53248
  v_mfma_f32_16x16x32_bf16 v[76:79], a[160:163], a[20:23], v[76:79]
  ds_read_b64_tr_b16 a[154:155], v8 offset:55296
  v_mfma_f32_16x16x32_bf16 v[136:139], a[164:167], a[16:19], v[136:139]
  ds_read_b64_tr_b16 a[156:157], v8 offset:57344
  buffer_load_dwordx4 a[56:59], v2, s[16:19], s31 offen
  v_mfma_f32_16x16x32_bf16 v[140:143], a[164:167], a[20:23], v[140:143]
  ds_read_b64_tr_b16 a[158:159], v8 offset:59392
  s_waitcnt lgkmcnt(8)
  v_mfma_f32_16x16x32_bf16 v[80:83], a[168:171], a[16:19], v[80:83]
  ds_read_b64_tr_b16 a[160:161], v9 offset:53248
  s_add_u32 m0, s32, 8064
  v_mfma_f32_16x16x32_bf16 v[84:87], a[168:171], a[20:23], v[84:87]
  ds_read_b64_tr_b16 a[162:163], v9 offset:55296
  buffer_load_dwordx4 v3, s[12:15], s30 offen offset:128 lds
  v_mfma_f32_16x16x32_bf16 v[144:147], a[172:175], a[16:19], v[144:147]
  ds_read_b64_tr_b16 a[164:165], v9 offset:57344
  v_mfma_f32_16x16x32_bf16 v[148:151], a[172:175], a[20:23], v[148:151]
  ds_read_b64_tr_b16 a[166:167], v9 offset:59392
  s_waitcnt vmcnt(30) lgkmcnt(8)
  v_mfma_f32_16x16x32_bf16 v[24:27], a[144:147], a[24:27], v[24:27]
  ds_read_b64_tr_b16 a[168:169], v10 offset:53248
  s_waitcnt vmcnt(29)
  v_mfma_f32_16x16x32_bf16 v[28:31], a[144:147], a[28:31], v[28:31]
  ds_read_b64_tr_b16 a[170:171], v10 offset:55296
  buffer_load_dwordx4 a[60:63], v2, s[16:19], s31 offen offset:1024
  s_add_u32 s31, s31, 4096
  v_mfma_f32_16x16x32_bf16 v[88:91], a[148:151], a[24:27], v[88:91]
  ds_read_b64_tr_b16 a[172:173], v10 offset:57344
  v_mfma_f32_16x16x32_bf16 v[92:95], a[148:151], a[28:31], v[92:95]
  ds_read_b64_tr_b16 a[174:175], v10 offset:59392
  s_add_u32 m0, s32, 9088
  s_waitcnt lgkmcnt(8)
  v_mfma_f32_16x16x32_bf16 v[32:35], a[152:155], a[24:27], v[32:35]
  ds_read_b64_tr_b16 a[144:145], v7 offset:61440
k4_part_w0:
  s_cbranch_execz k4_part_w4
  buffer_load_dwordx4 v4, s[12:15], s30 offen offset:128 lds
  v_mfma_f32_16x16x32_bf16 v[36:39], a[152:155], a[28:31], v[36:39]
  ds_read_b64_tr_b16 a[146:147], v7 offset:63488
  v_mfma_f32_16x16x32_bf16 v[96:99], a[156:159], a[24:27], v[96:99]
  v_add_u32 v7, 65536, v7
  ds_read_b64_tr_b16 a[148:149], v7 offset:0
  v_mfma_f32_16x16x32_bf16 v[100:103], a[156:159], a[28:31], v[100:103]
  ds_read_b64_tr_b16 a[150:151], v7 offset:2048
  s_add_u32 m0, s32, 16384
  s_add_u32 s30, s30, 294912
  s_waitcnt lgkmcnt(8)
  v_mfma_f32_16x16x32_bf16 v[40:43], a[160:163], a[24:27], v[40:43]
  ds_read_b64_tr_b16 a[152:153], v8 offset:61440
  buffer_load_dwordx4 v3, s[12:15], s30 offen offset:0 lds
  v_mfma_f32_16x16x32_bf16 v[44:47], a[160:163], a[28:31], v[44:47]
  ds_read_b64_tr_b16 a[154:155], v8 offset:63488
  v_mfma_f32_16x16x32_bf16 v[104:107], a[164:167], a[24:27], v[104:107]
  v_add_u32 v8, 65536, v8
  ds_read_b64_tr_b16 a[156:157], v8 offset:0
  s_add_u32 m0, s32, 17408
  v_mfma_f32_16x16x32_bf16 v[108:111], a[164:167], a[28:31], v[108:111]
  ds_read_b64_tr_b16 a[158:159], v8 offset:2048
  buffer_load_dwordx4 v4, s[12:15], s30 offen offset:0 lds
  s_waitcnt lgkmcnt(8)
  v_mfma_f32_16x16x32_bf16 v[48:51], a[168:171], a[24:27], v[48:51]
  ds_read_b64_tr_b16 a[160:161], v9 offset:61440
  v_mfma_f32_16x16x32_bf16 v[52:55], a[168:171], a[28:31], v[52:55]
  ds_read_b64_tr_b16 a[162:163], v9 offset:63488
  v_mfma_f32_16x16x32_bf16 v[112:115], a[172:175], a[24:27], v[112:115]
  v_add_u32 v9, 65536, v9
  ds_read_b64_tr_b16 a[164:165], v9 offset:0
  s_add_u32 m0, s32, 24448
  v_mfma_f32_16x16x32_bf16 v[116:119], a[172:175], a[28:31], v[116:119]
  ds_read_b64_tr_b16 a[166:167], v9 offset:2048
  buffer_load_dwordx4 v3, s[12:15], s30 offen offset:128 lds
  s_waitcnt lgkmcnt(8)
  v_mfma_f32_16x16x32_bf16 v[56:59], a[144:147], a[24:27], v[56:59]
  ds_read_b64_tr_b16 a[168:169], v10 offset:61440
  v_mfma_f32_16x16x32_bf16 v[60:63], a[144:147], a[28:31], v[60:63]
  ds_read_b64_tr_b16 a[170:171], v10 offset:63488
  s_add_u32 m0, s32, 25472
  v_mfma_f32_16x16x32_bf16 v[120:123], a[148:151], a[24:27], v[120:123]
  v_add_u32 v10, 65536, v10
  ds_read_b64_tr_b16 a[172:173], v10 offset:0
  buffer_load_dwordx4 v4, s[12:15], s30 offen offset:128 lds
  v_mfma_f32_16x16x32_bf16 v[124:127], a[148:151], a[28:31], v[124:127]
  ds_read_b64_tr_b16 a[174:175], v10 offset:2048
  s_waitcnt lgkmcnt(8)
  v_mfma_f32_16x16x32_bf16 v[64:67], a[152:155], a[24:27], v[64:67]
  s_waitcnt vmcnt(26)
  s_barrier
  ds_read_b64_tr_b16 a[144:145], v11 offset:36864
  v_mfma_f32_16x16x32_bf16 v[68:71], a[152:155], a[28:31], v[68:71]
  ds_read_b64_tr_b16 a[146:147], v11 offset:37888
  v_mfma_f32_16x16x32_bf16 v[128:131], a[156:159], a[24:27], v[128:131]
  ds_read_b64_tr_b16 a[148:149], v11 offset:38912
  buffer_load_dwordx4 a[64:67], v2, s[16:19], s31 offen
  v_mfma_f32_16x16x32_bf16 v[132:135], a[156:159], a[28:31], v[132:135]
  ds_read_b64_tr_b16 a[150:151], v11 offset:39936
  s_waitcnt lgkmcnt(8)
  v_mfma_f32_16x16x32_bf16 v[72:75], a[160:163], a[24:27], v[72:75]
  ds_read_b64_tr_b16 a[152:153], v12 offset:36864
  v_mfma_f32_16x16x32_bf16 v[76:79], a[160:163], a[28:31], v[76:79]
  ds_read_b64_tr_b16 a[154:155], v12 offset:37888
  buffer_load_dwordx4 a[68:71], v2, s[16:19], s31 offen offset:1024
  s_add_u32 s31, s31, 4096
  v_mfma_f32_16x16x32_bf16 v[136:139], a[164:167], a[24:27], v[136:139]
  ds_read_b64_tr_b16 a[156:157], v12 offset:38912
  v_mfma_f32_16x16x32_bf16 v[140:143], a[164:167], a[28:31], v[140:143]
  ds_read_b64_tr_b16 a[158:159], v12 offset:39936
  s_waitcnt lgkmcnt(8)
  v_mfma_f32_16x16x32_bf16 v[80:83], a[168:171], a[24:27], v[80:83]
  ds_read_b64_tr_b16 a[160:161], v7 offset:8192
  v_mfma_f32_16x16x32_bf16 v[84:87], a[168:171], a[28:31], v[84:87]
  ds_read_b64_tr_b16 a[162:163], v7 offset:10240
  buffer_load_dwordx4 a[72:75], v2, s[16:19], s31 offen
  v_mfma_f32_16x16x32_bf16 v[144:147], a[172:175], a[24:27], v[144:147]
  ds_read_b64_tr_b16 a[164:165], v7 offset:12288
  v_mfma_f32_16x16x32_bf16 v[148:151], a[172:175], a[28:31], v[148:151]
  ds_read_b64_tr_b16 a[166:167], v7 offset:14336
  s_waitcnt lgkmcnt(8)
  v_mfma_f32_16x16x32_bf16 v[152:155], a[144:147], a[16:19], v[152:155]
  ds_read_b64_tr_b16 a[168:169], v8 offset:8192
  buffer_load_dwordx4 a[76:79], v2, s[16:19], s31 offen offset:1024
  s_add_u32 s31, s31, 4096
  v_mfma_f32_16x16x32_bf16 v[156:159], a[144:147], a[20:23], v[156:159]
  ds_read_b64_tr_b16 a[170:171], v8 offset:10240
  v_mfma_f32_16x16x32_bf16 v[168:171], a[148:151], a[16:19], v[168:171]
  ds_read_b64_tr_b16 a[172:173], v8 offset:12288
  v_mfma_f32_16x16x32_bf16 v[172:175], a[148:151], a[20:23], v[172:175]
  ds_read_b64_tr_b16 a[174:175], v8 offset:14336
  s_add_u32 m0, s27, 70656
  s_add_u32 s90, s90, 294912
  s_waitcnt lgkmcnt(8)
  v_mfma_f32_16x16x32_bf16 v[160:163], a[152:155], a[16:19], v[160:163]
  ds_read_b64_tr_b16 a[144:145], v9 offset:8192
  buffer_load_dwordx4 v5, s[12:15], s90 offen lds
  v_mfma_f32_16x16x32_bf16 v[164:167], a[152:155], a[20:23], v[164:167]
  ds_read_b64_tr_b16 a[146:147], v9 offset:10240
  v_mfma_f32_16x16x32_bf16 v[176:179], a[156:159], a[16:19], v[176:179]
  ds_read_b64_tr_b16 a[148:149], v9 offset:12288
  v_mfma_f32_16x16x32_bf16 v[180:183], a[156:159], a[20:23], v[180:183]
  ds_read_b64_tr_b16 a[150:151], v9 offset:14336
  s_waitcnt vmcnt(30) lgkmcnt(8)
  v_mfma_f32_16x16x32_bf16 v[24:27], a[160:163], a[32:35], v[24:27]
  ds_read_b64_tr_b16 a[152:153], v10 offset:8192
  s_waitcnt vmcnt(29)
  v_mfma_f32_16x16x32_bf16 v[28:31], a[160:163], a[36:39], v[28:31]
  ds_read_b64_tr_b16 a[154:155], v10 offset:10240
  v_mfma_f32_16x16x32_bf16 v[88:91], a[164:167], a[32:35], v[88:91]
  ds_read_b64_tr_b16 a[156:157], v10 offset:12288
  v_mfma_f32_16x16x32_bf16 v[92:95], a[164:167], a[36:39], v[92:95]
  ds_read_b64_tr_b16 a[158:159], v10 offset:14336
  s_waitcnt lgkmcnt(8)
  v_mfma_f32_16x16x32_bf16 v[32:35], a[168:171], a[32:35], v[32:35]
  ds_read_b64_tr_b16 a[160:161], v7 offset:16384
  s_add_u32 m0, s32, 36864
  s_add_u32 s30, s30, 294912
  v_mfma_f32_16x16x32_bf16 v[36:39], a[168:171], a[36:39], v[36:39]
  ds_read_b64_tr_b16 a[162:163], v7 offset:18432
  buffer_load_dwordx4 v3, s[12:15], s30 offen offset:0 lds
  v_mfma_f32_16x16x32_bf16 v[96:99], a[172:175], a[32:35], v[96:99]
  ds_read_b64_tr_b16 a[164:165], v7 offset:20480
  v_mfma_f32_16x16x32_bf16 v[100:103], a[172:175], a[36:39], v[100:103]
  ds_read_b64_tr_b16 a[166:167], v7 offset:22528
  s_waitcnt lgkmcnt(8)
  v_mfma_f32_16x16x32_bf16 v[40:43], a[144:147], a[32:35], v[40:43]
  ds_read_b64_tr_b16 a[168:169], v8 offset:16384
  s_add_u32 m0, s32, 37888
  v_mfma_f32_16x16x32_bf16 v[44:47], a[144:147], a[36:39], v[44:47]
  ds_read_b64_tr_b16 a[170:171], v8 offset:18432
  buffer_load_dwordx4 v4, s[12:15], s30 offen offset:0 lds
  v_mfma_f32_16x16x32_bf16 v[104:107], a[148:151], a[32:35], v[104:107]
  ds_read_b64_tr_b16 a[172:173], v8 offset:20480
  v_mfma_f32_16x16x32_bf16 v[108:111], a[148:151], a[36:39], v[108:111]
  ds_read_b64_tr_b16 a[174:175], v8 offset:22528
  s_waitcnt lgkmcnt(8)
  v_mfma_f32_16x16x32_bf16 v[48:51], a[152:155], a[32:35], v[48:51]
  ds_read_b64_tr_b16 a[144:145], v9 offset:16384
  v_mfma_f32_16x16x32_bf16 v[52:55], a[152:155], a[36:39], v[52:55]
  ds_read_b64_tr_b16 a[146:147], v9 offset:18432
  s_add_u32 m0, s32, 44928
  v_mfma_f32_16x16x32_bf16 v[112:115], a[156:159], a[32:35], v[112:115]
  ds_read_b64_tr_b16 a[148:149], v9 offset:20480
  buffer_load_dwordx4 v3, s[12:15], s30 offen offset:128 lds
  v_mfma_f32_16x16x32_bf16 v[116:119], a[156:159], a[36:39], v[116:119]
  ds_read_b64_tr_b16 a[150:151], v9 offset:22528
  s_waitcnt lgkmcnt(8)
  v_mfma_f32_16x16x32_bf16 v[56:59], a[160:163], a[32:35], v[56:59]
  ds_read_b64_tr_b16 a[152:153], v10 offset:16384
  v_mfma_f32_16x16x32_bf16 v[60:63], a[160:163], a[36:39], v[60:63]
  ds_read_b64_tr_b16 a[154:155], v10 offset:18432
  s_add_u32 m0, s32, 45952
  v_mfma_f32_16x16x32_bf16 v[120:123], a[164:167], a[32:35], v[120:123]
  ds_read_b64_tr_b16 a[156:157], v10 offset:20480
  buffer_load_dwordx4 v4, s[12:15], s30 offen offset:128 lds
  v_mfma_f32_16x16x32_bf16 v[124:127], a[164:167], a[36:39], v[124:127]
  ds_read_b64_tr_b16 a[158:159], v10 offset:22528
  s_waitcnt lgkmcnt(8)
  v_mfma_f32_16x16x32_bf16 v[64:67], a[168:171], a[32:35], v[64:67]
  ds_read_b64_tr_b16 a[160:161], v7 offset:24576
  v_mfma_f32_16x16x32_bf16 v[68:71], a[168:171], a[36:39], v[68:71]
  ds_read_b64_tr_b16 a[162:163], v7 offset:26624
  v_mfma_f32_16x16x32_bf16 v[128:131], a[172:175], a[32:35], v[128:131]
  ds_read_b64_tr_b16 a[164:165], v7 offset:28672
  s_add_u32 m0, s32, 53248
  s_add_u32 s30, s30, 294912
  v_mfma_f32_16x16x32_bf16 v[132:135], a[172:175], a[36:39], v[132:135]
  ds_read_b64_tr_b16 a[166:167], v7 offset:30720
  buffer_load_dwordx4 v3, s[12:15], s30 offen offset:0 lds
  s_waitcnt lgkmcnt(8)
  v_mfma_f32_16x16x32_bf16 v[72:75], a[144:147], a[32:35], v[72:75]
  ds_read_b64_tr_b16 a[168:169], v8 offset:24576
  v_mfma_f32_16x16x32_bf16 v[76:79], a[144:147], a[36:39], v[76:79]
  ds_read_b64_tr_b16 a[170:171], v8 offset:26624
  v_mfma_f32_16x16x32_bf16 v[136:139], a[148:151], a[32:35], v[136:139]
  ds_read_b64_tr_b16 a[172:173], v8 offset:28672
  s_add_u32 m0, s32, 54272
  v_mfma_f32_16x16x32_bf16 v[140:143], a[148:151], a[36:39], v[140:143]
  ds_read_b64_tr_b16 a[174:175], v8 offset:30720
  buffer_load_dwordx4 v4, s[12:15], s30 offen offset:0 lds
  s_waitcnt lgkmcnt(8)
  v_mfma_f32_16x16x32_bf16 v[80:83], a[152:155], a[32:35], v[80:83]
  ds_read_b64_tr_b16 a[144:145], v9 offset:24576
  v_mfma_f32_16x16x32_bf16 v[84:87], a[152:155], a[36:39], v[84:87]
  ds_read_b64_tr_b16 a[146:147], v9 offset:26624
  v_mfma_f32_16x16x32_bf16 v[144:147], a[156:159], a[32:35], v[144:147]
  ds_read_b64_tr_b16 a[148:149], v9 offset:28672
  v_mfma_f32_16x16x32_bf16 v[148:151], a[156:159], a[36:39], v[148:151]
  ds_read_b64_tr_b16 a[150:151], v9 offset:30720
  s_add_u32 m0, s32, 61312
  s_waitcnt vmcnt(31) lgkmcnt(8)
  v_mfma_f32_16x16x32_bf16 v[24:27], a[160:163], a[40:43], v[24:27]
  ds_read_b64_tr_b16 a[152:153], v10 offset:24576
  buffer_load_dwordx4 v3, s[12:15], s30 offen offset:128 lds
  s_waitcnt vmcnt(30)
  v_mfma_f32_16x16x32_bf16 v[28:31], a[160:163], a[44:47], v[28:31]
  ds_read_b64_tr_b16 a[154:155], v10 offset:26624
  v_mfma_f32_16x16x32_bf16 v[88:91], a[164:167], a[40:43], v[88:91]
  ds_read_b64_tr_b16 a[156:157], v10 offset:28672
  v_mfma_f32_16x16x32_bf16 v[92:95], a[164:167], a[44:47], v[92:95]
  ds_read_b64_tr_b16 a[158:159], v10 offset:30720
  s_add_u32 m0, s32, 62336
  s_waitcnt lgkmcnt(8)
  v_mfma_f32_16x16x32_bf16 v[32:35], a[168:171], a[40:43], v[32:35]
  ds_read_b64_tr_b16 a[160:161], v7 offset:32768
  buffer_load_dwordx4 v4, s[12:15], s30 offen offset:128 lds
  v_mfma_f32_16x16x32_bf16 v[36:39], a[168:171], a[44:47], v[36:39]
  ds_read_b64_tr_b16 a[162:163], v7 offset:34816
  v_mfma_f32_16x16x32_bf16 v[96:99], a[172:175], a[40:43], v[96:99]
  ds_read_b64_tr_b16 a[164:165], v7 offset:36864
  v_mfma_f32_16x16x32_bf16 v[100:103], a[172:175], a[44:47], v[100:103]
  ds_read_b64_tr_b16 a[166:167], v7 offset:38912
  s_waitcnt lgkmcnt(8)
  v_mfma_f32_16x16x32_bf16 v[40:43], a[144:147], a[40:43], v[40:43]
  ds_read_b64_tr_b16 a[168:169], v8 offset:32768
  v_mfma_f32_16x16x32_bf16 v[44:47], a[144:147], a[44:47], v[44:47]
  ds_read_b64_tr_b16 a[170:171], v8 offset:34816
  buffer_load_dwordx4 a[80:83], v2, s[16:19], s31 offen
  v_mfma_f32_16x16x32_bf16 v[104:107], a[148:151], a[40:43], v[104:107]
  ds_read_b64_tr_b16 a[172:173], v8 offset:36864
  v_mfma_f32_16x16x32_bf16 v[108:111], a[148:151], a[44:47], v[108:111]
  ds_read_b64_tr_b16 a[174:175], v8 offset:38912
  s_waitcnt lgkmcnt(8)
  v_mfma_f32_16x16x32_bf16 v[48:51], a[152:155], a[40:43], v[48:51]
  ds_read_b64_tr_b16 a[144:145], v9 offset:32768
  v_mfma_f32_16x16x32_bf16 v[52:55], a[152:155], a[44:47], v[52:55]
  ds_read_b64_tr_b16 a[146:147], v9 offset:34816
  buffer_load_dwordx4 a[84:87], v2, s[16:19], s31 offen offset:1024
  s_add_u32 s31, s31, 4096
  v_mfma_f32_16x16x32_bf16 v[112:115], a[156:159], a[40:43], v[112:115]
  ds_read_b64_tr_b16 a[148:149], v9 offset:36864
  v_mfma_f32_16x16x32_bf16 v[116:119], a[156:159], a[44:47], v[116:119]
  ds_read_b64_tr_b16 a[150:151], v9 offset:38912
  s_waitcnt lgkmcnt(8)
  v_mfma_f32_16x16x32_bf16 v[56:59], a[160:163], a[40:43], v[56:59]
  ds_read_b64_tr_b16 a[152:153], v10 offset:32768
  v_mfma_f32_16x16x32_bf16 v[60:63], a[160:163], a[44:47], v[60:63]
  ds_read_b64_tr_b16 a[154:155], v10 offset:34816
  v_mfma_f32_16x16x32_bf16 v[120:123], a[164:167], a[40:43], v[120:123]
  ds_read_b64_tr_b16 a[156:157], v10 offset:36864
  buffer_load_dwordx4 a[88:91], v2, s[16:19], s31 offen
  v_mfma_f32_16x16x32_bf16 v[124:127], a[164:167], a[44:47], v[124:127]
  ds_read_b64_tr_b16 a[158:159], v10 offset:38912
  s_waitcnt lgkmcnt(8)
  v_mfma_f32_16x16x32_bf16 v[64:67], a[168:171], a[40:43], v[64:67]
  s_waitcnt vmcnt(29)
  s_barrier
  v_add_u32 v11, 73728, v11
  ds_read_b64_tr_b16 a[160:161], v11 offset:0
  v_mfma_f32_16x16x32_bf16 v[68:71], a[168:171], a[44:47], v[68:71]
  ds_read_b64_tr_b16 a[162:163], v11 offset:1024
  v_mfma_f32_16x16x32_bf16 v[128:131], a[172:175], a[40:43], v[128:131]
  ds_read_b64_tr_b16 a[164:165], v11 offset:2048
  buffer_load_dwordx4 a[92:95], v2, s[16:19], s31 offen offset:1024
  s_add_u32 s31, s31, 4096
  v_mfma_f32_16x16x32_bf16 v[132:135], a[172:175], a[44:47], v[132:135]
  ds_read_b64_tr_b16 a[166:167], v11 offset:3072
  s_waitcnt lgkmcnt(8)
  v_mfma_f32_16x16x32_bf16 v[72:75], a[144:147], a[40:43], v[72:75]
  v_add_u32 v12, 73728, v12
  ds_read_b64_tr_b16 a[168:169], v12 offset:0
  v_mfma_f32_16x16x32_bf16 v[76:79], a[144:147], a[44:47], v[76:79]
  ds_read_b64_tr_b16 a[170:171], v12 offset:1024
  v_mfma_f32_16x16x32_bf16 v[136:139], a[148:151], a[40:43], v[136:139]
  ds_read_b64_tr_b16 a[172:173], v12 offset:2048
  v_mfma_f32_16x16x32_bf16 v[140:143], a[148:151], a[44:47], v[140:143]
  ds_read_b64_tr_b16 a[174:175], v12 offset:3072
  buffer_load_dwordx4 a[96:99], v2, s[16:19], s31 offen
  s_waitcnt lgkmcnt(8)
  v_mfma_f32_16x16x32_bf16 v[80:83], a[152:155], a[40:43], v[80:83]
  ds_read_b64_tr_b16 a[144:145], v7 offset:45056
  v_mfma_f32_16x16x32_bf16 v[84:87], a[152:155], a[44:47], v[84:87]
  ds_read_b64_tr_b16 a[146:147], v7 offset:47104
  v_mfma_f32_16x16x32_bf16 v[144:147], a[156:159], a[40:43], v[144:147]
  ds_read_b64_tr_b16 a[148:149], v7 offset:49152
  v_mfma_f32_16x16x32_bf16 v[148:151], a[156:159], a[44:47], v[148:151]
  ds_read_b64_tr_b16 a[150:151], v7 offset:51200
  buffer_load_dwordx4 a[100:103], v2, s[16:19], s31 offen offset:1024
  s_add_u32 s31, s31, 4096
  s_waitcnt lgkmcnt(8)
  v_mfma_f32_16x16x32_bf16 v[152:155], a[160:163], a[24:27], v[152:155]
  ds_read_b64_tr_b16 a[152:153], v8 offset:45056
  v_mfma_f32_16x16x32_bf16 v[156:159], a[160:163], a[28:31], v[156:159]
  ds_read_b64_tr_b16 a[154:155], v8 offset:47104
  v_mfma_f32_16x16x32_bf16 v[168:171], a[164:167], a[24:27], v[168:171]
  ds_read_b64_tr_b16 a[156:157], v8 offset:49152
  v_mfma_f32_16x16x32_bf16 v[172:175], a[164:167], a[28:31], v[172:175]
  ds_read_b64_tr_b16 a[158:159], v8 offset:51200
  s_add_u32 m0, s27, 107520
  s_add_u32 s90, s90, 294912
  s_waitcnt lgkmcnt(8)
  v_mfma_f32_16x16x32_bf16 v[160:163], a[168:171], a[24:27], v[160:163]
  ds_read_b64_tr_b16 a[160:161], v9 offset:45056
  buffer_load_dwordx4 v5, s[12:15], s90 offen lds
  v_mfma_f32_16x16x32_bf16 v[164:167], a[168:171], a[28:31], v[164:167]
  ds_read_b64_tr_b16 a[162:163], v9 offset:47104
  v_mfma_f32_16x16x32_bf16 v[176:179], a[172:175], a[24:27], v[176:179]
  ds_read_b64_tr_b16 a[164:165], v9 offset:49152
  v_mfma_f32_16x16x32_bf16 v[180:183], a[172:175], a[28:31], v[180:183]
  ds_read_b64_tr_b16 a[166:167], v9 offset:51200
  s_waitcnt vmcnt(32) lgkmcnt(8)
  v_mfma_f32_16x16x32_bf16 v[24:27], a[144:147], a[48:51], v[24:27]
  ds_read_b64_tr_b16 a[168:169], v10 offset:45056
  s_waitcnt vmcnt(31)
  v_mfma_f32_16x16x32_bf16 v[28:31], a[144:147], a[52:55], v[28:31]
  ds_read_b64_tr_b16 a[170:171], v10 offset:47104
  v_mfma_f32_16x16x32_bf16 v[88:91], a[148:151], a[48:51], v[88:91]
  ds_read_b64_tr_b16 a[172:173], v10 offset:49152
  v_mfma_f32_16x16x32_bf16 v[92:95], a[148:151], a[52:55], v[92:95]
  ds_read_b64_tr_b16 a[174:175], v10 offset:51200
  s_waitcnt lgkmcnt(8)
  v_mfma_f32_16x16x32_bf16 v[32:35], a[152:155], a[48:51], v[32:35]
  ds_read_b64_tr_b16 a[144:145], v7 offset:53248
  s_add_u32 m0, s32, 73728
  s_add_u32 s30, s30, 294912
  v_mfma_f32_16x16x32_bf16 v[36:39], a[152:155], a[52:55], v[36:39]
  ds_read_b64_tr_b16 a[146:147], v7 offset:55296
  buffer_load_dwordx4 v3, s[12:15], s30 offen offset:0 lds
  v_mfma_f32_16x16x32_bf16 v[96:99], a[156:159], a[48:51], v[96:99]
  ds_read_b64_tr_b16 a[148:149], v7 offset:57344
  v_mfma_f32_16x16x32_bf16 v[100:103], a[156:159], a[52:55], v[100:103]
  ds_read_b64_tr_b16 a[150:151], v7 offset:59392
  s_waitcnt lgkmcnt(8)
  v_mfma_f32_16x16x32_bf16 v[40:43], a[160:163], a[48:51], v[40:43]
  ds_read_b64_tr_b16 a[152:153], v8 offset:53248
  s_add_u32 m0, s32, 74752
  v_mfma_f32_16x16x32_bf16 v[44:47], a[160:163], a[52:55], v[44:47]
  ds_read_b64_tr_b16 a[154:155], v8 offset:55296
  buffer_load_dwordx4 v4, s[12:15], s30 offen offset:0 lds
  v_mfma_f32_16x16x32_bf16 v[104:107], a[164:167], a[48:51], v[104:107]
  ds_read_b64_tr_b16 a[156:157], v8 offset:57344
  v_mfma_f32_16x16x32_bf16 v[108:111], a[164:167], a[52:55], v[108:111]
  ds_read_b64_tr_b16 a[158:159], v8 offset:59392
  s_waitcnt lgkmcnt(8)
  v_mfma_f32_16x16x32_bf16 v[48:51], a[168:171], a[48:51], v[48:51]
  ds_read_b64_tr_b16 a[160:161], v9 offset:53248
  v_mfma_f32_16x16x32_bf16 v[52:55], a[168:171], a[52:55], v[52:55]
  ds_read_b64_tr_b16 a[162:163], v9 offset:55296
  s_add_u32 m0, s32, 81792
  v_mfma_f32_16x16x32_bf16 v[112:115], a[172:175], a[48:51], v[112:115]
  ds_read_b64_tr_b16 a[164:165], v9 offset:57344
  buffer_load_dwordx4 v3, s[12:15], s30 offen offset:128 lds
  v_mfma_f32_16x16x32_bf16 v[116:119], a[172:175], a[52:55], v[116:119]
  ds_read_b64_tr_b16 a[166:167], v9 offset:59392
  s_waitcnt lgkmcnt(8)
  v_mfma_f32_16x16x32_bf16 v[56:59], a[144:147], a[48:51], v[56:59]
  ds_read_b64_tr_b16 a[168:169], v10 offset:53248
  v_mfma_f32_16x16x32_bf16 v[60:63], a[144:147], a[52:55], v[60:63]
  ds_read_b64_tr_b16 a[170:171], v10 offset:55296
  s_add_u32 m0, s32, 82816
  v_mfma_f32_16x16x32_bf16 v[120:123], a[148:151], a[48:51], v[120:123]
  ds_read_b64_tr_b16 a[172:173], v10 offset:57344
  buffer_load_dwordx4 v4, s[12:15], s30 offen offset:128 lds
  v_mfma_f32_16x16x32_bf16 v[124:127], a[148:151], a[52:55], v[124:127]
  ds_read_b64_tr_b16 a[174:175], v10 offset:59392
  s_waitcnt lgkmcnt(8)
  v_mfma_f32_16x16x32_bf16 v[64:67], a[152:155], a[48:51], v[64:67]
  ds_read_b64_tr_b16 a[144:145], v7 offset:61440
  v_mfma_f32_16x16x32_bf16 v[68:71], a[152:155], a[52:55], v[68:71]
  ds_read_b64_tr_b16 a[146:147], v7 offset:63488
  v_mfma_f32_16x16x32_bf16 v[128:131], a[156:159], a[48:51], v[128:131]
  v_add_u32 v7, 65536, v7
  ds_read_b64_tr_b16 a[148:149], v7 offset:0
  s_add_u32 m0, s32, 90112
  s_add_u32 s30, s30, 294912
  v_mfma_f32_16x16x32_bf16 v[132:135], a[156:159], a[52:55], v[132:135]
  ds_read_b64_tr_b16 a[150:151], v7 offset:2048
  buffer_load_dwordx4 v3, s[12:15], s30 offen offset:0 lds
  s_waitcnt lgkmcnt(8)
  v_mfma_f32_16x16x32_bf16 v[72:75], a[160:163], a[48:51], v[72:75]
  ds_read_b64_tr_b16 a[152:153], v8 offset:61440
  v_mfma_f32_16x16x32_bf16 v[76:79], a[160:163], a[52:55], v[76:79]
  ds_read_b64_tr_b16 a[154:155], v8 offset:63488
  v_mfma_f32_16x16x32_bf16 v[136:139], a[164:167], a[48:51], v[136:139]
  v_add_u32 v8, 65536, v8
  ds_read_b64_tr_b16 a[156:157], v8 offset:0
  s_add_u32 m0, s32, 91136
  v_mfma_f32_16x16x32_bf16 v[140:143], a[164:167], a[52:55], v[140:143]
  ds_read_b64_tr_b16 a[158:159], v8 offset:2048
  buffer_load_dwordx4 v4, s[12:15], s30 offen offset:0 lds
  s_waitcnt lgkmcnt(8)
  v_mfma_f32_16x16x32_bf16 v[80:83], a[168:171], a[48:51], v[80:83]
  ds_read_b64_tr_b16 a[160:161], v9 offset:61440
  v_mfma_f32_16x16x32_bf16 v[84:87], a[168:171], a[52:55], v[84:87]
  ds_read_b64_tr_b16 a[162:163], v9 offset:63488
  v_mfma_f32_16x16x32_bf16 v[144:147], a[172:175], a[48:51], v[144:147]
  v_add_u32 v9, 65536, v9
  ds_read_b64_tr_b16 a[164:165], v9 offset:0
  v_mfma_f32_16x16x32_bf16 v[148:151], a[172:175], a[52:55], v[148:151]
  ds_read_b64_tr_b16 a[166:167], v9 offset:2048
  s_add_u32 m0, s32, 98176
  s_waitcnt vmcnt(33) lgkmcnt(8)
  v_mfma_f32_16x16x32_bf16 v[24:27], a[144:147], a[56:59], v[24:27]
  ds_read_b64_tr_b16 a[168:169], v10 offset:61440
  buffer_load_dwordx4 v3, s[12:15], s30 offen offset:128 lds
  s_waitcnt vmcnt(32)
  v_mfma_f32_16x16x32_bf16 v[28:31], a[144:147], a[60:63], v[28:31]
  ds_read_b64_tr_b16 a[170:171], v10 offset:63488
  v_mfma_f32_16x16x32_bf16 v[88:91], a[148:151], a[56:59], v[88:91]
  v_add_u32 v10, 65536, v10
  ds_read_b64_tr_b16 a[172:173], v10 offset:0
  v_mfma_f32_16x16x32_bf16 v[92:95], a[148:151], a[60:63], v[92:95]
  ds_read_b64_tr_b16 a[174:175], v10 offset:2048
  s_add_u32 m0, s32, 99200
  s_waitcnt lgkmcnt(8)
  v_mfma_f32_16x16x32_bf16 v[32:35], a[152:155], a[56:59], v[32:35]
  ds_read_b64_tr_b16 a[144:145], v7 offset:4096
  buffer_load_dwordx4 v4, s[12:15], s30 offen offset:128 lds
  v_mfma_f32_16x16x32_bf16 v[36:39], a[152:155], a[60:63], v[36:39]
  ds_read_b64_tr_b16 a[146:147], v7 offset:6144
  v_mfma_f32_16x16x32_bf16 v[96:99], a[156:159], a[56:59], v[96:99]
  ds_read_b64_tr_b16 a[148:149], v7 offset:8192
  v_mfma_f32_16x16x32_bf16 v[100:103], a[156:159], a[60:63], v[100:103]
  ds_read_b64_tr_b16 a[150:151], v7 offset:10240
  s_waitcnt lgkmcnt(8)
  v_mfma_f32_16x16x32_bf16 v[40:43], a[160:163], a[56:59], v[40:43]
  ds_read_b64_tr_b16 a[152:153], v8 offset:4096
  v_mfma_f32_16x16x32_bf16 v[44:47], a[160:163], a[60:63], v[44:47]
  ds_read_b64_tr_b16 a[154:155], v8 offset:6144
  buffer_load_dwordx4 a[104:107], v2, s[16:19], s31 offen
  v_mfma_f32_16x16x32_bf16 v[104:107], a[164:167], a[56:59], v[104:107]
  ds_read_b64_tr_b16 a[156:157], v8 offset:8192
  v_mfma_f32_16x16x32_bf16 v[108:111], a[164:167], a[60:63], v[108:111]
  ds_read_b64_tr_b16 a[158:159], v8 offset:10240
  s_waitcnt lgkmcnt(8)
  v_mfma_f32_16x16x32_bf16 v[48:51], a[168:171], a[56:59], v[48:51]
  ds_read_b64_tr_b16 a[160:161], v9 offset:4096
  v_mfma_f32_16x16x32_bf16 v[52:55], a[168:171], a[60:63], v[52:55]
  ds_read_b64_tr_b16 a[162:163], v9 offset:6144
  buffer_load_dwordx4 a[108:111], v2, s[16:19], s31 offen offset:1024
  s_add_u32 s31, s31, 4096
  v_mfma_f32_16x16x32_bf16 v[112:115], a[172:175], a[56:59], v[112:115]
  ds_read_b64_tr_b16 a[164:165], v9 offset:8192
  v_mfma_f32_16x16x32_bf16 v[116:119], a[172:175], a[60:63], v[116:119]
  ds_read_b64_tr_b16 a[166:167], v9 offset:10240
  s_waitcnt lgkmcnt(8)
  v_mfma_f32_16x16x32_bf16 v[56:59], a[144:147], a[56:59], v[56:59]
  ds_read_b64_tr_b16 a[168:169], v10 offset:4096
  v_mfma_f32_16x16x32_bf16 v[60:63], a[144:147], a[60:63], v[60:63]
  ds_read_b64_tr_b16 a[170:171], v10 offset:6144
  v_mfma_f32_16x16x32_bf16 v[120:123], a[148:151], a[56:59], v[120:123]
  ds_read_b64_tr_b16 a[172:173], v10 offset:8192
  buffer_load_dwordx4 a[112:115], v2, s[16:19], s31 offen
  v_mfma_f32_16x16x32_bf16 v[124:127], a[148:151], a[60:63], v[124:127]
  ds_read_b64_tr_b16 a[174:175], v10 offset:10240
  s_waitcnt lgkmcnt(8)
  v_mfma_f32_16x16x32_bf16 v[64:67], a[152:155], a[56:59], v[64:67]
  s_waitcnt vmcnt(31)
  s_barrier
  v_add_u32 v11, -110592, v11
  ds_read_b64_tr_b16 a[144:145], v11 offset:0
  v_mfma_f32_16x16x32_bf16 v[68:71], a[152:155], a[60:63], v[68:71]
  ds_read_b64_tr_b16 a[146:147], v11 offset:1024
  v_mfma_f32_16x16x32_bf16 v[128:131], a[156:159], a[56:59], v[128:131]
  ds_read_b64_tr_b16 a[148:149], v11 offset:2048
  buffer_load_dwordx4 a[116:119], v2, s[16:19], s31 offen offset:1024
  s_add_u32 s31, s31, 4096
  v_mfma_f32_16x16x32_bf16 v[132:135], a[156:159], a[60:63], v[132:135]
  ds_read_b64_tr_b16 a[150:151], v11 offset:3072
  s_waitcnt lgkmcnt(8)
  v_mfma_f32_16x16x32_bf16 v[72:75], a[160:163], a[56:59], v[72:75]
  v_add_u32 v12, -110592, v12
  ds_read_b64_tr_b16 a[152:153], v12 offset:0
  v_mfma_f32_16x16x32_bf16 v[76:79], a[160:163], a[60:63], v[76:79]
  ds_read_b64_tr_b16 a[154:155], v12 offset:1024
  v_mfma_f32_16x16x32_bf16 v[136:139], a[164:167], a[56:59], v[136:139]
  ds_read_b64_tr_b16 a[156:157], v12 offset:2048
  v_mfma_f32_16x16x32_bf16 v[140:143], a[164:167], a[60:63], v[140:143]
  ds_read_b64_tr_b16 a[158:159], v12 offset:3072
  buffer_load_dwordx4 a[120:123], v2, s[16:19], s31 offen
  s_waitcnt lgkmcnt(8)
  v_mfma_f32_16x16x32_bf16 v[80:83], a[168:171], a[56:59], v[80:83]
  v_add_u32 v7, -131072, v7
  ds_read_b64_tr_b16 a[160:161], v7 offset:0
  v_mfma_f32_16x16x32_bf16 v[84:87], a[168:171], a[60:63], v[84:87]
  ds_read_b64_tr_b16 a[162:163], v7 offset:2048
  v_mfma_f32_16x16x32_bf16 v[144:147], a[172:175], a[56:59], v[144:147]
  ds_read_b64_tr_b16 a[164:165], v7 offset:4096
  v_mfma_f32_16x16x32_bf16 v[148:151], a[172:175], a[60:63], v[148:151]
  ds_read_b64_tr_b16 a[166:167], v7 offset:6144
  buffer_load_dwordx4 a[124:127], v2, s[16:19], s31 offen offset:1024
  s_add_u32 s31, s31, 4096
  s_waitcnt lgkmcnt(8)
  v_mfma_f32_16x16x32_bf16 v[152:155], a[144:147], a[32:35], v[152:155]
  v_add_u32 v8, -131072, v8
  ds_read_b64_tr_b16 a[168:169], v8 offset:0
  v_and_b32 v224, 15, v1
  v_mfma_f32_16x16x32_bf16 v[156:159], a[144:147], a[36:39], v[156:159]
  ds_read_b64_tr_b16 a[170:171], v8 offset:2048
  v_lshrrev_b32 v225, 4, v1
  v_mfma_f32_16x16x32_bf16 v[168:171], a[148:151], a[32:35], v[168:171]
  ds_read_b64_tr_b16 a[172:173], v8 offset:4096
  v_lshlrev_b32 v17, 2, v224
  v_mfma_f32_16x16x32_bf16 v[172:175], a[148:151], a[36:39], v[172:175]
  ds_read_b64_tr_b16 a[174:175], v8 offset:6144
  s_add_u32 m0, s27, 144384
  s_add_u32 s90, s90, 294912
  s_waitcnt lgkmcnt(8)
  v_mfma_f32_16x16x32_bf16 v[160:163], a[152:155], a[32:35], v[160:163]
  v_add_u32 v9, -131072, v9
  ds_read_b64_tr_b16 a[144:145], v9 offset:0
  buffer_load_dwordx4 v5, s[12:15], s90 offen lds
  v_mfma_f32_16x16x32_bf16 v[164:167], a[152:155], a[36:39], v[164:167]
  ds_read_b64_tr_b16 a[146:147], v9 offset:2048
  v_and_b32 v226, 1, v225
  v_mfma_f32_16x16x32_bf16 v[176:179], a[156:159], a[32:35], v[176:179]
  ds_read_b64_tr_b16 a[148:149], v9 offset:4096
  v_lshl_add_u32 v227, v226, 10, v17
  v_mfma_f32_16x16x32_bf16 v[180:183], a[156:159], a[36:39], v[180:183]
  ds_read_b64_tr_b16 a[150:151], v9 offset:6144
  s_waitcnt vmcnt(34) lgkmcnt(8)
  v_mfma_f32_16x16x32_bf16 v[24:27], a[160:163], a[64:67], v[24:27]
  v_add_u32 v10, -131072, v10
  ds_read_b64_tr_b16 a[152:153], v10 offset:0
  v_lshrrev_b32 v228, 1, v225
  s_waitcnt vmcnt(33)
  v_mfma_f32_16x16x32_bf16 v[28:31], a[160:163], a[68:71], v[28:31]
  ds_read_b64_tr_b16 a[154:155], v10 offset:2048
  v_lshl_add_u32 v227, v228, 6, v227
  v_mfma_f32_16x16x32_bf16 v[88:91], a[164:167], a[64:67], v[88:91]
  ds_read_b64_tr_b16 a[156:157], v10 offset:4096
  s_lshl_b32 s98, s26, 2
  v_mfma_f32_16x16x32_bf16 v[92:95], a[164:167], a[68:71], v[92:95]
  ds_read_b64_tr_b16 a[158:159], v10 offset:6144
  s_waitcnt lgkmcnt(8)
  v_mfma_f32_16x16x32_bf16 v[32:35], a[168:171], a[64:67], v[32:35]
  ds_read_b64_tr_b16 a[160:161], v7 offset:8192
  s_add_u32 m0, s32, 110592
  s_add_u32 s30, s30, 294912
  v_mfma_f32_16x16x32_bf16 v[36:39], a[168:171], a[68:71], v[36:39]
  ds_read_b64_tr_b16 a[162:163], v7 offset:10240
  buffer_load_dwordx4 v3, s[12:15], s30 offen offset:0 lds
  v_mfma_f32_16x16x32_bf16 v[96:99], a[172:175], a[64:67], v[96:99]
  ds_read_b64_tr_b16 a[164:165], v7 offset:12288
  s_add_u32 s98, s98, s24
  v_mfma_f32_16x16x32_bf16 v[100:103], a[172:175], a[68:71], v[100:103]
  ds_read_b64_tr_b16 a[166:167], v7 offset:14336
  s_waitcnt lgkmcnt(8)
  v_mfma_f32_16x16x32_bf16 v[40:43], a[144:147], a[64:67], v[40:43]
  ds_read_b64_tr_b16 a[168:169], v8 offset:8192
  s_add_u32 m0, s32, 111616
  v_mfma_f32_16x16x32_bf16 v[44:47], a[144:147], a[68:71], v[44:47]
  ds_read_b64_tr_b16 a[170:171], v8 offset:10240
k4_part_w1:
  s_cbranch_execz k4_part_w5
  buffer_load_dwordx4 v4, s[12:15], s30 offen offset:0 lds
  v_mfma_f32_16x16x32_bf16 v[104:107], a[148:151], a[64:67], v[104:107]
  ds_read_b64_tr_b16 a[172:173], v8 offset:12288
  s_lshl_b32 s100, s98, 11
  v_mfma_f32_16x16x32_bf16 v[108:111], a[148:151], a[68:71], v[108:111]
  ds_read_b64_tr_b16 a[174:175], v8 offset:14336
  s_waitcnt lgkmcnt(8)
  v_mfma_f32_16x16x32_bf16 v[48:51], a[152:155], a[64:67], v[48:51]
  ds_read_b64_tr_b16 a[144:145], v9 offset:8192
  s_add_u32 s100, s100, 17301504
  v_mfma_f32_16x16x32_bf16 v[52:55], a[152:155], a[68:71], v[52:55]
  ds_read_b64_tr_b16 a[146:147], v9 offset:10240
  s_add_u32 m0, s32, 118656
  v_mfma_f32_16x16x32_bf16 v[112:115], a[156:159], a[64:67], v[112:115]
  ds_read_b64_tr_b16 a[148:149], v9 offset:12288
  buffer_load_dwordx4 v3, s[12:15], s30 offen offset:128 lds
  v_mfma_f32_16x16x32_bf16 v[116:119], a[156:159], a[68:71], v[116:119]
  ds_read_b64_tr_b16 a[150:151], v9 offset:14336
  s_waitcnt lgkmcnt(8)
  v_mfma_f32_16x16x32_bf16 v[56:59], a[160:163], a[64:67], v[56:59]
  ds_read_b64_tr_b16 a[152:153], v10 offset:8192
  buffer_load_dword v232, v227, s[8:11], s100 offen offset:0
  v_mfma_f32_16x16x32_bf16 v[60:63], a[160:163], a[68:71], v[60:63]
  ds_read_b64_tr_b16 a[154:155], v10 offset:10240
  s_add_u32 m0, s32, 119680
  v_mfma_f32_16x16x32_bf16 v[120:123], a[164:167], a[64:67], v[120:123]
  ds_read_b64_tr_b16 a[156:157], v10 offset:12288
  buffer_load_dwordx4 v4, s[12:15], s30 offen offset:128 lds
  v_mfma_f32_16x16x32_bf16 v[124:127], a[164:167], a[68:71], v[124:127]
  ds_read_b64_tr_b16 a[158:159], v10 offset:14336
  s_waitcnt lgkmcnt(8)
  v_mfma_f32_16x16x32_bf16 v[64:67], a[168:171], a[64:67], v[64:67]
  ds_read_b64_tr_b16 a[160:161], v7 offset:16384
  buffer_load_dword v233, v227, s[8:11], s100 offen offset:128
  v_mfma_f32_16x16x32_bf16 v[68:71], a[168:171], a[68:71], v[68:71]
  ds_read_b64_tr_b16 a[162:163], v7 offset:18432
  buffer_load_dword v234, v227, s[8:11], s100 offen offset:256
  v_mfma_f32_16x16x32_bf16 v[128:131], a[172:175], a[64:67], v[128:131]
  ds_read_b64_tr_b16 a[164:165], v7 offset:20480
  s_add_u32 m0, s32, 126976
  s_add_u32 s30, s30, 294912
  v_mfma_f32_16x16x32_bf16 v[132:135], a[172:175], a[68:71], v[132:135]
  ds_read_b64_tr_b16 a[166:167], v7 offset:22528
  buffer_load_dwordx4 v3, s[12:15], s30 offen offset:0 lds
  s_waitcnt lgkmcnt(8)
  v_mfma_f32_16x16x32_bf16 v[72:75], a[144:147], a[64:67], v[72:75]
  ds_read_b64_tr_b16 a[168:169], v8 offset:16384
  buffer_load_dword v235, v227, s[8:11], s100 offen offset:384
  v_mfma_f32_16x16x32_bf16 v[76:79], a[144:147], a[68:71], v[76:79]
  ds_read_b64_tr_b16 a[170:171], v8 offset:18432
  buffer_load_dword v236, v227, s[8:11], s100 offen offset:512
  v_mfma_f32_16x16x32_bf16 v[136:139], a[148:151], a[64:67], v[136:139]
  ds_read_b64_tr_b16 a[172:173], v8 offset:20480
  s_add_u32 m0, s32, 128000
  v_mfma_f32_16x16x32_bf16 v[140:143], a[148:151], a[68:71], v[140:143]
  ds_read_b64_tr_b16 a[174:175], v8 offset:22528
  buffer_load_dwordx4 v4, s[12:15], s30 offen offset:0 lds
  s_waitcnt lgkmcnt(8)
  v_mfma_f32_16x16x32_bf16 v[80:83], a[152:155], a[64:67], v[80:83]
  ds_read_b64_tr_b16 a[144:145], v9 offset:16384
  buffer_load_dword v237, v227, s[8:11], s100 offen offset:640
  v_mfma_f32_16x16x32_bf16 v[84:87], a[152:155], a[68:71], v[84:87]
  ds_read_b64_tr_b16 a[146:147], v9 offset:18432
  s_mul_i32 s95, s98, 36864
  v_mfma_f32_16x16x32_bf16 v[144:147], a[156:159], a[64:67], v[144:147]
  ds_read_b64_tr_b16 a[148:149], v9 offset:20480
  s_lshr_b32 s100, s98, 1
  v_mfma_f32_16x16x32_bf16 v[148:151], a[156:159], a[68:71], v[148:151]
  ds_read_b64_tr_b16 a[150:151], v9 offset:22528
  s_add_u32 m0, s32, 135040
  s_waitcnt vmcnt(44) lgkmcnt(8)
  v_mfma_f32_16x16x32_bf16 v[24:27], a[160:163], a[72:75], v[24:27]
  ds_read_b64_tr_b16 a[152:153], v10 offset:16384
  buffer_load_dwordx4 v3, s[12:15], s30 offen offset:128 lds
  s_waitcnt vmcnt(44)
  v_mfma_f32_16x16x32_bf16 v[28:31], a[160:163], a[76:79], v[28:31]
  ds_read_b64_tr_b16 a[154:155], v10 offset:18432
  s_mul_i32 s100, s100, 73728
  v_mfma_f32_16x16x32_bf16 v[88:91], a[164:167], a[72:75], v[88:91]
  ds_read_b64_tr_b16 a[156:157], v10 offset:20480
  s_add_u32 s100, s100, 12582912
  v_mfma_f32_16x16x32_bf16 v[92:95], a[164:167], a[76:79], v[92:95]
  ds_read_b64_tr_b16 a[158:159], v10 offset:22528
  s_add_u32 m0, s32, 136064
  s_waitcnt lgkmcnt(8)
  v_mfma_f32_16x16x32_bf16 v[32:35], a[168:171], a[72:75], v[32:35]
  ds_read_b64_tr_b16 a[160:161], v7 offset:24576
  buffer_load_dwordx4 v4, s[12:15], s30 offen offset:128 lds
  v_mfma_f32_16x16x32_bf16 v[36:39], a[168:171], a[76:79], v[36:39]
  ds_read_b64_tr_b16 a[162:163], v7 offset:26624
  s_lshl_b32 s101, s21, 2
  v_mfma_f32_16x16x32_bf16 v[96:99], a[172:175], a[72:75], v[96:99]
  ds_read_b64_tr_b16 a[164:165], v7 offset:28672
  s_add_u32 s101, s101, s20
  v_mfma_f32_16x16x32_bf16 v[100:103], a[172:175], a[76:79], v[100:103]
  ds_read_b64_tr_b16 a[166:167], v7 offset:30720
  s_waitcnt lgkmcnt(8)
  v_mfma_f32_16x16x32_bf16 v[40:43], a[144:147], a[72:75], v[40:43]
  ds_read_b64_tr_b16 a[168:169], v8 offset:24576
  s_lshl_b32 s28, s101, 12
  v_mfma_f32_16x16x32_bf16 v[44:47], a[144:147], a[76:79], v[44:47]
  ds_read_b64_tr_b16 a[170:171], v8 offset:26624
  buffer_load_dwordx4 a[128:131], v2, s[16:19], s31 offen
  v_mfma_f32_16x16x32_bf16 v[104:107], a[148:151], a[72:75], v[104:107]
  ds_read_b64_tr_b16 a[172:173], v8 offset:28672
  s_add_u32 s22, s100, s28
  v_mfma_f32_16x16x32_bf16 v[108:111], a[148:151], a[76:79], v[108:111]
  ds_read_b64_tr_b16 a[174:175], v8 offset:30720
  s_waitcnt lgkmcnt(8)
  v_mfma_f32_16x16x32_bf16 v[48:51], a[152:155], a[72:75], v[48:51]
  ds_read_b64_tr_b16 a[144:145], v9 offset:24576
  s_and_b32 s99, s21, 1
  v_mfma_f32_16x16x32_bf16 v[52:55], a[152:155], a[76:79], v[52:55]
  ds_read_b64_tr_b16 a[146:147], v9 offset:26624
  buffer_load_dwordx4 a[132:135], v2, s[16:19], s31 offen offset:1024
  s_add_u32 s31, s31, 4096
  v_mfma_f32_16x16x32_bf16 v[112:115], a[156:159], a[72:75], v[112:115]
  ds_read_b64_tr_b16 a[148:149], v9 offset:28672
  s_mul_i32 s96, s99, 18432
  v_mfma_f32_16x16x32_bf16 v[116:119], a[156:159], a[76:79], v[116:119]
  ds_read_b64_tr_b16 a[150:151], v9 offset:30720
  s_waitcnt lgkmcnt(8)
  v_mfma_f32_16x16x32_bf16 v[56:59], a[160:163], a[72:75], v[56:59]
  ds_read_b64_tr_b16 a[152:153], v10 offset:24576
  s_add_u32 s96, s96, s95
  v_mfma_f32_16x16x32_bf16 v[60:63], a[160:163], a[76:79], v[60:63]
  ds_read_b64_tr_b16 a[154:155], v10 offset:26624
  s_lshl_b32 s28, s101, 6
  v_mfma_f32_16x16x32_bf16 v[120:123], a[164:167], a[72:75], v[120:123]
  ds_read_b64_tr_b16 a[156:157], v10 offset:28672
  buffer_load_dwordx4 a[136:139], v2, s[16:19], s31 offen
  v_mfma_f32_16x16x32_bf16 v[124:127], a[164:167], a[76:79], v[124:127]
  ds_read_b64_tr_b16 a[158:159], v10 offset:30720
  s_waitcnt lgkmcnt(8)
  v_mfma_f32_16x16x32_bf16 v[64:67], a[168:171], a[72:75], v[64:67]
  s_waitcnt vmcnt(39)
  s_barrier
  ds_read_b64_tr_b16 a[160:161], v11 offset:36864
  s_add_u32 s95, s95, s28
  v_mfma_f32_16x16x32_bf16 v[68:71], a[168:171], a[76:79], v[68:71]
  ds_read_b64_tr_b16 a[162:163], v11 offset:37888
  s_lshr_b32 s28, s21, 1
  v_mfma_f32_16x16x32_bf16 v[128:131], a[172:175], a[72:75], v[128:131]
  ds_read_b64_tr_b16 a[164:165], v11 offset:38912
  buffer_load_dwordx4 a[140:143], v2, s[16:19], s31 offen offset:1024
  s_add_u32 s31, s31, 4096
  v_mfma_f32_16x16x32_bf16 v[132:135], a[172:175], a[76:79], v[132:135]
  ds_read_b64_tr_b16 a[166:167], v11 offset:39936
  s_waitcnt lgkmcnt(8)
  v_mfma_f32_16x16x32_bf16 v[72:75], a[144:147], a[72:75], v[72:75]
  ds_read_b64_tr_b16 a[168:169], v12 offset:36864
  s_lshl_b32 s29, s28, 6
  v_mfma_f32_16x16x32_bf16 v[76:79], a[144:147], a[76:79], v[76:79]
  ds_read_b64_tr_b16 a[170:171], v12 offset:37888
  s_add_u32 s96, s96, s29
  v_mfma_f32_16x16x32_bf16 v[136:139], a[148:151], a[72:75], v[136:139]
  ds_read_b64_tr_b16 a[172:173], v12 offset:38912
  s_lshl_b32 s29, s20, 3
  v_mfma_f32_16x16x32_bf16 v[140:143], a[148:151], a[76:79], v[140:143]
  ds_read_b64_tr_b16 a[174:175], v12 offset:39936
  s_waitcnt lgkmcnt(8)
  v_mfma_f32_16x16x32_bf16 v[80:83], a[152:155], a[72:75], v[80:83]
  ds_read_b64_tr_b16 a[144:145], v7 offset:36864
  s_add_u32 s96, s96, s29
  v_mfma_f32_16x16x32_bf16 v[84:87], a[152:155], a[76:79], v[84:87]
  ds_read_b64_tr_b16 a[146:147], v7 offset:38912
  s_lshl_b32 s99, s99, 10
  v_mfma_f32_16x16x32_bf16 v[144:147], a[156:159], a[72:75], v[144:147]
  ds_read_b64_tr_b16 a[148:149], v7 offset:40960
  s_lshl_b32 s29, s20, 8
  v_mfma_f32_16x16x32_bf16 v[148:151], a[156:159], a[76:79], v[148:151]
  ds_read_b64_tr_b16 a[150:151], v7 offset:43008
  s_waitcnt lgkmcnt(8)
  v_mfma_f32_16x16x32_bf16 v[152:155], a[160:163], a[40:43], v[152:155]
  ds_read_b64_tr_b16 a[152:153], v8 offset:36864
  s_add_u32 m0, s27, 33792
  s_add_u32 s90, s90, 294912
  v_mfma_f32_16x16x32_bf16 v[156:159], a[160:163], a[44:47], v[156:159]
  ds_read_b64_tr_b16 a[154:155], v8 offset:38912
  buffer_load_dwordx4 v5, s[12:15], s90 offen lds
  v_mfma_f32_16x16x32_bf16 v[168:171], a[164:167], a[40:43], v[168:171]
  ds_read_b64_tr_b16 a[156:157], v8 offset:40960
  s_add_u32 s99, s99, s29
  v_mfma_f32_16x16x32_bf16 v[172:175], a[164:167], a[44:47], v[172:175]
  ds_read_b64_tr_b16 a[158:159], v8 offset:43008
  s_waitcnt lgkmcnt(8)
  v_mfma_f32_16x16x32_bf16 v[160:163], a[168:171], a[40:43], v[160:163]
  ds_read_b64_tr_b16 a[160:161], v9 offset:36864
  s_lshl_b32 s29, s28, 12
  v_mfma_f32_16x16x32_bf16 v[164:167], a[168:171], a[44:47], v[164:167]
  ds_read_b64_tr_b16 a[162:163], v9 offset:38912
  s_add_u32 s23, s100, s29
  v_mfma_f32_16x16x32_bf16 v[176:179], a[172:175], a[40:43], v[176:179]
  ds_read_b64_tr_b16 a[164:165], v9 offset:40960
  s_add_u32 s23, s23, s99
  v_mfma_f32_16x16x32_bf16 v[180:183], a[172:175], a[44:47], v[180:183]
  ds_read_b64_tr_b16 a[166:167], v9 offset:43008
  s_waitcnt vmcnt(40) lgkmcnt(8)
  v_mfma_f32_16x16x32_bf16 v[24:27], a[144:147], a[80:83], v[24:27]
  ds_read_b64_tr_b16 a[168:169], v10 offset:36864
  s_add_u32 m0, s32, 0
  s_add_u32 s30, s30, 294912
  s_waitcnt vmcnt(39)
  v_mfma_f32_16x16x32_bf16 v[28:31], a[144:147], a[84:87], v[28:31]
  ds_read_b64_tr_b16 a[170:171], v10 offset:38912
  buffer_load_dwordx4 v3, s[12:15], s30 offen offset:0 lds
  v_mfma_f32_16x16x32_bf16 v[88:91], a[148:151], a[80:83], v[88:91]
  ds_read_b64_tr_b16 a[172:173], v10 offset:40960
  s_add_u32 s23, s23, s33
  v_mfma_f32_16x16x32_bf16 v[92:95], a[148:151], a[84:87], v[92:95]
  ds_read_b64_tr_b16 a[174:175], v10 offset:43008
  s_waitcnt lgkmcnt(8)
  v_mfma_f32_16x16x32_bf16 v[32:35], a[152:155], a[80:83], v[32:35]
  ds_read_b64_tr_b16 a[144:145], v7 offset:45056
  s_add_u32 s23, s23, 65536
  v_mfma_f32_16x16x32_bf16 v[36:39], a[152:155], a[84:87], v[36:39]
  ds_read_b64_tr_b16 a[146:147], v7 offset:47104
  s_add_u32 m0, s32, 1024
  v_mfma_f32_16x16x32_bf16 v[96:99], a[156:159], a[80:83], v[96:99]
  ds_read_b64_tr_b16 a[148:149], v7 offset:49152
  buffer_load_dwordx4 v4, s[12:15], s30 offen offset:0 lds
  v_mfma_f32_16x16x32_bf16 v[100:103], a[156:159], a[84:87], v[100:103]
  ds_read_b64_tr_b16 a[150:151], v7 offset:51200
  s_waitcnt lgkmcnt(8)
  v_mfma_f32_16x16x32_bf16 v[40:43], a[160:163], a[80:83], v[40:43]
  ds_read_b64_tr_b16 a[152:153], v8 offset:45056
  s_mul_i32 s89, s26, 786432
  v_mfma_f32_16x16x32_bf16 v[44:47], a[160:163], a[84:87], v[44:47]
  ds_read_b64_tr_b16 a[154:155], v8 offset:47104
  s_add_u32 m0, s32, 8064
  v_mfma_f32_16x16x32_bf16 v[104:107], a[164:167], a[80:83], v[104:107]
  ds_read_b64_tr_b16 a[156:157], v8 offset:49152
  buffer_load_dwordx4 v3, s[12:15], s30 offen offset:128 lds
  v_mfma_f32_16x16x32_bf16 v[108:111], a[164:167], a[84:87], v[108:111]
  ds_read_b64_tr_b16 a[158:159], v8 offset:51200
  s_waitcnt lgkmcnt(8)
  v_mfma_f32_16x16x32_bf16 v[48:51], a[168:171], a[80:83], v[48:51]
  ds_read_b64_tr_b16 a[160:161], v9 offset:45056
  s_mul_i32 s29, s24, 12288
  v_mfma_f32_16x16x32_bf16 v[52:55], a[168:171], a[84:87], v[52:55]
  ds_read_b64_tr_b16 a[162:163], v9 offset:47104
  s_add_u32 s89, s89, s29
  v_mfma_f32_16x16x32_bf16 v[112:115], a[172:175], a[80:83], v[112:115]
  ds_read_b64_tr_b16 a[164:165], v9 offset:49152
  s_add_u32 m0, s32, 9088
  v_mfma_f32_16x16x32_bf16 v[116:119], a[172:175], a[84:87], v[116:119]
  ds_read_b64_tr_b16 a[166:167], v9 offset:51200
  buffer_load_dwordx4 v4, s[12:15], s30 offen offset:128 lds
  s_waitcnt lgkmcnt(8)
  v_mfma_f32_16x16x32_bf16 v[56:59], a[144:147], a[80:83], v[56:59]
  ds_read_b64_tr_b16 a[168:169], v10 offset:45056
  s_add_u32 s89, s89, 41943040
  v_mfma_f32_16x16x32_bf16 v[60:63], a[144:147], a[84:87], v[60:63]
  ds_read_b64_tr_b16 a[170:171], v10 offset:47104
  s_lshl_b32 s28, s28, 11
  v_mfma_f32_16x16x32_bf16 v[120:123], a[148:151], a[80:83], v[120:123]
  ds_read_b64_tr_b16 a[172:173], v10 offset:49152
  s_add_u32 m0, s32, 16384
  s_add_u32 s30, s30, 294912
  v_mfma_f32_16x16x32_bf16 v[124:127], a[148:151], a[84:87], v[124:127]
  ds_read_b64_tr_b16 a[174:175], v10 offset:51200
  buffer_load_dwordx4 v3, s[12:15], s30 offen offset:0 lds
  s_waitcnt lgkmcnt(8)
  v_mfma_f32_16x16x32_bf16 v[64:67], a[152:155], a[80:83], v[64:67]
  ds_read_b64_tr_b16 a[144:145], v7 offset:53248
  s_add_u32 s89, s89, s28
  v_mfma_f32_16x16x32_bf16 v[68:71], a[152:155], a[84:87], v[68:71]
  ds_read_b64_tr_b16 a[146:147], v7 offset:55296
  s_add_u32 s89, s89, s99
  v_mfma_f32_16x16x32_bf16 v[128:131], a[156:159], a[80:83], v[128:131]
  ds_read_b64_tr_b16 a[148:149], v7 offset:57344
  v_lshlrev_b32 v14, 4, v224
  v_mfma_f32_16x16x32_bf16 v[132:135], a[156:159], a[84:87], v[132:135]
  ds_read_b64_tr_b16 a[150:151], v7 offset:59392
  s_add_u32 m0, s32, 17408
  s_waitcnt lgkmcnt(8)
  v_mfma_f32_16x16x32_bf16 v[72:75], a[160:163], a[80:83], v[72:75]
  ds_read_b64_tr_b16 a[152:153], v8 offset:53248
  buffer_load_dwordx4 v4, s[12:15], s30 offen offset:0 lds
  v_mfma_f32_16x16x32_bf16 v[76:79], a[160:163], a[84:87], v[76:79]
  ds_read_b64_tr_b16 a[154:155], v8 offset:55296
  v_lshl_add_u32 v16, v228, 3, v14
  v_mfma_f32_16x16x32_bf16 v[136:139], a[164:167], a[80:83], v[136:139]
  ds_read_b64_tr_b16 a[156:157], v8 offset:57344
  s_mov_b32 s28, 196608
  v_mfma_f32_16x16x32_bf16 v[140:143], a[164:167], a[84:87], v[140:143]
  ds_read_b64_tr_b16 a[158:159], v8 offset:59392
  s_add_u32 m0, s32, 24448
  s_waitcnt lgkmcnt(8)
  v_mfma_f32_16x16x32_bf16 v[80:83], a[168:171], a[80:83], v[80:83]
  ds_read_b64_tr_b16 a[160:161], v9 offset:53248
  buffer_load_dwordx4 v3, s[12:15], s30 offen offset:128 lds
  v_mfma_f32_16x16x32_bf16 v[84:87], a[168:171], a[84:87], v[84:87]
  ds_read_b64_tr_b16 a[162:163], v9 offset:55296
  v_mad_u32_u24 v14, v225, s28, v14
  v_mfma_f32_16x16x32_bf16 v[144:147], a[172:175], a[80:83], v[144:147]
  ds_read_b64_tr_b16 a[164:165], v9 offset:57344
  v_mul_u32_u24 v15, 1152, v224
  v_mfma_f32_16x16x32_bf16 v[148:151], a[172:175], a[84:87], v[148:151]
  ds_read_b64_tr_b16 a[166:167], v9 offset:59392
  s_waitcnt vmcnt(45) lgkmcnt(8)
  v_mfma_f32_16x16x32_bf16 v[24:27], a[144:147], a[88:91], v[24:27]
  ds_read_b64_tr_b16 a[168:169], v10 offset:53248
  s_add_u32 m0, s32, 25472
  s_waitcnt vmcnt(44)
  v_mfma_f32_16x16x32_bf16 v[28:31], a[144:147], a[92:95], v[28:31]
  ds_read_b64_tr_b16 a[170:171], v10 offset:55296
  buffer_load_dwordx4 v4, s[12:15], s30 offen offset:128 lds
  v_mfma_f32_16x16x32_bf16 v[88:91], a[148:151], a[88:91], v[88:91]
  ds_read_b64_tr_b16 a[172:173], v10 offset:57344
  v_lshl_add_u32 v15, v225, 4, v15
  v_mfma_f32_16x16x32_bf16 v[92:95], a[148:151], a[92:95], v[92:95]
  ds_read_b64_tr_b16 a[174:175], v10 offset:59392
  s_waitcnt lgkmcnt(8)
  v_mfma_f32_16x16x32_bf16 v[32:35], a[152:155], a[88:91], v[32:35]
  ds_read_b64_tr_b16 a[144:145], v7 offset:61440
  v_mfma_f32_16x16x32_bf16 v[36:39], a[152:155], a[92:95], v[36:39]
  ds_read_b64_tr_b16 a[146:147], v7 offset:63488
  v_mfma_f32_16x16x32_bf16 v[96:99], a[156:159], a[88:91], v[96:99]
  v_add_u32 v7, 65536, v7
  ds_read_b64_tr_b16 a[148:149], v7 offset:0
  v_mfma_f32_16x16x32_bf16 v[100:103], a[156:159], a[92:95], v[100:103]
  ds_read_b64_tr_b16 a[150:151], v7 offset:2048
  s_waitcnt lgkmcnt(8)
  v_mfma_f32_16x16x32_bf16 v[40:43], a[160:163], a[88:91], v[40:43]
  ds_read_b64_tr_b16 a[152:153], v8 offset:61440
  v_mfma_f32_16x16x32_bf16 v[44:47], a[160:163], a[92:95], v[44:47]
  ds_read_b64_tr_b16 a[154:155], v8 offset:63488
  v_mfma_f32_16x16x32_bf16 v[104:107], a[164:167], a[88:91], v[104:107]
  v_add_u32 v8, 65536, v8
  ds_read_b64_tr_b16 a[156:157], v8 offset:0
  v_mfma_f32_16x16x32_bf16 v[108:111], a[164:167], a[92:95], v[108:111]
  ds_read_b64_tr_b16 a[158:159], v8 offset:2048
  s_waitcnt lgkmcnt(8)
  v_mfma_f32_16x16x32_bf16 v[48:51], a[168:171], a[88:91], v[48:51]
  ds_read_b64_tr_b16 a[160:161], v9 offset:61440
  v_mfma_f32_16x16x32_bf16 v[52:55], a[168:171], a[92:95], v[52:55]
  ds_read_b64_tr_b16 a[162:163], v9 offset:63488
  v_mfma_f32_16x16x32_bf16 v[112:115], a[172:175], a[88:91], v[112:115]
  v_add_u32 v9, 65536, v9
  ds_read_b64_tr_b16 a[164:165], v9 offset:0
  v_mfma_f32_16x16x32_bf16 v[116:119], a[172:175], a[92:95], v[116:119]
  ds_read_b64_tr_b16 a[166:167], v9 offset:2048
  s_waitcnt lgkmcnt(8)
  v_mfma_f32_16x16x32_bf16 v[56:59], a[144:147], a[88:91], v[56:59]
  ds_read_b64_tr_b16 a[168:169], v10 offset:61440
  v_mfma_f32_16x16x32_bf16 v[60:63], a[144:147], a[92:95], v[60:63]
  ds_read_b64_tr_b16 a[170:171], v10 offset:63488
  v_mfma_f32_16x16x32_bf16 v[120:123], a[148:151], a[88:91], v[120:123]
  v_add_u32 v10, 65536, v10
  ds_read_b64_tr_b16 a[172:173], v10 offset:0
  v_mfma_f32_16x16x32_bf16 v[124:127], a[148:151], a[92:95], v[124:127]
  ds_read_b64_tr_b16 a[174:175], v10 offset:2048
  s_waitcnt lgkmcnt(8)
  v_mfma_f32_16x16x32_bf16 v[64:67], a[152:155], a[88:91], v[64:67]
  s_waitcnt vmcnt(34)
  s_barrier
  v_add_u32 v11, 73728, v11
  ds_read_b64_tr_b16 a[144:145], v11 offset:0
  v_mfma_f32_16x16x32_bf16 v[68:71], a[152:155], a[92:95], v[68:71]
  ds_read_b64_tr_b16 a[146:147], v11 offset:1024
  v_mfma_f32_16x16x32_bf16 v[128:131], a[156:159], a[88:91], v[128:131]
  ds_read_b64_tr_b16 a[148:149], v11 offset:2048
  v_mfma_f32_16x16x32_bf16 v[132:135], a[156:159], a[92:95], v[132:135]
  ds_read_b64_tr_b16 a[150:151], v11 offset:3072
  s_waitcnt lgkmcnt(8)
  v_mfma_f32_16x16x32_bf16 v[72:75], a[160:163], a[88:91], v[72:75]
  v_add_u32 v12, 73728, v12
  ds_read_b64_tr_b16 a[152:153], v12 offset:0
  v_mfma_f32_16x16x32_bf16 v[76:79], a[160:163], a[92:95], v[76:79]
  ds_read_b64_tr_b16 a[154:155], v12 offset:1024
  v_mfma_f32_16x16x32_bf16 v[136:139], a[164:167], a[88:91], v[136:139]
  ds_read_b64_tr_b16 a[156:157], v12 offset:2048
  v_mfma_f32_16x16x32_bf16 v[140:143], a[164:167], a[92:95], v[140:143]
  ds_read_b64_tr_b16 a[158:159], v12 offset:3072
  s_waitcnt lgkmcnt(8)
  v_mfma_f32_16x16x32_bf16 v[80:83], a[168:171], a[88:91], v[80:83]
  ds_read_b64_tr_b16 a[160:161], v7 offset:8192
  v_mfma_f32_16x16x32_bf16 v[84:87], a[168:171], a[92:95], v[84:87]
  ds_read_b64_tr_b16 a[162:163], v7 offset:10240
  v_mfma_f32_16x16x32_bf16 v[144:147], a[172:175], a[88:91], v[144:147]
  ds_read_b64_tr_b16 a[164:165], v7 offset:12288
  v_mfma_f32_16x16x32_bf16 v[148:151], a[172:175], a[92:95], v[148:151]
  ds_read_b64_tr_b16 a[166:167], v7 offset:14336
  s_waitcnt lgkmcnt(8)
  v_mfma_f32_16x16x32_bf16 v[152:155], a[144:147], a[48:51], v[152:155]
  ds_read_b64_tr_b16 a[168:169], v8 offset:8192
  s_add_u32 m0, s27, 70656
  s_add_u32 s90, s90, 294912
  v_mfma_f32_16x16x32_bf16 v[156:159], a[144:147], a[52:55], v[156:159]
  ds_read_b64_tr_b16 a[170:171], v8 offset:10240
  buffer_load_dwordx4 v5, s[12:15], s90 offen lds
  v_mfma_f32_16x16x32_bf16 v[168:171], a[148:151], a[48:51], v[168:171]
  ds_read_b64_tr_b16 a[172:173], v8 offset:12288
  v_mfma_f32_16x16x32_bf16 v[172:175], a[148:151], a[52:55], v[172:175]
  ds_read_b64_tr_b16 a[174:175], v8 offset:14336
  s_waitcnt lgkmcnt(8)
  v_mfma_f32_16x16x32_bf16 v[160:163], a[152:155], a[48:51], v[160:163]
  ds_read_b64_tr_b16 a[144:145], v9 offset:8192
  v_mfma_f32_16x16x32_bf16 v[164:167], a[152:155], a[52:55], v[164:167]
  ds_read_b64_tr_b16 a[146:147], v9 offset:10240
  v_mfma_f32_16x16x32_bf16 v[176:179], a[156:159], a[48:51], v[176:179]
  ds_read_b64_tr_b16 a[148:149], v9 offset:12288
  v_mfma_f32_16x16x32_bf16 v[180:183], a[156:159], a[52:55], v[180:183]
  ds_read_b64_tr_b16 a[150:151], v9 offset:14336
  s_waitcnt vmcnt(45) lgkmcnt(8)
  v_mfma_f32_16x16x32_bf16 v[24:27], a[160:163], a[96:99], v[24:27]
  ds_read_b64_tr_b16 a[152:153], v10 offset:8192
  s_add_u32 m0, s32, 36608
  s_sub_u32 s30, s30, s35
  s_waitcnt vmcnt(44)
  v_mfma_f32_16x16x32_bf16 v[28:31], a[160:163], a[100:103], v[28:31]
  ds_read_b64_tr_b16 a[154:155], v10 offset:10240
  buffer_load_dwordx4 v3, s[12:15], s30 offen offset:256 lds
  v_mfma_f32_16x16x32_bf16 v[88:91], a[164:167], a[96:99], v[88:91]
  ds_read_b64_tr_b16 a[156:157], v10 offset:12288
  v_mfma_f32_16x16x32_bf16 v[92:95], a[164:167], a[100:103], v[92:95]
  ds_read_b64_tr_b16 a[158:159], v10 offset:14336
  s_waitcnt lgkmcnt(8)
  v_mfma_f32_16x16x32_bf16 v[32:35], a[168:171], a[96:99], v[32:35]
  ds_read_b64_tr_b16 a[160:161], v7 offset:16384
  v_mfma_f32_16x16x32_bf16 v[36:39], a[168:171], a[100:103], v[36:39]
  ds_read_b64_tr_b16 a[162:163], v7 offset:18432
  s_add_u32 m0, s32, 37632
  v_mfma_f32_16x16x32_bf16 v[96:99], a[172:175], a[96:99], v[96:99]
  ds_read_b64_tr_b16 a[164:165], v7 offset:20480
  buffer_load_dwordx4 v4, s[12:15], s30 offen offset:256 lds
  v_mfma_f32_16x16x32_bf16 v[100:103], a[172:175], a[100:103], v[100:103]
  ds_read_b64_tr_b16 a[166:167], v7 offset:22528
  s_waitcnt lgkmcnt(8)
  v_mfma_f32_16x16x32_bf16 v[40:43], a[144:147], a[96:99], v[40:43]
  ds_read_b64_tr_b16 a[168:169], v8 offset:16384
  v_mfma_f32_16x16x32_bf16 v[44:47], a[144:147], a[100:103], v[44:47]
  ds_read_b64_tr_b16 a[170:171], v8 offset:18432
  s_add_u32 m0, s32, 44800
  s_add_u32 s30, s30, 294912
  v_mfma_f32_16x16x32_bf16 v[104:107], a[148:151], a[96:99], v[104:107]
  ds_read_b64_tr_b16 a[172:173], v8 offset:20480
  buffer_load_dwordx4 v3, s[12:15], s30 offen offset:256 lds
  v_mfma_f32_16x16x32_bf16 v[108:111], a[148:151], a[100:103], v[108:111]
  ds_read_b64_tr_b16 a[174:175], v8 offset:22528
  s_waitcnt lgkmcnt(8)
  v_mfma_f32_16x16x32_bf16 v[48:51], a[152:155], a[96:99], v[48:51]
  ds_read_b64_tr_b16 a[144:145], v9 offset:16384
  v_mfma_f32_16x16x32_bf16 v[52:55], a[152:155], a[100:103], v[52:55]
  ds_read_b64_tr_b16 a[146:147], v9 offset:18432
  v_mfma_f32_16x16x32_bf16 v[112:115], a[156:159], a[96:99], v[112:115]
  ds_read_b64_tr_b16 a[148:149], v9 offset:20480
  s_add_u32 m0, s32, 45824
  v_mfma_f32_16x16x32_bf16 v[116:119], a[156:159], a[100:103], v[116:119]
  ds_read_b64_tr_b16 a[150:151], v9 offset:22528
  buffer_load_dwordx4 v4, s[12:15], s30 offen offset:256 lds
  s_waitcnt lgkmcnt(8)
  v_mfma_f32_16x16x32_bf16 v[56:59], a[160:163], a[96:99], v[56:59]
  ds_read_b64_tr_b16 a[152:153], v10 offset:16384
  v_mfma_f32_16x16x32_bf16 v[60:63], a[160:163], a[100:103], v[60:63]
  ds_read_b64_tr_b16 a[154:155], v10 offset:18432
  v_mfma_f32_16x16x32_bf16 v[120:123], a[164:167], a[96:99], v[120:123]
  ds_read_b64_tr_b16 a[156:157], v10 offset:20480
  s_add_u32 m0, s32, 52992
  s_add_u32 s30, s30, 294912
  v_mfma_f32_16x16x32_bf16 v[124:127], a[164:167], a[100:103], v[124:127]
  ds_read_b64_tr_b16 a[158:159], v10 offset:22528
  buffer_load_dwordx4 v3, s[12:15], s30 offen offset:256 lds
  s_waitcnt lgkmcnt(8)
  v_mfma_f32_16x16x32_bf16 v[64:67], a[168:171], a[96:99], v[64:67]
  ds_read_b64_tr_b16 a[160:161], v7 offset:24576
  v_mfma_f32_16x16x32_bf16 v[68:71], a[168:171], a[100:103], v[68:71]
  ds_read_b64_tr_b16 a[162:163], v7 offset:26624
  v_mfma_f32_16x16x32_bf16 v[128:131], a[172:175], a[96:99], v[128:131]
  ds_read_b64_tr_b16 a[164:165], v7 offset:28672
  v_mfma_f32_16x16x32_bf16 v[132:135], a[172:175], a[100:103], v[132:135]
  ds_read_b64_tr_b16 a[166:167], v7 offset:30720
  s_add_u32 m0, s32, 54016
  s_waitcnt lgkmcnt(8)
  v_mfma_f32_16x16x32_bf16 v[72:75], a[144:147], a[96:99], v[72:75]
  ds_read_b64_tr_b16 a[168:169], v8 offset:24576
  buffer_load_dwordx4 v4, s[12:15], s30 offen offset:256 lds
  v_mfma_f32_16x16x32_bf16 v[76:79], a[144:147], a[100:103], v[76:79]
  ds_read_b64_tr_b16 a[170:171], v8 offset:26624
  v_mfma_f32_16x16x32_bf16 v[136:139], a[148:151], a[96:99], v[136:139]
  ds_read_b64_tr_b16 a[172:173], v8 offset:28672
  v_mfma_f32_16x16x32_bf16 v[140:143], a[148:151], a[100:103], v[140:143]
  ds_read_b64_tr_b16 a[174:175], v8 offset:30720
  s_add_u32 m0, s32, 61184
  s_add_u32 s30, s30, 294912
  s_waitcnt lgkmcnt(8)
  v_mfma_f32_16x16x32_bf16 v[80:83], a[152:155], a[96:99], v[80:83]
  ds_read_b64_tr_b16 a[144:145], v9 offset:24576
  buffer_load_dwordx4 v3, s[12:15], s30 offen offset:256 lds
  v_mfma_f32_16x16x32_bf16 v[84:87], a[152:155], a[100:103], v[84:87]
  ds_read_b64_tr_b16 a[146:147], v9 offset:26624
  v_mfma_f32_16x16x32_bf16 v[144:147], a[156:159], a[96:99], v[144:147]
  ds_read_b64_tr_b16 a[148:149], v9 offset:28672
  v_mfma_f32_16x16x32_bf16 v[148:151], a[156:159], a[100:103], v[148:151]
  ds_read_b64_tr_b16 a[150:151], v9 offset:30720
  s_waitcnt vmcnt(41) lgkmcnt(8)
  v_mfma_f32_16x16x32_bf16 v[24:27], a[160:163], a[104:107], v[24:27]
  ds_read_b64_tr_b16 a[152:153], v10 offset:24576
  s_add_u32 m0, s32, 62208
  s_waitcnt vmcnt(40)
  v_mfma_f32_16x16x32_bf16 v[28:31], a[160:163], a[108:111], v[28:31]
  ds_read_b64_tr_b16 a[154:155], v10 offset:26624
  buffer_load_dwordx4 v4, s[12:15], s30 offen offset:256 lds
  v_mfma_f32_16x16x32_bf16 v[88:91], a[164:167], a[104:107], v[88:91]
  ds_read_b64_tr_b16 a[156:157], v10 offset:28672
  v_mfma_f32_16x16x32_bf16 v[92:95], a[164:167], a[108:111], v[92:95]
  ds_read_b64_tr_b16 a[158:159], v10 offset:30720
  s_waitcnt lgkmcnt(8)
  v_mfma_f32_16x16x32_bf16 v[32:35], a[168:171], a[104:107], v[32:35]
  ds_read_b64_tr_b16 a[160:161], v7 offset:32768
  v_mfma_f32_16x16x32_bf16 v[36:39], a[168:171], a[108:111], v[36:39]
  ds_read_b64_tr_b16 a[162:163], v7 offset:34816
  v_mfma_f32_16x16x32_bf16 v[96:99], a[172:175], a[104:107], v[96:99]
  ds_read_b64_tr_b16 a[164:165], v7 offset:36864
  v_mfma_f32_16x16x32_bf16 v[100:103], a[172:175], a[108:111], v[100:103]
  ds_read_b64_tr_b16 a[166:167], v7 offset:38912
  s_waitcnt lgkmcnt(8)
  v_mfma_f32_16x16x32_bf16 v[40:43], a[144:147], a[104:107], v[40:43]
  ds_read_b64_tr_b16 a[168:169], v8 offset:32768
  v_mfma_f32_16x16x32_bf16 v[44:47], a[144:147], a[108:111], v[44:47]
  ds_read_b64_tr_b16 a[170:171], v8 offset:34816
  v_mfma_f32_16x16x32_bf16 v[104:107], a[148:151], a[104:107], v[104:107]
  ds_read_b64_tr_b16 a[172:173], v8 offset:36864
  v_mfma_f32_16x16x32_bf16 v[108:111], a[148:151], a[108:111], v[108:111]
  ds_read_b64_tr_b16 a[174:175], v8 offset:38912
  s_waitcnt lgkmcnt(8)
  v_mfma_f32_16x16x32_bf16 v[48:51], a[152:155], a[104:107], v[48:51]
  ds_read_b64_tr_b16 a[144:145], v9 offset:32768
  v_mfma_f32_16x16x32_bf16 v[52:55], a[152:155], a[108:111], v[52:55]
  ds_read_b64_tr_b16 a[146:147], v9 offset:34816
  v_mfma_f32_16x16x32_bf16 v[112:115], a[156:159], a[104:107], v[112:115]
  ds_read_b64_tr_b16 a[148:149], v9 offset:36864
  v_mfma_f32_16x16x32_bf16 v[116:119], a[156:159], a[108:111], v[116:119]
  ds_read_b64_tr_b16 a[150:151], v9 offset:38912
  s_waitcnt lgkmcnt(8)
  v_mfma_f32_16x16x32_bf16 v[56:59], a[160:163], a[104:107], v[56:59]
  ds_read_b64_tr_b16 a[152:153], v10 offset:32768
  v_mfma_f32_16x16x32_bf16 v[60:63], a[160:163], a[108:111], v[60:63]
  ds_read_b64_tr_b16 a[154:155], v10 offset:34816
  v_mfma_f32_16x16x32_bf16 v[120:123], a[164:167], a[104:107], v[120:123]
  ds_read_b64_tr_b16 a[156:157], v10 offset:36864
  v_mfma_f32_16x16x32_bf16 v[124:127], a[164:167], a[108:111], v[124:127]
  ds_read_b64_tr_b16 a[158:159], v10 offset:38912
  s_waitcnt lgkmcnt(8)
  v_mfma_f32_16x16x32_bf16 v[64:67], a[168:171], a[104:107], v[64:67]
  s_waitcnt vmcnt(22)
  s_barrier
  ds_read_b64_tr_b16 a[160:161], v11 offset:36864
  v_mfma_f32_16x16x32_bf16 v[68:71], a[168:171], a[108:111], v[68:71]
  ds_read_b64_tr_b16 a[162:163], v11 offset:37888
  v_mfma_f32_16x16x32_bf16 v[128:131], a[172:175], a[104:107], v[128:131]
  ds_read_b64_tr_b16 a[164:165], v11 offset:38912
  v_mfma_f32_16x16x32_bf16 v[132:135], a[172:175], a[108:111], v[132:135]
  ds_read_b64_tr_b16 a[166:167], v11 offset:39936
k4_part_w2:
  s_cbranch_execz k4_part_w6
  s_waitcnt lgkmcnt(8)
  v_mfma_f32_16x16x32_bf16 v[72:75], a[144:147], a[104:107], v[72:75]
  ds_read_b64_tr_b16 a[168:169], v12 offset:36864
  v_mfma_f32_16x16x32_bf16 v[76:79], a[144:147], a[108:111], v[76:79]
  ds_read_b64_tr_b16 a[170:171], v12 offset:37888
  v_mfma_f32_16x16x32_bf16 v[136:139], a[148:151], a[104:107], v[136:139]
  ds_read_b64_tr_b16 a[172:173], v12 offset:38912
  v_mfma_f32_16x16x32_bf16 v[140:143], a[148:151], a[108:111], v[140:143]
  ds_read_b64_tr_b16 a[174:175], v12 offset:39936
  s_waitcnt lgkmcnt(8)
  v_mfma_f32_16x16x32_bf16 v[80:83], a[152:155], a[104:107], v[80:83]
  ds_read_b64_tr_b16 a[144:145], v7 offset:45056
  v_mfma_f32_16x16x32_bf16 v[84:87], a[152:155], a[108:111], v[84:87]
  ds_read_b64_tr_b16 a[146:147], v7 offset:47104
  v_mfma_f32_16x16x32_bf16 v[144:147], a[156:159], a[104:107], v[144:147]
  ds_read_b64_tr_b16 a[148:149], v7 offset:49152
  v_mfma_f32_16x16x32_bf16 v[148:151], a[156:159], a[108:111], v[148:151]
  ds_read_b64_tr_b16 a[150:151], v7 offset:51200
  s_waitcnt lgkmcnt(8)
  v_mfma_f32_16x16x32_bf16 v[152:155], a[160:163], a[56:59], v[152:155]
  ds_read_b64_tr_b16 a[152:153], v8 offset:45056
  s_add_u32 m0, s27, 107520
  s_add_u32 s90, s90, 294912
  v_mfma_f32_16x16x32_bf16 v[156:159], a[160:163], a[60:63], v[156:159]
  ds_read_b64_tr_b16 a[154:155], v8 offset:47104
  buffer_load_dwordx4 v5, s[12:15], s90 offen lds
  v_mfma_f32_16x16x32_bf16 v[168:171], a[164:167], a[56:59], v[168:171]
  ds_read_b64_tr_b16 a[156:157], v8 offset:49152
  s_waitcnt vmcnt(25)
  v_mov_b32 v18, v232
  v_mfma_f32_16x16x32_bf16 v[172:175], a[164:167], a[60:63], v[172:175]
  ds_read_b64_tr_b16 a[158:159], v8 offset:51200
  s_waitcnt lgkmcnt(8)
  v_mfma_f32_16x16x32_bf16 v[160:163], a[168:171], a[56:59], v[160:163]
  ds_read_b64_tr_b16 a[160:161], v9 offset:45056
  v_add_f32 v232, v232, v233
  v_mfma_f32_16x16x32_bf16 v[164:167], a[168:171], a[60:63], v[164:167]
  ds_read_b64_tr_b16 a[162:163], v9 offset:47104
  v_add_f32 v232, v232, v234
  v_mfma_f32_16x16x32_bf16 v[176:179], a[172:175], a[56:59], v[176:179]
  ds_read_b64_tr_b16 a[164:165], v9 offset:49152
  v_add_f32 v232, v232, v235
  v_mfma_f32_16x16x32_bf16 v[180:183], a[172:175], a[60:63], v[180:183]
  ds_read_b64_tr_b16 a[166:167], v9 offset:51200
  s_waitcnt vmcnt(41) lgkmcnt(8)
  v_mfma_f32_16x16x32_bf16 v[24:27], a[144:147], a[112:115], v[24:27]
  ds_read_b64_tr_b16 a[168:169], v10 offset:45056
  s_add_u32 m0, s32, 73472
  s_add_u32 s30, s30, 294912
  s_waitcnt vmcnt(40)
  v_mfma_f32_16x16x32_bf16 v[28:31], a[144:147], a[116:119], v[28:31]
  ds_read_b64_tr_b16 a[170:171], v10 offset:47104
  buffer_load_dwordx4 v3, s[12:15], s30 offen offset:256 lds
  v_mfma_f32_16x16x32_bf16 v[88:91], a[148:151], a[112:115], v[88:91]
  ds_read_b64_tr_b16 a[172:173], v10 offset:49152
  v_add_f32 v232, v232, v236
  v_mfma_f32_16x16x32_bf16 v[92:95], a[148:151], a[116:119], v[92:95]
  ds_read_b64_tr_b16 a[174:175], v10 offset:51200
  s_waitcnt lgkmcnt(8)
  v_mfma_f32_16x16x32_bf16 v[32:35], a[152:155], a[112:115], v[32:35]
  ds_read_b64_tr_b16 a[144:145], v7 offset:53248
  v_add_f32 v232, v232, v237
  v_mfma_f32_16x16x32_bf16 v[36:39], a[152:155], a[116:119], v[36:39]
  ds_read_b64_tr_b16 a[146:147], v7 offset:55296
  s_add_u32 m0, s32, 74496
  v_mfma_f32_16x16x32_bf16 v[96:99], a[156:159], a[112:115], v[96:99]
  ds_read_b64_tr_b16 a[148:149], v7 offset:57344
  buffer_load_dwordx4 v4, s[12:15], s30 offen offset:256 lds
  v_mfma_f32_16x16x32_bf16 v[100:103], a[156:159], a[116:119], v[100:103]
  ds_read_b64_tr_b16 a[150:151], v7 offset:59392
  s_waitcnt lgkmcnt(8)
  v_mfma_f32_16x16x32_bf16 v[40:43], a[160:163], a[112:115], v[40:43]
  ds_read_b64_tr_b16 a[152:153], v8 offset:53248
  v_mov_b32 v20, 0x3727c5ac
  v_mfma_f32_16x16x32_bf16 v[44:47], a[160:163], a[116:119], v[44:47]
  ds_read_b64_tr_b16 a[154:155], v8 offset:55296
  s_add_u32 m0, s32, 81664
  s_add_u32 s30, s30, 294912
  v_mfma_f32_16x16x32_bf16 v[104:107], a[164:167], a[112:115], v[104:107]
  ds_read_b64_tr_b16 a[156:157], v8 offset:57344
  buffer_load_dwordx4 v3, s[12:15], s30 offen offset:256 lds
  v_mfma_f32_16x16x32_bf16 v[108:111], a[164:167], a[116:119], v[108:111]
  ds_read_b64_tr_b16 a[158:159], v8 offset:59392
  s_waitcnt lgkmcnt(8)
  v_mfma_f32_16x16x32_bf16 v[48:51], a[168:171], a[112:115], v[48:51]
  ds_read_b64_tr_b16 a[160:161], v9 offset:53248
  v_fmac_f32 v20, 0x3ae38e39, v232
  v_mfma_f32_16x16x32_bf16 v[52:55], a[168:171], a[116:119], v[52:55]
  ds_read_b64_tr_b16 a[162:163], v9 offset:55296
  v_rcp_f32 v20, v20
  v_mfma_f32_16x16x32_bf16 v[112:115], a[172:175], a[112:115], v[112:115]
  ds_read_b64_tr_b16 a[164:165], v9 offset:57344
  s_add_u32 m0, s32, 82688
  v_mfma_f32_16x16x32_bf16 v[116:119], a[172:175], a[116:119], v[116:119]
  ds_read_b64_tr_b16 a[166:167], v9 offset:59392
  buffer_load_dwordx4 v4, s[12:15], s30 offen offset:256 lds
  s_waitcnt lgkmcnt(8)
  v_mfma_f32_16x16x32_bf16 v[56:59], a[144:147], a[112:115], v[56:59]
  ds_read_b64_tr_b16 a[168:169], v10 offset:53248
  v_mov_b32 v232, v18
  s_nop 0
  v_mfma_f32_16x16x32_bf16 v[60:63], a[144:147], a[116:119], v[60:63]
  ds_read_b64_tr_b16 a[170:171], v10 offset:55296
  v_mov_b32 v233, v20
  s_nop 1
  v_mfma_f32_16x16x32_bf16 v[120:123], a[148:151], a[112:115], v[120:123]
  ds_read_b64_tr_b16 a[172:173], v10 offset:57344
  s_add_u32 m0, s32, 89856
  s_add_u32 s30, s30, 294912
  v_mfma_f32_16x16x32_bf16 v[124:127], a[148:151], a[116:119], v[124:127]
  ds_read_b64_tr_b16 a[174:175], v10 offset:59392
  buffer_load_dwordx4 v3, s[12:15], s30 offen offset:256 lds
  s_waitcnt lgkmcnt(8)
  v_mfma_f32_16x16x32_bf16 v[64:67], a[152:155], a[112:115], v[64:67]
  ds_read_b64_tr_b16 a[144:145], v7 offset:61440
  v_permlane32_swap_b32 v232, v18
  v_mfma_f32_16x16x32_bf16 v[68:71], a[152:155], a[116:119], v[68:71]
  ds_read_b64_tr_b16 a[146:147], v7 offset:63488
  v_permlane32_swap_b32 v20, v233
  v_mfma_f32_16x16x32_bf16 v[128:131], a[156:159], a[112:115], v[128:131]
  v_add_u32 v7, 65536, v7
  ds_read_b64_tr_b16 a[148:149], v7 offset:0
  v_mov_b32 v19, v18
  v_mfma_f32_16x16x32_bf16 v[132:135], a[156:159], a[116:119], v[132:135]
  ds_read_b64_tr_b16 a[150:151], v7 offset:2048
  s_add_u32 m0, s32, 90880
  s_waitcnt lgkmcnt(8)
  v_mfma_f32_16x16x32_bf16 v[72:75], a[160:163], a[112:115], v[72:75]
  ds_read_b64_tr_b16 a[152:153], v8 offset:61440
  buffer_load_dwordx4 v4, s[12:15], s30 offen offset:256 lds
  v_mfma_f32_16x16x32_bf16 v[76:79], a[160:163], a[116:119], v[76:79]
  ds_read_b64_tr_b16 a[154:155], v8 offset:63488
  v_mov_b32 v21, v20
  s_nop 1
  v_mfma_f32_16x16x32_bf16 v[136:139], a[164:167], a[112:115], v[136:139]
  v_add_u32 v8, 65536, v8
  ds_read_b64_tr_b16 a[156:157], v8 offset:0
  v_permlane16_swap_b32 v18, v19
  v_mfma_f32_16x16x32_bf16 v[140:143], a[164:167], a[116:119], v[140:143]
  ds_read_b64_tr_b16 a[158:159], v8 offset:2048
  s_add_u32 m0, s32, 98048
  s_add_u32 s30, s30, 294912
  s_waitcnt lgkmcnt(8)
  v_mfma_f32_16x16x32_bf16 v[80:83], a[168:171], a[112:115], v[80:83]
  ds_read_b64_tr_b16 a[160:161], v9 offset:61440
  buffer_load_dwordx4 v3, s[12:15], s30 offen offset:256 lds
  v_mfma_f32_16x16x32_bf16 v[84:87], a[168:171], a[116:119], v[84:87]
  ds_read_b64_tr_b16 a[162:163], v9 offset:63488
  v_permlane16_swap_b32 v20, v21
  v_mfma_f32_16x16x32_bf16 v[144:147], a[172:175], a[112:115], v[144:147]
  v_add_u32 v9, 65536, v9
  ds_read_b64_tr_b16 a[164:165], v9 offset:0
  s_xor_b32 s99, s25, 0
  v_mfma_f32_16x16x32_bf16 v[148:151], a[172:175], a[116:119], v[148:151]
  ds_read_b64_tr_b16 a[166:167], v9 offset:2048
  s_waitcnt vmcnt(46) lgkmcnt(8)
  v_mfma_f32_16x16x32_bf16 v[24:27], a[144:147], a[120:123], v[24:27]
  ds_read_b64_tr_b16 a[168:169], v10 offset:61440
  s_add_u32 m0, s32, 99072
  s_waitcnt vmcnt(45)
  v_mfma_f32_16x16x32_bf16 v[28:31], a[144:147], a[124:127], v[28:31]
  ds_read_b64_tr_b16 a[170:171], v10 offset:63488
  buffer_load_dwordx4 v4, s[12:15], s30 offen offset:256 lds
  v_mfma_f32_16x16x32_bf16 v[88:91], a[148:151], a[120:123], v[88:91]
  v_add_u32 v10, 65536, v10
  ds_read_b64_tr_b16 a[172:173], v10 offset:0
  s_mul_i32 s40, s99, 331776
  v_mfma_f32_16x16x32_bf16 v[92:95], a[148:151], a[124:127], v[92:95]
  ds_read_b64_tr_b16 a[174:175], v10 offset:2048
  s_waitcnt lgkmcnt(8)
  v_mfma_f32_16x16x32_bf16 v[32:35], a[152:155], a[120:123], v[32:35]
  ds_read_b64_tr_b16 a[144:145], v7 offset:4096
  s_bitcmp1_b32 s99, 0
  s_cselect_b32 s98, 36864, 0
  s_cselect_b32 s100, 0, 294912
  v_mfma_f32_16x16x32_bf16 v[36:39], a[152:155], a[124:127], v[36:39]
  ds_read_b64_tr_b16 a[146:147], v7 offset:6144
  s_add_u32 s16, s40, s98
  v_mfma_f32_16x16x32_bf16 v[96:99], a[156:159], a[120:123], v[96:99]
  ds_read_b64_tr_b16 a[148:149], v7 offset:8192
  s_add_u32 s40, s40, s100
  v_mfma_f32_16x16x32_bf16 v[100:103], a[156:159], a[124:127], v[100:103]
  ds_read_b64_tr_b16 a[150:151], v7 offset:10240
  s_waitcnt lgkmcnt(8)
  v_mfma_f32_16x16x32_bf16 v[40:43], a[160:163], a[120:123], v[40:43]
  ds_read_b64_tr_b16 a[152:153], v8 offset:4096
  s_bitcmp1_b32 10320, s99
  s_cselect_b32 s98, 147456, 0
  s_cselect_b32 s100, 0, 147456
  v_mfma_f32_16x16x32_bf16 v[44:47], a[160:163], a[124:127], v[44:47]
  ds_read_b64_tr_b16 a[154:155], v8 offset:6144
  s_add_u32 s36, s16, s98
  v_mfma_f32_16x16x32_bf16 v[104:107], a[164:167], a[120:123], v[104:107]
  ds_read_b64_tr_b16 a[156:157], v8 offset:8192
  s_add_u32 s16, s16, s100
  v_mfma_f32_16x16x32_bf16 v[108:111], a[164:167], a[124:127], v[108:111]
  ds_read_b64_tr_b16 a[158:159], v8 offset:10240
  s_waitcnt lgkmcnt(8)
  v_mfma_f32_16x16x32_bf16 v[48:51], a[168:171], a[120:123], v[48:51]
  ds_read_b64_tr_b16 a[160:161], v9 offset:4096
  s_xor_b32 s99, s25, 1
  v_mfma_f32_16x16x32_bf16 v[52:55], a[168:171], a[124:127], v[52:55]
  ds_read_b64_tr_b16 a[162:163], v9 offset:6144
  s_mul_i32 s41, s99, 331776
  v_mfma_f32_16x16x32_bf16 v[112:115], a[172:175], a[120:123], v[112:115]
  ds_read_b64_tr_b16 a[164:165], v9 offset:8192
  s_bitcmp1_b32 s99, 0
  s_cselect_b32 s98, 36864, 0
  s_cselect_b32 s100, 0, 294912
  v_mfma_f32_16x16x32_bf16 v[116:119], a[172:175], a[124:127], v[116:119]
  ds_read_b64_tr_b16 a[166:167], v9 offset:10240
  s_waitcnt lgkmcnt(8)
  v_mfma_f32_16x16x32_bf16 v[56:59], a[144:147], a[120:123], v[56:59]
  ds_read_b64_tr_b16 a[168:169], v10 offset:4096
  s_add_u32 s17, s41, s98
  v_mfma_f32_16x16x32_bf16 v[60:63], a[144:147], a[124:127], v[60:63]
  ds_read_b64_tr_b16 a[170:171], v10 offset:6144
  s_add_u32 s41, s41, s100
  v_mfma_f32_16x16x32_bf16 v[120:123], a[148:151], a[120:123], v[120:123]
  ds_read_b64_tr_b16 a[172:173], v10 offset:8192
  s_bitcmp1_b32 10320, s99
  s_cselect_b32 s98, 147456, 0
  s_cselect_b32 s100, 0, 147456
  v_mfma_f32_16x16x32_bf16 v[124:127], a[148:151], a[124:127], v[124:127]
  ds_read_b64_tr_b16 a[174:175], v10 offset:10240
  s_waitcnt lgkmcnt(8)
  v_mfma_f32_16x16x32_bf16 v[64:67], a[152:155], a[120:123], v[64:67]
  s_waitcnt vmcnt(18)
  s_barrier
  v_add_u32 v11, -73728, v11
  ds_read_b64_tr_b16 a[144:145], v11 offset:0
  s_add_u32 s37, s17, s98
  v_mfma_f32_16x16x32_bf16 v[68:71], a[152:155], a[124:127], v[68:71]
  ds_read_b64_tr_b16 a[146:147], v11 offset:1024
  s_add_u32 s17, s17, s100
  v_mfma_f32_16x16x32_bf16 v[128:131], a[156:159], a[120:123], v[128:131]
  ds_read_b64_tr_b16 a[148:149], v11 offset:2048
  s_xor_b32 s99, s25, 2
  v_mfma_f32_16x16x32_bf16 v[132:135], a[156:159], a[124:127], v[132:135]
  ds_read_b64_tr_b16 a[150:151], v11 offset:3072
  s_waitcnt lgkmcnt(8)
  v_mfma_f32_16x16x32_bf16 v[72:75], a[160:163], a[120:123], v[72:75]
  v_add_u32 v12, -73728, v12
  ds_read_b64_tr_b16 a[152:153], v12 offset:0
  s_mul_i32 s42, s99, 331776
  v_mfma_f32_16x16x32_bf16 v[76:79], a[160:163], a[124:127], v[76:79]
  ds_read_b64_tr_b16 a[154:155], v12 offset:1024
  s_bitcmp1_b32 s99, 0
  s_cselect_b32 s98, 36864, 0
  s_cselect_b32 s100, 0, 294912
  v_mfma_f32_16x16x32_bf16 v[136:139], a[164:167], a[120:123], v[136:139]
  ds_read_b64_tr_b16 a[156:157], v12 offset:2048
  s_add_u32 s18, s42, s98
  v_mfma_f32_16x16x32_bf16 v[140:143], a[164:167], a[124:127], v[140:143]
  ds_read_b64_tr_b16 a[158:159], v12 offset:3072
  s_waitcnt lgkmcnt(8)
  v_mfma_f32_16x16x32_bf16 v[80:83], a[168:171], a[120:123], v[80:83]
  v_add_u32 v7, -131072, v7
  ds_read_b64_tr_b16 a[160:161], v7 offset:0
  s_add_u32 s42, s42, s100
  v_mfma_f32_16x16x32_bf16 v[84:87], a[168:171], a[124:127], v[84:87]
  ds_read_b64_tr_b16 a[162:163], v7 offset:2048
  s_bitcmp1_b32 10320, s99
  s_cselect_b32 s98, 147456, 0
  s_cselect_b32 s100, 0, 147456
  v_mfma_f32_16x16x32_bf16 v[144:147], a[172:175], a[120:123], v[144:147]
  ds_read_b64_tr_b16 a[164:165], v7 offset:4096
  s_add_u32 s38, s18, s98
  v_mfma_f32_16x16x32_bf16 v[148:151], a[172:175], a[124:127], v[148:151]
  ds_read_b64_tr_b16 a[166:167], v7 offset:6144
  s_waitcnt lgkmcnt(8)
  v_mfma_f32_16x16x32_bf16 v[152:155], a[144:147], a[64:67], v[152:155]
  v_add_u32 v8, -131072, v8
  ds_read_b64_tr_b16 a[168:169], v8 offset:0
  s_add_u32 m0, s27, 144384
  s_add_u32 s90, s90, 294912
  v_mfma_f32_16x16x32_bf16 v[156:159], a[144:147], a[68:71], v[156:159]
  ds_read_b64_tr_b16 a[170:171], v8 offset:2048
  buffer_load_dwordx4 v5, s[12:15], s90 offen lds
  v_mfma_f32_16x16x32_bf16 v[168:171], a[148:151], a[64:67], v[168:171]
  ds_read_b64_tr_b16 a[172:173], v8 offset:4096
  s_add_u32 s18, s18, s100
  v_mfma_f32_16x16x32_bf16 v[172:175], a[148:151], a[68:71], v[172:175]
  ds_read_b64_tr_b16 a[174:175], v8 offset:6144
  s_waitcnt lgkmcnt(8)
  v_mfma_f32_16x16x32_bf16 v[160:163], a[152:155], a[64:67], v[160:163]
  v_add_u32 v9, -131072, v9
  ds_read_b64_tr_b16 a[144:145], v9 offset:0
  s_xor_b32 s99, s25, 3
  v_mfma_f32_16x16x32_bf16 v[164:167], a[152:155], a[68:71], v[164:167]
  ds_read_b64_tr_b16 a[146:147], v9 offset:2048
  s_mul_i32 s43, s99, 331776
  v_mfma_f32_16x16x32_bf16 v[176:179], a[156:159], a[64:67], v[176:179]
  ds_read_b64_tr_b16 a[148:149], v9 offset:4096
  s_bitcmp1_b32 s99, 0
  s_cselect_b32 s98, 36864, 0
  s_cselect_b32 s100, 0, 294912
  v_mfma_f32_16x16x32_bf16 v[180:183], a[156:159], a[68:71], v[180:183]
  ds_read_b64_tr_b16 a[150:151], v9 offset:6144
  s_waitcnt vmcnt(31) lgkmcnt(8)
  v_mfma_f32_16x16x32_bf16 v[24:27], a[160:163], a[128:131], v[24:27]
  v_add_u32 v10, -131072, v10
  ds_read_b64_tr_b16 a[152:153], v10 offset:0
  s_add_u32 m0, s32, 110336
  s_add_u32 s30, s30, 294912
  s_waitcnt vmcnt(30)
  v_mfma_f32_16x16x32_bf16 v[28:31], a[160:163], a[132:135], v[28:31]
  ds_read_b64_tr_b16 a[154:155], v10 offset:2048
  buffer_load_dwordx4 v3, s[12:15], s30 offen offset:256 lds
  v_mfma_f32_16x16x32_bf16 v[88:91], a[164:167], a[128:131], v[88:91]
  ds_read_b64_tr_b16 a[156:157], v10 offset:4096
  s_add_u32 s19, s43, s98
  v_mfma_f32_16x16x32_bf16 v[92:95], a[164:167], a[132:135], v[92:95]
  ds_read_b64_tr_b16 a[158:159], v10 offset:6144
  s_waitcnt lgkmcnt(8)
  v_mfma_f32_16x16x32_bf16 v[32:35], a[168:171], a[128:131], v[32:35]
  ds_read_b64_tr_b16 a[160:161], v7 offset:8192
  s_add_u32 s43, s43, s100
  v_mfma_f32_16x16x32_bf16 v[36:39], a[168:171], a[132:135], v[36:39]
  ds_read_b64_tr_b16 a[162:163], v7 offset:10240
  s_add_u32 m0, s32, 111360
  v_mfma_f32_16x16x32_bf16 v[96:99], a[172:175], a[128:131], v[96:99]
  ds_read_b64_tr_b16 a[164:165], v7 offset:12288
  buffer_load_dwordx4 v4, s[12:15], s30 offen offset:256 lds
  v_mfma_f32_16x16x32_bf16 v[100:103], a[172:175], a[132:135], v[100:103]
  ds_read_b64_tr_b16 a[166:167], v7 offset:14336
  s_waitcnt lgkmcnt(8)
  v_mfma_f32_16x16x32_bf16 v[40:43], a[144:147], a[128:131], v[40:43]
  ds_read_b64_tr_b16 a[168:169], v8 offset:8192
  s_bitcmp1_b32 10320, s99
  s_cselect_b32 s98, 147456, 0
  s_cselect_b32 s100, 0, 147456
  v_mfma_f32_16x16x32_bf16 v[44:47], a[144:147], a[132:135], v[44:47]
  ds_read_b64_tr_b16 a[170:171], v8 offset:10240
  s_add_u32 m0, s32, 118528
  s_add_u32 s30, s30, 294912
  v_mfma_f32_16x16x32_bf16 v[104:107], a[148:151], a[128:131], v[104:107]
  ds_read_b64_tr_b16 a[172:173], v8 offset:12288
  buffer_load_dwordx4 v3, s[12:15], s30 offen offset:256 lds
  v_mfma_f32_16x16x32_bf16 v[108:111], a[148:151], a[132:135], v[108:111]
  ds_read_b64_tr_b16 a[174:175], v8 offset:14336
  s_waitcnt lgkmcnt(8)
  v_mfma_f32_16x16x32_bf16 v[48:51], a[152:155], a[128:131], v[48:51]
  ds_read_b64_tr_b16 a[144:145], v9 offset:8192
  s_add_u32 s39, s19, s98
  v_mfma_f32_16x16x32_bf16 v[52:55], a[152:155], a[132:135], v[52:55]
  ds_read_b64_tr_b16 a[146:147], v9 offset:10240
  s_add_u32 s19, s19, s100
  v_mfma_f32_16x16x32_bf16 v[112:115], a[156:159], a[128:131], v[112:115]
  ds_read_b64_tr_b16 a[148:149], v9 offset:12288
  s_add_u32 m0, s32, 119552
  v_mfma_f32_16x16x32_bf16 v[116:119], a[156:159], a[132:135], v[116:119]
  ds_read_b64_tr_b16 a[150:151], v9 offset:14336
  buffer_load_dwordx4 v4, s[12:15], s30 offen offset:256 lds
  s_waitcnt lgkmcnt(8)
  v_mfma_f32_16x16x32_bf16 v[56:59], a[160:163], a[128:131], v[56:59]
  ds_read_b64_tr_b16 a[152:153], v10 offset:8192
  s_bitcmp1_b32 s20, 0
  s_cselect_b32 s35, 147456, 0
  s_cselect_b32 s100, 2048, 0
  v_mfma_f32_16x16x32_bf16 v[60:63], a[160:163], a[132:135], v[60:63]
  ds_read_b64_tr_b16 a[154:155], v10 offset:10240
  s_sub_u32 s35, s35, 73728
  v_mfma_f32_16x16x32_bf16 v[120:123], a[164:167], a[128:131], v[120:123]
  ds_read_b64_tr_b16 a[156:157], v10 offset:12288
  s_add_u32 m0, s32, 126720
  s_add_u32 s30, s30, 294912
  v_mfma_f32_16x16x32_bf16 v[124:127], a[164:167], a[132:135], v[124:127]
  ds_read_b64_tr_b16 a[158:159], v10 offset:14336
  buffer_load_dwordx4 v3, s[12:15], s30 offen offset:256 lds
  s_waitcnt lgkmcnt(8)
  v_mfma_f32_16x16x32_bf16 v[64:67], a[168:171], a[128:131], v[64:67]
  ds_read_b64_tr_b16 a[160:161], v7 offset:16384
  s_add_u32 s100, s100, 41947136
  v_mfma_f32_16x16x32_bf16 v[68:71], a[168:171], a[132:135], v[68:71]
  ds_read_b64_tr_b16 a[162:163], v7 offset:18432
  s_lshl_b32 s98, s26, 4
  v_mfma_f32_16x16x32_bf16 v[128:131], a[172:175], a[128:131], v[128:131]
  ds_read_b64_tr_b16 a[164:165], v7 offset:20480
  s_add_u32 s98, s98, s25
  v_mfma_f32_16x16x32_bf16 v[132:135], a[172:175], a[132:135], v[132:135]
  ds_read_b64_tr_b16 a[166:167], v7 offset:22528
  s_add_u32 m0, s32, 127744
  s_waitcnt lgkmcnt(8)
  v_mfma_f32_16x16x32_bf16 v[72:75], a[144:147], a[128:131], v[72:75]
  ds_read_b64_tr_b16 a[168:169], v8 offset:16384
  buffer_load_dwordx4 v4, s[12:15], s30 offen offset:256 lds
  v_mfma_f32_16x16x32_bf16 v[76:79], a[144:147], a[132:135], v[76:79]
  ds_read_b64_tr_b16 a[170:171], v8 offset:18432
  s_lshl_b32 s98, s98, 2
  v_mfma_f32_16x16x32_bf16 v[136:139], a[148:151], a[128:131], v[136:139]
  ds_read_b64_tr_b16 a[172:173], v8 offset:20480
  s_add_u32 s98, s98, s24
  v_mfma_f32_16x16x32_bf16 v[140:143], a[148:151], a[132:135], v[140:143]
  ds_read_b64_tr_b16 a[174:175], v8 offset:22528
  s_add_u32 m0, s32, 134912
  s_add_u32 s30, s30, 294912
  s_waitcnt lgkmcnt(8)
  v_mfma_f32_16x16x32_bf16 v[80:83], a[152:155], a[128:131], v[80:83]
  ds_read_b64_tr_b16 a[144:145], v9 offset:16384
  buffer_load_dwordx4 v3, s[12:15], s30 offen offset:256 lds
  v_mfma_f32_16x16x32_bf16 v[84:87], a[152:155], a[132:135], v[84:87]
  ds_read_b64_tr_b16 a[146:147], v9 offset:18432
  s_sub_u32 s100, s100, s33
  v_mfma_f32_16x16x32_bf16 v[144:147], a[156:159], a[128:131], v[144:147]
  ds_read_b64_tr_b16 a[148:149], v9 offset:20480
  s_sub_u32 s101, 41951232, s33
  v_mfma_f32_16x16x32_bf16 v[148:151], a[156:159], a[132:135], v[148:151]
  ds_read_b64_tr_b16 a[150:151], v9 offset:22528
  s_waitcnt vmcnt(36) lgkmcnt(8)
  v_mfma_f32_16x16x32_bf16 v[24:27], a[160:163], a[136:139], v[24:27]
  ds_read_b64_tr_b16 a[152:153], v10 offset:16384
  s_add_u32 m0, s32, 135936
  s_waitcnt vmcnt(35)
  v_mfma_f32_16x16x32_bf16 v[28:31], a[160:163], a[140:143], v[28:31]
  ds_read_b64_tr_b16 a[154:155], v10 offset:18432
  buffer_load_dwordx4 v4, s[12:15], s30 offen offset:256 lds
  v_mfma_f32_16x16x32_bf16 v[88:91], a[164:167], a[136:139], v[88:91]
  ds_read_b64_tr_b16 a[156:157], v10 offset:20480
  s_xor_b32 s31, s98, 16
  v_mfma_f32_16x16x32_bf16 v[92:95], a[164:167], a[140:143], v[92:95]
  ds_read_b64_tr_b16 a[158:159], v10 offset:22528
  s_waitcnt lgkmcnt(8)
  v_mfma_f32_16x16x32_bf16 v[32:35], a[168:171], a[136:139], v[32:35]
  ds_read_b64_tr_b16 a[160:161], v7 offset:24576
  s_mul_i32 s31, s31, 12288
  v_mfma_f32_16x16x32_bf16 v[36:39], a[168:171], a[140:143], v[36:39]
  ds_read_b64_tr_b16 a[162:163], v7 offset:26624
  s_add_u32 s31, s31, s101
  v_mfma_f32_16x16x32_bf16 v[96:99], a[172:175], a[136:139], v[96:99]
  ds_read_b64_tr_b16 a[164:165], v7 offset:28672
  s_xor_b32 s34, s98, 32
  v_mfma_f32_16x16x32_bf16 v[100:103], a[172:175], a[140:143], v[100:103]
  ds_read_b64_tr_b16 a[166:167], v7 offset:30720
  v_mul_f32 v24, v24, v88
  s_waitcnt lgkmcnt(8)
  v_mfma_f32_16x16x32_bf16 v[40:43], a[144:147], a[136:139], v[40:43]
  ds_read_b64_tr_b16 a[168:169], v8 offset:24576
  s_mul_i32 s34, s34, 12288
  v_mfma_f32_16x16x32_bf16 v[44:47], a[144:147], a[140:143], v[44:47]
  ds_read_b64_tr_b16 a[170:171], v8 offset:26624
  s_add_u32 s34, s34, s100
  v_mfma_f32_16x16x32_bf16 v[104:107], a[148:151], a[136:139], v[104:107]
  ds_read_b64_tr_b16 a[172:173], v8 offset:28672
  s_xor_b32 s88, s98, 48
  v_mfma_f32_16x16x32_bf16 v[108:111], a[148:151], a[140:143], v[108:111]
  ds_read_b64_tr_b16 a[174:175], v8 offset:30720
  v_mul_f32 v25, v25, v89
  s_waitcnt lgkmcnt(8)
  v_mfma_f32_16x16x32_bf16 v[48:51], a[152:155], a[136:139], v[48:51]
  ds_read_b64_tr_b16 a[144:145], v9 offset:24576
  s_mul_i32 s88, s88, 12288
  v_mfma_f32_16x16x32_bf16 v[52:55], a[152:155], a[140:143], v[52:55]
  ds_read_b64_tr_b16 a[146:147], v9 offset:26624
  s_add_u32 s88, s88, s100
  v_mfma_f32_16x16x32_bf16 v[112:115], a[156:159], a[136:139], v[112:115]
  ds_read_b64_tr_b16 a[148:149], v9 offset:28672
  v_mul_f32 v26, v26, v90
  v_mfma_f32_16x16x32_bf16 v[116:119], a[156:159], a[140:143], v[116:119]
  ds_read_b64_tr_b16 a[150:151], v9 offset:30720
  v_mul_f32 v27, v27, v91
  s_waitcnt lgkmcnt(8)
  v_mfma_f32_16x16x32_bf16 v[56:59], a[160:163], a[136:139], v[56:59]
  ds_read_b64_tr_b16 a[152:153], v10 offset:24576
  v_cvt_pk_bf16_f32 v184, v24, v25
  v_mfma_f32_16x16x32_bf16 v[60:63], a[160:163], a[140:143], v[60:63]
  ds_read_b64_tr_b16 a[154:155], v10 offset:26624
  v_cvt_pk_bf16_f32 v185, v26, v27
  v_mfma_f32_16x16x32_bf16 v[120:123], a[164:167], a[136:139], v[120:123]
  ds_read_b64_tr_b16 a[156:157], v10 offset:28672
  v_mul_f32 v32, v32, v96
  v_mul_f32 v33, v33, v97
  v_mul_f32 v34, v34, v98
  v_mul_f32 v35, v35, v99
  v_cvt_pk_bf16_f32 v186, v32, v33
  v_cvt_pk_bf16_f32 v187, v34, v35
  v_mfma_f32_16x16x32_bf16 v[124:127], a[164:167], a[140:143], v[124:127]
  ds_read_b64_tr_b16 a[158:159], v10 offset:30720
  s_add_u32 s3, s47, 0
  buffer_store_dwordx4 v[184:187], v2, s[8:11], s3 offen offset:0 sc1
  s_waitcnt lgkmcnt(8)
  v_mfma_f32_16x16x32_bf16 v[64:67], a[168:171], a[136:139], v[64:67]
  s_waitcnt vmcnt(19)
  s_barrier
  ds_read_b64_tr_b16 a[160:161], v11 offset:36864
  v_mul_f32 v28, v28, v92
  v_mfma_f32_16x16x32_bf16 v[68:71], a[168:171], a[140:143], v[68:71]
  ds_read_b64_tr_b16 a[162:163], v11 offset:37888
  v_mul_f32 v29, v29, v93
  v_mfma_f32_16x16x32_bf16 v[128:131], a[172:175], a[136:139], v[128:131]
  ds_read_b64_tr_b16 a[164:165], v11 offset:38912
  v_mul_f32 v30, v30, v94
  v_mfma_f32_16x16x32_bf16 v[132:135], a[172:175], a[140:143], v[132:135]
  ds_read_b64_tr_b16 a[166:167], v11 offset:39936
  v_mul_f32 v31, v31, v95
  s_waitcnt lgkmcnt(8)
  v_mfma_f32_16x16x32_bf16 v[72:75], a[144:147], a[136:139], v[72:75]
  ds_read_b64_tr_b16 a[168:169], v12 offset:36864
  v_cvt_pk_bf16_f32 v188, v28, v29
  v_mfma_f32_16x16x32_bf16 v[76:79], a[144:147], a[140:143], v[76:79]
  ds_read_b64_tr_b16 a[170:171], v12 offset:37888
  v_cvt_pk_bf16_f32 v189, v30, v31
  v_mfma_f32_16x16x32_bf16 v[136:139], a[148:151], a[136:139], v[136:139]
  ds_read_b64_tr_b16 a[172:173], v12 offset:38912
  v_mul_f32 v36, v36, v100
  v_mfma_f32_16x16x32_bf16 v[140:143], a[148:151], a[140:143], v[140:143]
  ds_read_b64_tr_b16 a[174:175], v12 offset:39936
  v_mul_f32 v37, v37, v101
  s_waitcnt lgkmcnt(8)
  v_mfma_f32_16x16x32_bf16 v[80:83], a[152:155], a[136:139], v[80:83]
  ds_read_b64_tr_b16 a[144:145], v7 offset:36864
  v_mul_f32 v38, v38, v102
  v_mfma_f32_16x16x32_bf16 v[84:87], a[152:155], a[140:143], v[84:87]
  ds_read_b64_tr_b16 a[146:147], v7 offset:38912
  v_mul_f32 v39, v39, v103
  v_mfma_f32_16x16x32_bf16 v[144:147], a[156:159], a[136:139], v[144:147]
  ds_read_b64_tr_b16 a[148:149], v7 offset:40960
  v_cvt_pk_bf16_f32 v190, v36, v37
  v_mfma_f32_16x16x32_bf16 v[148:151], a[156:159], a[140:143], v[148:151]
  ds_read_b64_tr_b16 a[150:151], v7 offset:43008
  v_cvt_pk_bf16_f32 v191, v38, v39
  s_waitcnt lgkmcnt(8)
  v_mfma_f32_16x16x32_bf16 v[152:155], a[160:163], a[72:75], v[152:155]
  ds_read_b64_tr_b16 a[152:153], v8 offset:36864
  s_add_u32 m0, s27, 33792
  s_add_u32 s90, s90, 294912
  v_mfma_f32_16x16x32_bf16 v[156:159], a[160:163], a[76:79], v[156:159]
  ds_read_b64_tr_b16 a[154:155], v8 offset:38912
  buffer_load_dwordx4 v5, s[12:15], s90 offen lds
  v_mfma_f32_16x16x32_bf16 v[168:171], a[164:167], a[72:75], v[168:171]
  ds_read_b64_tr_b16 a[156:157], v8 offset:40960
  v_mul_f32 v40, v40, v104
  v_mfma_f32_16x16x32_bf16 v[172:175], a[164:167], a[76:79], v[172:175]
  ds_read_b64_tr_b16 a[158:159], v8 offset:43008
  v_mul_f32 v41, v41, v105
  s_waitcnt lgkmcnt(8)
  v_mfma_f32_16x16x32_bf16 v[160:163], a[168:171], a[72:75], v[160:163]
  ds_read_b64_tr_b16 a[160:161], v9 offset:36864
  v_mul_f32 v42, v42, v106
  v_mfma_f32_16x16x32_bf16 v[164:167], a[168:171], a[76:79], v[164:167]
  ds_read_b64_tr_b16 a[162:163], v9 offset:38912
  v_mul_f32 v43, v43, v107
  v_mfma_f32_16x16x32_bf16 v[176:179], a[172:175], a[72:75], v[176:179]
  ds_read_b64_tr_b16 a[164:165], v9 offset:40960
  v_cvt_pk_bf16_f32 v192, v40, v41
  v_mfma_f32_16x16x32_bf16 v[180:183], a[172:175], a[76:79], v[180:183]
  ds_read_b64_tr_b16 a[166:167], v9 offset:43008
  v_cvt_pk_bf16_f32 v193, v42, v43
  s_waitcnt lgkmcnt(8)
  v_mfma_f32_16x16x32_bf16 v[24:27], a[144:147], a[0:3], 0
  ds_read_b64_tr_b16 a[168:169], v10 offset:36864
  s_add_u32 m0, s32, -256
  s_add_u32 s30, s30, 294912
  v_mfma_f32_16x16x32_bf16 v[28:31], a[144:147], a[4:7], 0
  ds_read_b64_tr_b16 a[170:171], v10 offset:38912
  buffer_load_dwordx4 v3, s[12:15], s30 offen offset:256 lds
  v_mfma_f32_16x16x32_bf16 v[88:91], a[148:151], a[0:3], 0
  ds_read_b64_tr_b16 a[172:173], v10 offset:40960
  v_mul_f32 v48, v48, v112
  v_mfma_f32_16x16x32_bf16 v[92:95], a[148:151], a[4:7], 0
  ds_read_b64_tr_b16 a[174:175], v10 offset:43008
  v_mul_f32 v49, v49, v113
  s_waitcnt lgkmcnt(8)
  v_mfma_f32_16x16x32_bf16 v[32:35], a[152:155], a[0:3], 0
  ds_read_b64_tr_b16 a[144:145], v7 offset:45056
  v_mul_f32 v50, v50, v114
  v_mfma_f32_16x16x32_bf16 v[36:39], a[152:155], a[4:7], 0
  ds_read_b64_tr_b16 a[146:147], v7 offset:47104
  s_add_u32 m0, s32, 768
  v_mfma_f32_16x16x32_bf16 v[96:99], a[156:159], a[0:3], 0
  ds_read_b64_tr_b16 a[148:149], v7 offset:49152
  buffer_load_dwordx4 v4, s[12:15], s30 offen offset:256 lds
  v_mfma_f32_16x16x32_bf16 v[100:103], a[156:159], a[4:7], 0
  ds_read_b64_tr_b16 a[150:151], v7 offset:51200
  v_mul_f32 v51, v51, v115
  v_cvt_pk_bf16_f32 v194, v48, v49
k4_part_w3:
  s_cbranch_execz k4_part_w7
  v_cvt_pk_bf16_f32 v195, v50, v51
  v_mul_f32 v44, v44, v108
  v_mul_f32 v45, v45, v109
  v_mul_f32 v46, v46, v110
  v_mul_f32 v47, v47, v111
  v_cvt_pk_bf16_f32 v196, v44, v45
  v_cvt_pk_bf16_f32 v197, v46, v47
  s_waitcnt lgkmcnt(8)
  v_mfma_f32_16x16x32_bf16 v[40:43], a[160:163], a[0:3], 0
  ds_read_b64_tr_b16 a[152:153], v8 offset:45056
  v_mul_f32 v52, v52, v116
  v_mfma_f32_16x16x32_bf16 v[44:47], a[160:163], a[4:7], 0
  ds_read_b64_tr_b16 a[154:155], v8 offset:47104
  v_mul_f32 v53, v53, v117
  v_mfma_f32_16x16x32_bf16 v[104:107], a[164:167], a[0:3], 0
  ds_read_b64_tr_b16 a[156:157], v8 offset:49152
  buffer_store_dwordx4 v[188:191], v2, s[8:11], s3 offen offset:1024 sc1
  v_mfma_f32_16x16x32_bf16 v[108:111], a[164:167], a[4:7], 0
  ds_read_b64_tr_b16 a[158:159], v8 offset:51200
  v_mul_f32 v54, v54, v118
  v_mul_f32 v55, v55, v119
  v_cvt_pk_bf16_f32 v198, v52, v53
  v_cvt_pk_bf16_f32 v199, v54, v55
  s_waitcnt lgkmcnt(8)
  v_mfma_f32_16x16x32_bf16 v[48:51], a[168:171], a[0:3], 0
  ds_read_b64_tr_b16 a[160:161], v9 offset:45056
  v_mul_f32 v56, v56, v120
  v_mfma_f32_16x16x32_bf16 v[52:55], a[168:171], a[4:7], 0
  ds_read_b64_tr_b16 a[162:163], v9 offset:47104
  v_mul_f32 v57, v57, v121
  v_mfma_f32_16x16x32_bf16 v[112:115], a[172:175], a[0:3], 0
  ds_read_b64_tr_b16 a[164:165], v9 offset:49152
  s_add_u32 m0, s32, 7936
  s_add_u32 s30, s30, 294912
  v_mfma_f32_16x16x32_bf16 v[116:119], a[172:175], a[4:7], 0
  ds_read_b64_tr_b16 a[166:167], v9 offset:51200
  buffer_load_dwordx4 v3, s[12:15], s30 offen offset:256 lds
  s_waitcnt lgkmcnt(8)
  v_mfma_f32_16x16x32_bf16 v[24:27], a[144:147], a[8:11], v[24:27]
  ds_read_b64_tr_b16 a[168:169], v10 offset:45056
  v_mul_f32 v58, v58, v122
  v_mfma_f32_16x16x32_bf16 v[28:31], a[144:147], a[12:15], v[28:31]
  ds_read_b64_tr_b16 a[170:171], v10 offset:47104
  v_mul_f32 v59, v59, v123
  v_mfma_f32_16x16x32_bf16 v[88:91], a[148:151], a[8:11], v[88:91]
  ds_read_b64_tr_b16 a[172:173], v10 offset:49152
  s_add_u32 m0, s32, 8960
  v_mfma_f32_16x16x32_bf16 v[92:95], a[148:151], a[12:15], v[92:95]
  ds_read_b64_tr_b16 a[174:175], v10 offset:51200
  buffer_load_dwordx4 v4, s[12:15], s30 offen offset:256 lds
  s_waitcnt lgkmcnt(8)
  v_mfma_f32_16x16x32_bf16 v[32:35], a[152:155], a[8:11], v[32:35]
  ds_read_b64_tr_b16 a[144:145], v7 offset:53248
  v_cvt_pk_bf16_f32 v200, v56, v57
  v_mfma_f32_16x16x32_bf16 v[36:39], a[152:155], a[12:15], v[36:39]
  ds_read_b64_tr_b16 a[146:147], v7 offset:55296
  v_cvt_pk_bf16_f32 v201, v58, v59
  v_mfma_f32_16x16x32_bf16 v[96:99], a[156:159], a[8:11], v[96:99]
  ds_read_b64_tr_b16 a[148:149], v7 offset:57344
  v_mul_f32 v64, v64, v128
  v_mfma_f32_16x16x32_bf16 v[100:103], a[156:159], a[12:15], v[100:103]
  ds_read_b64_tr_b16 a[150:151], v7 offset:59392
  s_add_u32 m0, s32, 16128
  s_add_u32 s30, s30, 294912
  s_waitcnt lgkmcnt(8)
  v_mfma_f32_16x16x32_bf16 v[40:43], a[160:163], a[8:11], v[40:43]
  ds_read_b64_tr_b16 a[152:153], v8 offset:53248
  buffer_load_dwordx4 v3, s[12:15], s30 offen offset:256 lds
  v_mfma_f32_16x16x32_bf16 v[44:47], a[160:163], a[12:15], v[44:47]
  ds_read_b64_tr_b16 a[154:155], v8 offset:55296
  v_mul_f32 v65, v65, v129
  v_mfma_f32_16x16x32_bf16 v[104:107], a[164:167], a[8:11], v[104:107]
  ds_read_b64_tr_b16 a[156:157], v8 offset:57344
  v_mul_f32 v66, v66, v130
  v_mfma_f32_16x16x32_bf16 v[108:111], a[164:167], a[12:15], v[108:111]
  ds_read_b64_tr_b16 a[158:159], v8 offset:59392
  s_add_u32 m0, s32, 17152
  s_waitcnt lgkmcnt(8)
  v_mfma_f32_16x16x32_bf16 v[48:51], a[168:171], a[8:11], v[48:51]
  ds_read_b64_tr_b16 a[160:161], v9 offset:53248
  buffer_load_dwordx4 v4, s[12:15], s30 offen offset:256 lds
  v_mfma_f32_16x16x32_bf16 v[52:55], a[168:171], a[12:15], v[52:55]
  ds_read_b64_tr_b16 a[162:163], v9 offset:55296
  v_mul_f32 v67, v67, v131
  v_mfma_f32_16x16x32_bf16 v[112:115], a[172:175], a[8:11], v[112:115]
  ds_read_b64_tr_b16 a[164:165], v9 offset:57344
  v_cvt_pk_bf16_f32 v202, v64, v65
  v_mfma_f32_16x16x32_bf16 v[116:119], a[172:175], a[12:15], v[116:119]
  ds_read_b64_tr_b16 a[166:167], v9 offset:59392
  v_cvt_pk_bf16_f32 v203, v66, v67
  s_waitcnt lgkmcnt(8)
  v_mfma_f32_16x16x32_bf16 v[24:27], a[144:147], a[16:19], v[24:27]
  ds_read_b64_tr_b16 a[168:169], v10 offset:53248
  s_add_u32 m0, s32, 24320
  s_add_u32 s30, s30, 294912
  v_mfma_f32_16x16x32_bf16 v[28:31], a[144:147], a[20:23], v[28:31]
  ds_read_b64_tr_b16 a[170:171], v10 offset:55296
  buffer_load_dwordx4 v3, s[12:15], s30 offen offset:256 lds
  v_mfma_f32_16x16x32_bf16 v[88:91], a[148:151], a[16:19], v[88:91]
  ds_read_b64_tr_b16 a[172:173], v10 offset:57344
  v_mul_f32 v60, v60, v124
  v_mfma_f32_16x16x32_bf16 v[92:95], a[148:151], a[20:23], v[92:95]
  ds_read_b64_tr_b16 a[174:175], v10 offset:59392
  v_mul_f32 v61, v61, v125
  s_waitcnt lgkmcnt(8)
  v_mfma_f32_16x16x32_bf16 v[32:35], a[152:155], a[16:19], v[32:35]
  ds_read_b64_tr_b16 a[144:145], v7 offset:61440
  s_add_u32 m0, s32, 25344
  v_mfma_f32_16x16x32_bf16 v[36:39], a[152:155], a[20:23], v[36:39]
  ds_read_b64_tr_b16 a[146:147], v7 offset:63488
  buffer_load_dwordx4 v4, s[12:15], s30 offen offset:256 lds
  v_mfma_f32_16x16x32_bf16 v[96:99], a[156:159], a[16:19], v[96:99]
  v_add_u32 v7, 65536, v7
  ds_read_b64_tr_b16 a[148:149], v7 offset:0
  v_mul_f32 v62, v62, v126
  v_mfma_f32_16x16x32_bf16 v[100:103], a[156:159], a[20:23], v[100:103]
  ds_read_b64_tr_b16 a[150:151], v7 offset:2048
  v_mul_f32 v63, v63, v127
  s_waitcnt lgkmcnt(8)
  v_mfma_f32_16x16x32_bf16 v[40:43], a[160:163], a[16:19], v[40:43]
  ds_read_b64_tr_b16 a[152:153], v8 offset:61440
  v_cvt_pk_bf16_f32 v204, v60, v61
  v_mfma_f32_16x16x32_bf16 v[44:47], a[160:163], a[20:23], v[44:47]
  ds_read_b64_tr_b16 a[154:155], v8 offset:63488
  v_cvt_pk_bf16_f32 v205, v62, v63
  v_mfma_f32_16x16x32_bf16 v[104:107], a[164:167], a[16:19], v[104:107]
  v_add_u32 v8, 65536, v8
  ds_read_b64_tr_b16 a[156:157], v8 offset:0
  buffer_store_dwordx4 v[192:195], v2, s[8:11], s3 offen offset:2048 sc1
  v_mfma_f32_16x16x32_bf16 v[108:111], a[164:167], a[20:23], v[108:111]
  ds_read_b64_tr_b16 a[158:159], v8 offset:2048
  v_mul_f32 v68, v68, v132
  s_waitcnt lgkmcnt(8)
  v_mfma_f32_16x16x32_bf16 v[48:51], a[168:171], a[16:19], v[48:51]
  ds_read_b64_tr_b16 a[160:161], v9 offset:61440
  v_mul_f32 v69, v69, v133
  v_mfma_f32_16x16x32_bf16 v[52:55], a[168:171], a[20:23], v[52:55]
  ds_read_b64_tr_b16 a[162:163], v9 offset:63488
  v_mul_f32 v70, v70, v134
  v_mfma_f32_16x16x32_bf16 v[112:115], a[172:175], a[16:19], v[112:115]
  v_add_u32 v9, 65536, v9
  ds_read_b64_tr_b16 a[164:165], v9 offset:0
  v_mul_f32 v71, v71, v135
  v_mfma_f32_16x16x32_bf16 v[116:119], a[172:175], a[20:23], v[116:119]
  ds_read_b64_tr_b16 a[166:167], v9 offset:2048
  v_cvt_pk_bf16_f32 v206, v68, v69
  s_waitcnt lgkmcnt(8)
  v_mfma_f32_16x16x32_bf16 v[24:27], a[144:147], a[24:27], v[24:27]
  ds_read_b64_tr_b16 a[168:169], v10 offset:61440
  v_cvt_pk_bf16_f32 v207, v70, v71
  v_mfma_f32_16x16x32_bf16 v[28:31], a[144:147], a[28:31], v[28:31]
  ds_read_b64_tr_b16 a[170:171], v10 offset:63488
  v_mul_f32 v72, v72, v136
  v_mfma_f32_16x16x32_bf16 v[88:91], a[148:151], a[24:27], v[88:91]
  v_add_u32 v10, 65536, v10
  ds_read_b64_tr_b16 a[172:173], v10 offset:0
  v_mul_f32 v73, v73, v137
  v_mfma_f32_16x16x32_bf16 v[92:95], a[148:151], a[28:31], v[92:95]
  ds_read_b64_tr_b16 a[174:175], v10 offset:2048
  v_mul_f32 v74, v74, v138
  s_waitcnt lgkmcnt(8)
  v_mfma_f32_16x16x32_bf16 v[32:35], a[152:155], a[24:27], v[32:35]
  s_waitcnt vmcnt(21)
  s_barrier
  v_add_u32 v11, 73728, v11
  ds_read_b64_tr_b16 a[144:145], v11 offset:0
  v_mul_f32 v75, v75, v139
  v_mfma_f32_16x16x32_bf16 v[36:39], a[152:155], a[28:31], v[36:39]
  ds_read_b64_tr_b16 a[146:147], v11 offset:1024
  v_cvt_pk_bf16_f32 v208, v72, v73
  v_mfma_f32_16x16x32_bf16 v[96:99], a[156:159], a[24:27], v[96:99]
  ds_read_b64_tr_b16 a[148:149], v11 offset:2048
  v_cvt_pk_bf16_f32 v209, v74, v75
  v_mfma_f32_16x16x32_bf16 v[100:103], a[156:159], a[28:31], v[100:103]
  ds_read_b64_tr_b16 a[150:151], v11 offset:3072
  v_mul_f32 v80, v80, v144
  s_waitcnt lgkmcnt(8)
  v_mfma_f32_16x16x32_bf16 v[40:43], a[160:163], a[24:27], v[40:43]
  v_add_u32 v12, 73728, v12
  ds_read_b64_tr_b16 a[152:153], v12 offset:0
  v_mul_f32 v81, v81, v145
  v_mfma_f32_16x16x32_bf16 v[44:47], a[160:163], a[28:31], v[44:47]
  ds_read_b64_tr_b16 a[154:155], v12 offset:1024
  v_mul_f32 v82, v82, v146
  v_mfma_f32_16x16x32_bf16 v[104:107], a[164:167], a[24:27], v[104:107]
  ds_read_b64_tr_b16 a[156:157], v12 offset:2048
  v_mul_f32 v83, v83, v147
  v_mfma_f32_16x16x32_bf16 v[108:111], a[164:167], a[28:31], v[108:111]
  ds_read_b64_tr_b16 a[158:159], v12 offset:3072
  v_cvt_pk_bf16_f32 v210, v80, v81
  s_waitcnt lgkmcnt(8)
  v_mfma_f32_16x16x32_bf16 v[48:51], a[168:171], a[24:27], v[48:51]
  ds_read_b64_tr_b16 a[160:161], v7 offset:8192
  v_cvt_pk_bf16_f32 v211, v82, v83
  v_mfma_f32_16x16x32_bf16 v[52:55], a[168:171], a[28:31], v[52:55]
  ds_read_b64_tr_b16 a[162:163], v7 offset:10240
  v_mul_f32 v76, v76, v140
  v_mfma_f32_16x16x32_bf16 v[112:115], a[172:175], a[24:27], v[112:115]
  ds_read_b64_tr_b16 a[164:165], v7 offset:12288
  v_mul_f32 v77, v77, v141
  v_mfma_f32_16x16x32_bf16 v[116:119], a[172:175], a[28:31], v[116:119]
  ds_read_b64_tr_b16 a[166:167], v7 offset:14336
  v_mul_f32 v78, v78, v142
  s_waitcnt lgkmcnt(8)
  v_mfma_f32_16x16x32_bf16 v[152:155], a[144:147], a[80:83], v[152:155]
  ds_read_b64_tr_b16 a[168:169], v8 offset:8192
  s_add_u32 m0, s27, 70656
  s_add_u32 s90, s90, 294912
  v_mfma_f32_16x16x32_bf16 v[156:159], a[144:147], a[84:87], v[156:159]
  ds_read_b64_tr_b16 a[170:171], v8 offset:10240
  buffer_load_dwordx4 v5, s[12:15], s90 offen lds
  v_mfma_f32_16x16x32_bf16 v[168:171], a[148:151], a[80:83], v[168:171]
  ds_read_b64_tr_b16 a[172:173], v8 offset:12288
  v_mul_f32 v79, v79, v143
  v_mfma_f32_16x16x32_bf16 v[172:175], a[148:151], a[84:87], v[172:175]
  ds_read_b64_tr_b16 a[174:175], v8 offset:14336
  v_cvt_pk_bf16_f32 v212, v76, v77
  s_waitcnt lgkmcnt(8)
  v_mfma_f32_16x16x32_bf16 v[160:163], a[152:155], a[80:83], v[160:163]
  ds_read_b64_tr_b16 a[144:145], v9 offset:8192
  v_cvt_pk_bf16_f32 v213, v78, v79
  v_mfma_f32_16x16x32_bf16 v[164:167], a[152:155], a[84:87], v[164:167]
  ds_read_b64_tr_b16 a[146:147], v9 offset:10240
  v_mul_f32 v84, v84, v148
  v_mfma_f32_16x16x32_bf16 v[176:179], a[156:159], a[80:83], v[176:179]
  ds_read_b64_tr_b16 a[148:149], v9 offset:12288
  v_mul_f32 v85, v85, v149
  v_mfma_f32_16x16x32_bf16 v[180:183], a[156:159], a[84:87], v[180:183]
  ds_read_b64_tr_b16 a[150:151], v9 offset:14336
  v_mul_f32 v86, v86, v150
  s_waitcnt lgkmcnt(8)
  v_mfma_f32_16x16x32_bf16 v[24:27], a[160:163], a[32:35], v[24:27]
  ds_read_b64_tr_b16 a[152:153], v10 offset:8192
  v_mul_f32 v87, v87, v151
  v_mfma_f32_16x16x32_bf16 v[28:31], a[160:163], a[36:39], v[28:31]
  ds_read_b64_tr_b16 a[154:155], v10 offset:10240
  buffer_store_dwordx4 v[196:199], v2, s[8:11], s3 offen offset:3072 sc1
  v_mfma_f32_16x16x32_bf16 v[88:91], a[164:167], a[32:35], v[88:91]
  ds_read_b64_tr_b16 a[156:157], v10 offset:12288
  v_cvt_pk_bf16_f32 v214, v84, v85
  v_mfma_f32_16x16x32_bf16 v[92:95], a[164:167], a[36:39], v[92:95]
  ds_read_b64_tr_b16 a[158:159], v10 offset:14336
  v_cvt_pk_bf16_f32 v215, v86, v87
  s_waitcnt lgkmcnt(8)
  v_mfma_f32_16x16x32_bf16 v[32:35], a[168:171], a[32:35], v[32:35]
  ds_read_b64_tr_b16 a[160:161], v7 offset:16384
  v_mfma_f32_16x16x32_bf16 v[36:39], a[168:171], a[36:39], v[36:39]
  ds_read_b64_tr_b16 a[162:163], v7 offset:18432
  s_add_u32 m0, s32, 36608
  s_add_u32 s30, s30, 294912
  v_mfma_f32_16x16x32_bf16 v[96:99], a[172:175], a[32:35], v[96:99]
  ds_read_b64_tr_b16 a[164:165], v7 offset:20480
  buffer_load_dwordx4 v3, s[12:15], s30 offen offset:256 lds
  v_mfma_f32_16x16x32_bf16 v[100:103], a[172:175], a[36:39], v[100:103]
  ds_read_b64_tr_b16 a[166:167], v7 offset:22528
  s_waitcnt lgkmcnt(8)
  v_mfma_f32_16x16x32_bf16 v[40:43], a[144:147], a[32:35], v[40:43]
  ds_read_b64_tr_b16 a[168:169], v8 offset:16384
  v_mfma_f32_16x16x32_bf16 v[44:47], a[144:147], a[36:39], v[44:47]
  ds_read_b64_tr_b16 a[170:171], v8 offset:18432
  s_add_u32 m0, s32, 37632
  v_mfma_f32_16x16x32_bf16 v[104:107], a[148:151], a[32:35], v[104:107]
  ds_read_b64_tr_b16 a[172:173], v8 offset:20480
  buffer_load_dwordx4 v4, s[12:15], s30 offen offset:256 lds
  v_mfma_f32_16x16x32_bf16 v[108:111], a[148:151], a[36:39], v[108:111]
  ds_read_b64_tr_b16 a[174:175], v8 offset:22528
  s_waitcnt lgkmcnt(8)
  v_mfma_f32_16x16x32_bf16 v[48:51], a[152:155], a[32:35], v[48:51]
  ds_read_b64_tr_b16 a[144:145], v9 offset:16384
  v_mfma_f32_16x16x32_bf16 v[52:55], a[152:155], a[36:39], v[52:55]
  ds_read_b64_tr_b16 a[146:147], v9 offset:18432
  v_mfma_f32_16x16x32_bf16 v[112:115], a[156:159], a[32:35], v[112:115]
  ds_read_b64_tr_b16 a[148:149], v9 offset:20480
  s_add_u32 m0, s32, 44800
  s_add_u32 s30, s30, 294912
  v_mfma_f32_16x16x32_bf16 v[116:119], a[156:159], a[36:39], v[116:119]
  ds_read_b64_tr_b16 a[150:151], v9 offset:22528
  buffer_load_dwordx4 v3, s[12:15], s30 offen offset:256 lds
  s_waitcnt lgkmcnt(8)
  v_mfma_f32_16x16x32_bf16 v[24:27], a[160:163], a[40:43], v[24:27]
  ds_read_b64_tr_b16 a[152:153], v10 offset:16384
  v_mfma_f32_16x16x32_bf16 v[28:31], a[160:163], a[44:47], v[28:31]
  ds_read_b64_tr_b16 a[154:155], v10 offset:18432
  v_mfma_f32_16x16x32_bf16 v[88:91], a[164:167], a[40:43], v[88:91]
  ds_read_b64_tr_b16 a[156:157], v10 offset:20480
  s_add_u32 m0, s32, 45824
  v_mfma_f32_16x16x32_bf16 v[92:95], a[164:167], a[44:47], v[92:95]
  ds_read_b64_tr_b16 a[158:159], v10 offset:22528
  buffer_load_dwordx4 v4, s[12:15], s30 offen offset:256 lds
  s_waitcnt lgkmcnt(8)
  v_mfma_f32_16x16x32_bf16 v[32:35], a[168:171], a[40:43], v[32:35]
  ds_read_b64_tr_b16 a[160:161], v7 offset:24576
  v_mfma_f32_16x16x32_bf16 v[36:39], a[168:171], a[44:47], v[36:39]
  ds_read_b64_tr_b16 a[162:163], v7 offset:26624
  v_mfma_f32_16x16x32_bf16 v[96:99], a[172:175], a[40:43], v[96:99]
  ds_read_b64_tr_b16 a[164:165], v7 offset:28672
  v_mfma_f32_16x16x32_bf16 v[100:103], a[172:175], a[44:47], v[100:103]
  ds_read_b64_tr_b16 a[166:167], v7 offset:30720
  s_add_u32 m0, s32, 52864
  s_add_u32 s30, s30, -5013504
  s_waitcnt lgkmcnt(8)
  v_mfma_f32_16x16x32_bf16 v[40:43], a[144:147], a[40:43], v[40:43]
  ds_read_b64_tr_b16 a[168:169], v8 offset:24576
  buffer_load_dwordx4 v3, s[12:15], s30 offen offset:384 lds
  v_mfma_f32_16x16x32_bf16 v[44:47], a[144:147], a[44:47], v[44:47]
  ds_read_b64_tr_b16 a[170:171], v8 offset:26624
  v_mfma_f32_16x16x32_bf16 v[104:107], a[148:151], a[40:43], v[104:107]
  ds_read_b64_tr_b16 a[172:173], v8 offset:28672
  v_mfma_f32_16x16x32_bf16 v[108:111], a[148:151], a[44:47], v[108:111]
  ds_read_b64_tr_b16 a[174:175], v8 offset:30720
  s_waitcnt lgkmcnt(8)
  v_mfma_f32_16x16x32_bf16 v[48:51], a[152:155], a[40:43], v[48:51]
  ds_read_b64_tr_b16 a[144:145], v9 offset:24576
  s_add_u32 s3, s47, 4096
  buffer_store_dwordx4 v[200:203], v2, s[8:11], s3 offen offset:0 sc1
  v_mfma_f32_16x16x32_bf16 v[52:55], a[152:155], a[44:47], v[52:55]
  ds_read_b64_tr_b16 a[146:147], v9 offset:26624
  v_mfma_f32_16x16x32_bf16 v[112:115], a[156:159], a[40:43], v[112:115]
  ds_read_b64_tr_b16 a[148:149], v9 offset:28672
  v_mfma_f32_16x16x32_bf16 v[116:119], a[156:159], a[44:47], v[116:119]
  ds_read_b64_tr_b16 a[150:151], v9 offset:30720
  s_waitcnt lgkmcnt(8)
  v_mfma_f32_16x16x32_bf16 v[24:27], a[160:163], a[48:51], v[24:27]
  ds_read_b64_tr_b16 a[152:153], v10 offset:24576
  s_add_u32 m0, s32, 53888
  v_mfma_f32_16x16x32_bf16 v[28:31], a[160:163], a[52:55], v[28:31]
  ds_read_b64_tr_b16 a[154:155], v10 offset:26624
  buffer_load_dwordx4 v4, s[12:15], s30 offen offset:384 lds
  v_mfma_f32_16x16x32_bf16 v[88:91], a[164:167], a[48:51], v[88:91]
  ds_read_b64_tr_b16 a[156:157], v10 offset:28672
  v_mfma_f32_16x16x32_bf16 v[92:95], a[164:167], a[52:55], v[92:95]
  ds_read_b64_tr_b16 a[158:159], v10 offset:30720
  s_waitcnt lgkmcnt(8)
  v_mfma_f32_16x16x32_bf16 v[32:35], a[168:171], a[48:51], v[32:35]
  ds_read_b64_tr_b16 a[160:161], v7 offset:32768
  s_add_u32 m0, s32, 61056
  s_add_u32 s30, s30, 294912
  v_mfma_f32_16x16x32_bf16 v[36:39], a[168:171], a[52:55], v[36:39]
  ds_read_b64_tr_b16 a[162:163], v7 offset:34816
  buffer_load_dwordx4 v3, s[12:15], s30 offen offset:384 lds
  v_mfma_f32_16x16x32_bf16 v[96:99], a[172:175], a[48:51], v[96:99]
  ds_read_b64_tr_b16 a[164:165], v7 offset:36864
  v_mfma_f32_16x16x32_bf16 v[100:103], a[172:175], a[52:55], v[100:103]
  ds_read_b64_tr_b16 a[166:167], v7 offset:38912
  s_waitcnt lgkmcnt(8)
  v_mfma_f32_16x16x32_bf16 v[40:43], a[144:147], a[48:51], v[40:43]
  ds_read_b64_tr_b16 a[168:169], v8 offset:32768
  v_mfma_f32_16x16x32_bf16 v[44:47], a[144:147], a[52:55], v[44:47]
  ds_read_b64_tr_b16 a[170:171], v8 offset:34816
  s_add_u32 m0, s32, 62080
  v_mfma_f32_16x16x32_bf16 v[104:107], a[148:151], a[48:51], v[104:107]
  ds_read_b64_tr_b16 a[172:173], v8 offset:36864
  buffer_load_dwordx4 v4, s[12:15], s30 offen offset:384 lds
  v_mfma_f32_16x16x32_bf16 v[108:111], a[148:151], a[52:55], v[108:111]
  ds_read_b64_tr_b16 a[174:175], v8 offset:38912
  s_waitcnt lgkmcnt(8)
  v_mfma_f32_16x16x32_bf16 v[48:51], a[152:155], a[48:51], v[48:51]
  ds_read_b64_tr_b16 a[144:145], v9 offset:32768
  v_mfma_f32_16x16x32_bf16 v[52:55], a[152:155], a[52:55], v[52:55]
  ds_read_b64_tr_b16 a[146:147], v9 offset:34816
  v_mfma_f32_16x16x32_bf16 v[112:115], a[156:159], a[48:51], v[112:115]
  ds_read_b64_tr_b16 a[148:149], v9 offset:36864
  v_mfma_f32_16x16x32_bf16 v[116:119], a[156:159], a[52:55], v[116:119]
  ds_read_b64_tr_b16 a[150:151], v9 offset:38912
  s_waitcnt lgkmcnt(8)
  v_mfma_f32_16x16x32_bf16 v[24:27], a[160:163], a[56:59], v[24:27]
  ds_read_b64_tr_b16 a[152:153], v10 offset:32768
  v_mfma_f32_16x16x32_bf16 v[28:31], a[160:163], a[60:63], v[28:31]
  ds_read_b64_tr_b16 a[154:155], v10 offset:34816
  v_mfma_f32_16x16x32_bf16 v[88:91], a[164:167], a[56:59], v[88:91]
  ds_read_b64_tr_b16 a[156:157], v10 offset:36864
  v_mfma_f32_16x16x32_bf16 v[92:95], a[164:167], a[60:63], v[92:95]
  ds_read_b64_tr_b16 a[158:159], v10 offset:38912
  s_waitcnt lgkmcnt(8)
  v_mfma_f32_16x16x32_bf16 v[32:35], a[168:171], a[56:59], v[32:35]
  s_waitcnt vmcnt(23)
  s_barrier
  ds_read_b64_tr_b16 a[160:161], v11 offset:36864
  v_mfma_f32_16x16x32_bf16 v[36:39], a[168:171], a[60:63], v[36:39]
  ds_read_b64_tr_b16 a[162:163], v11 offset:37888
  v_mfma_f32_16x16x32_bf16 v[96:99], a[172:175], a[56:59], v[96:99]
  ds_read_b64_tr_b16 a[164:165], v11 offset:38912
  v_mfma_f32_16x16x32_bf16 v[100:103], a[172:175], a[60:63], v[100:103]
  ds_read_b64_tr_b16 a[166:167], v11 offset:39936
  s_waitcnt lgkmcnt(8)
  v_mfma_f32_16x16x32_bf16 v[40:43], a[144:147], a[56:59], v[40:43]
  ds_read_b64_tr_b16 a[168:169], v12 offset:36864
  v_mfma_f32_16x16x32_bf16 v[44:47], a[144:147], a[60:63], v[44:47]
  ds_read_b64_tr_b16 a[170:171], v12 offset:37888
  buffer_store_dwordx4 v[204:207], v2, s[8:11], s3 offen offset:1024 sc1
  v_mfma_f32_16x16x32_bf16 v[104:107], a[148:151], a[56:59], v[104:107]
  ds_read_b64_tr_b16 a[172:173], v12 offset:38912
  v_mfma_f32_16x16x32_bf16 v[108:111], a[148:151], a[60:63], v[108:111]
  ds_read_b64_tr_b16 a[174:175], v12 offset:39936
  s_waitcnt lgkmcnt(8)
  v_mfma_f32_16x16x32_bf16 v[48:51], a[152:155], a[56:59], v[48:51]
  ds_read_b64_tr_b16 a[144:145], v7 offset:45056
  v_mfma_f32_16x16x32_bf16 v[52:55], a[152:155], a[60:63], v[52:55]
  ds_read_b64_tr_b16 a[146:147], v7 offset:47104
  v_mfma_f32_16x16x32_bf16 v[112:115], a[156:159], a[56:59], v[112:115]
  ds_read_b64_tr_b16 a[148:149], v7 offset:49152
  v_mfma_f32_16x16x32_bf16 v[116:119], a[156:159], a[60:63], v[116:119]
  ds_read_b64_tr_b16 a[150:151], v7 offset:51200
  s_waitcnt lgkmcnt(8)
  v_mfma_f32_16x16x32_bf16 v[152:155], a[160:163], a[88:91], v[152:155]
  ds_read_b64_tr_b16 a[152:153], v8 offset:45056
  s_add_u32 m0, s27, 107520
  s_add_u32 s90, s90, 294912
  v_mfma_f32_16x16x32_bf16 v[156:159], a[160:163], a[92:95], v[156:159]
  ds_read_b64_tr_b16 a[154:155], v8 offset:47104
  buffer_load_dwordx4 v5, s[12:15], s90 offen lds
  v_mfma_f32_16x16x32_bf16 v[168:171], a[164:167], a[88:91], v[168:171]
  ds_read_b64_tr_b16 a[156:157], v8 offset:49152
  v_mfma_f32_16x16x32_bf16 v[172:175], a[164:167], a[92:95], v[172:175]
  ds_read_b64_tr_b16 a[158:159], v8 offset:51200
  s_waitcnt lgkmcnt(8)
  v_mfma_f32_16x16x32_bf16 v[160:163], a[168:171], a[88:91], v[160:163]
  ds_read_b64_tr_b16 a[160:161], v9 offset:45056
  v_mfma_f32_16x16x32_bf16 v[164:167], a[168:171], a[92:95], v[164:167]
  ds_read_b64_tr_b16 a[162:163], v9 offset:47104
  v_mfma_f32_16x16x32_bf16 v[176:179], a[172:175], a[88:91], v[176:179]
  ds_read_b64_tr_b16 a[164:165], v9 offset:49152
  v_mfma_f32_16x16x32_bf16 v[180:183], a[172:175], a[92:95], v[180:183]
  ds_read_b64_tr_b16 a[166:167], v9 offset:51200
  s_waitcnt lgkmcnt(8)
  v_mfma_f32_16x16x32_bf16 v[24:27], a[144:147], a[64:67], v[24:27]
  ds_read_b64_tr_b16 a[168:169], v10 offset:45056
  s_add_u32 m0, s32, 73344
  s_add_u32 s30, s30, 294912
  v_mfma_f32_16x16x32_bf16 v[28:31], a[144:147], a[68:71], v[28:31]
  ds_read_b64_tr_b16 a[170:171], v10 offset:47104
  buffer_load_dwordx4 v3, s[12:15], s30 offen offset:384 lds
  v_mfma_f32_16x16x32_bf16 v[88:91], a[148:151], a[64:67], v[88:91]
  ds_read_b64_tr_b16 a[172:173], v10 offset:49152
  v_mfma_f32_16x16x32_bf16 v[92:95], a[148:151], a[68:71], v[92:95]
  ds_read_b64_tr_b16 a[174:175], v10 offset:51200
  s_waitcnt lgkmcnt(8)
  v_mfma_f32_16x16x32_bf16 v[32:35], a[152:155], a[64:67], v[32:35]
  ds_read_b64_tr_b16 a[144:145], v7 offset:53248
  v_mfma_f32_16x16x32_bf16 v[36:39], a[152:155], a[68:71], v[36:39]
  ds_read_b64_tr_b16 a[146:147], v7 offset:55296
  s_add_u32 m0, s32, 74368
  v_mfma_f32_16x16x32_bf16 v[96:99], a[156:159], a[64:67], v[96:99]
  ds_read_b64_tr_b16 a[148:149], v7 offset:57344
  buffer_load_dwordx4 v4, s[12:15], s30 offen offset:384 lds
  v_mfma_f32_16x16x32_bf16 v[100:103], a[156:159], a[68:71], v[100:103]
  ds_read_b64_tr_b16 a[150:151], v7 offset:59392
  s_waitcnt lgkmcnt(8)
  v_mfma_f32_16x16x32_bf16 v[40:43], a[160:163], a[64:67], v[40:43]
  ds_read_b64_tr_b16 a[152:153], v8 offset:53248
  v_mfma_f32_16x16x32_bf16 v[44:47], a[160:163], a[68:71], v[44:47]
  ds_read_b64_tr_b16 a[154:155], v8 offset:55296
  s_add_u32 m0, s32, 81536
  s_add_u32 s30, s30, 294912
  v_mfma_f32_16x16x32_bf16 v[104:107], a[164:167], a[64:67], v[104:107]
  ds_read_b64_tr_b16 a[156:157], v8 offset:57344
  buffer_load_dwordx4 v3, s[12:15], s30 offen offset:384 lds
  v_mfma_f32_16x16x32_bf16 v[108:111], a[164:167], a[68:71], v[108:111]
  ds_read_b64_tr_b16 a[158:159], v8 offset:59392
  s_waitcnt lgkmcnt(8)
  v_mfma_f32_16x16x32_bf16 v[48:51], a[168:171], a[64:67], v[48:51]
  ds_read_b64_tr_b16 a[160:161], v9 offset:53248
  v_mfma_f32_16x16x32_bf16 v[52:55], a[168:171], a[68:71], v[52:55]
  ds_read_b64_tr_b16 a[162:163], v9 offset:55296
  v_mfma_f32_16x16x32_bf16 v[112:115], a[172:175], a[64:67], v[112:115]
  ds_read_b64_tr_b16 a[164:165], v9 offset:57344
  v_mfma_f32_16x16x32_bf16 v[116:119], a[172:175], a[68:71], v[116:119]
  ds_read_b64_tr_b16 a[166:167], v9 offset:59392
  buffer_store_dwordx4 v[208:211], v2, s[8:11], s3 offen offset:2048 sc1
  s_waitcnt lgkmcnt(8)
  v_mfma_f32_16x16x32_bf16 v[24:27], a[144:147], a[72:75], v[24:27]
  ds_read_b64_tr_b16 a[168:169], v10 offset:53248
  v_mfma_f32_16x16x32_bf16 v[28:31], a[144:147], a[76:79], v[28:31]
  ds_read_b64_tr_b16 a[170:171], v10 offset:55296
  v_mfma_f32_16x16x32_bf16 v[88:91], a[148:151], a[72:75], v[88:91]
  ds_read_b64_tr_b16 a[172:173], v10 offset:57344
  s_add_u32 m0, s32, 82560
  v_mfma_f32_16x16x32_bf16 v[92:95], a[148:151], a[76:79], v[92:95]
  ds_read_b64_tr_b16 a[174:175], v10 offset:59392
  buffer_load_dwordx4 v4, s[12:15], s30 offen offset:384 lds
  s_waitcnt lgkmcnt(8)
  v_mfma_f32_16x16x32_bf16 v[32:35], a[152:155], a[72:75], v[32:35]
  ds_read_b64_tr_b16 a[144:145], v7 offset:61440
  v_mfma_f32_16x16x32_bf16 v[36:39], a[152:155], a[76:79], v[36:39]
  ds_read_b64_tr_b16 a[146:147], v7 offset:63488
  v_mfma_f32_16x16x32_bf16 v[96:99], a[156:159], a[72:75], v[96:99]
  v_add_u32 v7, 65536, v7
  ds_read_b64_tr_b16 a[148:149], v7 offset:0
  v_mfma_f32_16x16x32_bf16 v[100:103], a[156:159], a[76:79], v[100:103]
  ds_read_b64_tr_b16 a[150:151], v7 offset:2048
  s_add_u32 m0, s32, 89728
  s_add_u32 s30, s30, 294912
  s_waitcnt lgkmcnt(8)
  v_mfma_f32_16x16x32_bf16 v[40:43], a[160:163], a[72:75], v[40:43]
  ds_read_b64_tr_b16 a[152:153], v8 offset:61440
  buffer_load_dwordx4 v3, s[12:15], s30 offen offset:384 lds
  v_mfma_f32_16x16x32_bf16 v[44:47], a[160:163], a[76:79], v[44:47]
  ds_read_b64_tr_b16 a[154:155], v8 offset:63488
  v_mfma_f32_16x16x32_bf16 v[104:107], a[164:167], a[72:75], v[104:107]
  v_add_u32 v8, 65536, v8
  ds_read_b64_tr_b16 a[156:157], v8 offset:0
  v_mfma_f32_16x16x32_bf16 v[108:111], a[164:167], a[76:79], v[108:111]
  ds_read_b64_tr_b16 a[158:159], v8 offset:2048
  s_add_u32 m0, s32, 90752
  s_waitcnt lgkmcnt(8)
  v_mfma_f32_16x16x32_bf16 v[48:51], a[168:171], a[72:75], v[48:51]
  ds_read_b64_tr_b16 a[160:161], v9 offset:61440
  buffer_load_dwordx4 v4, s[12:15], s30 offen offset:384 lds
  v_mfma_f32_16x16x32_bf16 v[52:55], a[168:171], a[76:79], v[52:55]
  ds_read_b64_tr_b16 a[162:163], v9 offset:63488
  v_mfma_f32_16x16x32_bf16 v[112:115], a[172:175], a[72:75], v[112:115]
  v_add_u32 v9, 65536, v9
  ds_read_b64_tr_b16 a[164:165], v9 offset:0
  v_mfma_f32_16x16x32_bf16 v[116:119], a[172:175], a[76:79], v[116:119]
  ds_read_b64_tr_b16 a[166:167], v9 offset:2048
  s_waitcnt lgkmcnt(8)
  v_mfma_f32_16x16x32_bf16 v[24:27], a[144:147], a[80:83], v[24:27]
  ds_read_b64_tr_b16 a[168:169], v10 offset:61440
  s_add_u32 m0, s32, 97920
  s_add_u32 s30, s30, 294912
  v_mfma_f32_16x16x32_bf16 v[28:31], a[144:147], a[84:87], v[28:31]
  ds_read_b64_tr_b16 a[170:171], v10 offset:63488
  buffer_load_dwordx4 v3, s[12:15], s30 offen offset:384 lds
  v_mfma_f32_16x16x32_bf16 v[88:91], a[148:151], a[80:83], v[88:91]
  v_add_u32 v10, 65536, v10
  ds_read_b64_tr_b16 a[172:173], v10 offset:0
  v_mfma_f32_16x16x32_bf16 v[92:95], a[148:151], a[84:87], v[92:95]
  ds_read_b64_tr_b16 a[174:175], v10 offset:2048
  s_waitcnt lgkmcnt(8)
  v_mfma_f32_16x16x32_bf16 v[32:35], a[152:155], a[80:83], v[32:35]
  ds_read_b64_tr_b16 a[144:145], v7 offset:4096
  s_add_u32 m0, s32, 98944
  v_mfma_f32_16x16x32_bf16 v[36:39], a[152:155], a[84:87], v[36:39]
  ds_read_b64_tr_b16 a[146:147], v7 offset:6144
  buffer_load_dwordx4 v4, s[12:15], s30 offen offset:384 lds
  v_mfma_f32_16x16x32_bf16 v[96:99], a[156:159], a[80:83], v[96:99]
  ds_read_b64_tr_b16 a[148:149], v7 offset:8192
  v_mfma_f32_16x16x32_bf16 v[100:103], a[156:159], a[84:87], v[100:103]
  ds_read_b64_tr_b16 a[150:151], v7 offset:10240
  s_waitcnt lgkmcnt(8)
  v_mfma_f32_16x16x32_bf16 v[40:43], a[160:163], a[80:83], v[40:43]
  ds_read_b64_tr_b16 a[152:153], v8 offset:4096
  v_mfma_f32_16x16x32_bf16 v[44:47], a[160:163], a[84:87], v[44:47]
  ds_read_b64_tr_b16 a[154:155], v8 offset:6144
  v_mfma_f32_16x16x32_bf16 v[104:107], a[164:167], a[80:83], v[104:107]
  ds_read_b64_tr_b16 a[156:157], v8 offset:8192
  v_mfma_f32_16x16x32_bf16 v[108:111], a[164:167], a[84:87], v[108:111]
  ds_read_b64_tr_b16 a[158:159], v8 offset:10240
  s_waitcnt lgkmcnt(8)
  v_mfma_f32_16x16x32_bf16 v[48:51], a[168:171], a[80:83], v[48:51]
  ds_read_b64_tr_b16 a[160:161], v9 offset:4096
  v_mfma_f32_16x16x32_bf16 v[52:55], a[168:171], a[84:87], v[52:55]
  ds_read_b64_tr_b16 a[162:163], v9 offset:6144
  buffer_store_dwordx4 v[212:215], v2, s[8:11], s3 offen offset:3072 sc1
  v_mfma_f32_16x16x32_bf16 v[112:115], a[172:175], a[80:83], v[112:115]
  ds_read_b64_tr_b16 a[164:165], v9 offset:8192
  v_mfma_f32_16x16x32_bf16 v[116:119], a[172:175], a[84:87], v[116:119]
k4_part_w4:
  s_cbranch_execz k4_part_w8
  ds_read_b64_tr_b16 a[166:167], v9 offset:10240
  s_waitcnt lgkmcnt(8)
  v_mfma_f32_16x16x32_bf16 v[24:27], a[144:147], a[88:91], v[24:27]
  ds_read_b64_tr_b16 a[168:169], v10 offset:4096
  v_mfma_f32_16x16x32_bf16 v[28:31], a[144:147], a[92:95], v[28:31]
  ds_read_b64_tr_b16 a[170:171], v10 offset:6144
  v_mfma_f32_16x16x32_bf16 v[88:91], a[148:151], a[88:91], v[88:91]
  ds_read_b64_tr_b16 a[172:173], v10 offset:8192
  v_mfma_f32_16x16x32_bf16 v[92:95], a[148:151], a[92:95], v[92:95]
  ds_read_b64_tr_b16 a[174:175], v10 offset:10240
  s_waitcnt lgkmcnt(8)
  v_mfma_f32_16x16x32_bf16 v[32:35], a[152:155], a[88:91], v[32:35]
  s_waitcnt vmcnt(24)
  s_barrier
  v_add_u32 v11, -73728, v11
  ds_read_b64_tr_b16 a[144:145], v11 offset:0
  v_mfma_f32_16x16x32_bf16 v[36:39], a[152:155], a[92:95], v[36:39]
  ds_read_b64_tr_b16 a[146:147], v11 offset:1024
  v_mfma_f32_16x16x32_bf16 v[96:99], a[156:159], a[88:91], v[96:99]
  ds_read_b64_tr_b16 a[148:149], v11 offset:2048
  v_mfma_f32_16x16x32_bf16 v[100:103], a[156:159], a[92:95], v[100:103]
  ds_read_b64_tr_b16 a[150:151], v11 offset:3072
  s_waitcnt lgkmcnt(8)
  v_mfma_f32_16x16x32_bf16 v[40:43], a[160:163], a[88:91], v[40:43]
  v_add_u32 v12, -73728, v12
  ds_read_b64_tr_b16 a[152:153], v12 offset:0
  v_mfma_f32_16x16x32_bf16 v[44:47], a[160:163], a[92:95], v[44:47]
  ds_read_b64_tr_b16 a[154:155], v12 offset:1024
  v_mfma_f32_16x16x32_bf16 v[104:107], a[164:167], a[88:91], v[104:107]
  ds_read_b64_tr_b16 a[156:157], v12 offset:2048
  v_mfma_f32_16x16x32_bf16 v[108:111], a[164:167], a[92:95], v[108:111]
  ds_read_b64_tr_b16 a[158:159], v12 offset:3072
  s_waitcnt lgkmcnt(8)
  v_mfma_f32_16x16x32_bf16 v[48:51], a[168:171], a[88:91], v[48:51]
  v_add_u32 v7, -131072, v7
  ds_read_b64_tr_b16 a[160:161], v7 offset:0
  v_mfma_f32_16x16x32_bf16 v[52:55], a[168:171], a[92:95], v[52:55]
  ds_read_b64_tr_b16 a[162:163], v7 offset:2048
  v_mfma_f32_16x16x32_bf16 v[112:115], a[172:175], a[88:91], v[112:115]
  ds_read_b64_tr_b16 a[164:165], v7 offset:4096
  v_mfma_f32_16x16x32_bf16 v[116:119], a[172:175], a[92:95], v[116:119]
  ds_read_b64_tr_b16 a[166:167], v7 offset:6144
  s_waitcnt lgkmcnt(8)
  v_mfma_f32_16x16x32_bf16 v[152:155], a[144:147], a[96:99], v[152:155]
  v_add_u32 v8, -131072, v8
  ds_read_b64_tr_b16 a[168:169], v8 offset:0
  s_add_u32 m0, s27, 144384
  s_add_u32 s90, s90, 294912
  v_mfma_f32_16x16x32_bf16 v[156:159], a[144:147], a[100:103], v[156:159]
  ds_read_b64_tr_b16 a[170:171], v8 offset:2048
  buffer_load_dwordx4 v5, s[12:15], s90 offen lds
  v_mfma_f32_16x16x32_bf16 v[168:171], a[148:151], a[96:99], v[168:171]
  ds_read_b64_tr_b16 a[172:173], v8 offset:4096
  v_mfma_f32_16x16x32_bf16 v[172:175], a[148:151], a[100:103], v[172:175]
  ds_read_b64_tr_b16 a[174:175], v8 offset:6144
  s_waitcnt lgkmcnt(8)
  v_mfma_f32_16x16x32_bf16 v[160:163], a[152:155], a[96:99], v[160:163]
  v_add_u32 v9, -131072, v9
  ds_read_b64_tr_b16 a[144:145], v9 offset:0
  v_mfma_f32_16x16x32_bf16 v[164:167], a[152:155], a[100:103], v[164:167]
  ds_read_b64_tr_b16 a[146:147], v9 offset:2048
  v_mfma_f32_16x16x32_bf16 v[176:179], a[156:159], a[96:99], v[176:179]
  ds_read_b64_tr_b16 a[148:149], v9 offset:4096
  v_mfma_f32_16x16x32_bf16 v[180:183], a[156:159], a[100:103], v[180:183]
  ds_read_b64_tr_b16 a[150:151], v9 offset:6144
  s_waitcnt lgkmcnt(8)
  v_mfma_f32_16x16x32_bf16 v[24:27], a[160:163], a[96:99], v[24:27]
  v_add_u32 v10, -131072, v10
  ds_read_b64_tr_b16 a[152:153], v10 offset:0
  s_add_u32 m0, s32, 110208
  s_add_u32 s30, s30, 294912
  v_mfma_f32_16x16x32_bf16 v[28:31], a[160:163], a[100:103], v[28:31]
  ds_read_b64_tr_b16 a[154:155], v10 offset:2048
  buffer_load_dwordx4 v3, s[12:15], s30 offen offset:384 lds
  v_mfma_f32_16x16x32_bf16 v[88:91], a[164:167], a[96:99], v[88:91]
  ds_read_b64_tr_b16 a[156:157], v10 offset:4096
  v_mfma_f32_16x16x32_bf16 v[92:95], a[164:167], a[100:103], v[92:95]
  ds_read_b64_tr_b16 a[158:159], v10 offset:6144
  s_waitcnt lgkmcnt(8)
  v_mfma_f32_16x16x32_bf16 v[32:35], a[168:171], a[96:99], v[32:35]
  ds_read_b64_tr_b16 a[160:161], v7 offset:8192
  v_mfma_f32_16x16x32_bf16 v[36:39], a[168:171], a[100:103], v[36:39]
  ds_read_b64_tr_b16 a[162:163], v7 offset:10240
  s_add_u32 m0, s32, 111232
  v_mfma_f32_16x16x32_bf16 v[96:99], a[172:175], a[96:99], v[96:99]
  ds_read_b64_tr_b16 a[164:165], v7 offset:12288
  buffer_load_dwordx4 v4, s[12:15], s30 offen offset:384 lds
  v_mfma_f32_16x16x32_bf16 v[100:103], a[172:175], a[100:103], v[100:103]
  ds_read_b64_tr_b16 a[166:167], v7 offset:14336
  s_waitcnt lgkmcnt(8)
  v_mfma_f32_16x16x32_bf16 v[40:43], a[144:147], a[96:99], v[40:43]
  ds_read_b64_tr_b16 a[168:169], v8 offset:8192
  v_mfma_f32_16x16x32_bf16 v[44:47], a[144:147], a[100:103], v[44:47]
  ds_read_b64_tr_b16 a[170:171], v8 offset:10240
  s_add_u32 m0, s32, 118400
  s_add_u32 s30, s30, 294912
  v_mfma_f32_16x16x32_bf16 v[104:107], a[148:151], a[96:99], v[104:107]
  ds_read_b64_tr_b16 a[172:173], v8 offset:12288
  buffer_load_dwordx4 v3, s[12:15], s30 offen offset:384 lds
  v_mfma_f32_16x16x32_bf16 v[108:111], a[148:151], a[100:103], v[108:111]
  ds_read_b64_tr_b16 a[174:175], v8 offset:14336
  s_waitcnt lgkmcnt(8)
  v_mfma_f32_16x16x32_bf16 v[48:51], a[152:155], a[96:99], v[48:51]
  ds_read_b64_tr_b16 a[144:145], v9 offset:8192
  v_lshrrev_b32 v244, 2, v1
  v_mfma_f32_16x16x32_bf16 v[52:55], a[152:155], a[100:103], v[52:55]
  ds_read_b64_tr_b16 a[146:147], v9 offset:10240
  v_lshlrev_b32 v244, 8, v244
  v_mfma_f32_16x16x32_bf16 v[112:115], a[156:159], a[96:99], v[112:115]
  ds_read_b64_tr_b16 a[148:149], v9 offset:12288
  s_add_u32 m0, s32, 119424
  v_mfma_f32_16x16x32_bf16 v[116:119], a[156:159], a[100:103], v[116:119]
  ds_read_b64_tr_b16 a[150:151], v9 offset:14336
  buffer_load_dwordx4 v4, s[12:15], s30 offen offset:384 lds
  s_waitcnt lgkmcnt(8)
  v_mfma_f32_16x16x32_bf16 v[24:27], a[160:163], a[104:107], v[24:27]
  ds_read_b64_tr_b16 a[152:153], v10 offset:8192
  v_lshl_add_u32 v244, v13, 2, v244
  v_mfma_f32_16x16x32_bf16 v[28:31], a[160:163], a[108:111], v[28:31]
  ds_read_b64_tr_b16 a[154:155], v10 offset:10240
  s_lshl_b32 s94, s24, 12
  v_mfma_f32_16x16x32_bf16 v[88:91], a[164:167], a[104:107], v[88:91]
  ds_read_b64_tr_b16 a[156:157], v10 offset:12288
  s_add_u32 m0, s32, 126592
  s_add_u32 s30, s30, 294912
  v_mfma_f32_16x16x32_bf16 v[92:95], a[164:167], a[108:111], v[92:95]
  ds_read_b64_tr_b16 a[158:159], v10 offset:14336
  buffer_load_dwordx4 v3, s[12:15], s30 offen offset:384 lds
  s_waitcnt lgkmcnt(8)
  v_mfma_f32_16x16x32_bf16 v[32:35], a[168:171], a[104:107], v[32:35]
  ds_read_b64_tr_b16 a[160:161], v7 offset:16384
  s_add_u32 s94, s94, 18546688
  v_mfma_f32_16x16x32_bf16 v[36:39], a[168:171], a[108:111], v[36:39]
  ds_read_b64_tr_b16 a[162:163], v7 offset:18432
  buffer_load_dwordx4 v[240:243], v244, s[8:11], s94 offen sc1
  v_mfma_f32_16x16x32_bf16 v[96:99], a[172:175], a[104:107], v[96:99]
  ds_read_b64_tr_b16 a[164:165], v7 offset:20480
  v_mfma_f32_16x16x32_bf16 v[100:103], a[172:175], a[108:111], v[100:103]
  ds_read_b64_tr_b16 a[166:167], v7 offset:22528
  s_add_u32 m0, s32, 127616
  s_waitcnt lgkmcnt(8)
  v_mfma_f32_16x16x32_bf16 v[40:43], a[144:147], a[104:107], v[40:43]
  ds_read_b64_tr_b16 a[168:169], v8 offset:16384
  buffer_load_dwordx4 v4, s[12:15], s30 offen offset:384 lds
  v_mfma_f32_16x16x32_bf16 v[44:47], a[144:147], a[108:111], v[44:47]
  ds_read_b64_tr_b16 a[170:171], v8 offset:18432
  v_mfma_f32_16x16x32_bf16 v[104:107], a[148:151], a[104:107], v[104:107]
  ds_read_b64_tr_b16 a[172:173], v8 offset:20480
  v_mfma_f32_16x16x32_bf16 v[108:111], a[148:151], a[108:111], v[108:111]
  ds_read_b64_tr_b16 a[174:175], v8 offset:22528
  s_add_u32 m0, s32, 134784
  s_add_u32 s30, s30, 294912
  s_waitcnt lgkmcnt(8)
  v_mfma_f32_16x16x32_bf16 v[48:51], a[152:155], a[104:107], v[48:51]
  ds_read_b64_tr_b16 a[144:145], v9 offset:16384
  buffer_load_dwordx4 v3, s[12:15], s30 offen offset:384 lds
  v_mfma_f32_16x16x32_bf16 v[52:55], a[152:155], a[108:111], v[52:55]
  ds_read_b64_tr_b16 a[146:147], v9 offset:18432
  v_mfma_f32_16x16x32_bf16 v[112:115], a[156:159], a[104:107], v[112:115]
  ds_read_b64_tr_b16 a[148:149], v9 offset:20480
  v_mfma_f32_16x16x32_bf16 v[116:119], a[156:159], a[108:111], v[116:119]
  ds_read_b64_tr_b16 a[150:151], v9 offset:22528
  s_waitcnt lgkmcnt(8)
  v_mfma_f32_16x16x32_bf16 v[24:27], a[160:163], a[112:115], v[24:27]
  ds_read_b64_tr_b16 a[152:153], v10 offset:16384
  s_add_u32 m0, s32, 135808
  v_mfma_f32_16x16x32_bf16 v[28:31], a[160:163], a[116:119], v[28:31]
  ds_read_b64_tr_b16 a[154:155], v10 offset:18432
  buffer_load_dwordx4 v4, s[12:15], s30 offen offset:384 lds
  v_mfma_f32_16x16x32_bf16 v[88:91], a[164:167], a[112:115], v[88:91]
  ds_read_b64_tr_b16 a[156:157], v10 offset:20480
  v_mfma_f32_16x16x32_bf16 v[92:95], a[164:167], a[116:119], v[92:95]
  ds_read_b64_tr_b16 a[158:159], v10 offset:22528
  s_waitcnt lgkmcnt(8)
  v_mfma_f32_16x16x32_bf16 v[32:35], a[168:171], a[112:115], v[32:35]
  ds_read_b64_tr_b16 a[160:161], v7 offset:24576
  v_mfma_f32_16x16x32_bf16 v[36:39], a[168:171], a[116:119], v[36:39]
  ds_read_b64_tr_b16 a[162:163], v7 offset:26624
  v_mfma_f32_16x16x32_bf16 v[96:99], a[172:175], a[112:115], v[96:99]
  ds_read_b64_tr_b16 a[164:165], v7 offset:28672
  v_mfma_f32_16x16x32_bf16 v[100:103], a[172:175], a[116:119], v[100:103]
  ds_read_b64_tr_b16 a[166:167], v7 offset:30720
  s_waitcnt lgkmcnt(8)
  v_mfma_f32_16x16x32_bf16 v[40:43], a[144:147], a[112:115], v[40:43]
  ds_read_b64_tr_b16 a[168:169], v8 offset:24576
  v_mfma_f32_16x16x32_bf16 v[44:47], a[144:147], a[116:119], v[44:47]
  ds_read_b64_tr_b16 a[170:171], v8 offset:26624
  v_mfma_f32_16x16x32_bf16 v[104:107], a[148:151], a[112:115], v[104:107]
  ds_read_b64_tr_b16 a[172:173], v8 offset:28672
  v_mfma_f32_16x16x32_bf16 v[108:111], a[148:151], a[116:119], v[108:111]
  ds_read_b64_tr_b16 a[174:175], v8 offset:30720
  s_waitcnt lgkmcnt(8)
  v_mfma_f32_16x16x32_bf16 v[48:51], a[152:155], a[112:115], v[48:51]
  ds_read_b64_tr_b16 a[144:145], v9 offset:24576
  v_mfma_f32_16x16x32_bf16 v[52:55], a[152:155], a[116:119], v[52:55]
  ds_read_b64_tr_b16 a[146:147], v9 offset:26624
  v_mfma_f32_16x16x32_bf16 v[112:115], a[156:159], a[112:115], v[112:115]
  ds_read_b64_tr_b16 a[148:149], v9 offset:28672
  v_mfma_f32_16x16x32_bf16 v[116:119], a[156:159], a[116:119], v[116:119]
  ds_read_b64_tr_b16 a[150:151], v9 offset:30720
  s_waitcnt lgkmcnt(8)
  v_mfma_f32_16x16x32_bf16 v[24:27], a[160:163], a[120:123], v[24:27]
  ds_read_b64_tr_b16 a[152:153], v10 offset:24576
  v_mfma_f32_16x16x32_bf16 v[28:31], a[160:163], a[124:127], v[28:31]
  ds_read_b64_tr_b16 a[154:155], v10 offset:26624
  v_mfma_f32_16x16x32_bf16 v[88:91], a[164:167], a[120:123], v[88:91]
  ds_read_b64_tr_b16 a[156:157], v10 offset:28672
  v_mfma_f32_16x16x32_bf16 v[92:95], a[164:167], a[124:127], v[92:95]
  ds_read_b64_tr_b16 a[158:159], v10 offset:30720
  s_waitcnt lgkmcnt(8)
  v_mfma_f32_16x16x32_bf16 v[32:35], a[168:171], a[120:123], v[32:35]
  s_waitcnt vmcnt(22)
  s_barrier
  ds_read_b64_tr_b16 a[160:161], v11 offset:36864
  v_mfma_f32_16x16x32_bf16 v[36:39], a[168:171], a[124:127], v[36:39]
  ds_read_b64_tr_b16 a[162:163], v11 offset:37888
  v_mfma_f32_16x16x32_bf16 v[96:99], a[172:175], a[120:123], v[96:99]
  ds_read_b64_tr_b16 a[164:165], v11 offset:38912
  v_mfma_f32_16x16x32_bf16 v[100:103], a[172:175], a[124:127], v[100:103]
  ds_read_b64_tr_b16 a[166:167], v11 offset:39936
  s_waitcnt lgkmcnt(8)
  v_mfma_f32_16x16x32_bf16 v[40:43], a[144:147], a[120:123], v[40:43]
  ds_read_b64_tr_b16 a[168:169], v12 offset:36864
  v_mfma_f32_16x16x32_bf16 v[44:47], a[144:147], a[124:127], v[44:47]
  ds_read_b64_tr_b16 a[170:171], v12 offset:37888
  v_mfma_f32_16x16x32_bf16 v[104:107], a[148:151], a[120:123], v[104:107]
  ds_read_b64_tr_b16 a[172:173], v12 offset:38912
  v_mfma_f32_16x16x32_bf16 v[108:111], a[148:151], a[124:127], v[108:111]
  ds_read_b64_tr_b16 a[174:175], v12 offset:39936
  s_waitcnt lgkmcnt(8)
  v_mfma_f32_16x16x32_bf16 v[48:51], a[152:155], a[120:123], v[48:51]
  ds_read_b64_tr_b16 a[144:145], v7 offset:36864
  v_mfma_f32_16x16x32_bf16 v[52:55], a[152:155], a[124:127], v[52:55]
  ds_read_b64_tr_b16 a[146:147], v7 offset:38912
  v_mfma_f32_16x16x32_bf16 v[112:115], a[156:159], a[120:123], v[112:115]
  ds_read_b64_tr_b16 a[148:149], v7 offset:40960
  v_mfma_f32_16x16x32_bf16 v[116:119], a[156:159], a[124:127], v[116:119]
  ds_read_b64_tr_b16 a[150:151], v7 offset:43008
  s_waitcnt lgkmcnt(8)
  v_mfma_f32_16x16x32_bf16 v[152:155], a[160:163], a[104:107], v[152:155]
  ds_read_b64_tr_b16 a[152:153], v8 offset:36864
  s_add_u32 m0, s27, 33792
  s_add_u32 s90, s90, 294912
  v_mfma_f32_16x16x32_bf16 v[156:159], a[160:163], a[108:111], v[156:159]
  ds_read_b64_tr_b16 a[154:155], v8 offset:38912
  buffer_load_dwordx4 v5, s[12:15], s90 offen lds
  v_mfma_f32_16x16x32_bf16 v[168:171], a[164:167], a[104:107], v[168:171]
  ds_read_b64_tr_b16 a[156:157], v8 offset:40960
  v_mfma_f32_16x16x32_bf16 v[172:175], a[164:167], a[108:111], v[172:175]
  ds_read_b64_tr_b16 a[158:159], v8 offset:43008
  s_waitcnt lgkmcnt(8)
  v_mfma_f32_16x16x32_bf16 v[160:163], a[168:171], a[104:107], v[160:163]
  ds_read_b64_tr_b16 a[160:161], v9 offset:36864
  v_mfma_f32_16x16x32_bf16 v[164:167], a[168:171], a[108:111], v[164:167]
  ds_read_b64_tr_b16 a[162:163], v9 offset:38912
  v_mfma_f32_16x16x32_bf16 v[176:179], a[172:175], a[104:107], v[176:179]
  ds_read_b64_tr_b16 a[164:165], v9 offset:40960
  v_mfma_f32_16x16x32_bf16 v[180:183], a[172:175], a[108:111], v[180:183]
  ds_read_b64_tr_b16 a[166:167], v9 offset:43008
  s_waitcnt lgkmcnt(8)
  v_mfma_f32_16x16x32_bf16 v[24:27], a[144:147], a[128:131], v[24:27]
  ds_read_b64_tr_b16 a[168:169], v10 offset:36864
  s_add_u32 m0, s32, -384
  s_add_u32 s30, s30, 294912
  v_mfma_f32_16x16x32_bf16 v[28:31], a[144:147], a[132:135], v[28:31]
  ds_read_b64_tr_b16 a[170:171], v10 offset:38912
  buffer_load_dwordx4 v3, s[12:15], s30 offen offset:384 lds
  v_mfma_f32_16x16x32_bf16 v[88:91], a[148:151], a[128:131], v[88:91]
  ds_read_b64_tr_b16 a[172:173], v10 offset:40960
  v_mfma_f32_16x16x32_bf16 v[92:95], a[148:151], a[132:135], v[92:95]
  ds_read_b64_tr_b16 a[174:175], v10 offset:43008
  s_waitcnt lgkmcnt(8)
  v_mfma_f32_16x16x32_bf16 v[32:35], a[152:155], a[128:131], v[32:35]
  ds_read_b64_tr_b16 a[144:145], v7 offset:45056
  v_mfma_f32_16x16x32_bf16 v[36:39], a[152:155], a[132:135], v[36:39]
  ds_read_b64_tr_b16 a[146:147], v7 offset:47104
  s_add_u32 m0, s32, 640
  v_mfma_f32_16x16x32_bf16 v[96:99], a[156:159], a[128:131], v[96:99]
  ds_read_b64_tr_b16 a[148:149], v7 offset:49152
  buffer_load_dwordx4 v4, s[12:15], s30 offen offset:384 lds
  v_mfma_f32_16x16x32_bf16 v[100:103], a[156:159], a[132:135], v[100:103]
  ds_read_b64_tr_b16 a[150:151], v7 offset:51200
  s_waitcnt lgkmcnt(8)
  v_mfma_f32_16x16x32_bf16 v[40:43], a[160:163], a[128:131], v[40:43]
  ds_read_b64_tr_b16 a[152:153], v8 offset:45056
  v_mfma_f32_16x16x32_bf16 v[44:47], a[160:163], a[132:135], v[44:47]
  ds_read_b64_tr_b16 a[154:155], v8 offset:47104
  s_add_u32 m0, s32, 7808
  s_add_u32 s30, s30, 294912
  v_mfma_f32_16x16x32_bf16 v[104:107], a[164:167], a[128:131], v[104:107]
  ds_read_b64_tr_b16 a[156:157], v8 offset:49152
  buffer_load_dwordx4 v3, s[12:15], s30 offen offset:384 lds
  v_mfma_f32_16x16x32_bf16 v[108:111], a[164:167], a[132:135], v[108:111]
  ds_read_b64_tr_b16 a[158:159], v8 offset:51200
  s_waitcnt lgkmcnt(8)
  v_mfma_f32_16x16x32_bf16 v[48:51], a[168:171], a[128:131], v[48:51]
  ds_read_b64_tr_b16 a[160:161], v9 offset:45056
  s_waitcnt vmcnt(7)
  v_min3_u32 v240, v240, v241, v242
  v_min_u32 v240, v240, v243
  v_cmp_eq_u32 vcc, 0, v240
  s_cbranch_vccz k4_part_bkw
k4_part_slw:
  s_sleep 1
  buffer_load_dwordx4 v[240:243], v244, s[8:11], s94 offen sc1
  s_sub_u32 s87, s87, 1
  s_max_i32 s87, s87, 0
  s_waitcnt vmcnt(0)
  s_cbranch_scc0 k4_part_bkw
  v_min3_u32 v240, v240, v241, v242
  v_min_u32 v240, v240, v243
  v_cmp_eq_u32 vcc, 0, v240
  s_cbranch_vccnz k4_part_slw
k4_part_bkw:
  v_mfma_f32_16x16x32_bf16 v[52:55], a[168:171], a[132:135], v[52:55]
  ds_read_b64_tr_b16 a[162:163], v9 offset:47104
  v_mfma_f32_16x16x32_bf16 v[112:115], a[172:175], a[128:131], v[112:115]
  ds_read_b64_tr_b16 a[164:165], v9 offset:49152
  s_add_u32 m0, s32, 8832
  v_mfma_f32_16x16x32_bf16 v[116:119], a[172:175], a[132:135], v[116:119]
  ds_read_b64_tr_b16 a[166:167], v9 offset:51200
  buffer_load_dwordx4 v4, s[12:15], s30 offen offset:384 lds
  s_waitcnt lgkmcnt(8)
  v_mfma_f32_16x16x32_bf16 v[24:27], a[144:147], a[136:139], v[24:27]
  ds_read_b64_tr_b16 a[168:169], v10 offset:45056
  v_mfma_f32_16x16x32_bf16 v[28:31], a[144:147], a[140:143], v[28:31]
  ds_read_b64_tr_b16 a[170:171], v10 offset:47104
  v_mfma_f32_16x16x32_bf16 v[88:91], a[148:151], a[136:139], v[88:91]
  ds_read_b64_tr_b16 a[172:173], v10 offset:49152
  s_add_u32 m0, s32, 16000
  s_add_u32 s30, s30, 294912
  v_mfma_f32_16x16x32_bf16 v[92:95], a[148:151], a[140:143], v[92:95]
  ds_read_b64_tr_b16 a[174:175], v10 offset:51200
  buffer_load_dwordx4 v3, s[12:15], s30 offen offset:384 lds
  s_waitcnt lgkmcnt(8)
  v_mfma_f32_16x16x32_bf16 v[32:35], a[152:155], a[136:139], v[32:35]
  ds_read_b64_tr_b16 a[144:145], v7 offset:53248
  v_mul_f32 v24, v24, v88
  v_mfma_f32_16x16x32_bf16 v[36:39], a[152:155], a[140:143], v[36:39]
  ds_read_b64_tr_b16 a[146:147], v7 offset:55296
  s_waitcnt vmcnt(16)
  s_mov_b64 exec, 1
  buffer_store_dword v7, off, s[8:11], s83 offset:384 sc1
  s_mov_b64 exec, -1
  v_mfma_f32_16x16x32_bf16 v[96:99], a[156:159], a[136:139], v[96:99]
  ds_read_b64_tr_b16 a[148:149], v7 offset:57344
  v_mul_f32 v25, v25, v89
  v_mfma_f32_16x16x32_bf16 v[100:103], a[156:159], a[140:143], v[100:103]
  ds_read_b64_tr_b16 a[150:151], v7 offset:59392
  s_add_u32 m0, s32, 17024
  s_waitcnt lgkmcnt(8)
  v_mfma_f32_16x16x32_bf16 v[40:43], a[160:163], a[136:139], v[40:43]
  ds_read_b64_tr_b16 a[152:153], v8 offset:53248
  buffer_load_dwordx4 v4, s[12:15], s30 offen offset:384 lds
  v_mfma_f32_16x16x32_bf16 v[44:47], a[160:163], a[140:143], v[44:47]
  ds_read_b64_tr_b16 a[154:155], v8 offset:55296
  v_mul_f32 v26, v26, v90
  v_mfma_f32_16x16x32_bf16 v[104:107], a[164:167], a[136:139], v[104:107]
  ds_read_b64_tr_b16 a[156:157], v8 offset:57344
  v_mul_f32 v27, v27, v91
  v_mfma_f32_16x16x32_bf16 v[108:111], a[164:167], a[140:143], v[108:111]
  ds_read_b64_tr_b16 a[158:159], v8 offset:59392
  s_add_u32 m0, s32, 24192
  s_add_u32 s30, s30, 294912
  s_waitcnt lgkmcnt(8)
  v_mfma_f32_16x16x32_bf16 v[48:51], a[168:171], a[136:139], v[48:51]
  ds_read_b64_tr_b16 a[160:161], v9 offset:53248
  buffer_load_dwordx4 v3, s[12:15], s30 offen offset:384 lds
  v_mfma_f32_16x16x32_bf16 v[52:55], a[168:171], a[140:143], v[52:55]
  ds_read_b64_tr_b16 a[162:163], v9 offset:55296
  v_cvt_pk_bf16_f32 v24, v24, v25
  v_mfma_f32_16x16x32_bf16 v[112:115], a[172:175], a[136:139], v[112:115]
  ds_read_b64_tr_b16 a[164:165], v9 offset:57344
  v_cvt_pk_bf16_f32 v25, v26, v27
  v_mfma_f32_16x16x32_bf16 v[116:119], a[172:175], a[140:143], v[116:119]
  ds_read_b64_tr_b16 a[166:167], v9 offset:59392
  v_mul_f32 v32, v32, v96
  s_waitcnt lgkmcnt(8)
  v_mfma_f32_16x16x32_bf16 v[56:59], a[144:147], a[0:3], 0
  ds_read_b64_tr_b16 a[168:169], v10 offset:53248
  s_add_u32 m0, s32, 25216
  v_mfma_f32_16x16x32_bf16 v[60:63], a[144:147], a[4:7], 0
  ds_read_b64_tr_b16 a[170:171], v10 offset:55296
  buffer_load_dwordx4 v4, s[12:15], s30 offen offset:384 lds
  v_mfma_f32_16x16x32_bf16 v[120:123], a[148:151], a[0:3], 0
  ds_read_b64_tr_b16 a[172:173], v10 offset:57344
  v_mul_f32 v33, v33, v97
  v_mfma_f32_16x16x32_bf16 v[124:127], a[148:151], a[4:7], 0
  ds_read_b64_tr_b16 a[174:175], v10 offset:59392
  v_mul_f32 v34, v34, v98
  s_waitcnt lgkmcnt(8)
  v_mfma_f32_16x16x32_bf16 v[64:67], a[152:155], a[0:3], 0
  ds_read_b64_tr_b16 a[144:145], v7 offset:61440
  v_mul_f32 v35, v35, v99
  v_cvt_pk_bf16_f32 v26, v32, v33
  v_cvt_pk_bf16_f32 v27, v34, v35
  v_mfma_f32_16x16x32_bf16 v[68:71], a[152:155], a[4:7], 0
  ds_read_b64_tr_b16 a[146:147], v7 offset:63488
  s_add_u32 s3, s47, 8192
  buffer_store_dwordx4 v[24:27], v2, s[8:11], s3 offen offset:0 sc1
  v_mfma_f32_16x16x32_bf16 v[128:131], a[156:159], a[0:3], 0
  v_add_u32 v7, 65536, v7
  ds_read_b64_tr_b16 a[148:149], v7 offset:0
  v_mul_f32 v28, v28, v92
  v_mfma_f32_16x16x32_bf16 v[132:135], a[156:159], a[4:7], 0
  ds_read_b64_tr_b16 a[150:151], v7 offset:2048
  v_mul_f32 v29, v29, v93
  s_waitcnt lgkmcnt(8)
  v_mfma_f32_16x16x32_bf16 v[72:75], a[160:163], a[0:3], 0
  ds_read_b64_tr_b16 a[152:153], v8 offset:61440
  v_mul_f32 v30, v30, v94
  v_mfma_f32_16x16x32_bf16 v[76:79], a[160:163], a[4:7], 0
  ds_read_b64_tr_b16 a[154:155], v8 offset:63488
  v_mul_f32 v31, v31, v95
  v_mfma_f32_16x16x32_bf16 v[136:139], a[164:167], a[0:3], 0
  v_add_u32 v8, 65536, v8
  ds_read_b64_tr_b16 a[156:157], v8 offset:0
  v_cvt_pk_bf16_f32 v28, v28, v29
  v_mfma_f32_16x16x32_bf16 v[140:143], a[164:167], a[4:7], 0
  ds_read_b64_tr_b16 a[158:159], v8 offset:2048
  v_cvt_pk_bf16_f32 v29, v30, v31
  s_waitcnt lgkmcnt(8)
  v_mfma_f32_16x16x32_bf16 v[80:83], a[168:171], a[0:3], 0
  ds_read_b64_tr_b16 a[160:161], v9 offset:61440
  v_mul_f32 v36, v36, v100
  v_mfma_f32_16x16x32_bf16 v[84:87], a[168:171], a[4:7], 0
  ds_read_b64_tr_b16 a[162:163], v9 offset:63488
  v_mul_f32 v37, v37, v101
  v_mfma_f32_16x16x32_bf16 v[144:147], a[172:175], a[0:3], 0
  v_add_u32 v9, 65536, v9
  ds_read_b64_tr_b16 a[164:165], v9 offset:0
  v_mul_f32 v38, v38, v102
  v_mfma_f32_16x16x32_bf16 v[148:151], a[172:175], a[4:7], 0
  ds_read_b64_tr_b16 a[166:167], v9 offset:2048
  v_mul_f32 v39, v39, v103
  s_waitcnt lgkmcnt(8)
  v_mfma_f32_16x16x32_bf16 v[56:59], a[144:147], a[8:11], v[56:59]
  ds_read_b64_tr_b16 a[168:169], v10 offset:61440
  v_cvt_pk_bf16_f32 v30, v36, v37
  v_mfma_f32_16x16x32_bf16 v[60:63], a[144:147], a[12:15], v[60:63]
  ds_read_b64_tr_b16 a[170:171], v10 offset:63488
  v_cvt_pk_bf16_f32 v31, v38, v39
  v_mfma_f32_16x16x32_bf16 v[120:123], a[148:151], a[8:11], v[120:123]
  v_add_u32 v10, 65536, v10
  ds_read_b64_tr_b16 a[172:173], v10 offset:0
  v_mul_f32 v40, v40, v104
  v_mfma_f32_16x16x32_bf16 v[124:127], a[148:151], a[12:15], v[124:127]
  ds_read_b64_tr_b16 a[174:175], v10 offset:2048
  v_mul_f32 v41, v41, v105
  s_waitcnt lgkmcnt(8)
  v_mfma_f32_16x16x32_bf16 v[64:67], a[152:155], a[8:11], v[64:67]
  s_waitcnt vmcnt(22)
  s_barrier
  v_add_u32 v11, 73728, v11
  ds_read_b64_tr_b16 a[144:145], v11 offset:0
  v_mul_f32 v42, v42, v106
  v_mfma_f32_16x16x32_bf16 v[68:71], a[152:155], a[12:15], v[68:71]
  ds_read_b64_tr_b16 a[146:147], v11 offset:1024
  v_mul_f32 v43, v43, v107
  v_mfma_f32_16x16x32_bf16 v[128:131], a[156:159], a[8:11], v[128:131]
  ds_read_b64_tr_b16 a[148:149], v11 offset:2048
  v_cvt_pk_bf16_f32 v40, v40, v41
  v_mfma_f32_16x16x32_bf16 v[132:135], a[156:159], a[12:15], v[132:135]
  ds_read_b64_tr_b16 a[150:151], v11 offset:3072
  v_cvt_pk_bf16_f32 v41, v42, v43
  s_waitcnt lgkmcnt(8)
  v_mfma_f32_16x16x32_bf16 v[72:75], a[160:163], a[8:11], v[72:75]
  v_add_u32 v12, 73728, v12
  ds_read_b64_tr_b16 a[152:153], v12 offset:0
  v_mul_f32 v48, v48, v112
  v_mfma_f32_16x16x32_bf16 v[76:79], a[160:163], a[12:15], v[76:79]
  ds_read_b64_tr_b16 a[154:155], v12 offset:1024
  v_mul_f32 v49, v49, v113
  v_mfma_f32_16x16x32_bf16 v[136:139], a[164:167], a[8:11], v[136:139]
  ds_read_b64_tr_b16 a[156:157], v12 offset:2048
  v_mul_f32 v50, v50, v114
  v_mfma_f32_16x16x32_bf16 v[140:143], a[164:167], a[12:15], v[140:143]
  ds_read_b64_tr_b16 a[158:159], v12 offset:3072
  v_mul_f32 v51, v51, v115
  s_waitcnt lgkmcnt(8)
  v_mfma_f32_16x16x32_bf16 v[80:83], a[168:171], a[8:11], v[80:83]
  ds_read_b64_tr_b16 a[160:161], v7 offset:8192
  v_cvt_pk_bf16_f32 v42, v48, v49
  v_mfma_f32_16x16x32_bf16 v[84:87], a[168:171], a[12:15], v[84:87]
  ds_read_b64_tr_b16 a[162:163], v7 offset:10240
  v_cvt_pk_bf16_f32 v43, v50, v51
  v_mfma_f32_16x16x32_bf16 v[144:147], a[172:175], a[8:11], v[144:147]
  ds_read_b64_tr_b16 a[164:165], v7 offset:12288
  v_mul_f32 v44, v44, v108
  v_mfma_f32_16x16x32_bf16 v[148:151], a[172:175], a[12:15], v[148:151]
  ds_read_b64_tr_b16 a[166:167], v7 offset:14336
  v_mul_f32 v45, v45, v109
  s_waitcnt lgkmcnt(8)
  v_mfma_f32_16x16x32_bf16 v[152:155], a[144:147], a[112:115], v[152:155]
  ds_read_b64_tr_b16 a[168:169], v8 offset:8192
  v_mul_f32 v46, v46, v110
  v_mfma_f32_16x16x32_bf16 v[156:159], a[144:147], a[116:119], v[156:159]
  ds_read_b64_tr_b16 a[170:171], v8 offset:10240
  buffer_store_dwordx4 v[28:31], v2, s[8:11], s3 offen offset:1024 sc1
  v_mfma_f32_16x16x32_bf16 v[168:171], a[148:151], a[112:115], v[168:171]
  ds_read_b64_tr_b16 a[172:173], v8 offset:12288
  v_mul_f32 v47, v47, v111
  v_mfma_f32_16x16x32_bf16 v[172:175], a[148:151], a[116:119], v[172:175]
  ds_read_b64_tr_b16 a[174:175], v8 offset:14336
  v_cvt_pk_bf16_f32 v44, v44, v45
  s_waitcnt lgkmcnt(8)
  v_mfma_f32_16x16x32_bf16 v[160:163], a[152:155], a[112:115], v[160:163]
  ds_read_b64_tr_b16 a[144:145], v9 offset:8192
  s_add_u32 m0, s27, 70656
  s_add_u32 s90, s90, 294912
  v_mfma_f32_16x16x32_bf16 v[164:167], a[152:155], a[116:119], v[164:167]
  ds_read_b64_tr_b16 a[146:147], v9 offset:10240
  buffer_load_dwordx4 v5, s[12:15], s90 offen lds
  v_mfma_f32_16x16x32_bf16 v[176:179], a[156:159], a[112:115], v[176:179]
  ds_read_b64_tr_b16 a[148:149], v9 offset:12288
  v_cvt_pk_bf16_f32 v45, v46, v47
  v_mfma_f32_16x16x32_bf16 v[180:183], a[156:159], a[116:119], v[180:183]
  ds_read_b64_tr_b16 a[150:151], v9 offset:14336
  v_mul_f32 v52, v52, v116
  s_waitcnt lgkmcnt(8)
  v_mfma_f32_16x16x32_bf16 v[56:59], a[160:163], a[16:19], v[56:59]
  ds_read_b64_tr_b16 a[152:153], v10 offset:8192
  v_mul_f32 v53, v53, v117
  v_mfma_f32_16x16x32_bf16 v[60:63], a[160:163], a[20:23], v[60:63]
  ds_read_b64_tr_b16 a[154:155], v10 offset:10240
  v_mul_f32 v54, v54, v118
  v_mfma_f32_16x16x32_bf16 v[120:123], a[164:167], a[16:19], v[120:123]
  ds_read_b64_tr_b16 a[156:157], v10 offset:12288
  v_mul_f32 v55, v55, v119
  v_mfma_f32_16x16x32_bf16 v[124:127], a[164:167], a[20:23], v[124:127]
  ds_read_b64_tr_b16 a[158:159], v10 offset:14336
  v_cvt_pk_bf16_f32 v46, v52, v53
  s_waitcnt lgkmcnt(8)
  v_mfma_f32_16x16x32_bf16 v[64:67], a[168:171], a[16:19], v[64:67]
  ds_read_b64_tr_b16 a[160:161], v7 offset:16384
  v_cvt_pk_bf16_f32 v47, v54, v55
  v_mfma_f32_16x16x32_bf16 v[68:71], a[168:171], a[20:23], v[68:71]
  ds_read_b64_tr_b16 a[162:163], v7 offset:18432
  s_add_u32 m0, s32, 36480
  s_add_u32 s30, s30, 294912
  v_mfma_f32_16x16x32_bf16 v[128:131], a[172:175], a[16:19], v[128:131]
  ds_read_b64_tr_b16 a[164:165], v7 offset:20480
  buffer_load_dwordx4 v3, s[12:15], s30 offen offset:384 lds
  v_mfma_f32_16x16x32_bf16 v[132:135], a[172:175], a[20:23], v[132:135]
  ds_read_b64_tr_b16 a[166:167], v7 offset:22528
  s_waitcnt lgkmcnt(8)
  v_mfma_f32_16x16x32_bf16 v[72:75], a[144:147], a[16:19], v[72:75]
  ds_read_b64_tr_b16 a[168:169], v8 offset:16384
  v_mfma_f32_16x16x32_bf16 v[76:79], a[144:147], a[20:23], v[76:79]
  ds_read_b64_tr_b16 a[170:171], v8 offset:18432
  s_add_u32 m0, s32, 37504
  v_mfma_f32_16x16x32_bf16 v[136:139], a[148:151], a[16:19], v[136:139]
  ds_read_b64_tr_b16 a[172:173], v8 offset:20480
  buffer_load_dwordx4 v4, s[12:15], s30 offen offset:384 lds
  v_mfma_f32_16x16x32_bf16 v[140:143], a[148:151], a[20:23], v[140:143]
  ds_read_b64_tr_b16 a[174:175], v8 offset:22528
  s_waitcnt lgkmcnt(8)
  v_mfma_f32_16x16x32_bf16 v[80:83], a[152:155], a[16:19], v[80:83]
  ds_read_b64_tr_b16 a[144:145], v9 offset:16384
  v_mfma_f32_16x16x32_bf16 v[84:87], a[152:155], a[20:23], v[84:87]
  ds_read_b64_tr_b16 a[146:147], v9 offset:18432
  v_mfma_f32_16x16x32_bf16 v[144:147], a[156:159], a[16:19], v[144:147]
  ds_read_b64_tr_b16 a[148:149], v9 offset:20480
  s_add_u32 m0, s32, 44672
k4_part_w5:
  s_cbranch_execz k4_part_w9
  s_add_u32 s30, s30, 294912
  v_mfma_f32_16x16x32_bf16 v[148:151], a[156:159], a[20:23], v[148:151]
  ds_read_b64_tr_b16 a[150:151], v9 offset:22528
  buffer_load_dwordx4 v3, s[12:15], s30 offen offset:384 lds
  s_waitcnt lgkmcnt(8)
  v_mfma_f32_16x16x32_bf16 v[56:59], a[160:163], a[24:27], v[56:59]
  ds_read_b64_tr_b16 a[152:153], v10 offset:16384
  v_mfma_f32_16x16x32_bf16 v[60:63], a[160:163], a[28:31], v[60:63]
  ds_read_b64_tr_b16 a[154:155], v10 offset:18432
  v_mfma_f32_16x16x32_bf16 v[120:123], a[164:167], a[24:27], v[120:123]
  ds_read_b64_tr_b16 a[156:157], v10 offset:20480
  s_add_u32 m0, s32, 45696
  v_mfma_f32_16x16x32_bf16 v[124:127], a[164:167], a[28:31], v[124:127]
  ds_read_b64_tr_b16 a[158:159], v10 offset:22528
  buffer_load_dwordx4 v4, s[12:15], s30 offen offset:384 lds
  s_waitcnt lgkmcnt(8)
  v_mfma_f32_16x16x32_bf16 v[64:67], a[168:171], a[24:27], v[64:67]
  ds_read_b64_tr_b16 a[160:161], v7 offset:24576
  v_mfma_f32_16x16x32_bf16 v[68:71], a[168:171], a[28:31], v[68:71]
  ds_read_b64_tr_b16 a[162:163], v7 offset:26624
  v_mfma_f32_16x16x32_bf16 v[128:131], a[172:175], a[24:27], v[128:131]
  ds_read_b64_tr_b16 a[164:165], v7 offset:28672
  v_mfma_f32_16x16x32_bf16 v[132:135], a[172:175], a[28:31], v[132:135]
  ds_read_b64_tr_b16 a[166:167], v7 offset:30720
  s_waitcnt lgkmcnt(8)
  v_mfma_f32_16x16x32_bf16 v[72:75], a[144:147], a[24:27], v[72:75]
  ds_read_b64_tr_b16 a[168:169], v8 offset:24576
  buffer_store_dwordx4 v[40:43], v2, s[8:11], s3 offen offset:2048 sc1
  v_mfma_f32_16x16x32_bf16 v[76:79], a[144:147], a[28:31], v[76:79]
  ds_read_b64_tr_b16 a[170:171], v8 offset:26624
  v_mfma_f32_16x16x32_bf16 v[136:139], a[148:151], a[24:27], v[136:139]
  ds_read_b64_tr_b16 a[172:173], v8 offset:28672
  v_mfma_f32_16x16x32_bf16 v[140:143], a[148:151], a[28:31], v[140:143]
  ds_read_b64_tr_b16 a[174:175], v8 offset:30720
  s_add_u32 m0, s32, 52864
  s_add_u32 s30, s30, 294912
  s_waitcnt lgkmcnt(8)
  v_mfma_f32_16x16x32_bf16 v[80:83], a[152:155], a[24:27], v[80:83]
  ds_read_b64_tr_b16 a[144:145], v9 offset:24576
  buffer_load_dwordx4 v3, s[12:15], s30 offen offset:384 lds
  v_mfma_f32_16x16x32_bf16 v[84:87], a[152:155], a[28:31], v[84:87]
  ds_read_b64_tr_b16 a[146:147], v9 offset:26624
  buffer_load_dword v23, v13, s[8:11], s84 offen offset:384 sc1
  v_mfma_f32_16x16x32_bf16 v[144:147], a[156:159], a[24:27], v[144:147]
  ds_read_b64_tr_b16 a[148:149], v9 offset:28672
  v_mfma_f32_16x16x32_bf16 v[148:151], a[156:159], a[28:31], v[148:151]
  ds_read_b64_tr_b16 a[150:151], v9 offset:30720
  s_waitcnt lgkmcnt(8)
  v_mfma_f32_16x16x32_bf16 v[56:59], a[160:163], a[32:35], v[56:59]
  ds_read_b64_tr_b16 a[152:153], v10 offset:24576
  s_add_u32 m0, s32, 53888
  v_mfma_f32_16x16x32_bf16 v[60:63], a[160:163], a[36:39], v[60:63]
  ds_read_b64_tr_b16 a[154:155], v10 offset:26624
  buffer_load_dwordx4 v4, s[12:15], s30 offen offset:384 lds
  v_mfma_f32_16x16x32_bf16 v[120:123], a[164:167], a[32:35], v[120:123]
  ds_read_b64_tr_b16 a[156:157], v10 offset:28672
  v_mfma_f32_16x16x32_bf16 v[124:127], a[164:167], a[36:39], v[124:127]
  ds_read_b64_tr_b16 a[158:159], v10 offset:30720
  s_waitcnt lgkmcnt(8)
  v_mfma_f32_16x16x32_bf16 v[64:67], a[168:171], a[32:35], v[64:67]
  ds_read_b64_tr_b16 a[160:161], v7 offset:32768
  s_add_u32 m0, s32, 61056
  s_add_u32 s30, s30, 294912
  v_mfma_f32_16x16x32_bf16 v[68:71], a[168:171], a[36:39], v[68:71]
  ds_read_b64_tr_b16 a[162:163], v7 offset:34816
  buffer_load_dwordx4 v3, s[12:15], s30 offen offset:384 lds
  v_mfma_f32_16x16x32_bf16 v[128:131], a[172:175], a[32:35], v[128:131]
  ds_read_b64_tr_b16 a[164:165], v7 offset:36864
  v_mfma_f32_16x16x32_bf16 v[132:135], a[172:175], a[36:39], v[132:135]
  ds_read_b64_tr_b16 a[166:167], v7 offset:38912
  s_waitcnt lgkmcnt(8)
  v_mfma_f32_16x16x32_bf16 v[72:75], a[144:147], a[32:35], v[72:75]
  ds_read_b64_tr_b16 a[168:169], v8 offset:32768
  v_mfma_f32_16x16x32_bf16 v[76:79], a[144:147], a[36:39], v[76:79]
  ds_read_b64_tr_b16 a[170:171], v8 offset:34816
  s_add_u32 m0, s32, 62080
  v_mfma_f32_16x16x32_bf16 v[136:139], a[148:151], a[32:35], v[136:139]
  ds_read_b64_tr_b16 a[172:173], v8 offset:36864
  buffer_load_dwordx4 v4, s[12:15], s30 offen offset:384 lds
  v_mfma_f32_16x16x32_bf16 v[140:143], a[148:151], a[36:39], v[140:143]
  ds_read_b64_tr_b16 a[174:175], v8 offset:38912
  s_waitcnt lgkmcnt(8)
  v_mfma_f32_16x16x32_bf16 v[80:83], a[152:155], a[32:35], v[80:83]
  ds_read_b64_tr_b16 a[144:145], v9 offset:32768
  v_mfma_f32_16x16x32_bf16 v[84:87], a[152:155], a[36:39], v[84:87]
  ds_read_b64_tr_b16 a[146:147], v9 offset:34816
  v_mfma_f32_16x16x32_bf16 v[144:147], a[156:159], a[32:35], v[144:147]
  ds_read_b64_tr_b16 a[148:149], v9 offset:36864
  v_mfma_f32_16x16x32_bf16 v[148:151], a[156:159], a[36:39], v[148:151]
  ds_read_b64_tr_b16 a[150:151], v9 offset:38912
  s_waitcnt lgkmcnt(8)
  v_mfma_f32_16x16x32_bf16 v[56:59], a[160:163], a[40:43], v[56:59]
  ds_read_b64_tr_b16 a[152:153], v10 offset:32768
  v_mfma_f32_16x16x32_bf16 v[60:63], a[160:163], a[44:47], v[60:63]
  ds_read_b64_tr_b16 a[154:155], v10 offset:34816
  v_mfma_f32_16x16x32_bf16 v[120:123], a[164:167], a[40:43], v[120:123]
  ds_read_b64_tr_b16 a[156:157], v10 offset:36864
  v_mfma_f32_16x16x32_bf16 v[124:127], a[164:167], a[44:47], v[124:127]
  ds_read_b64_tr_b16 a[158:159], v10 offset:38912
  s_waitcnt lgkmcnt(8)
  v_mfma_f32_16x16x32_bf16 v[64:67], a[168:171], a[40:43], v[64:67]
  s_waitcnt vmcnt(23)
  s_barrier
  ds_read_b64_tr_b16 a[160:161], v11 offset:36864
  v_mfma_f32_16x16x32_bf16 v[68:71], a[168:171], a[44:47], v[68:71]
  ds_read_b64_tr_b16 a[162:163], v11 offset:37888
  buffer_store_dwordx4 v[44:47], v2, s[8:11], s3 offen offset:3072 sc1
  v_mfma_f32_16x16x32_bf16 v[128:131], a[172:175], a[40:43], v[128:131]
  ds_read_b64_tr_b16 a[164:165], v11 offset:38912
  v_mfma_f32_16x16x32_bf16 v[132:135], a[172:175], a[44:47], v[132:135]
  ds_read_b64_tr_b16 a[166:167], v11 offset:39936
  s_waitcnt lgkmcnt(8)
  v_mfma_f32_16x16x32_bf16 v[72:75], a[144:147], a[40:43], v[72:75]
  ds_read_b64_tr_b16 a[168:169], v12 offset:36864
  v_mfma_f32_16x16x32_bf16 v[76:79], a[144:147], a[44:47], v[76:79]
  ds_read_b64_tr_b16 a[170:171], v12 offset:37888
  v_mfma_f32_16x16x32_bf16 v[136:139], a[148:151], a[40:43], v[136:139]
  ds_read_b64_tr_b16 a[172:173], v12 offset:38912
  v_mfma_f32_16x16x32_bf16 v[140:143], a[148:151], a[44:47], v[140:143]
  ds_read_b64_tr_b16 a[174:175], v12 offset:39936
  s_waitcnt lgkmcnt(8)
  v_mfma_f32_16x16x32_bf16 v[80:83], a[152:155], a[40:43], v[80:83]
  ds_read_b64_tr_b16 a[144:145], v7 offset:45056
  v_mfma_f32_16x16x32_bf16 v[84:87], a[152:155], a[44:47], v[84:87]
  ds_read_b64_tr_b16 a[146:147], v7 offset:47104
  v_mfma_f32_16x16x32_bf16 v[144:147], a[156:159], a[40:43], v[144:147]
  ds_read_b64_tr_b16 a[148:149], v7 offset:49152
  v_mfma_f32_16x16x32_bf16 v[148:151], a[156:159], a[44:47], v[148:151]
  ds_read_b64_tr_b16 a[150:151], v7 offset:51200
  s_waitcnt lgkmcnt(8)
  v_mfma_f32_16x16x32_bf16 v[152:155], a[160:163], a[120:123], v[152:155]
  ds_read_b64_tr_b16 a[152:153], v8 offset:45056
  s_add_u32 m0, s27, 74752
  v_mfma_f32_16x16x32_bf16 v[156:159], a[160:163], a[124:127], v[156:159]
  ds_read_b64_tr_b16 a[154:155], v8 offset:47104
  buffer_load_dwordx4 v6, s[4:7], s36 offen lds
  v_mfma_f32_16x16x32_bf16 v[168:171], a[164:167], a[120:123], v[168:171]
  ds_read_b64_tr_b16 a[156:157], v8 offset:49152
  v_mfma_f32_16x16x32_bf16 v[172:175], a[164:167], a[124:127], v[172:175]
  ds_read_b64_tr_b16 a[158:159], v8 offset:51200
  s_waitcnt lgkmcnt(8)
  v_mfma_f32_16x16x32_bf16 v[160:163], a[168:171], a[120:123], v[160:163]
  ds_read_b64_tr_b16 a[160:161], v9 offset:45056
  s_add_u32 m0, s27, 78848
  v_add_u32 v3, s35, v0
  s_add_u32 s46, s36, 36864
  v_mfma_f32_16x16x32_bf16 v[164:167], a[168:171], a[124:127], v[164:167]
  ds_read_b64_tr_b16 a[162:163], v9 offset:47104
  buffer_load_dwordx4 v6, s[4:7], s46 offen lds
  v_mfma_f32_16x16x32_bf16 v[176:179], a[172:175], a[120:123], v[176:179]
  ds_read_b64_tr_b16 a[164:165], v9 offset:49152
  v_mfma_f32_16x16x32_bf16 v[180:183], a[172:175], a[124:127], v[180:183]
  ds_read_b64_tr_b16 a[166:167], v9 offset:51200
  s_waitcnt lgkmcnt(8)
  v_mfma_f32_16x16x32_bf16 v[56:59], a[144:147], a[48:51], v[56:59]
  ds_read_b64_tr_b16 a[168:169], v10 offset:45056
  s_add_u32 m0, s27, 82944
  s_add_u32 s46, s46, 36864
  v_mfma_f32_16x16x32_bf16 v[60:63], a[144:147], a[52:55], v[60:63]
  ds_read_b64_tr_b16 a[170:171], v10 offset:47104
  buffer_load_dwordx4 v6, s[4:7], s46 offen lds
  v_mfma_f32_16x16x32_bf16 v[120:123], a[148:151], a[48:51], v[120:123]
  ds_read_b64_tr_b16 a[172:173], v10 offset:49152
  v_mfma_f32_16x16x32_bf16 v[124:127], a[148:151], a[52:55], v[124:127]
  ds_read_b64_tr_b16 a[174:175], v10 offset:51200
  s_waitcnt lgkmcnt(8)
  v_mfma_f32_16x16x32_bf16 v[64:67], a[152:155], a[48:51], v[64:67]
  ds_read_b64_tr_b16 a[144:145], v7 offset:53248
  v_mfma_f32_16x16x32_bf16 v[68:71], a[152:155], a[52:55], v[68:71]
  ds_read_b64_tr_b16 a[146:147], v7 offset:55296
  s_add_u32 m0, s27, 87040
  s_add_u32 s46, s46, 36864
  v_mfma_f32_16x16x32_bf16 v[128:131], a[156:159], a[48:51], v[128:131]
  ds_read_b64_tr_b16 a[148:149], v7 offset:57344
  buffer_load_dwordx4 v6, s[4:7], s46 offen lds
  v_mfma_f32_16x16x32_bf16 v[132:135], a[156:159], a[52:55], v[132:135]
  ds_read_b64_tr_b16 a[150:151], v7 offset:59392
  s_waitcnt lgkmcnt(8)
  v_mfma_f32_16x16x32_bf16 v[72:75], a[160:163], a[48:51], v[72:75]
  ds_read_b64_tr_b16 a[152:153], v8 offset:53248
  v_mfma_f32_16x16x32_bf16 v[76:79], a[160:163], a[52:55], v[76:79]
  ds_read_b64_tr_b16 a[154:155], v8 offset:55296
  s_add_u32 m0, s27, 91136
  s_xor_b32 s46, s45, 0
  v_mfma_f32_16x16x32_bf16 v[136:139], a[164:167], a[48:51], v[136:139]
  ds_read_b64_tr_b16 a[156:157], v8 offset:57344
  buffer_load_dwordx4 v0, s[8:11], s46 offen lds
  v_mfma_f32_16x16x32_bf16 v[140:143], a[164:167], a[52:55], v[140:143]
  ds_read_b64_tr_b16 a[158:159], v8 offset:59392
  s_waitcnt lgkmcnt(8)
  v_mfma_f32_16x16x32_bf16 v[80:83], a[168:171], a[48:51], v[80:83]
  ds_read_b64_tr_b16 a[160:161], v9 offset:53248
  v_mfma_f32_16x16x32_bf16 v[84:87], a[168:171], a[52:55], v[84:87]
  ds_read_b64_tr_b16 a[162:163], v9 offset:55296
  v_mfma_f32_16x16x32_bf16 v[144:147], a[172:175], a[48:51], v[144:147]
  ds_read_b64_tr_b16 a[164:165], v9 offset:57344
  s_add_u32 m0, s27, 95232
  s_xor_b32 s46, s45, 4096
  v_mfma_f32_16x16x32_bf16 v[148:151], a[172:175], a[52:55], v[148:151]
  ds_read_b64_tr_b16 a[166:167], v9 offset:59392
  buffer_load_dwordx4 v0, s[8:11], s46 offen lds
  s_waitcnt lgkmcnt(8)
  v_mfma_f32_16x16x32_bf16 v[56:59], a[144:147], a[56:59], v[56:59]
  ds_read_b64_tr_b16 a[168:169], v10 offset:53248
  v_mfma_f32_16x16x32_bf16 v[60:63], a[144:147], a[60:63], v[60:63]
  ds_read_b64_tr_b16 a[170:171], v10 offset:55296
  v_mfma_f32_16x16x32_bf16 v[120:123], a[148:151], a[56:59], v[120:123]
  ds_read_b64_tr_b16 a[172:173], v10 offset:57344
  s_add_u32 m0, s27, 99328
  v_mfma_f32_16x16x32_bf16 v[124:127], a[148:151], a[60:63], v[124:127]
  ds_read_b64_tr_b16 a[174:175], v10 offset:59392
  buffer_load_dwordx4 v6, s[4:7], s16 offen lds
  s_waitcnt lgkmcnt(8)
  v_mfma_f32_16x16x32_bf16 v[64:67], a[152:155], a[56:59], v[64:67]
  ds_read_b64_tr_b16 a[144:145], v7 offset:61440
  v_mfma_f32_16x16x32_bf16 v[68:71], a[152:155], a[60:63], v[68:71]
  ds_read_b64_tr_b16 a[146:147], v7 offset:63488
  v_mfma_f32_16x16x32_bf16 v[128:131], a[156:159], a[56:59], v[128:131]
  v_add_u32 v7, 65536, v7
  ds_read_b64_tr_b16 a[148:149], v7 offset:0
  v_mfma_f32_16x16x32_bf16 v[132:135], a[156:159], a[60:63], v[132:135]
  ds_read_b64_tr_b16 a[150:151], v7 offset:2048
  s_add_u32 m0, s27, 103424
  s_add_u32 s46, s16, 36864
  s_waitcnt lgkmcnt(8)
  v_mfma_f32_16x16x32_bf16 v[72:75], a[160:163], a[56:59], v[72:75]
  ds_read_b64_tr_b16 a[152:153], v8 offset:61440
  buffer_load_dwordx4 v6, s[4:7], s46 offen lds
  v_mfma_f32_16x16x32_bf16 v[76:79], a[160:163], a[60:63], v[76:79]
  ds_read_b64_tr_b16 a[154:155], v8 offset:63488
  v_mfma_f32_16x16x32_bf16 v[136:139], a[164:167], a[56:59], v[136:139]
  v_add_u32 v8, 65536, v8
  ds_read_b64_tr_b16 a[156:157], v8 offset:0
  v_mfma_f32_16x16x32_bf16 v[140:143], a[164:167], a[60:63], v[140:143]
  ds_read_b64_tr_b16 a[158:159], v8 offset:2048
  s_add_u32 m0, s27, 107520
  s_add_u32 s46, s36, s44
  s_waitcnt lgkmcnt(8)
  v_mfma_f32_16x16x32_bf16 v[80:83], a[168:171], a[56:59], v[80:83]
  ds_read_b64_tr_b16 a[160:161], v9 offset:61440
  buffer_load_dwordx4 v6, s[4:7], s46 offen lds
  v_mfma_f32_16x16x32_bf16 v[84:87], a[168:171], a[60:63], v[84:87]
  ds_read_b64_tr_b16 a[162:163], v9 offset:63488
  v_mfma_f32_16x16x32_bf16 v[144:147], a[172:175], a[56:59], v[144:147]
  v_add_u32 v9, 65536, v9
  ds_read_b64_tr_b16 a[164:165], v9 offset:0
  v_mfma_f32_16x16x32_bf16 v[148:151], a[172:175], a[60:63], v[148:151]
  ds_read_b64_tr_b16 a[166:167], v9 offset:2048
  s_waitcnt lgkmcnt(8)
  v_mfma_f32_16x16x32_bf16 v[56:59], a[144:147], a[64:67], v[56:59]
  ds_read_b64_tr_b16 a[168:169], v10 offset:61440
  v_mfma_f32_16x16x32_bf16 v[60:63], a[144:147], a[68:71], v[60:63]
  ds_read_b64_tr_b16 a[170:171], v10 offset:63488
  v_mfma_f32_16x16x32_bf16 v[120:123], a[148:151], a[64:67], v[120:123]
  v_add_u32 v10, 65536, v10
  ds_read_b64_tr_b16 a[172:173], v10 offset:0
  v_mfma_f32_16x16x32_bf16 v[124:127], a[148:151], a[68:71], v[124:127]
  ds_read_b64_tr_b16 a[174:175], v10 offset:2048
  s_waitcnt lgkmcnt(8)
  v_mfma_f32_16x16x32_bf16 v[64:67], a[152:155], a[64:67], v[64:67]
  ds_read_b64_tr_b16 a[144:145], v7 offset:4096
  v_mfma_f32_16x16x32_bf16 v[68:71], a[152:155], a[68:71], v[68:71]
  ds_read_b64_tr_b16 a[146:147], v7 offset:6144
  s_waitcnt vmcnt(13)
  v_cmp_eq_u32 vcc, 0, v23
  v_mfma_f32_16x16x32_bf16 v[128:131], a[156:159], a[64:67], v[128:131]
  ds_read_b64_tr_b16 a[148:149], v7 offset:8192
  s_cbranch_vccz k4_part_bk3
k4_part_sl3:
  s_sleep 1
  buffer_load_dword v23, v13, s[8:11], s84 offen offset:384 sc1
  s_sub_u32 s87, s87, 1
  s_max_i32 s87, s87, 0
  s_waitcnt vmcnt(0)
  s_cbranch_scc0 k4_part_bk3
  v_cmp_eq_u32 vcc, 0, v23
  s_cbranch_vccnz k4_part_sl3
k4_part_bk3:
  v_mfma_f32_16x16x32_bf16 v[132:135], a[156:159], a[68:71], v[132:135]
  ds_read_b64_tr_b16 a[150:151], v7 offset:10240
  s_waitcnt lgkmcnt(8)
  v_mfma_f32_16x16x32_bf16 v[72:75], a[160:163], a[64:67], v[72:75]
  ds_read_b64_tr_b16 a[152:153], v8 offset:4096
  buffer_load_dwordx4 a[176:179], v2, s[8:11], s80 offen offset:0
  v_mfma_f32_16x16x32_bf16 v[76:79], a[160:163], a[68:71], v[76:79]
  ds_read_b64_tr_b16 a[154:155], v8 offset:6144
  v_mfma_f32_16x16x32_bf16 v[136:139], a[164:167], a[64:67], v[136:139]
  ds_read_b64_tr_b16 a[156:157], v8 offset:8192
  v_mfma_f32_16x16x32_bf16 v[140:143], a[164:167], a[68:71], v[140:143]
  ds_read_b64_tr_b16 a[158:159], v8 offset:10240
  s_waitcnt lgkmcnt(8)
  v_mfma_f32_16x16x32_bf16 v[80:83], a[168:171], a[64:67], v[80:83]
  ds_read_b64_tr_b16 a[160:161], v9 offset:4096
  v_mfma_f32_16x16x32_bf16 v[84:87], a[168:171], a[68:71], v[84:87]
  ds_read_b64_tr_b16 a[162:163], v9 offset:6144
  v_mfma_f32_16x16x32_bf16 v[144:147], a[172:175], a[64:67], v[144:147]
  ds_read_b64_tr_b16 a[164:165], v9 offset:8192
  v_mfma_f32_16x16x32_bf16 v[148:151], a[172:175], a[68:71], v[148:151]
  ds_read_b64_tr_b16 a[166:167], v9 offset:10240
  s_waitcnt lgkmcnt(8)
  v_mfma_f32_16x16x32_bf16 v[56:59], a[144:147], a[72:75], v[56:59]
  ds_read_b64_tr_b16 a[168:169], v10 offset:4096
  v_mfma_f32_16x16x32_bf16 v[60:63], a[144:147], a[76:79], v[60:63]
  ds_read_b64_tr_b16 a[170:171], v10 offset:6144
  v_mfma_f32_16x16x32_bf16 v[120:123], a[148:151], a[72:75], v[120:123]
  ds_read_b64_tr_b16 a[172:173], v10 offset:8192
  v_mfma_f32_16x16x32_bf16 v[124:127], a[148:151], a[76:79], v[124:127]
  ds_read_b64_tr_b16 a[174:175], v10 offset:10240
  buffer_load_dwordx4 a[180:183], v2, s[8:11], s81 offen offset:0
  s_waitcnt lgkmcnt(8)
  v_mfma_f32_16x16x32_bf16 v[64:67], a[152:155], a[72:75], v[64:67]
  s_waitcnt vmcnt(25)
  s_barrier
  v_add_u32 v11, -73728, v11
  ds_read_b64_tr_b16 a[144:145], v11 offset:0
  v_mfma_f32_16x16x32_bf16 v[68:71], a[152:155], a[76:79], v[68:71]
  ds_read_b64_tr_b16 a[146:147], v11 offset:1024
  v_mfma_f32_16x16x32_bf16 v[128:131], a[156:159], a[72:75], v[128:131]
  ds_read_b64_tr_b16 a[148:149], v11 offset:2048
  v_mfma_f32_16x16x32_bf16 v[132:135], a[156:159], a[76:79], v[132:135]
  ds_read_b64_tr_b16 a[150:151], v11 offset:3072
  s_waitcnt lgkmcnt(8)
  v_mfma_f32_16x16x32_bf16 v[72:75], a[160:163], a[72:75], v[72:75]
  v_add_u32 v12, -73728, v12
  ds_read_b64_tr_b16 a[152:153], v12 offset:0
  v_mfma_f32_16x16x32_bf16 v[76:79], a[160:163], a[76:79], v[76:79]
  ds_read_b64_tr_b16 a[154:155], v12 offset:1024
  v_mfma_f32_16x16x32_bf16 v[136:139], a[164:167], a[72:75], v[136:139]
  ds_read_b64_tr_b16 a[156:157], v12 offset:2048
  v_mfma_f32_16x16x32_bf16 v[140:143], a[164:167], a[76:79], v[140:143]
  ds_read_b64_tr_b16 a[158:159], v12 offset:3072
  s_waitcnt lgkmcnt(8)
  v_mfma_f32_16x16x32_bf16 v[80:83], a[168:171], a[72:75], v[80:83]
  v_add_u32 v7, -131072, v7
  ds_read_b64_tr_b16 a[160:161], v7 offset:0
  v_mfma_f32_16x16x32_bf16 v[84:87], a[168:171], a[76:79], v[84:87]
  ds_read_b64_tr_b16 a[162:163], v7 offset:2048
  v_mfma_f32_16x16x32_bf16 v[144:147], a[172:175], a[72:75], v[144:147]
  ds_read_b64_tr_b16 a[164:165], v7 offset:4096
  buffer_load_dwordx4 a[184:187], v2, s[8:11], s82 offen offset:0
  v_mfma_f32_16x16x32_bf16 v[148:151], a[172:175], a[76:79], v[148:151]
  ds_read_b64_tr_b16 a[166:167], v7 offset:6144
  s_waitcnt lgkmcnt(8)
  v_mfma_f32_16x16x32_bf16 v[152:155], a[144:147], a[128:131], v[152:155]
  v_add_u32 v8, -131072, v8
  ds_read_b64_tr_b16 a[168:169], v8 offset:0
  v_mfma_f32_16x16x32_bf16 v[156:159], a[144:147], a[132:135], v[156:159]
  ds_read_b64_tr_b16 a[170:171], v8 offset:2048
  s_add_u32 m0, s27, 111616
  s_add_u32 s46, s46, 36864
  v_mfma_f32_16x16x32_bf16 v[168:171], a[148:151], a[128:131], v[168:171]
  ds_read_b64_tr_b16 a[172:173], v8 offset:4096
  buffer_load_dwordx4 v6, s[4:7], s46 offen lds
  v_mfma_f32_16x16x32_bf16 v[172:175], a[148:151], a[132:135], v[172:175]
  ds_read_b64_tr_b16 a[174:175], v8 offset:6144
  s_waitcnt lgkmcnt(8)
  v_mfma_f32_16x16x32_bf16 v[160:163], a[152:155], a[128:131], v[160:163]
  v_add_u32 v9, -131072, v9
  ds_read_b64_tr_b16 a[144:145], v9 offset:0
  v_mfma_f32_16x16x32_bf16 v[164:167], a[152:155], a[132:135], v[164:167]
  ds_read_b64_tr_b16 a[146:147], v9 offset:2048
  s_add_u32 m0, s27, 115712
  s_add_u32 s46, s46, 36864
  v_mfma_f32_16x16x32_bf16 v[176:179], a[156:159], a[128:131], v[176:179]
  ds_read_b64_tr_b16 a[148:149], v9 offset:4096
  buffer_load_dwordx4 v6, s[4:7], s46 offen lds
  v_mfma_f32_16x16x32_bf16 v[180:183], a[156:159], a[132:135], v[180:183]
  ds_read_b64_tr_b16 a[150:151], v9 offset:6144
  s_waitcnt lgkmcnt(8)
  v_mfma_f32_16x16x32_bf16 v[56:59], a[160:163], a[80:83], v[56:59]
  v_add_u32 v10, -131072, v10
  ds_read_b64_tr_b16 a[152:153], v10 offset:0
  v_mfma_f32_16x16x32_bf16 v[60:63], a[160:163], a[84:87], v[60:63]
  ds_read_b64_tr_b16 a[154:155], v10 offset:2048
  v_mfma_f32_16x16x32_bf16 v[120:123], a[164:167], a[80:83], v[120:123]
  ds_read_b64_tr_b16 a[156:157], v10 offset:4096
  s_add_u32 m0, s27, 119808
  s_add_u32 s46, s46, 36864
  v_mfma_f32_16x16x32_bf16 v[124:127], a[164:167], a[84:87], v[124:127]
  ds_read_b64_tr_b16 a[158:159], v10 offset:6144
  buffer_load_dwordx4 v6, s[4:7], s46 offen lds
  s_waitcnt lgkmcnt(8)
  v_mfma_f32_16x16x32_bf16 v[64:67], a[168:171], a[80:83], v[64:67]
  ds_read_b64_tr_b16 a[160:161], v7 offset:8192
  v_mfma_f32_16x16x32_bf16 v[68:71], a[168:171], a[84:87], v[68:71]
  ds_read_b64_tr_b16 a[162:163], v7 offset:10240
  v_mfma_f32_16x16x32_bf16 v[128:131], a[172:175], a[80:83], v[128:131]
  ds_read_b64_tr_b16 a[164:165], v7 offset:12288
  s_add_u32 m0, s27, 123904
  s_add_u32 s46, s16, s44
  v_mfma_f32_16x16x32_bf16 v[132:135], a[172:175], a[84:87], v[132:135]
  ds_read_b64_tr_b16 a[166:167], v7 offset:14336
  buffer_load_dwordx4 v6, s[4:7], s46 offen lds
  s_waitcnt lgkmcnt(8)
  v_mfma_f32_16x16x32_bf16 v[72:75], a[144:147], a[80:83], v[72:75]
  ds_read_b64_tr_b16 a[168:169], v8 offset:8192
  v_mfma_f32_16x16x32_bf16 v[76:79], a[144:147], a[84:87], v[76:79]
  ds_read_b64_tr_b16 a[170:171], v8 offset:10240
  v_mfma_f32_16x16x32_bf16 v[136:139], a[148:151], a[80:83], v[136:139]
  ds_read_b64_tr_b16 a[172:173], v8 offset:12288
  v_mfma_f32_16x16x32_bf16 v[140:143], a[148:151], a[84:87], v[140:143]
  ds_read_b64_tr_b16 a[174:175], v8 offset:14336
  s_add_u32 m0, s27, 128000
  s_add_u32 s46, s46, 36864
  s_waitcnt lgkmcnt(8)
  v_mfma_f32_16x16x32_bf16 v[80:83], a[152:155], a[80:83], v[80:83]
  ds_read_b64_tr_b16 a[144:145], v9 offset:8192
  buffer_load_dwordx4 v6, s[4:7], s46 offen lds
  v_mfma_f32_16x16x32_bf16 v[84:87], a[152:155], a[84:87], v[84:87]
  ds_read_b64_tr_b16 a[146:147], v9 offset:10240
  v_mfma_f32_16x16x32_bf16 v[144:147], a[156:159], a[80:83], v[144:147]
  ds_read_b64_tr_b16 a[148:149], v9 offset:12288
  v_mfma_f32_16x16x32_bf16 v[148:151], a[156:159], a[84:87], v[148:151]
  ds_read_b64_tr_b16 a[150:151], v9 offset:14336
  s_add_u32 m0, s27, 132096
  s_add_u32 s46, s40, s44
  s_waitcnt lgkmcnt(8)
  v_mfma_f32_16x16x32_bf16 v[56:59], a[160:163], a[88:91], v[56:59]
  ds_read_b64_tr_b16 a[152:153], v10 offset:8192
  buffer_load_dwordx4 v6, s[4:7], s46 offen lds
  v_mfma_f32_16x16x32_bf16 v[60:63], a[160:163], a[92:95], v[60:63]
  ds_read_b64_tr_b16 a[154:155], v10 offset:10240
  v_mfma_f32_16x16x32_bf16 v[120:123], a[164:167], a[88:91], v[120:123]
  ds_read_b64_tr_b16 a[156:157], v10 offset:12288
  v_mfma_f32_16x16x32_bf16 v[124:127], a[164:167], a[92:95], v[124:127]
  ds_read_b64_tr_b16 a[158:159], v10 offset:14336
  s_waitcnt lgkmcnt(8)
  v_mfma_f32_16x16x32_bf16 v[64:67], a[168:171], a[88:91], v[64:67]
  ds_read_b64_tr_b16 a[160:161], v7 offset:16384
  s_add_u32 m0, s27, 136192
  s_add_u32 s46, s16, s44
  s_add_u32 s46, s46, 73728
  v_mfma_f32_16x16x32_bf16 v[68:71], a[168:171], a[92:95], v[68:71]
  ds_read_b64_tr_b16 a[162:163], v7 offset:18432
  buffer_load_dwordx4 v6, s[4:7], s46 offen lds
  v_mfma_f32_16x16x32_bf16 v[128:131], a[172:175], a[88:91], v[128:131]
  ds_read_b64_tr_b16 a[164:165], v7 offset:20480
  v_mfma_f32_16x16x32_bf16 v[132:135], a[172:175], a[92:95], v[132:135]
  ds_read_b64_tr_b16 a[166:167], v7 offset:22528
  s_waitcnt lgkmcnt(8)
  v_mfma_f32_16x16x32_bf16 v[72:75], a[144:147], a[88:91], v[72:75]
  ds_read_b64_tr_b16 a[168:169], v8 offset:16384
  s_add_u32 m0, s27, 140288
  s_add_u32 s46, s46, 36864
  v_mfma_f32_16x16x32_bf16 v[76:79], a[144:147], a[92:95], v[76:79]
  ds_read_b64_tr_b16 a[170:171], v8 offset:18432
  buffer_load_dwordx4 v6, s[4:7], s46 offen lds
  v_mfma_f32_16x16x32_bf16 v[136:139], a[148:151], a[88:91], v[136:139]
  ds_read_b64_tr_b16 a[172:173], v8 offset:20480
  v_mfma_f32_16x16x32_bf16 v[140:143], a[148:151], a[92:95], v[140:143]
  ds_read_b64_tr_b16 a[174:175], v8 offset:22528
  s_waitcnt lgkmcnt(8)
  v_mfma_f32_16x16x32_bf16 v[80:83], a[152:155], a[88:91], v[80:83]
  ds_read_b64_tr_b16 a[144:145], v9 offset:16384
  v_mfma_f32_16x16x32_bf16 v[84:87], a[152:155], a[92:95], v[84:87]
  ds_read_b64_tr_b16 a[146:147], v9 offset:18432
  s_waitcnt vmcnt(20)
  s_mov_b64 exec, 1
  buffer_store_dword v7, off, s[8:11], s83 offset:640 sc1
  s_mov_b64 exec, -1
  s_add_u32 m0, s27, 144384
  v_mfma_f32_16x16x32_bf16 v[144:147], a[156:159], a[88:91], v[144:147]
  ds_read_b64_tr_b16 a[148:149], v9 offset:20480
  buffer_load_dwordx4 v6, s[4:7], s40 offen lds
  v_mfma_f32_16x16x32_bf16 v[148:151], a[156:159], a[92:95], v[148:151]
  ds_read_b64_tr_b16 a[150:151], v9 offset:22528
  s_waitcnt lgkmcnt(8)
  v_mfma_f32_16x16x32_bf16 v[56:59], a[160:163], a[96:99], v[56:59]
  ds_read_b64_tr_b16 a[152:153], v10 offset:16384
  v_mfma_f32_16x16x32_bf16 v[60:63], a[160:163], a[100:103], v[60:63]
  ds_read_b64_tr_b16 a[154:155], v10 offset:18432
  v_mfma_f32_16x16x32_bf16 v[120:123], a[164:167], a[96:99], v[120:123]
  ds_read_b64_tr_b16 a[156:157], v10 offset:20480
  buffer_load_dwordx4 a[188:191], v2, s[8:11], s80 offen offset:1024
  v_mfma_f32_16x16x32_bf16 v[124:127], a[164:167], a[100:103], v[124:127]
  ds_read_b64_tr_b16 a[158:159], v10 offset:22528
  s_waitcnt lgkmcnt(8)
  v_mfma_f32_16x16x32_bf16 v[64:67], a[168:171], a[96:99], v[64:67]
  ds_read_b64_tr_b16 a[160:161], v7 offset:24576
  v_mfma_f32_16x16x32_bf16 v[68:71], a[168:171], a[100:103], v[68:71]
  ds_read_b64_tr_b16 a[162:163], v7 offset:26624
  v_mfma_f32_16x16x32_bf16 v[128:131], a[172:175], a[96:99], v[128:131]
  ds_read_b64_tr_b16 a[164:165], v7 offset:28672
  v_mfma_f32_16x16x32_bf16 v[132:135], a[172:175], a[100:103], v[132:135]
  ds_read_b64_tr_b16 a[166:167], v7 offset:30720
  buffer_load_dwordx4 a[192:195], v2, s[8:11], s81 offen offset:1024
  s_waitcnt lgkmcnt(8)
  v_mfma_f32_16x16x32_bf16 v[72:75], a[144:147], a[96:99], v[72:75]
  ds_read_b64_tr_b16 a[168:169], v8 offset:24576
  v_mfma_f32_16x16x32_bf16 v[76:79], a[144:147], a[100:103], v[76:79]
  ds_read_b64_tr_b16 a[170:171], v8 offset:26624
  v_mfma_f32_16x16x32_bf16 v[136:139], a[148:151], a[96:99], v[136:139]
  ds_read_b64_tr_b16 a[172:173], v8 offset:28672
  v_mfma_f32_16x16x32_bf16 v[140:143], a[148:151], a[100:103], v[140:143]
  ds_read_b64_tr_b16 a[174:175], v8 offset:30720
  buffer_load_dwordx4 a[196:199], v2, s[8:11], s82 offen offset:1024
  s_waitcnt lgkmcnt(8)
  v_mfma_f32_16x16x32_bf16 v[80:83], a[152:155], a[96:99], v[80:83]
  ds_read_b64_tr_b16 a[144:145], v9 offset:24576
  v_mfma_f32_16x16x32_bf16 v[84:87], a[152:155], a[100:103], v[84:87]
  ds_read_b64_tr_b16 a[146:147], v9 offset:26624
  v_mfma_f32_16x16x32_bf16 v[144:147], a[156:159], a[96:99], v[144:147]
  ds_read_b64_tr_b16 a[148:149], v9 offset:28672
  v_mfma_f32_16x16x32_bf16 v[148:151], a[156:159], a[100:103], v[148:151]
  ds_read_b64_tr_b16 a[150:151], v9 offset:30720
  s_waitcnt lgkmcnt(8)
  v_mfma_f32_16x16x32_bf16 v[56:59], a[160:163], a[104:107], v[56:59]
  ds_read_b64_tr_b16 a[152:153], v10 offset:24576
  buffer_load_dwordx4 a[200:203], v2, s[8:11], s80 offen offset:2048
  v_mfma_f32_16x16x32_bf16 v[60:63], a[160:163], a[108:111], v[60:63]
  ds_read_b64_tr_b16 a[154:155], v10 offset:26624
  v_mfma_f32_16x16x32_bf16 v[120:123], a[164:167], a[104:107], v[120:123]
  ds_read_b64_tr_b16 a[156:157], v10 offset:28672
  v_mfma_f32_16x16x32_bf16 v[124:127], a[164:167], a[108:111], v[124:127]
  ds_read_b64_tr_b16 a[158:159], v10 offset:30720
  s_waitcnt lgkmcnt(8)
  v_mfma_f32_16x16x32_bf16 v[64:67], a[168:171], a[104:107], v[64:67]
  s_waitcnt vmcnt(27)
  s_barrier
  ds_read_b64_tr_b16 a[160:161], v11 offset:36864
  buffer_load_dwordx4 a[204:207], v2, s[8:11], s81 offen offset:2048
  v_mfma_f32_16x16x32_bf16 v[68:71], a[168:171], a[108:111], v[68:71]
  ds_read_b64_tr_b16 a[162:163], v11 offset:37888
  v_mfma_f32_16x16x32_bf16 v[128:131], a[172:175], a[104:107], v[128:131]
  ds_read_b64_tr_b16 a[164:165], v11 offset:38912
  v_mfma_f32_16x16x32_bf16 v[132:135], a[172:175], a[108:111], v[132:135]
  ds_read_b64_tr_b16 a[166:167], v11 offset:39936
  s_waitcnt lgkmcnt(8)
  v_mfma_f32_16x16x32_bf16 v[72:75], a[144:147], a[104:107], v[72:75]
  ds_read_b64_tr_b16 a[168:169], v12 offset:36864
  v_mfma_f32_16x16x32_bf16 v[76:79], a[144:147], a[108:111], v[76:79]
  ds_read_b64_tr_b16 a[170:171], v12 offset:37888
  buffer_load_dwordx4 a[208:211], v2, s[8:11], s82 offen offset:2048
  v_mfma_f32_16x16x32_bf16 v[136:139], a[148:151], a[104:107], v[136:139]
  ds_read_b64_tr_b16 a[172:173], v12 offset:38912
  v_mfma_f32_16x16x32_bf16 v[140:143], a[148:151], a[108:111], v[140:143]
  ds_read_b64_tr_b16 a[174:175], v12 offset:39936
  s_waitcnt lgkmcnt(8)
  v_mfma_f32_16x16x32_bf16 v[80:83], a[152:155], a[104:107], v[80:83]
  ds_read_b64_tr_b16 a[144:145], v7 offset:36864
  v_mfma_f32_16x16x32_bf16 v[84:87], a[152:155], a[108:111], v[84:87]
  ds_read_b64_tr_b16 a[146:147], v7 offset:38912
  v_mfma_f32_16x16x32_bf16 v[144:147], a[156:159], a[104:107], v[144:147]
  ds_read_b64_tr_b16 a[148:149], v7 offset:40960
  v_mfma_f32_16x16x32_bf16 v[148:151], a[156:159], a[108:111], v[148:151]
  ds_read_b64_tr_b16 a[150:151], v7 offset:43008
  s_waitcnt lgkmcnt(8)
  v_mfma_f32_16x16x32_bf16 v[152:155], a[160:163], a[136:139], v[152:155]
  ds_read_b64_tr_b16 a[152:153], v8 offset:36864
  s_add_u32 m0, s27, 1024
  s_add_u32 s46, s16, 73728
k4_part_w6:
  s_cbranch_execz k4_part_w10
  v_mfma_f32_16x16x32_bf16 v[156:159], a[160:163], a[140:143], v[156:159]
  ds_read_b64_tr_b16 a[154:155], v8 offset:38912
  buffer_load_dwordx4 v6, s[4:7], s46 offen lds
  v_mfma_f32_16x16x32_bf16 v[168:171], a[164:167], a[136:139], v[168:171]
  ds_read_b64_tr_b16 a[156:157], v8 offset:40960
  v_mfma_f32_16x16x32_bf16 v[172:175], a[164:167], a[140:143], v[172:175]
  ds_read_b64_tr_b16 a[158:159], v8 offset:43008
  s_waitcnt lgkmcnt(8)
  v_mfma_f32_16x16x32_bf16 v[160:163], a[168:171], a[136:139], v[160:163]
  ds_read_b64_tr_b16 a[160:161], v9 offset:36864
  s_add_u32 m0, s27, 5120
  s_add_u32 s46, s46, 36864
  v_mfma_f32_16x16x32_bf16 v[164:167], a[168:171], a[140:143], v[164:167]
  ds_read_b64_tr_b16 a[162:163], v9 offset:38912
  buffer_load_dwordx4 v6, s[4:7], s46 offen lds
  v_mfma_f32_16x16x32_bf16 v[176:179], a[172:175], a[136:139], v[176:179]
  ds_read_b64_tr_b16 a[164:165], v9 offset:40960
  v_mul_f32 v152, v152, v168
  v_mfma_f32_16x16x32_bf16 v[180:183], a[172:175], a[140:143], v[180:183]
  ds_read_b64_tr_b16 a[166:167], v9 offset:43008
  v_mul_f32 v153, v153, v169
  s_waitcnt lgkmcnt(8)
  v_mfma_f32_16x16x32_bf16 v[56:59], a[144:147], a[112:115], v[56:59]
  ds_read_b64_tr_b16 a[168:169], v10 offset:36864
  s_add_u32 m0, s27, 9216
  s_xor_b32 s46, s45, 8192
  v_mfma_f32_16x16x32_bf16 v[60:63], a[144:147], a[116:119], v[60:63]
  ds_read_b64_tr_b16 a[170:171], v10 offset:38912
  buffer_load_dwordx4 v0, s[8:11], s46 offen lds
  v_mfma_f32_16x16x32_bf16 v[120:123], a[148:151], a[112:115], v[120:123]
  ds_read_b64_tr_b16 a[172:173], v10 offset:40960
  v_mul_f32 v154, v154, v170
  v_mfma_f32_16x16x32_bf16 v[124:127], a[148:151], a[116:119], v[124:127]
  ds_read_b64_tr_b16 a[174:175], v10 offset:43008
  v_mul_f32 v155, v155, v171
  s_waitcnt lgkmcnt(8)
  v_mfma_f32_16x16x32_bf16 v[64:67], a[152:155], a[112:115], v[64:67]
  ds_read_b64_tr_b16 a[144:145], v7 offset:45056
  v_cvt_pk_bf16_f32 v216, v152, v153
  v_mfma_f32_16x16x32_bf16 v[68:71], a[152:155], a[116:119], v[68:71]
  ds_read_b64_tr_b16 a[146:147], v7 offset:47104
  s_add_u32 m0, s27, 13312
  s_xor_b32 s46, s45, 12288
  v_mfma_f32_16x16x32_bf16 v[128:131], a[156:159], a[112:115], v[128:131]
  ds_read_b64_tr_b16 a[148:149], v7 offset:49152
  buffer_load_dwordx4 v0, s[8:11], s46 offen lds
  v_mfma_f32_16x16x32_bf16 v[132:135], a[156:159], a[116:119], v[132:135]
  ds_read_b64_tr_b16 a[150:151], v7 offset:51200
  v_cvt_pk_bf16_f32 v217, v154, v155
  s_waitcnt lgkmcnt(8)
  v_mfma_f32_16x16x32_bf16 v[72:75], a[160:163], a[112:115], v[72:75]
  ds_read_b64_tr_b16 a[152:153], v8 offset:45056
  v_mul_f32 v160, v160, v176
  v_mfma_f32_16x16x32_bf16 v[76:79], a[160:163], a[116:119], v[76:79]
  ds_read_b64_tr_b16 a[154:155], v8 offset:47104
  s_add_u32 m0, s27, 17408
  v_mfma_f32_16x16x32_bf16 v[136:139], a[164:167], a[112:115], v[136:139]
  ds_read_b64_tr_b16 a[156:157], v8 offset:49152
  buffer_load_dwordx4 v6, s[4:7], s37 offen lds
  v_mfma_f32_16x16x32_bf16 v[140:143], a[164:167], a[116:119], v[140:143]
  ds_read_b64_tr_b16 a[158:159], v8 offset:51200
  v_mul_f32 v161, v161, v177
  s_waitcnt lgkmcnt(8)
  v_mfma_f32_16x16x32_bf16 v[80:83], a[168:171], a[112:115], v[80:83]
  ds_read_b64_tr_b16 a[160:161], v9 offset:45056
  v_mul_f32 v162, v162, v178
  v_mfma_f32_16x16x32_bf16 v[84:87], a[168:171], a[116:119], v[84:87]
  ds_read_b64_tr_b16 a[162:163], v9 offset:47104
  v_mul_f32 v163, v163, v179
  v_mfma_f32_16x16x32_bf16 v[144:147], a[172:175], a[112:115], v[144:147]
  ds_read_b64_tr_b16 a[164:165], v9 offset:49152
  v_cvt_pk_bf16_f32 v218, v160, v161
  v_cvt_pk_bf16_f32 v219, v162, v163
  v_mfma_f32_16x16x32_bf16 v[148:151], a[172:175], a[116:119], v[148:151]
  ds_read_b64_tr_b16 a[166:167], v9 offset:51200
  s_add_u32 s3, s47, 16384
  buffer_store_dwordx4 v[216:219], v2, s[8:11], s3 offen offset:0 sc1
  s_waitcnt lgkmcnt(8)
  v_mfma_f32_16x16x32_bf16 v[56:59], a[144:147], a[120:123], v[56:59]
  ds_read_b64_tr_b16 a[168:169], v10 offset:45056
  v_mul_f32 v156, v156, v172
  v_mfma_f32_16x16x32_bf16 v[60:63], a[144:147], a[124:127], v[60:63]
  ds_read_b64_tr_b16 a[170:171], v10 offset:47104
  v_mul_f32 v157, v157, v173
  v_mfma_f32_16x16x32_bf16 v[120:123], a[148:151], a[120:123], v[120:123]
  ds_read_b64_tr_b16 a[172:173], v10 offset:49152
  s_add_u32 m0, s27, 21504
  s_add_u32 s46, s37, 36864
  v_mfma_f32_16x16x32_bf16 v[124:127], a[148:151], a[124:127], v[124:127]
  ds_read_b64_tr_b16 a[174:175], v10 offset:51200
  buffer_load_dwordx4 v6, s[4:7], s46 offen lds
  s_waitcnt lgkmcnt(8)
  v_mfma_f32_16x16x32_bf16 v[64:67], a[152:155], a[120:123], v[64:67]
  ds_read_b64_tr_b16 a[144:145], v7 offset:53248
  v_mul_f32 v158, v158, v174
  v_mfma_f32_16x16x32_bf16 v[68:71], a[152:155], a[124:127], v[68:71]
  ds_read_b64_tr_b16 a[146:147], v7 offset:55296
  v_mul_f32 v159, v159, v175
  v_mfma_f32_16x16x32_bf16 v[128:131], a[156:159], a[120:123], v[128:131]
  ds_read_b64_tr_b16 a[148:149], v7 offset:57344
  v_cvt_pk_bf16_f32 v220, v156, v157
  v_mfma_f32_16x16x32_bf16 v[132:135], a[156:159], a[124:127], v[132:135]
  ds_read_b64_tr_b16 a[150:151], v7 offset:59392
  s_add_u32 m0, s27, 25600
  s_xor_b32 s46, s45, 16384
  s_waitcnt lgkmcnt(8)
  v_mfma_f32_16x16x32_bf16 v[72:75], a[160:163], a[120:123], v[72:75]
  ds_read_b64_tr_b16 a[152:153], v8 offset:53248
  buffer_load_dwordx4 v0, s[8:11], s46 offen lds
  v_mfma_f32_16x16x32_bf16 v[76:79], a[160:163], a[124:127], v[76:79]
  ds_read_b64_tr_b16 a[154:155], v8 offset:55296
  v_cvt_pk_bf16_f32 v221, v158, v159
  v_mfma_f32_16x16x32_bf16 v[136:139], a[164:167], a[120:123], v[136:139]
  ds_read_b64_tr_b16 a[156:157], v8 offset:57344
  v_mul_f32 v164, v164, v180
  v_mfma_f32_16x16x32_bf16 v[140:143], a[164:167], a[124:127], v[140:143]
  ds_read_b64_tr_b16 a[158:159], v8 offset:59392
  s_add_u32 m0, s27, 29696
  s_add_u32 s46, s37, 73728
  s_waitcnt lgkmcnt(8)
  v_mfma_f32_16x16x32_bf16 v[80:83], a[168:171], a[120:123], v[80:83]
  ds_read_b64_tr_b16 a[160:161], v9 offset:53248
  buffer_load_dwordx4 v6, s[4:7], s46 offen lds
  v_mfma_f32_16x16x32_bf16 v[84:87], a[168:171], a[124:127], v[84:87]
  ds_read_b64_tr_b16 a[162:163], v9 offset:55296
  v_mul_f32 v165, v165, v181
  v_mfma_f32_16x16x32_bf16 v[144:147], a[172:175], a[120:123], v[144:147]
  ds_read_b64_tr_b16 a[164:165], v9 offset:57344
  v_mul_f32 v166, v166, v182
  v_mfma_f32_16x16x32_bf16 v[148:151], a[172:175], a[124:127], v[148:151]
  ds_read_b64_tr_b16 a[166:167], v9 offset:59392
  v_mul_f32 v167, v167, v183
  s_waitcnt lgkmcnt(8)
  v_mfma_f32_16x16x32_bf16 v[56:59], a[144:147], a[128:131], v[56:59]
  ds_read_b64_tr_b16 a[168:169], v10 offset:53248
  s_add_u32 m0, s27, 33792
  s_add_u32 s46, s46, 36864
  v_mfma_f32_16x16x32_bf16 v[60:63], a[144:147], a[132:135], v[60:63]
  ds_read_b64_tr_b16 a[170:171], v10 offset:55296
  buffer_load_dwordx4 v6, s[4:7], s46 offen lds
  v_mfma_f32_16x16x32_bf16 v[120:123], a[148:151], a[128:131], v[120:123]
  ds_read_b64_tr_b16 a[172:173], v10 offset:57344
  v_cvt_pk_bf16_f32 v222, v164, v165
  v_mfma_f32_16x16x32_bf16 v[124:127], a[148:151], a[132:135], v[124:127]
  ds_read_b64_tr_b16 a[174:175], v10 offset:59392
  v_cvt_pk_bf16_f32 v223, v166, v167
  s_waitcnt lgkmcnt(8)
  v_mfma_f32_16x16x32_bf16 v[64:67], a[152:155], a[128:131], v[64:67]
  ds_read_b64_tr_b16 a[144:145], v7 offset:61440
  v_mfma_f32_16x16x32_bf16 v[68:71], a[152:155], a[132:135], v[68:71]
  ds_read_b64_tr_b16 a[146:147], v7 offset:63488
  buffer_load_dword v23, v13, s[8:11], s84 offen offset:640 sc1
  buffer_load_dwordx4 a[212:215], v2, s[8:11], s80 offen offset:3072
  v_mfma_f32_16x16x32_bf16 v[128:131], a[156:159], a[128:131], v[128:131]
  v_add_u32 v7, 65536, v7
  ds_read_b64_tr_b16 a[148:149], v7 offset:0
  v_mfma_f32_16x16x32_bf16 v[132:135], a[156:159], a[132:135], v[132:135]
  ds_read_b64_tr_b16 a[150:151], v7 offset:2048
  s_waitcnt lgkmcnt(8)
  v_mfma_f32_16x16x32_bf16 v[72:75], a[160:163], a[128:131], v[72:75]
  ds_read_b64_tr_b16 a[152:153], v8 offset:61440
  v_mfma_f32_16x16x32_bf16 v[76:79], a[160:163], a[132:135], v[76:79]
  ds_read_b64_tr_b16 a[154:155], v8 offset:63488
  v_mfma_f32_16x16x32_bf16 v[136:139], a[164:167], a[128:131], v[136:139]
  v_add_u32 v8, 65536, v8
  ds_read_b64_tr_b16 a[156:157], v8 offset:0
  buffer_store_dwordx4 v[220:223], v2, s[8:11], s3 offen offset:1024 sc1
  v_mfma_f32_16x16x32_bf16 v[140:143], a[164:167], a[132:135], v[140:143]
  ds_read_b64_tr_b16 a[158:159], v8 offset:2048
  s_waitcnt lgkmcnt(8)
  v_mfma_f32_16x16x32_bf16 v[80:83], a[168:171], a[128:131], v[80:83]
  ds_read_b64_tr_b16 a[160:161], v9 offset:61440
  v_mfma_f32_16x16x32_bf16 v[84:87], a[168:171], a[132:135], v[84:87]
  ds_read_b64_tr_b16 a[162:163], v9 offset:63488
  v_mfma_f32_16x16x32_bf16 v[144:147], a[172:175], a[128:131], v[144:147]
  v_add_u32 v9, 65536, v9
  ds_read_b64_tr_b16 a[164:165], v9 offset:0
  buffer_load_dwordx4 a[216:219], v2, s[8:11], s81 offen offset:3072
  v_mfma_f32_16x16x32_bf16 v[148:151], a[172:175], a[132:135], v[148:151]
  ds_read_b64_tr_b16 a[166:167], v9 offset:2048
  s_waitcnt lgkmcnt(8)
  v_mfma_f32_16x16x32_bf16 v[56:59], a[144:147], a[136:139], v[56:59]
  ds_read_b64_tr_b16 a[168:169], v10 offset:61440
  v_mfma_f32_16x16x32_bf16 v[60:63], a[144:147], a[140:143], v[60:63]
  ds_read_b64_tr_b16 a[170:171], v10 offset:63488
  v_mfma_f32_16x16x32_bf16 v[120:123], a[148:151], a[136:139], v[120:123]
  v_add_u32 v10, 65536, v10
  ds_read_b64_tr_b16 a[172:173], v10 offset:0
  v_mfma_f32_16x16x32_bf16 v[124:127], a[148:151], a[140:143], v[124:127]
  ds_read_b64_tr_b16 a[174:175], v10 offset:2048
  buffer_load_dwordx4 a[220:223], v2, s[8:11], s82 offen offset:3072
  s_waitcnt lgkmcnt(8)
  v_mfma_f32_16x16x32_bf16 v[64:67], a[152:155], a[136:139], v[64:67]
  s_waitcnt vmcnt(34)
  s_barrier
  ds_read_b64_tr_b16 a[144:145], v7 offset:8192
  v_mul_f32 v56, v56, v120
  v_mfma_f32_16x16x32_bf16 v[68:71], a[152:155], a[140:143], v[68:71]
  ds_read_b64_tr_b16 a[146:147], v7 offset:10240
  v_mul_f32 v57, v57, v121
  v_mfma_f32_16x16x32_bf16 v[128:131], a[156:159], a[136:139], v[128:131]
  ds_read_b64_tr_b16 a[148:149], v8 offset:8192
  v_mul_f32 v58, v58, v122
  v_mfma_f32_16x16x32_bf16 v[132:135], a[156:159], a[140:143], v[132:135]
  ds_read_b64_tr_b16 a[150:151], v8 offset:10240
  s_add_u32 s48, s80, 4096
  buffer_load_dwordx4 a[224:227], v2, s[8:11], s48 offen offset:0
  s_waitcnt lgkmcnt(8)
  v_mfma_f32_16x16x32_bf16 v[72:75], a[160:163], a[136:139], v[72:75]
  ds_read_b64_tr_b16 a[152:153], v9 offset:8192
  v_mul_f32 v59, v59, v123
  v_mfma_f32_16x16x32_bf16 v[76:79], a[160:163], a[140:143], v[76:79]
  ds_read_b64_tr_b16 a[154:155], v9 offset:10240
  v_cvt_pk_bf16_f32 v56, v56, v57
  v_mfma_f32_16x16x32_bf16 v[136:139], a[164:167], a[136:139], v[136:139]
  ds_read_b64_tr_b16 a[156:157], v10 offset:8192
  v_cvt_pk_bf16_f32 v57, v58, v59
  v_mfma_f32_16x16x32_bf16 v[140:143], a[164:167], a[140:143], v[140:143]
  ds_read_b64_tr_b16 a[158:159], v10 offset:10240
  v_mul_f32 v64, v64, v128
  s_waitcnt lgkmcnt(8)
  v_mfma_f32_16x16x32_bf16 v[80:83], a[168:171], a[136:139], v[80:83]
  ds_read_b64_tr_b16 a[160:161], v7 offset:12288
  s_add_u32 s48, s81, 4096
  buffer_load_dwordx4 a[228:231], v2, s[8:11], s48 offen offset:0
  v_mfma_f32_16x16x32_bf16 v[84:87], a[168:171], a[140:143], v[84:87]
  ds_read_b64_tr_b16 a[162:163], v7 offset:14336
  v_mul_f32 v65, v65, v129
  v_mfma_f32_16x16x32_bf16 v[144:147], a[172:175], a[136:139], v[144:147]
  ds_read_b64_tr_b16 a[164:165], v8 offset:12288
  v_mul_f32 v66, v66, v130
  v_mfma_f32_16x16x32_bf16 v[148:151], a[172:175], a[140:143], v[148:151]
  ds_read_b64_tr_b16 a[166:167], v8 offset:14336
  v_mul_f32 v67, v67, v131
  s_waitcnt lgkmcnt(8)
  v_mfma_f32_16x16x32_bf16 v[152:155], a[144:147], v[184:187], 0
  ds_read_b64_tr_b16 a[168:169], v9 offset:12288
  s_add_u32 s48, s82, 4096
  buffer_load_dwordx4 a[232:235], v2, s[8:11], s48 offen offset:0
  v_mfma_f32_16x16x32_bf16 v[156:159], a[144:147], v[188:191], 0
  ds_read_b64_tr_b16 a[170:171], v9 offset:14336
  v_cvt_pk_bf16_f32 v58, v64, v65
  v_mfma_f32_16x16x32_bf16 v[160:163], a[148:151], v[184:187], 0
  ds_read_b64_tr_b16 a[172:173], v10 offset:12288
  v_cvt_pk_bf16_f32 v59, v66, v67
  v_mfma_f32_16x16x32_bf16 v[164:167], a[148:151], v[188:191], 0
  ds_read_b64_tr_b16 a[174:175], v10 offset:14336
  v_mul_f32 v60, v60, v124
  s_waitcnt lgkmcnt(8)
  v_mfma_f32_16x16x32_bf16 v[168:171], a[152:155], v[184:187], 0
  ds_read_b64_tr_b16 a[144:145], v7 offset:16384
  v_mul_f32 v61, v61, v125
  v_mfma_f32_16x16x32_bf16 v[172:175], a[152:155], v[188:191], 0
  ds_read_b64_tr_b16 a[146:147], v7 offset:18432
  s_add_u32 s3, s47, 12288
  buffer_store_dwordx4 v[56:59], v2, s[8:11], s3 offen offset:0 sc1
  v_mfma_f32_16x16x32_bf16 v[176:179], a[156:159], v[184:187], 0
  ds_read_b64_tr_b16 a[148:149], v8 offset:16384
  v_mul_f32 v62, v62, v126
  v_mfma_f32_16x16x32_bf16 v[180:183], a[156:159], v[188:191], 0
  ds_read_b64_tr_b16 a[150:151], v8 offset:18432
  v_mul_f32 v63, v63, v127
  s_waitcnt lgkmcnt(8)
  v_mfma_f32_16x16x32_bf16 v[152:155], a[160:163], v[192:195], v[152:155]
  ds_read_b64_tr_b16 a[152:153], v9 offset:16384
  s_add_u32 m0, s27, 37888
  s_xor_b32 s46, s45, 20480
  v_mfma_f32_16x16x32_bf16 v[156:159], a[160:163], v[196:199], v[156:159]
  ds_read_b64_tr_b16 a[154:155], v9 offset:18432
  buffer_load_dwordx4 v0, s[8:11], s46 offen lds
  v_mfma_f32_16x16x32_bf16 v[160:163], a[164:167], v[192:195], v[160:163]
  ds_read_b64_tr_b16 a[156:157], v10 offset:16384
  v_cvt_pk_bf16_f32 v60, v60, v61
  v_mfma_f32_16x16x32_bf16 v[164:167], a[164:167], v[196:199], v[164:167]
  ds_read_b64_tr_b16 a[158:159], v10 offset:18432
  v_cvt_pk_bf16_f32 v61, v62, v63
  s_waitcnt lgkmcnt(8)
  v_mfma_f32_16x16x32_bf16 v[168:171], a[168:171], v[192:195], v[168:171]
  ds_read_b64_tr_b16 a[160:161], v7 offset:20480
  v_mul_f32 v68, v68, v132
  v_mfma_f32_16x16x32_bf16 v[172:175], a[168:171], v[196:199], v[172:175]
  ds_read_b64_tr_b16 a[162:163], v7 offset:22528
  s_add_u32 m0, s27, 41984
  v_mfma_f32_16x16x32_bf16 v[176:179], a[172:175], v[192:195], v[176:179]
  ds_read_b64_tr_b16 a[164:165], v8 offset:20480
  buffer_load_dwordx4 v6, s[4:7], s38 offen lds
  v_mfma_f32_16x16x32_bf16 v[180:183], a[172:175], v[196:199], v[180:183]
  ds_read_b64_tr_b16 a[166:167], v8 offset:22528
  v_mul_f32 v69, v69, v133
  s_waitcnt lgkmcnt(8)
  v_mfma_f32_16x16x32_bf16 v[152:155], a[144:147], v[200:203], v[152:155]
  ds_read_b64_tr_b16 a[168:169], v9 offset:20480
  v_mul_f32 v70, v70, v134
  v_mfma_f32_16x16x32_bf16 v[156:159], a[144:147], v[204:207], v[156:159]
  ds_read_b64_tr_b16 a[170:171], v9 offset:22528
  s_add_u32 m0, s27, 46080
  s_add_u32 s46, s38, 36864
  v_mfma_f32_16x16x32_bf16 v[160:163], a[148:151], v[200:203], v[160:163]
  ds_read_b64_tr_b16 a[172:173], v10 offset:20480
  buffer_load_dwordx4 v6, s[4:7], s46 offen lds
  v_mfma_f32_16x16x32_bf16 v[164:167], a[148:151], v[204:207], v[164:167]
  ds_read_b64_tr_b16 a[174:175], v10 offset:22528
  v_mul_f32 v71, v71, v135
  s_waitcnt lgkmcnt(8)
  v_mfma_f32_16x16x32_bf16 v[168:171], a[152:155], v[200:203], v[168:171]
  ds_read_b64_tr_b16 a[144:145], v11 offset:57344
  v_cvt_pk_bf16_f32 v62, v68, v69
  v_mfma_f32_16x16x32_bf16 v[172:175], a[152:155], v[204:207], v[172:175]
  ds_read_b64_tr_b16 a[146:147], v11 offset:58368
  v_cvt_pk_bf16_f32 v63, v70, v71
  v_mfma_f32_16x16x32_bf16 v[176:179], a[156:159], v[200:203], v[176:179]
  ds_read_b64_tr_b16 a[148:149], v12 offset:57344
  s_add_u32 m0, s27, 50176
  s_xor_b32 s46, s45, 32768
  v_mfma_f32_16x16x32_bf16 v[180:183], a[156:159], v[204:207], v[180:183]
  ds_read_b64_tr_b16 a[150:151], v12 offset:58368
  buffer_load_dwordx4 v0, s[8:11], s46 offen lds
  s_waitcnt lgkmcnt(8)
  v_mfma_f32_16x16x32_bf16 v[152:155], a[160:163], v[208:211], v[152:155]
  ds_read_b64_tr_b16 a[152:153], v11 offset:59392
  v_mul_f32 v72, v72, v136
  v_mfma_f32_16x16x32_bf16 v[156:159], a[160:163], v[212:215], v[156:159]
  ds_read_b64_tr_b16 a[154:155], v11 offset:60416
  v_mul_f32 v73, v73, v137
  v_mfma_f32_16x16x32_bf16 v[160:163], a[164:167], v[208:211], v[160:163]
  ds_read_b64_tr_b16 a[156:157], v12 offset:59392
  v_mul_f32 v74, v74, v138
  v_mfma_f32_16x16x32_bf16 v[164:167], a[164:167], v[212:215], v[164:167]
  ds_read_b64_tr_b16 a[158:159], v12 offset:60416
  s_add_u32 s48, s80, 4096
  buffer_load_dwordx4 a[236:239], v2, s[8:11], s48 offen offset:1024
  s_waitcnt lgkmcnt(8)
  v_mfma_f32_16x16x32_bf16 v[168:171], a[168:171], v[208:211], v[168:171]
  ds_read_b64_tr_b16 a[160:161], v11 offset:61440
  v_mul_f32 v75, v75, v139
  v_mfma_f32_16x16x32_bf16 v[172:175], a[168:171], v[212:215], v[172:175]
  ds_read_b64_tr_b16 a[162:163], v11 offset:62464
  v_cvt_pk_bf16_f32 v72, v72, v73
  v_mfma_f32_16x16x32_bf16 v[176:179], a[172:175], v[208:211], v[176:179]
  ds_read_b64_tr_b16 a[164:165], v12 offset:61440
  v_cvt_pk_bf16_f32 v73, v74, v75
  v_mfma_f32_16x16x32_bf16 v[180:183], a[172:175], v[212:215], v[180:183]
  ds_read_b64_tr_b16 a[166:167], v12 offset:62464
  s_add_u32 m0, s27, 54272
  s_add_u32 s46, s38, 73728
  s_waitcnt lgkmcnt(8)
  v_mfma_f32_16x16x32_bf16 v[224:227], a[144:147], v[184:187], 0
  ds_read_b64_tr_b16 a[168:169], v11 offset:63488
  buffer_load_dwordx4 v6, s[4:7], s46 offen lds
  v_mfma_f32_16x16x32_bf16 v[228:231], a[144:147], v[188:191], 0
  ds_read_b64_tr_b16 a[170:171], v11 offset:64512
  v_mul_f32 v80, v80, v144
  v_mfma_f32_16x16x32_bf16 v[232:235], a[148:151], v[184:187], 0
  ds_read_b64_tr_b16 a[172:173], v12 offset:63488
  v_mul_f32 v81, v81, v145
  v_mfma_f32_16x16x32_bf16 v[236:239], a[148:151], v[188:191], 0
  ds_read_b64_tr_b16 a[174:175], v12 offset:64512
  v_mul_f32 v82, v82, v146
  s_waitcnt lgkmcnt(8)
  v_mfma_f32_16x16x32_bf16 v[224:227], a[152:155], v[192:195], v[224:227]
  ds_read_b64_tr_b16 a[144:145], v7 offset:32768
  buffer_store_dwordx4 v[60:63], v2, s[8:11], s3 offen offset:1024 sc1
  v_mfma_f32_16x16x32_bf16 v[228:231], a[152:155], v[196:199], v[228:231]
  ds_read_b64_tr_b16 a[146:147], v7 offset:34816
  v_mul_f32 v83, v83, v147
  v_mfma_f32_16x16x32_bf16 v[232:235], a[156:159], v[192:195], v[232:235]
  ds_read_b64_tr_b16 a[148:149], v8 offset:32768
  v_cvt_pk_bf16_f32 v74, v80, v81
  v_mfma_f32_16x16x32_bf16 v[236:239], a[156:159], v[196:199], v[236:239]
  ds_read_b64_tr_b16 a[150:151], v8 offset:34816
  v_cvt_pk_bf16_f32 v75, v82, v83
  s_waitcnt lgkmcnt(8)
  v_mfma_f32_16x16x32_bf16 v[224:227], a[160:163], v[200:203], v[224:227]
  ds_read_b64_tr_b16 a[152:153], v9 offset:32768
  v_mul_f32 v76, v76, v140
  v_mfma_f32_16x16x32_bf16 v[228:231], a[160:163], v[204:207], v[228:231]
  ds_read_b64_tr_b16 a[154:155], v9 offset:34816
  s_add_u32 s48, s81, 4096
  buffer_load_dwordx4 a[240:243], v2, s[8:11], s48 offen offset:1024
  v_mfma_f32_16x16x32_bf16 v[232:235], a[164:167], v[200:203], v[232:235]
  ds_read_b64_tr_b16 a[156:157], v10 offset:32768
  v_mul_f32 v77, v77, v141
  v_mfma_f32_16x16x32_bf16 v[236:239], a[164:167], v[204:207], v[236:239]
  ds_read_b64_tr_b16 a[158:159], v10 offset:34816
  v_mul_f32 v78, v78, v142
  s_waitcnt lgkmcnt(8)
  v_mfma_f32_16x16x32_bf16 v[224:227], a[168:171], v[208:211], v[224:227]
  ds_read_b64_tr_b16 a[160:161], v7 offset:36864
  s_add_u32 m0, s27, 58368
  s_add_u32 s46, s46, 36864
  v_mfma_f32_16x16x32_bf16 v[228:231], a[168:171], v[212:215], v[228:231]
  ds_read_b64_tr_b16 a[162:163], v7 offset:38912
  buffer_load_dwordx4 v6, s[4:7], s46 offen lds
  v_mfma_f32_16x16x32_bf16 v[232:235], a[172:175], v[208:211], v[232:235]
  ds_read_b64_tr_b16 a[164:165], v8 offset:36864
  v_mul_f32 v79, v79, v143
  v_mfma_f32_16x16x32_bf16 v[236:239], a[172:175], v[212:215], v[236:239]
  ds_read_b64_tr_b16 a[166:167], v8 offset:38912
  v_cvt_pk_bf16_f32 v76, v76, v77
  s_waitcnt lgkmcnt(8)
  v_mfma_f32_16x16x32_bf16 v[152:155], a[144:147], v[24:27], v[152:155]
  ds_read_b64_tr_b16 a[168:169], v9 offset:36864
  v_cvt_pk_bf16_f32 v77, v78, v79
  v_mfma_f32_16x16x32_bf16 v[156:159], a[144:147], v[28:31], v[156:159]
  ds_read_b64_tr_b16 a[170:171], v9 offset:38912
  v_mul_f32 v84, v84, v148
  v_mfma_f32_16x16x32_bf16 v[160:163], a[148:151], v[24:27], v[160:163]
  ds_read_b64_tr_b16 a[172:173], v10 offset:36864
  s_add_u32 s48, s82, 4096
  buffer_load_dwordx4 a[244:247], v2, s[8:11], s48 offen offset:1024
  v_mfma_f32_16x16x32_bf16 v[164:167], a[148:151], v[28:31], v[164:167]
  ds_read_b64_tr_b16 a[174:175], v10 offset:38912
  v_mul_f32 v85, v85, v149
  s_waitcnt lgkmcnt(8)
  v_mfma_f32_16x16x32_bf16 v[168:171], a[152:155], v[24:27], v[168:171]
  ds_read_b64_tr_b16 a[144:145], v7 offset:40960
  v_mul_f32 v86, v86, v150
  v_mfma_f32_16x16x32_bf16 v[172:175], a[152:155], v[28:31], v[172:175]
  ds_read_b64_tr_b16 a[146:147], v7 offset:43008
  s_waitcnt vmcnt(18)
  v_cmp_eq_u32 vcc, 0, v23
  s_add_u32 m0, s27, 62464
  s_xor_b32 s46, s45, 36864
  v_mfma_f32_16x16x32_bf16 v[176:179], a[156:159], v[24:27], v[176:179]
  ds_read_b64_tr_b16 a[148:149], v8 offset:40960
  s_cbranch_vccz k4_part_bk5
k4_part_sl5:
  s_sleep 1
  buffer_load_dword v23, v13, s[8:11], s84 offen offset:640 sc1
  s_sub_u32 s87, s87, 1
  s_max_i32 s87, s87, 0
  s_waitcnt vmcnt(0)
  s_cbranch_scc0 k4_part_bk5
  v_cmp_eq_u32 vcc, 0, v23
  s_cbranch_vccnz k4_part_sl5
k4_part_bk5:
  buffer_load_dwordx4 v0, s[8:11], s46 offen lds
  v_mfma_f32_16x16x32_bf16 v[180:183], a[156:159], v[28:31], v[180:183]
  ds_read_b64_tr_b16 a[150:151], v8 offset:43008
  v_mul_f32 v87, v87, v151
  s_waitcnt lgkmcnt(8)
  v_mfma_f32_16x16x32_bf16 v[152:155], a[160:163], v[40:43], v[152:155]
  ds_read_b64_tr_b16 a[152:153], v9 offset:40960
  v_cvt_pk_bf16_f32 v78, v84, v85
  v_mfma_f32_16x16x32_bf16 v[156:159], a[160:163], v[44:47], v[156:159]
  ds_read_b64_tr_b16 a[154:155], v9 offset:43008
  v_cvt_pk_bf16_f32 v79, v86, v87
  v_mfma_f32_16x16x32_bf16 v[160:163], a[164:167], v[40:43], v[160:163]
  ds_read_b64_tr_b16 a[156:157], v10 offset:40960
  v_mfma_f32_16x16x32_bf16 v[164:167], a[164:167], v[44:47], v[164:167]
  ds_read_b64_tr_b16 a[158:159], v10 offset:43008
  s_add_u32 s48, s80, 4096
  buffer_load_dwordx4 a[248:251], v2, s[8:11], s48 offen offset:2048
  s_waitcnt lgkmcnt(8)
  v_mfma_f32_16x16x32_bf16 v[168:171], a[168:171], v[40:43], v[168:171]
  s_waitcnt vmcnt(37)
  s_barrier
  ds_read_b64_tr_b16 a[160:161], v7 offset:45056
  v_mfma_f32_16x16x32_bf16 v[172:175], a[168:171], v[44:47], v[172:175]
  ds_read_b64_tr_b16 a[162:163], v7 offset:47104
  v_mfma_f32_16x16x32_bf16 v[176:179], a[172:175], v[40:43], v[176:179]
  ds_read_b64_tr_b16 a[164:165], v8 offset:45056
  v_mfma_f32_16x16x32_bf16 v[180:183], a[172:175], v[44:47], v[180:183]
  ds_read_b64_tr_b16 a[166:167], v8 offset:47104
  buffer_store_dwordx4 v[72:75], v2, s[8:11], s3 offen offset:2048 sc1
  s_waitcnt lgkmcnt(8)
  v_mfma_f32_16x16x32_bf16 v[32:35], a[144:147], v[184:187], 0
  ds_read_b64_tr_b16 a[168:169], v9 offset:45056
  v_mfma_f32_16x16x32_bf16 v[36:39], a[144:147], v[188:191], 0
  ds_read_b64_tr_b16 a[170:171], v9 offset:47104
  v_mfma_f32_16x16x32_bf16 v[48:51], a[148:151], v[184:187], 0
  ds_read_b64_tr_b16 a[172:173], v10 offset:45056
  v_mfma_f32_16x16x32_bf16 v[52:55], a[148:151], v[188:191], 0
  ds_read_b64_tr_b16 a[174:175], v10 offset:47104
  s_add_u32 m0, s27, 66560
  s_waitcnt lgkmcnt(8)
  v_mfma_f32_16x16x32_bf16 v[64:67], a[152:155], v[184:187], 0
  ds_read_b64_tr_b16 a[144:145], v7 offset:49152
  buffer_load_dwordx4 v6, s[4:7], s39 offen lds
  v_mfma_f32_16x16x32_bf16 v[68:71], a[152:155], v[188:191], 0
  ds_read_b64_tr_b16 a[146:147], v7 offset:51200
  v_mfma_f32_16x16x32_bf16 v[80:83], a[156:159], v[184:187], 0
  ds_read_b64_tr_b16 a[148:149], v8 offset:49152
  v_mfma_f32_16x16x32_bf16 v[84:87], a[156:159], v[188:191], 0
  ds_read_b64_tr_b16 a[150:151], v8 offset:51200
  s_waitcnt lgkmcnt(8)
  v_mfma_f32_16x16x32_bf16 v[32:35], a[160:163], v[192:195], v[32:35]
  ds_read_b64_tr_b16 a[152:153], v9 offset:49152
  s_add_u32 s48, s81, 4096
  buffer_load_dwordx4 a[252:255], v2, s[8:11], s48 offen offset:2048
  v_mfma_f32_16x16x32_bf16 v[36:39], a[160:163], v[196:199], v[36:39]
  ds_read_b64_tr_b16 a[154:155], v9 offset:51200
  v_mfma_f32_16x16x32_bf16 v[48:51], a[164:167], v[192:195], v[48:51]
  ds_read_b64_tr_b16 a[156:157], v10 offset:49152
  v_mfma_f32_16x16x32_bf16 v[52:55], a[164:167], v[196:199], v[52:55]
  ds_read_b64_tr_b16 a[158:159], v10 offset:51200
  s_waitcnt lgkmcnt(8)
  v_mfma_f32_16x16x32_bf16 v[64:67], a[168:171], v[192:195], v[64:67]
  ds_read_b64_tr_b16 a[160:161], v7 offset:53248
  s_add_u32 m0, s27, 70656
  s_add_u32 s46, s39, 36864
  v_mfma_f32_16x16x32_bf16 v[68:71], a[168:171], v[196:199], v[68:71]
  ds_read_b64_tr_b16 a[162:163], v7 offset:55296
  buffer_load_dwordx4 v6, s[4:7], s46 offen lds
  v_mfma_f32_16x16x32_bf16 v[80:83], a[172:175], v[192:195], v[80:83]
  ds_read_b64_tr_b16 a[164:165], v8 offset:53248
  v_mfma_f32_16x16x32_bf16 v[84:87], a[172:175], v[196:199], v[84:87]
  ds_read_b64_tr_b16 a[166:167], v8 offset:55296
  s_waitcnt lgkmcnt(8)
  v_mfma_f32_16x16x32_bf16 v[32:35], a[144:147], v[200:203], v[32:35]
  ds_read_b64_tr_b16 a[168:169], v9 offset:53248
  v_mfma_f32_16x16x32_bf16 v[36:39], a[144:147], v[204:207], v[36:39]
  ds_read_b64_tr_b16 a[170:171], v9 offset:55296
  s_add_u32 s48, s82, 4096
  buffer_load_dwordx4 a[0:3], v2, s[8:11], s48 offen offset:2048
  v_mfma_f32_16x16x32_bf16 v[48:51], a[148:151], v[200:203], v[48:51]
  ds_read_b64_tr_b16 a[172:173], v10 offset:53248
  v_mfma_f32_16x16x32_bf16 v[52:55], a[148:151], v[204:207], v[52:55]
  ds_read_b64_tr_b16 a[174:175], v10 offset:55296
  s_waitcnt lgkmcnt(8)
  v_mfma_f32_16x16x32_bf16 v[64:67], a[152:155], v[200:203], v[64:67]
  ds_read_b64_tr_b16 a[144:145], v7 offset:57344
  v_mfma_f32_16x16x32_bf16 v[68:71], a[152:155], v[204:207], v[68:71]
  ds_read_b64_tr_b16 a[146:147], v7 offset:59392
  v_mfma_f32_16x16x32_bf16 v[80:83], a[156:159], v[200:203], v[80:83]
  ds_read_b64_tr_b16 a[148:149], v8 offset:57344
  s_add_u32 s48, s80, 4096
  buffer_load_dwordx4 a[4:7], v2, s[8:11], s48 offen offset:3072
  v_mfma_f32_16x16x32_bf16 v[84:87], a[156:159], v[204:207], v[84:87]
  ds_read_b64_tr_b16 a[150:151], v8 offset:59392
  s_waitcnt lgkmcnt(8)
  v_mfma_f32_16x16x32_bf16 v[32:35], a[160:163], v[208:211], v[32:35]
  ds_read_b64_tr_b16 a[152:153], v9 offset:57344
  v_mfma_f32_16x16x32_bf16 v[36:39], a[160:163], v[212:215], v[36:39]
  ds_read_b64_tr_b16 a[154:155], v9 offset:59392
  s_add_u32 m0, s27, 74752
  s_xor_b32 s46, s45, 49152
  v_mfma_f32_16x16x32_bf16 v[48:51], a[164:167], v[208:211], v[48:51]
  ds_read_b64_tr_b16 a[156:157], v10 offset:57344
  buffer_load_dwordx4 v0, s[8:11], s46 offen lds
  v_mfma_f32_16x16x32_bf16 v[52:55], a[164:167], v[212:215], v[52:55]
  ds_read_b64_tr_b16 a[158:159], v10 offset:59392
  s_waitcnt lgkmcnt(8)
  v_mfma_f32_16x16x32_bf16 v[64:67], a[168:171], v[208:211], v[64:67]
  ds_read_b64_tr_b16 a[160:161], v7 offset:61440
  v_mfma_f32_16x16x32_bf16 v[68:71], a[168:171], v[212:215], v[68:71]
  ds_read_b64_tr_b16 a[162:163], v7 offset:63488
  v_mfma_f32_16x16x32_bf16 v[80:83], a[172:175], v[208:211], v[80:83]
  ds_read_b64_tr_b16 a[164:165], v8 offset:61440
  v_mfma_f32_16x16x32_bf16 v[84:87], a[172:175], v[212:215], v[84:87]
  ds_read_b64_tr_b16 a[166:167], v8 offset:63488
  buffer_store_dwordx4 v[76:79], v2, s[8:11], s3 offen offset:3072 sc1
  s_waitcnt lgkmcnt(8)
  v_mfma_f32_16x16x32_bf16 v[32:35], a[144:147], v[24:27], v[32:35]
  ds_read_b64_tr_b16 a[168:169], v9 offset:61440
  v_mfma_f32_16x16x32_bf16 v[36:39], a[144:147], v[28:31], v[36:39]
  ds_read_b64_tr_b16 a[170:171], v9 offset:63488
  v_mfma_f32_16x16x32_bf16 v[48:51], a[148:151], v[24:27], v[48:51]
  ds_read_b64_tr_b16 a[172:173], v10 offset:61440
  s_add_u32 m0, s27, 78848
  s_add_u32 s46, s39, 73728
  v_mfma_f32_16x16x32_bf16 v[52:55], a[148:151], v[28:31], v[52:55]
  ds_read_b64_tr_b16 a[174:175], v10 offset:63488
  buffer_load_dwordx4 v6, s[4:7], s46 offen lds
  s_waitcnt lgkmcnt(8)
  v_mfma_f32_16x16x32_bf16 v[64:67], a[152:155], v[24:27], v[64:67]
k4_part_w7:
  s_cbranch_execz k4_part_wr
  v_add_u32 v7, 65536, v7
  ds_read_b64_tr_b16 a[144:145], v7 offset:0
  v_mfma_f32_16x16x32_bf16 v[68:71], a[152:155], v[28:31], v[68:71]
  ds_read_b64_tr_b16 a[146:147], v7 offset:2048
  v_mfma_f32_16x16x32_bf16 v[80:83], a[156:159], v[24:27], v[80:83]
  v_add_u32 v8, 65536, v8
  ds_read_b64_tr_b16 a[148:149], v8 offset:0
  buffer_load_dwordx2 v[100:101], v16, s[8:11], s23 offen
  v_mfma_f32_16x16x32_bf16 v[84:87], a[156:159], v[28:31], v[84:87]
  ds_read_b64_tr_b16 a[150:151], v8 offset:2048
  s_add_u32 m0, s27, 82944
  s_add_u32 s46, s46, 36864
  s_waitcnt lgkmcnt(8)
  v_mfma_f32_16x16x32_bf16 v[32:35], a[160:163], v[40:43], v[32:35]
  v_add_u32 v9, 65536, v9
  ds_read_b64_tr_b16 a[152:153], v9 offset:0
  buffer_load_dwordx4 v6, s[4:7], s46 offen lds
  v_mfma_f32_16x16x32_bf16 v[36:39], a[160:163], v[44:47], v[36:39]
  ds_read_b64_tr_b16 a[154:155], v9 offset:2048
  buffer_load_dwordx4 v[120:123], v2, s[8:11], s22 offen offset:0
  v_mfma_f32_16x16x32_bf16 v[48:51], a[164:167], v[40:43], v[48:51]
  v_add_u32 v10, 65536, v10
  ds_read_b64_tr_b16 a[156:157], v10 offset:0
  buffer_load_dwordx4 v[124:127], v2, s[8:11], s22 offen offset:1024
  v_mfma_f32_16x16x32_bf16 v[52:55], a[164:167], v[44:47], v[52:55]
  ds_read_b64_tr_b16 a[158:159], v10 offset:2048
  s_add_u32 m0, s27, 87040
  s_xor_b32 s46, s45, 53248
  s_waitcnt lgkmcnt(8)
  v_mfma_f32_16x16x32_bf16 v[64:67], a[168:171], v[40:43], v[64:67]
  ds_read_b64_tr_b16 a[160:161], v7 offset:4096
  buffer_load_dwordx4 v0, s[8:11], s46 offen lds
  v_mfma_f32_16x16x32_bf16 v[68:71], a[168:171], v[44:47], v[68:71]
  ds_read_b64_tr_b16 a[162:163], v7 offset:6144
  s_movk_i32 s28, 0x3f80
  v_mfma_f32_16x16x32_bf16 v[80:83], a[172:175], v[40:43], v[80:83]
  ds_read_b64_tr_b16 a[164:165], v8 offset:4096
  v_and_b32 v135, 1, v1
  v_mfma_f32_16x16x32_bf16 v[84:87], a[172:175], v[44:47], v[84:87]
  ds_read_b64_tr_b16 a[166:167], v8 offset:6144
  s_waitcnt lgkmcnt(8)
  v_mfma_f32_16x16x32_bf16 v[32:35], a[144:147], v[216:219], v[32:35]
  ds_read_b64_tr_b16 a[168:169], v9 offset:4096
  v_lshlrev_b32 v135, 4, v135
  v_mfma_f32_16x16x32_bf16 v[36:39], a[144:147], v[220:223], v[36:39]
  ds_read_b64_tr_b16 a[170:171], v9 offset:6144
  s_add_u32 s48, s81, 4096
  buffer_load_dwordx4 a[8:11], v2, s[8:11], s48 offen offset:3072
  v_mfma_f32_16x16x32_bf16 v[48:51], a[148:151], v[216:219], v[48:51]
  ds_read_b64_tr_b16 a[172:173], v10 offset:4096
  v_lshlrev_b32 v135, v135, s28
  v_mfma_f32_16x16x32_bf16 v[52:55], a[148:151], v[220:223], v[52:55]
  ds_read_b64_tr_b16 a[174:175], v10 offset:6144
  s_waitcnt lgkmcnt(8)
  v_mfma_f32_16x16x32_bf16 v[64:67], a[152:155], v[216:219], v[64:67]
  ds_read_b64_tr_b16 a[144:145], v7 offset:8192
  s_add_u32 m0, s27, 91136
  v_mfma_f32_16x16x32_bf16 v[68:71], a[152:155], v[220:223], v[68:71]
  ds_read_b64_tr_b16 a[146:147], v7 offset:10240
  buffer_load_dwordx4 v6, s[4:7], s17 offen lds
  v_mfma_f32_16x16x32_bf16 v[80:83], a[156:159], v[216:219], v[80:83]
  ds_read_b64_tr_b16 a[148:149], v8 offset:8192
  v_bfe_u32 v134, v1, 1, 1
  v_mfma_f32_16x16x32_bf16 v[84:87], a[156:159], v[220:223], v[84:87]
  ds_read_b64_tr_b16 a[150:151], v8 offset:10240
  s_waitcnt lgkmcnt(8)
  v_mfma_f32_16x16x32_bf16 v[32:35], a[160:163], v[56:59], v[32:35]
  ds_read_b64_tr_b16 a[152:153], v9 offset:8192
  v_bfe_u32 v136, v1, 3, 1
  v_mfma_f32_16x16x32_bf16 v[36:39], a[160:163], v[60:63], v[36:39]
  ds_read_b64_tr_b16 a[154:155], v9 offset:10240
  s_add_u32 m0, s27, 95232
  s_add_u32 s46, s17, 36864
  v_mfma_f32_16x16x32_bf16 v[48:51], a[164:167], v[56:59], v[48:51]
  ds_read_b64_tr_b16 a[156:157], v10 offset:8192
  buffer_load_dwordx4 v6, s[4:7], s46 offen lds
  v_mfma_f32_16x16x32_bf16 v[52:55], a[164:167], v[60:63], v[52:55]
  ds_read_b64_tr_b16 a[158:159], v10 offset:10240
  s_waitcnt lgkmcnt(8)
  v_mfma_f32_16x16x32_bf16 v[64:67], a[168:171], v[56:59], v[64:67]
  ds_read_b64_tr_b16 a[160:161], v7 offset:12288
  v_lshl_add_u32 v134, v136, 1, v134
  v_mfma_f32_16x16x32_bf16 v[68:71], a[168:171], v[60:63], v[68:71]
  ds_read_b64_tr_b16 a[162:163], v7 offset:14336
  s_add_u32 m0, s27, 99328
  s_xor_b32 s46, s45, 24576
  v_mfma_f32_16x16x32_bf16 v[80:83], a[172:175], v[56:59], v[80:83]
  ds_read_b64_tr_b16 a[164:165], v8 offset:12288
  buffer_load_dwordx4 v0, s[8:11], s46 offen lds
  v_mfma_f32_16x16x32_bf16 v[84:87], a[172:175], v[60:63], v[84:87]
  ds_read_b64_tr_b16 a[166:167], v8 offset:14336
  s_waitcnt lgkmcnt(8)
  v_mfma_f32_16x16x32_bf16 v[32:35], a[144:147], v[72:75], v[32:35]
  ds_read_b64_tr_b16 a[168:169], v9 offset:12288
  v_and_b32 v136, 4, v1
  v_mfma_f32_16x16x32_bf16 v[36:39], a[144:147], v[76:79], v[36:39]
  ds_read_b64_tr_b16 a[170:171], v9 offset:14336
  v_add_u32 v134, v134, v136
  v_mfma_f32_16x16x32_bf16 v[48:51], a[148:151], v[72:75], v[48:51]
  ds_read_b64_tr_b16 a[172:173], v10 offset:12288
  s_add_u32 m0, s27, 103424
  v_mfma_f32_16x16x32_bf16 v[52:55], a[148:151], v[76:79], v[52:55]
  ds_read_b64_tr_b16 a[174:175], v10 offset:14336
  buffer_load_dwordx4 v6, s[4:7], s18 offen lds
  s_waitcnt lgkmcnt(8)
  v_mfma_f32_16x16x32_bf16 v[64:67], a[152:155], v[72:75], v[64:67]
  s_waitcnt vmcnt(40)
  s_barrier
  v_add_u32 v7, -131072, v7
  ds_read_b64_tr_b16 a[144:145], v7 offset:0
  v_cmp_eq_u32 s[98:99], 0, v134
  v_mfma_f32_16x16x32_bf16 v[68:71], a[152:155], v[76:79], v[68:71]
  ds_read_b64_tr_b16 a[146:147], v7 offset:2048
  v_cndmask_b32 v96, 0, v135, s[98:99]
  v_mfma_f32_16x16x32_bf16 v[80:83], a[156:159], v[72:75], v[80:83]
  v_add_u32 v8, -131072, v8
  ds_read_b64_tr_b16 a[148:149], v8 offset:0
  s_add_u32 m0, s27, 107520
  s_add_u32 s46, s18, 36864
  v_mfma_f32_16x16x32_bf16 v[84:87], a[156:159], v[76:79], v[84:87]
  ds_read_b64_tr_b16 a[150:151], v8 offset:2048
  buffer_load_dwordx4 v6, s[4:7], s46 offen lds
  s_waitcnt lgkmcnt(8)
  v_mfma_f32_16x16x32_bf16 v[152:155], a[160:163], v[216:219], v[152:155]
  v_add_u32 v9, -131072, v9
  ds_read_b64_tr_b16 a[152:153], v9 offset:0
  v_cmp_eq_u32 s[98:99], 1, v134
  v_mfma_f32_16x16x32_bf16 v[156:159], a[160:163], v[220:223], v[156:159]
  ds_read_b64_tr_b16 a[154:155], v9 offset:2048
  v_cndmask_b32 v97, 0, v135, s[98:99]
  v_mfma_f32_16x16x32_bf16 v[160:163], a[164:167], v[216:219], v[160:163]
  v_add_u32 v10, -131072, v10
  ds_read_b64_tr_b16 a[156:157], v10 offset:0
  v_cmp_eq_u32 s[98:99], 2, v134
  v_mfma_f32_16x16x32_bf16 v[164:167], a[164:167], v[220:223], v[164:167]
  ds_read_b64_tr_b16 a[158:159], v10 offset:2048
  v_cvt_pk_bf16_f32 v32, v32, v33
  v_cvt_pk_bf16_f32 v33, v34, v35
  v_cvt_pk_bf16_f32 v34, v48, v49
  v_cvt_pk_bf16_f32 v35, v50, v51
  s_waitcnt lgkmcnt(8)
  v_mfma_f32_16x16x32_bf16 v[168:171], a[168:171], v[216:219], v[168:171]
  ds_read_b64_tr_b16 a[160:161], v7 offset:4096
  buffer_store_dwordx4 v[32:35], v2, s[8:11], s49 offen offset:0 sc1
  v_mfma_f32_16x16x32_bf16 v[172:175], a[168:171], v[220:223], v[172:175]
  ds_read_b64_tr_b16 a[162:163], v7 offset:6144
  v_cndmask_b32 v98, 0, v135, s[98:99]
  v_mfma_f32_16x16x32_bf16 v[176:179], a[172:175], v[216:219], v[176:179]
  ds_read_b64_tr_b16 a[164:165], v8 offset:4096
  v_cmp_eq_u32 s[98:99], 3, v134
  v_mfma_f32_16x16x32_bf16 v[180:183], a[172:175], v[220:223], v[180:183]
  ds_read_b64_tr_b16 a[166:167], v8 offset:6144
  v_cvt_pk_bf16_f32 v36, v36, v37
  s_waitcnt lgkmcnt(8)
  v_mfma_f32_16x16x32_bf16 v[152:155], a[144:147], v[56:59], v[152:155]
  ds_read_b64_tr_b16 a[168:169], v9 offset:4096
  s_add_u32 s91, s80, 8192
  buffer_load_dwordx4 a[16:19], v2, s[8:11], s91 offen offset:0
  v_mfma_f32_16x16x32_bf16 v[156:159], a[144:147], v[60:63], v[156:159]
  ds_read_b64_tr_b16 a[170:171], v9 offset:6144
  v_cndmask_b32 v99, 0, v135, s[98:99]
  v_mfma_f32_16x16x32_bf16 v[160:163], a[148:151], v[56:59], v[160:163]
  ds_read_b64_tr_b16 a[172:173], v10 offset:4096
  v_lshrrev_b32 v134, 3, v1
  v_mfma_f32_16x16x32_bf16 v[164:167], a[148:151], v[60:63], v[164:167]
  ds_read_b64_tr_b16 a[174:175], v10 offset:6144
  v_cvt_pk_bf16_f32 v37, v38, v39
  s_waitcnt lgkmcnt(8)
  v_mfma_f32_16x16x32_bf16 v[168:171], a[152:155], v[56:59], v[168:171]
  v_add_u32 v11, -24576, v11
  ds_read_b64_tr_b16 a[144:145], v11 offset:0
  v_and_b32 v134, 6, v134
  v_mfma_f32_16x16x32_bf16 v[172:175], a[152:155], v[60:63], v[172:175]
  ds_read_b64_tr_b16 a[146:147], v11 offset:1024
  s_add_u32 s91, s81, 8192
  buffer_load_dwordx4 a[20:23], v2, s[8:11], s91 offen offset:0
  v_mfma_f32_16x16x32_bf16 v[176:179], a[156:159], v[56:59], v[176:179]
  v_add_u32 v12, -24576, v12
  ds_read_b64_tr_b16 a[148:149], v12 offset:0
  v_bfe_u32 v136, v1, 1, 3
  v_mfma_f32_16x16x32_bf16 v[180:183], a[156:159], v[60:63], v[180:183]
  ds_read_b64_tr_b16 a[150:151], v12 offset:1024
  v_cvt_pk_bf16_f32 v38, v52, v53
  s_waitcnt lgkmcnt(8)
  v_mfma_f32_16x16x32_bf16 v[152:155], a[160:163], v[72:75], v[152:155]
  ds_read_b64_tr_b16 a[152:153], v11 offset:2048
  v_xor_b32 v134, v134, v136
  v_mfma_f32_16x16x32_bf16 v[156:159], a[160:163], v[76:79], v[156:159]
  ds_read_b64_tr_b16 a[154:155], v11 offset:3072
  s_add_u32 s91, s82, 8192
  buffer_load_dwordx4 a[24:27], v2, s[8:11], s91 offen offset:0
  v_mfma_f32_16x16x32_bf16 v[160:163], a[164:167], v[72:75], v[160:163]
  ds_read_b64_tr_b16 a[156:157], v12 offset:2048
  v_mov_b32 v128, 0
  v_mfma_f32_16x16x32_bf16 v[164:167], a[164:167], v[76:79], v[164:167]
  ds_read_b64_tr_b16 a[158:159], v12 offset:3072
  v_cvt_pk_bf16_f32 v39, v54, v55
  s_waitcnt lgkmcnt(8)
  v_mfma_f32_16x16x32_bf16 v[168:171], a[168:171], v[72:75], v[168:171]
  ds_read_b64_tr_b16 a[160:161], v11 offset:4096
  v_mov_b32 v129, 0
  v_mfma_f32_16x16x32_bf16 v[172:175], a[168:171], v[76:79], v[172:175]
  ds_read_b64_tr_b16 a[162:163], v11 offset:5120
  v_mov_b32 v132, 0
  v_mfma_f32_16x16x32_bf16 v[176:179], a[172:175], v[72:75], v[176:179]
  ds_read_b64_tr_b16 a[164:165], v12 offset:4096
  s_add_u32 s91, s80, 8192
  buffer_load_dwordx4 a[28:31], v2, s[8:11], s91 offen offset:1024
  v_mfma_f32_16x16x32_bf16 v[180:183], a[172:175], v[76:79], v[180:183]
  ds_read_b64_tr_b16 a[166:167], v12 offset:5120
  v_cvt_pk_bf16_f32 v64, v64, v65
  s_waitcnt lgkmcnt(8)
  v_mfma_f32_16x16x32_bf16 v[224:227], a[144:147], v[24:27], v[224:227]
  ds_read_b64_tr_b16 a[168:169], v11 offset:6144
  v_mov_b32 v133, 0
  v_mfma_f32_16x16x32_bf16 v[228:231], a[144:147], v[28:31], v[228:231]
  ds_read_b64_tr_b16 a[170:171], v11 offset:7168
  v_cmp_eq_u32 s[98:99], 0, v134
  v_mfma_f32_16x16x32_bf16 v[232:235], a[148:151], v[24:27], v[232:235]
  ds_read_b64_tr_b16 a[172:173], v12 offset:6144
  buffer_store_dwordx4 v[36:39], v2, s[8:11], s49 offen offset:1024 sc1
  v_mfma_f32_16x16x32_bf16 v[236:239], a[148:151], v[28:31], v[236:239]
  ds_read_b64_tr_b16 a[174:175], v12 offset:7168
  v_cvt_pk_bf16_f32 v65, v66, v67
  s_waitcnt lgkmcnt(8)
  v_mfma_f32_16x16x32_bf16 v[224:227], a[152:155], v[40:43], v[224:227]
  ds_read_b64_tr_b16 a[144:145], v7 offset:16384
  v_cndmask_b32 v130, 0, v135, s[98:99]
  v_mfma_f32_16x16x32_bf16 v[228:231], a[152:155], v[44:47], v[228:231]
  ds_read_b64_tr_b16 a[146:147], v7 offset:18432
  v_cmp_eq_u32 s[98:99], 1, v134
  v_mfma_f32_16x16x32_bf16 v[232:235], a[156:159], v[40:43], v[232:235]
  ds_read_b64_tr_b16 a[148:149], v8 offset:16384
  v_cndmask_b32 v131, 0, v135, s[98:99]
  v_mfma_f32_16x16x32_bf16 v[236:239], a[156:159], v[44:47], v[236:239]
  ds_read_b64_tr_b16 a[150:151], v8 offset:18432
  s_add_u32 s48, s82, 4096
  buffer_load_dwordx4 a[12:15], v2, s[8:11], s48 offen offset:3072
  s_waitcnt lgkmcnt(8)
  v_mfma_f32_16x16x32_bf16 v[224:227], a[160:163], v[56:59], v[224:227]
  ds_read_b64_tr_b16 a[152:153], v9 offset:16384
  v_and_b32 v134, 16, v1
  v_mfma_f32_16x16x32_bf16 v[228:231], a[160:163], v[60:63], v[228:231]
  ds_read_b64_tr_b16 a[154:155], v9 offset:18432
  v_lshrrev_b32 v135, 5, v1
  v_mfma_f32_16x16x32_bf16 v[232:235], a[164:167], v[56:59], v[232:235]
  ds_read_b64_tr_b16 a[156:157], v10 offset:16384
  v_lshlrev_b32 v135, 4, v135
  v_mfma_f32_16x16x32_bf16 v[236:239], a[164:167], v[60:63], v[236:239]
  ds_read_b64_tr_b16 a[158:159], v10 offset:18432
  s_add_u32 s91, s81, 8192
  buffer_load_dwordx4 a[32:35], v2, s[8:11], s91 offen offset:1024
  s_waitcnt lgkmcnt(8)
  v_mfma_f32_16x16x32_bf16 v[224:227], a[168:171], v[72:75], v[224:227]
  ds_read_b64_tr_b16 a[160:161], v7 offset:20480
  v_sub_u32 v134, v134, v135
  v_mfma_f32_16x16x32_bf16 v[228:231], a[168:171], v[76:79], v[228:231]
  ds_read_b64_tr_b16 a[162:163], v7 offset:22528
  v_add_u32 v102, v15, v134
  v_mfma_f32_16x16x32_bf16 v[232:235], a[172:175], v[72:75], v[232:235]
  ds_read_b64_tr_b16 a[164:165], v8 offset:20480
  s_bitcmp1_b32 s21, 0
  s_cselect_b64 s[98:99], -1, 0
  v_mfma_f32_16x16x32_bf16 v[236:239], a[172:175], v[76:79], v[236:239]
  ds_read_b64_tr_b16 a[166:167], v8 offset:22528
  v_cvt_pk_bf16_f32 v66, v80, v81
  s_waitcnt vmcnt(63) lgkmcnt(8)
  v_mfma_f32_16x16x32_bf16 v[152:155], a[144:147], a[176:179], v[152:155]
  ds_read_b64_tr_b16 a[168:169], v9 offset:20480
  s_add_u32 s91, s82, 8192
  buffer_load_dwordx4 a[36:39], v2, s[8:11], s91 offen offset:1024
  s_waitcnt vmcnt(63)
  v_mfma_f32_16x16x32_bf16 v[156:159], a[144:147], a[188:191], v[156:159]
  ds_read_b64_tr_b16 a[170:171], v9 offset:22528
  v_cndmask_b32 v103, v20, v21, s[98:99]
  v_mfma_f32_16x16x32_bf16 v[160:163], a[148:151], a[176:179], v[160:163]
  ds_read_b64_tr_b16 a[172:173], v10 offset:20480
  v_cndmask_b32 v136, v18, v19, s[98:99]
  v_mfma_f32_16x16x32_bf16 v[164:167], a[148:151], a[188:191], v[164:167]
  ds_read_b64_tr_b16 a[174:175], v10 offset:22528
  s_add_u32 m0, s27, 111616
  s_xor_b32 s46, s45, 40960
  s_waitcnt lgkmcnt(8)
  v_mfma_f32_16x16x32_bf16 v[168:171], a[152:155], a[176:179], v[168:171]
  ds_read_b64_tr_b16 a[144:145], v11 offset:16384
  buffer_load_dwordx4 v0, s[8:11], s46 offen lds
  v_mfma_f32_16x16x32_bf16 v[172:175], a[152:155], a[188:191], v[172:175]
  ds_read_b64_tr_b16 a[146:147], v11 offset:17408
  v_cvt_pk_bf16_f32 v67, v82, v83
  v_mfma_f32_16x16x32_bf16 v[176:179], a[156:159], a[176:179], v[176:179]
  ds_read_b64_tr_b16 a[148:149], v12 offset:16384
  v_cvt_pk_bf16_f32 v68, v68, v69
  v_mfma_f32_16x16x32_bf16 v[180:183], a[156:159], a[188:191], v[180:183]
  ds_read_b64_tr_b16 a[150:151], v12 offset:17408
  v_cvt_pk_bf16_f32 v69, v70, v71
  s_waitcnt vmcnt(63) lgkmcnt(8)
  v_mfma_f32_16x16x32_bf16 v[152:155], a[160:163], a[200:203], v[152:155]
  ds_read_b64_tr_b16 a[152:153], v11 offset:18432
  v_cvt_pk_bf16_f32 v70, v84, v85
  s_waitcnt vmcnt(49)
  v_mfma_f32_16x16x32_bf16 v[156:159], a[160:163], a[212:215], v[156:159]
  ds_read_b64_tr_b16 a[154:155], v11 offset:19456
  buffer_store_dwordx4 v[64:67], v2, s[8:11], s49 offen offset:2048 sc1
  v_mfma_f32_16x16x32_bf16 v[160:163], a[164:167], a[200:203], v[160:163]
  ds_read_b64_tr_b16 a[156:157], v12 offset:18432
  v_cvt_pk_bf16_f32 v71, v86, v87
  v_mfma_f32_16x16x32_bf16 v[164:167], a[164:167], a[212:215], v[164:167]
  ds_read_b64_tr_b16 a[158:159], v12 offset:19456
  s_waitcnt lgkmcnt(8)
  v_mfma_f32_16x16x32_bf16 v[168:171], a[168:171], a[200:203], v[168:171]
  ds_read_b64_tr_b16 a[160:161], v7 offset:28672
  v_mfma_f32_16x16x32_bf16 v[172:175], a[168:171], a[212:215], v[172:175]
  ds_read_b64_tr_b16 a[162:163], v7 offset:30720
  s_add_u32 s91, s80, 8192
  buffer_load_dwordx4 a[40:43], v2, s[8:11], s91 offen offset:2048
  v_mfma_f32_16x16x32_bf16 v[176:179], a[172:175], a[200:203], v[176:179]
  ds_read_b64_tr_b16 a[164:165], v8 offset:28672
  v_mfma_f32_16x16x32_bf16 v[180:183], a[172:175], a[212:215], v[180:183]
  ds_read_b64_tr_b16 a[166:167], v8 offset:30720
  s_waitcnt lgkmcnt(8)
  v_mfma_f32_16x16x32_bf16 v[224:227], a[144:147], a[176:179], v[224:227]
  ds_read_b64_tr_b16 a[168:169], v9 offset:28672
  v_mfma_f32_16x16x32_bf16 v[228:231], a[144:147], a[188:191], v[228:231]
  ds_read_b64_tr_b16 a[170:171], v9 offset:30720
  s_add_u32 m0, s27, 115712
  v_mfma_f32_16x16x32_bf16 v[232:235], a[148:151], a[176:179], v[232:235]
  ds_read_b64_tr_b16 a[172:173], v10 offset:28672
  buffer_load_dwordx4 v6, s[4:7], s19 offen lds
  v_mfma_f32_16x16x32_bf16 v[236:239], a[148:151], a[188:191], v[236:239]
  ds_read_b64_tr_b16 a[174:175], v10 offset:30720
  s_waitcnt vmcnt(25)
  s_mov_b64 exec, 1
  buffer_store_dword v7, off, s[8:11], s83 offset:512 sc1
  s_mov_b64 exec, -1
  s_waitcnt lgkmcnt(8)
  v_mfma_f32_16x16x32_bf16 v[224:227], a[152:155], a[200:203], v[224:227]
  ds_read_b64_tr_b16 a[144:145], v7 offset:32768
  v_mfma_f32_16x16x32_bf16 v[228:231], a[152:155], a[212:215], v[228:231]
  ds_read_b64_tr_b16 a[146:147], v7 offset:34816
  v_mfma_f32_16x16x32_bf16 v[232:235], a[156:159], a[200:203], v[232:235]
  ds_read_b64_tr_b16 a[148:149], v8 offset:32768
  s_add_u32 s91, s81, 8192
  buffer_load_dwordx4 a[44:47], v2, s[8:11], s91 offen offset:2048
  v_mfma_f32_16x16x32_bf16 v[236:239], a[156:159], a[212:215], v[236:239]
  ds_read_b64_tr_b16 a[150:151], v8 offset:34816
  s_waitcnt vmcnt(50) lgkmcnt(8)
  v_mfma_f32_16x16x32_bf16 v[152:155], a[160:163], a[224:227], v[152:155]
  ds_read_b64_tr_b16 a[152:153], v9 offset:32768
  s_waitcnt vmcnt(42)
  v_mfma_f32_16x16x32_bf16 v[156:159], a[160:163], a[236:239], v[156:159]
  ds_read_b64_tr_b16 a[154:155], v9 offset:34816
  v_mfma_f32_16x16x32_bf16 v[160:163], a[164:167], a[224:227], v[160:163]
  ds_read_b64_tr_b16 a[156:157], v10 offset:32768
  s_add_u32 m0, s27, 119808
  s_add_u32 s46, s19, 36864
  v_mfma_f32_16x16x32_bf16 v[164:167], a[164:167], a[236:239], v[164:167]
  ds_read_b64_tr_b16 a[158:159], v10 offset:34816
  buffer_load_dwordx4 v6, s[4:7], s46 offen lds
  s_waitcnt lgkmcnt(8)
  v_mfma_f32_16x16x32_bf16 v[168:171], a[168:171], a[224:227], v[168:171]
  s_waitcnt vmcnt(32)
  s_barrier
  ds_read_b64_tr_b16 a[160:161], v11 offset:28672
  v_mfma_f32_16x16x32_bf16 v[172:175], a[168:171], a[236:239], v[172:175]
  ds_read_b64_tr_b16 a[162:163], v11 offset:29696
  v_mfma_f32_16x16x32_bf16 v[176:179], a[172:175], a[224:227], v[176:179]
  ds_read_b64_tr_b16 a[164:165], v12 offset:28672
  v_mfma_f32_16x16x32_bf16 v[180:183], a[172:175], a[236:239], v[180:183]
  ds_read_b64_tr_b16 a[166:167], v12 offset:29696
  s_add_u32 s91, s82, 8192
  buffer_load_dwordx4 a[48:51], v2, s[8:11], s91 offen offset:2048
  s_waitcnt vmcnt(37) lgkmcnt(8)
  v_mfma_f32_16x16x32_bf16 v[152:155], a[144:147], a[248:251], v[152:155]
  ds_read_b64_tr_b16 a[168:169], v11 offset:30720
  s_waitcnt vmcnt(31)
  v_mfma_f32_16x16x32_bf16 v[156:159], a[144:147], a[4:7], v[156:159]
  ds_read_b64_tr_b16 a[170:171], v11 offset:31744
  v_mfma_f32_16x16x32_bf16 v[160:163], a[148:151], a[248:251], v[160:163]
  ds_read_b64_tr_b16 a[172:173], v12 offset:30720
  v_mfma_f32_16x16x32_bf16 v[164:167], a[148:151], a[4:7], v[164:167]
  ds_read_b64_tr_b16 a[174:175], v12 offset:31744
  s_waitcnt lgkmcnt(8)
  v_mfma_f32_16x16x32_bf16 v[168:171], a[152:155], a[248:251], v[168:171]
  ds_read_b64_tr_b16 a[144:145], v7 offset:40960
  buffer_store_dwordx4 v[68:71], v2, s[8:11], s49 offen offset:3072 sc1
  s_add_u32 s49, s49, 4096
  v_mfma_f32_16x16x32_bf16 v[172:175], a[152:155], a[4:7], v[172:175]
  ds_read_b64_tr_b16 a[146:147], v7 offset:43008
  v_mfma_f32_16x16x32_bf16 v[176:179], a[156:159], a[248:251], v[176:179]
  ds_read_b64_tr_b16 a[148:149], v8 offset:40960
  v_mfma_f32_16x16x32_bf16 v[180:183], a[156:159], a[4:7], v[180:183]
  ds_read_b64_tr_b16 a[150:151], v8 offset:43008
  s_add_u32 m0, s27, 123904
  s_xor_b32 s46, s45, 57344
  s_waitcnt lgkmcnt(8)
  v_mfma_f32_16x16x32_bf16 v[224:227], a[160:163], a[224:227], v[224:227]
  ds_read_b64_tr_b16 a[152:153], v9 offset:40960
  buffer_load_dwordx4 v0, s[8:11], s46 offen lds
  v_mfma_f32_16x16x32_bf16 v[228:231], a[160:163], a[236:239], v[228:231]
  ds_read_b64_tr_b16 a[154:155], v9 offset:43008
  v_mfma_f32_16x16x32_bf16 v[232:235], a[164:167], a[224:227], v[232:235]
  ds_read_b64_tr_b16 a[156:157], v10 offset:40960
  v_mfma_f32_16x16x32_bf16 v[236:239], a[164:167], a[236:239], v[236:239]
  ds_read_b64_tr_b16 a[158:159], v10 offset:43008
  s_waitcnt lgkmcnt(8)
  v_mfma_f32_16x16x32_bf16 v[224:227], a[168:171], a[248:251], v[224:227]
  ds_read_b64_tr_b16 a[160:161], v7 offset:45056
  v_mfma_f32_16x16x32_bf16 v[228:231], a[168:171], a[4:7], v[228:231]
  ds_read_b64_tr_b16 a[162:163], v7 offset:47104
  s_add_u32 s91, s80, 8192
  buffer_load_dwordx4 a[52:55], v2, s[8:11], s91 offen offset:3072
  v_mfma_f32_16x16x32_bf16 v[232:235], a[172:175], a[248:251], v[232:235]
  ds_read_b64_tr_b16 a[164:165], v8 offset:45056
  v_mfma_f32_16x16x32_bf16 v[236:239], a[172:175], a[4:7], v[236:239]
  ds_read_b64_tr_b16 a[166:167], v8 offset:47104
  s_waitcnt vmcnt(63) lgkmcnt(8)
  v_mfma_f32_16x16x32_bf16 v[152:155], a[144:147], a[180:183], v[152:155]
  ds_read_b64_tr_b16 a[168:169], v9 offset:45056
  s_add_u32 m0, s27, 128000
  s_add_u32 s46, s17, 73728
  s_waitcnt vmcnt(63)
  v_mfma_f32_16x16x32_bf16 v[156:159], a[144:147], a[192:195], v[156:159]
  ds_read_b64_tr_b16 a[170:171], v9 offset:47104
  buffer_load_dwordx4 v6, s[4:7], s46 offen lds
  v_mfma_f32_16x16x32_bf16 v[160:163], a[148:151], a[180:183], v[160:163]
  ds_read_b64_tr_b16 a[172:173], v10 offset:45056
  v_mfma_f32_16x16x32_bf16 v[164:167], a[148:151], a[192:195], v[164:167]
  ds_read_b64_tr_b16 a[174:175], v10 offset:47104
  s_waitcnt lgkmcnt(8)
  v_mfma_f32_16x16x32_bf16 v[168:171], a[152:155], a[180:183], v[168:171]
  ds_read_b64_tr_b16 a[144:145], v11 offset:40960
  v_mfma_f32_16x16x32_bf16 v[172:175], a[152:155], a[192:195], v[172:175]
  ds_read_b64_tr_b16 a[146:147], v11 offset:41984
  s_add_u32 m0, s27, 132096
  s_add_u32 s46, s46, 36864
  v_mfma_f32_16x16x32_bf16 v[176:179], a[156:159], a[180:183], v[176:179]
  ds_read_b64_tr_b16 a[148:149], v12 offset:40960
  buffer_load_dwordx4 v6, s[4:7], s46 offen lds
  v_mfma_f32_16x16x32_bf16 v[180:183], a[156:159], a[192:195], v[180:183]
  ds_read_b64_tr_b16 a[150:151], v12 offset:41984
  s_waitcnt vmcnt(63) lgkmcnt(8)
  v_mfma_f32_16x16x32_bf16 v[152:155], a[160:163], a[204:207], v[152:155]
  ds_read_b64_tr_b16 a[152:153], v11 offset:43008
  s_waitcnt vmcnt(59)
  v_mfma_f32_16x16x32_bf16 v[156:159], a[160:163], a[216:219], v[156:159]
  ds_read_b64_tr_b16 a[154:155], v11 offset:44032
  s_add_u32 m0, s27, 136192
  v_mfma_f32_16x16x32_bf16 v[160:163], a[164:167], a[204:207], v[160:163]
  ds_read_b64_tr_b16 a[156:157], v12 offset:43008
  buffer_load_dwordx4 v6, s[4:7], s41 offen lds
  v_mfma_f32_16x16x32_bf16 v[164:167], a[164:167], a[216:219], v[164:167]
  ds_read_b64_tr_b16 a[158:159], v12 offset:44032
  s_waitcnt lgkmcnt(8)
  v_mfma_f32_16x16x32_bf16 v[168:171], a[168:171], a[204:207], v[168:171]
  ds_read_b64_tr_b16 a[160:161], v7 offset:53248
  v_mfma_f32_16x16x32_bf16 v[172:175], a[168:171], a[216:219], v[172:175]
  ds_read_b64_tr_b16 a[162:163], v7 offset:55296
  v_mfma_f32_16x16x32_bf16 v[176:179], a[172:175], a[204:207], v[176:179]
  ds_read_b64_tr_b16 a[164:165], v8 offset:53248
  s_add_u32 m0, s27, 140288
  s_add_u32 s46, s18, 73728
  v_mfma_f32_16x16x32_bf16 v[180:183], a[172:175], a[216:219], v[180:183]
  ds_read_b64_tr_b16 a[166:167], v8 offset:55296
  buffer_load_dwordx4 v6, s[4:7], s46 offen lds
  s_waitcnt lgkmcnt(8)
  v_mfma_f32_16x16x32_bf16 v[224:227], a[144:147], a[180:183], v[224:227]
  ds_read_b64_tr_b16 a[168:169], v9 offset:53248
  v_mfma_f32_16x16x32_bf16 v[228:231], a[144:147], a[192:195], v[228:231]
  ds_read_b64_tr_b16 a[170:171], v9 offset:55296
  v_mfma_f32_16x16x32_bf16 v[232:235], a[148:151], a[180:183], v[232:235]
  ds_read_b64_tr_b16 a[172:173], v10 offset:53248
  s_add_u32 m0, s27, 144384
  s_add_u32 s46, s46, 36864
  v_mfma_f32_16x16x32_bf16 v[236:239], a[148:151], a[192:195], v[236:239]
  ds_read_b64_tr_b16 a[174:175], v10 offset:55296
  buffer_load_dwordx4 v6, s[4:7], s46 offen lds
  s_waitcnt lgkmcnt(8)
  v_mfma_f32_16x16x32_bf16 v[224:227], a[152:155], a[204:207], v[224:227]
  ds_read_b64_tr_b16 a[144:145], v7 offset:57344
  v_mfma_f32_16x16x32_bf16 v[228:231], a[152:155], a[216:219], v[228:231]
  ds_read_b64_tr_b16 a[146:147], v7 offset:59392
  v_mfma_f32_16x16x32_bf16 v[232:235], a[156:159], a[204:207], v[232:235]
  ds_read_b64_tr_b16 a[148:149], v8 offset:57344
  v_mfma_f32_16x16x32_bf16 v[236:239], a[156:159], a[216:219], v[236:239]
  ds_read_b64_tr_b16 a[150:151], v8 offset:59392
  s_waitcnt vmcnt(59) lgkmcnt(8)
  v_mfma_f32_16x16x32_bf16 v[152:155], a[160:163], a[228:231], v[152:155]
  ds_read_b64_tr_b16 a[152:153], v9 offset:57344
  s_add_u32 s91, s81, 8192
  buffer_load_dwordx4 a[56:59], v2, s[8:11], s91 offen offset:3072
  s_waitcnt vmcnt(50)
  v_mfma_f32_16x16x32_bf16 v[156:159], a[160:163], a[240:243], v[156:159]
  ds_read_b64_tr_b16 a[154:155], v9 offset:59392
  v_mfma_f32_16x16x32_bf16 v[160:163], a[164:167], a[228:231], v[160:163]
  ds_read_b64_tr_b16 a[156:157], v10 offset:57344
  v_mfma_f32_16x16x32_bf16 v[164:167], a[164:167], a[240:243], v[164:167]
  ds_read_b64_tr_b16 a[158:159], v10 offset:59392
  s_waitcnt lgkmcnt(8)
  v_mfma_f32_16x16x32_bf16 v[168:171], a[168:171], a[228:231], v[168:171]
  ds_read_b64_tr_b16 a[160:161], v11 offset:53248
  s_add_u32 s91, s82, 8192
  buffer_load_dwordx4 a[60:63], v2, s[8:11], s91 offen offset:3072
  v_mfma_f32_16x16x32_bf16 v[172:175], a[168:171], a[240:243], v[172:175]
  ds_read_b64_tr_b16 a[162:163], v11 offset:54272
  v_mfma_f32_16x16x32_bf16 v[176:179], a[172:175], a[228:231], v[176:179]
  ds_read_b64_tr_b16 a[164:165], v12 offset:53248
  v_mfma_f32_16x16x32_bf16 v[180:183], a[172:175], a[240:243], v[180:183]
  ds_read_b64_tr_b16 a[166:167], v12 offset:54272
  buffer_load_dword v22, v13, s[8:11], s84 offen offset:512 sc1
  s_waitcnt vmcnt(45) lgkmcnt(8)
  v_mfma_f32_16x16x32_bf16 v[152:155], a[144:147], a[252:255], v[152:155]
  ds_read_b64_tr_b16 a[168:169], v11 offset:55296
  s_add_u32 m0, s27, 1024
  s_waitcnt vmcnt(33)
  v_mfma_f32_16x16x32_bf16 v[156:159], a[144:147], a[8:11], v[156:159]
  ds_read_b64_tr_b16 a[170:171], v11 offset:56320
  buffer_load_dwordx4 v6, s[4:7], s42 offen lds
  v_mfma_f32_16x16x32_bf16 v[160:163], a[148:151], a[252:255], v[160:163]
  ds_read_b64_tr_b16 a[172:173], v12 offset:55296
  v_mfma_f32_16x16x32_bf16 v[164:167], a[148:151], a[8:11], v[164:167]
  ds_read_b64_tr_b16 a[174:175], v12 offset:56320
  s_waitcnt lgkmcnt(8)
  v_mfma_f32_16x16x32_bf16 v[168:171], a[152:155], a[252:255], v[168:171]
  v_add_u32 v7, 65536, v7
  ds_read_b64_tr_b16 a[144:145], v7 offset:0
  s_add_u32 m0, s27, 5120
  s_add_u32 s46, s19, 73728
  v_mfma_f32_16x16x32_bf16 v[172:175], a[152:155], a[8:11], v[172:175]
  ds_read_b64_tr_b16 a[146:147], v7 offset:2048
  buffer_load_dwordx4 v6, s[4:7], s46 offen lds
  v_mfma_f32_16x16x32_bf16 v[176:179], a[156:159], a[252:255], v[176:179]
  v_add_u32 v8, 65536, v8
  ds_read_b64_tr_b16 a[148:149], v8 offset:0
  v_mfma_f32_16x16x32_bf16 v[180:183], a[156:159], a[8:11], v[180:183]
  ds_read_b64_tr_b16 a[150:151], v8 offset:2048
  s_waitcnt lgkmcnt(8)
  v_mfma_f32_16x16x32_bf16 v[224:227], a[160:163], a[228:231], v[224:227]
  v_add_u32 v9, 65536, v9
  ds_read_b64_tr_b16 a[152:153], v9 offset:0
  v_mfma_f32_16x16x32_bf16 v[228:231], a[160:163], a[240:243], v[228:231]
  ds_read_b64_tr_b16 a[154:155], v9 offset:2048
  s_add_u32 m0, s27, 9216
  s_add_u32 s46, s46, 36864
  v_mfma_f32_16x16x32_bf16 v[232:235], a[164:167], a[228:231], v[232:235]
  v_add_u32 v10, 65536, v10
  ds_read_b64_tr_b16 a[156:157], v10 offset:0
  buffer_load_dwordx4 v6, s[4:7], s46 offen lds
  v_mfma_f32_16x16x32_bf16 v[236:239], a[164:167], a[240:243], v[236:239]
  ds_read_b64_tr_b16 a[158:159], v10 offset:2048
k4_part_w8:
  s_cbranch_execz k4_part_wr
  s_waitcnt lgkmcnt(8)
  v_mfma_f32_16x16x32_bf16 v[224:227], a[168:171], a[252:255], v[224:227]
  ds_read_b64_tr_b16 a[160:161], v7 offset:4096
  v_mfma_f32_16x16x32_bf16 v[228:231], a[168:171], a[8:11], v[228:231]
  ds_read_b64_tr_b16 a[162:163], v7 offset:6144
  s_add_u32 m0, s27, 13312
  v_mfma_f32_16x16x32_bf16 v[232:235], a[172:175], a[252:255], v[232:235]
  ds_read_b64_tr_b16 a[164:165], v8 offset:4096
  buffer_load_dwordx4 v6, s[4:7], s43 offen lds
  v_mfma_f32_16x16x32_bf16 v[236:239], a[172:175], a[8:11], v[236:239]
  ds_read_b64_tr_b16 a[166:167], v8 offset:6144
  s_waitcnt vmcnt(63) lgkmcnt(8)
  v_mfma_f32_16x16x32_bf16 v[152:155], a[144:147], a[184:187], v[152:155]
  ds_read_b64_tr_b16 a[168:169], v9 offset:4096
  s_waitcnt vmcnt(63)
  v_mfma_f32_16x16x32_bf16 v[156:159], a[144:147], a[196:199], v[156:159]
  ds_read_b64_tr_b16 a[170:171], v9 offset:6144
  v_mfma_f32_16x16x32_bf16 v[160:163], a[148:151], a[184:187], v[160:163]
  ds_read_b64_tr_b16 a[172:173], v10 offset:4096
  s_add_u32 m0, s27, 17408
  s_xor_b32 s46, s45, 28672
  v_mfma_f32_16x16x32_bf16 v[164:167], a[148:151], a[196:199], v[164:167]
  ds_read_b64_tr_b16 a[174:175], v10 offset:6144
  buffer_load_dwordx4 v0, s[8:11], s46 offen lds
  s_waitcnt lgkmcnt(8)
  v_mfma_f32_16x16x32_bf16 v[168:171], a[152:155], a[184:187], v[168:171]
  s_waitcnt vmcnt(33)
  s_barrier
  v_add_u32 v11, 65536, v11
  ds_read_b64_tr_b16 a[144:145], v11 offset:0
  v_mfma_f32_16x16x32_bf16 v[172:175], a[152:155], a[196:199], v[172:175]
  ds_read_b64_tr_b16 a[146:147], v11 offset:1024
  v_mfma_f32_16x16x32_bf16 v[176:179], a[156:159], a[184:187], v[176:179]
  v_add_u32 v12, 65536, v12
  ds_read_b64_tr_b16 a[148:149], v12 offset:0
  s_add_u32 m0, s27, 21504
  s_xor_b32 s46, s45, 45056
  v_mfma_f32_16x16x32_bf16 v[180:183], a[156:159], a[196:199], v[180:183]
  ds_read_b64_tr_b16 a[150:151], v12 offset:1024
  buffer_load_dwordx4 v0, s[8:11], s46 offen lds
  s_waitcnt vmcnt(63) lgkmcnt(8)
  v_mfma_f32_16x16x32_bf16 v[152:155], a[160:163], a[208:211], v[152:155]
  ds_read_b64_tr_b16 a[152:153], v11 offset:2048
  s_waitcnt vmcnt(63)
  v_mfma_f32_16x16x32_bf16 v[156:159], a[160:163], a[220:223], v[156:159]
  ds_read_b64_tr_b16 a[154:155], v11 offset:3072
  v_mfma_f32_16x16x32_bf16 v[160:163], a[164:167], a[208:211], v[160:163]
  ds_read_b64_tr_b16 a[156:157], v12 offset:2048
  v_mfma_f32_16x16x32_bf16 v[164:167], a[164:167], a[220:223], v[164:167]
  ds_read_b64_tr_b16 a[158:159], v12 offset:3072
  s_add_u32 m0, s27, 25600
  s_xor_b32 s46, s45, 61440
  s_waitcnt lgkmcnt(8)
  v_mfma_f32_16x16x32_bf16 v[168:171], a[168:171], a[208:211], v[168:171]
  ds_read_b64_tr_b16 a[160:161], v7 offset:12288
  buffer_load_dwordx4 v0, s[8:11], s46 offen lds
  v_mfma_f32_16x16x32_bf16 v[172:175], a[168:171], a[220:223], v[172:175]
  ds_read_b64_tr_b16 a[162:163], v7 offset:14336
  v_mfma_f32_16x16x32_bf16 v[176:179], a[172:175], a[208:211], v[176:179]
  ds_read_b64_tr_b16 a[164:165], v8 offset:12288
  v_mfma_f32_16x16x32_bf16 v[180:183], a[172:175], a[220:223], v[180:183]
  ds_read_b64_tr_b16 a[166:167], v8 offset:14336
  s_add_u32 m0, s27, 29696
  s_waitcnt lgkmcnt(8)
  v_mfma_f32_16x16x32_bf16 v[224:227], a[144:147], a[184:187], v[224:227]
  ds_read_b64_tr_b16 a[168:169], v9 offset:12288
  buffer_load_dwordx4 v0, s[8:11], s0 offen lds
  v_mfma_f32_16x16x32_bf16 v[228:231], a[144:147], a[196:199], v[228:231]
  ds_read_b64_tr_b16 a[170:171], v9 offset:14336
  v_mfma_f32_16x16x32_bf16 v[232:235], a[148:151], a[184:187], v[232:235]
  ds_read_b64_tr_b16 a[172:173], v10 offset:12288
  v_mfma_f32_16x16x32_bf16 v[236:239], a[148:151], a[196:199], v[236:239]
  ds_read_b64_tr_b16 a[174:175], v10 offset:14336
  s_waitcnt lgkmcnt(8)
  v_mfma_f32_16x16x32_bf16 v[224:227], a[152:155], a[208:211], v[224:227]
  ds_read_b64_tr_b16 a[144:145], v7 offset:16384
  s_add_u32 m0, s27, 33792
  v_mfma_f32_16x16x32_bf16 v[228:231], a[152:155], a[220:223], v[228:231]
  ds_read_b64_tr_b16 a[146:147], v7 offset:18432
  buffer_load_dwordx4 v0, s[8:11], s1 offen lds
  v_mfma_f32_16x16x32_bf16 v[232:235], a[156:159], a[208:211], v[232:235]
  ds_read_b64_tr_b16 a[148:149], v8 offset:16384
  v_mfma_f32_16x16x32_bf16 v[236:239], a[156:159], a[220:223], v[236:239]
  ds_read_b64_tr_b16 a[150:151], v8 offset:18432
  s_waitcnt vmcnt(63) lgkmcnt(8)
  v_mfma_f32_16x16x32_bf16 v[152:155], a[160:163], a[232:235], v[152:155]
  ds_read_b64_tr_b16 a[152:153], v9 offset:16384
  s_add_u32 m0, s27, 37888
  s_xor_b32 s46, s45, 0
  s_waitcnt vmcnt(59)
  v_mfma_f32_16x16x32_bf16 v[156:159], a[160:163], a[244:247], v[156:159]
  ds_read_b64_tr_b16 a[154:155], v9 offset:18432
  buffer_load_dwordx4 v3, s[8:11], s46 offen lds
  v_mfma_f32_16x16x32_bf16 v[160:163], a[164:167], a[232:235], v[160:163]
  ds_read_b64_tr_b16 a[156:157], v10 offset:16384
  v_mfma_f32_16x16x32_bf16 v[164:167], a[164:167], a[244:247], v[164:167]
  ds_read_b64_tr_b16 a[158:159], v10 offset:18432
  s_waitcnt lgkmcnt(8)
  v_mfma_f32_16x16x32_bf16 v[168:171], a[168:171], a[232:235], v[168:171]
  ds_read_b64_tr_b16 a[160:161], v11 offset:12288
  v_mfma_f32_16x16x32_bf16 v[172:175], a[168:171], a[244:247], v[172:175]
  ds_read_b64_tr_b16 a[162:163], v11 offset:13312
  s_add_u32 m0, s27, 41984
  s_xor_b32 s46, s45, 16384
  v_mfma_f32_16x16x32_bf16 v[176:179], a[172:175], a[232:235], v[176:179]
  ds_read_b64_tr_b16 a[164:165], v12 offset:12288
  buffer_load_dwordx4 v3, s[8:11], s46 offen lds
  v_mfma_f32_16x16x32_bf16 v[180:183], a[172:175], a[244:247], v[180:183]
  ds_read_b64_tr_b16 a[166:167], v12 offset:13312
  s_waitcnt vmcnt(54) lgkmcnt(8)
  v_mfma_f32_16x16x32_bf16 v[152:155], a[144:147], a[0:3], v[152:155]
  ds_read_b64_tr_b16 a[168:169], v11 offset:14336
  s_waitcnt vmcnt(32)
  v_mfma_f32_16x16x32_bf16 v[156:159], a[144:147], a[12:15], v[156:159]
  ds_read_b64_tr_b16 a[170:171], v11 offset:15360
  s_add_u32 m0, s27, 46080
  s_xor_b32 s46, s45, 32768
  v_mfma_f32_16x16x32_bf16 v[160:163], a[148:151], a[0:3], v[160:163]
  ds_read_b64_tr_b16 a[172:173], v12 offset:14336
  buffer_load_dwordx4 v3, s[8:11], s46 offen lds
  v_mfma_f32_16x16x32_bf16 v[164:167], a[148:151], a[12:15], v[164:167]
  ds_read_b64_tr_b16 a[174:175], v12 offset:15360
  s_waitcnt lgkmcnt(8)
  v_mfma_f32_16x16x32_bf16 v[168:171], a[152:155], a[0:3], v[168:171]
  ds_read_b64_tr_b16 a[144:145], v7 offset:24576
  v_mfma_f32_16x16x32_bf16 v[172:175], a[152:155], a[12:15], v[172:175]
  ds_read_b64_tr_b16 a[146:147], v7 offset:26624
  v_mfma_f32_16x16x32_bf16 v[176:179], a[156:159], a[0:3], v[176:179]
  ds_read_b64_tr_b16 a[148:149], v8 offset:24576
  s_add_u32 m0, s27, 50176
  s_xor_b32 s46, s45, 49152
  v_mfma_f32_16x16x32_bf16 v[180:183], a[156:159], a[12:15], v[180:183]
  ds_read_b64_tr_b16 a[150:151], v8 offset:26624
  buffer_load_dwordx4 v3, s[8:11], s46 offen lds
  s_waitcnt lgkmcnt(8)
  v_mfma_f32_16x16x32_bf16 v[224:227], a[160:163], a[232:235], v[224:227]
  ds_read_b64_tr_b16 a[152:153], v9 offset:24576
  s_waitcnt vmcnt(23)
  s_mov_b64 exec, 1
  buffer_store_dword v7, off, s[8:11], s83 offset:0 sc1
  s_mov_b64 exec, -1
  v_mfma_f32_16x16x32_bf16 v[228:231], a[160:163], a[244:247], v[228:231]
  ds_read_b64_tr_b16 a[154:155], v9 offset:26624
  v_mfma_f32_16x16x32_bf16 v[232:235], a[164:167], a[232:235], v[232:235]
  ds_read_b64_tr_b16 a[156:157], v10 offset:24576
  s_add_u32 m0, s27, 54272
  s_xor_b32 s46, s45, 4096
  v_mfma_f32_16x16x32_bf16 v[236:239], a[164:167], a[244:247], v[236:239]
  ds_read_b64_tr_b16 a[158:159], v10 offset:26624
  buffer_load_dwordx4 v3, s[8:11], s46 offen lds
  s_waitcnt lgkmcnt(8)
  v_mfma_f32_16x16x32_bf16 v[224:227], a[168:171], a[0:3], v[224:227]
  ds_read_b64_tr_b16 a[160:161], v7 offset:28672
  v_mfma_f32_16x16x32_bf16 v[228:231], a[168:171], a[12:15], v[228:231]
  ds_read_b64_tr_b16 a[162:163], v7 offset:30720
  v_mfma_f32_16x16x32_bf16 v[232:235], a[172:175], a[0:3], v[232:235]
  ds_read_b64_tr_b16 a[164:165], v8 offset:28672
  v_mfma_f32_16x16x32_bf16 v[236:239], a[172:175], a[12:15], v[236:239]
  ds_read_b64_tr_b16 a[166:167], v8 offset:30720
  s_add_u32 m0, s27, 58368
  s_xor_b32 s46, s45, 20480
  s_waitcnt vmcnt(41) lgkmcnt(8)
  v_mfma_f32_16x16x32_bf16 v[152:155], a[144:147], a[16:19], v[152:155]
  ds_read_b64_tr_b16 a[168:169], v9 offset:28672
  buffer_load_dwordx4 v3, s[8:11], s46 offen lds
  s_waitcnt vmcnt(39)
  v_mfma_f32_16x16x32_bf16 v[156:159], a[144:147], a[28:31], v[156:159]
  ds_read_b64_tr_b16 a[170:171], v9 offset:30720
  v_mfma_f32_16x16x32_bf16 v[160:163], a[148:151], a[16:19], v[160:163]
  ds_read_b64_tr_b16 a[172:173], v10 offset:28672
  v_mfma_f32_16x16x32_bf16 v[164:167], a[148:151], a[28:31], v[164:167]
  ds_read_b64_tr_b16 a[174:175], v10 offset:30720
  s_add_u32 m0, s27, 62464
  s_xor_b32 s46, s45, 36864
  s_waitcnt lgkmcnt(8)
  v_mfma_f32_16x16x32_bf16 v[168:171], a[152:155], a[16:19], v[168:171]
  ds_read_b64_tr_b16 a[144:145], v11 offset:24576
  buffer_load_dwordx4 v3, s[8:11], s46 offen lds
  v_mfma_f32_16x16x32_bf16 v[172:175], a[152:155], a[28:31], v[172:175]
  ds_read_b64_tr_b16 a[146:147], v11 offset:25600
  s_waitcnt vmcnt(17)
  v_cmp_eq_u32 vcc, 0, v22
  v_mfma_f32_16x16x32_bf16 v[176:179], a[156:159], a[16:19], v[176:179]
  ds_read_b64_tr_b16 a[148:149], v12 offset:24576
  s_cbranch_vccz k4_part_bk4
k4_part_sl4:
  s_sleep 1
  buffer_load_dword v22, v13, s[8:11], s84 offen offset:512 sc1
  s_sub_u32 s87, s87, 1
  s_max_i32 s87, s87, 0
  s_waitcnt vmcnt(0)
  s_cbranch_scc0 k4_part_bk4
  v_cmp_eq_u32 vcc, 0, v22
  s_cbranch_vccnz k4_part_sl4
k4_part_bk4:
  v_mfma_f32_16x16x32_bf16 v[180:183], a[156:159], a[28:31], v[180:183]
  ds_read_b64_tr_b16 a[150:151], v12 offset:25600
  s_waitcnt vmcnt(33) lgkmcnt(8)
  v_mfma_f32_16x16x32_bf16 v[152:155], a[160:163], a[40:43], v[152:155]
  ds_read_b64_tr_b16 a[152:153], v11 offset:26624
  s_waitcnt vmcnt(25)
  v_mfma_f32_16x16x32_bf16 v[156:159], a[160:163], a[52:55], v[156:159]
  ds_read_b64_tr_b16 a[154:155], v11 offset:27648
  s_add_u32 s94, s80, 12288
  buffer_load_dwordx4 a[64:67], v2, s[8:11], s94 offen offset:0
  v_mfma_f32_16x16x32_bf16 v[160:163], a[164:167], a[40:43], v[160:163]
  ds_read_b64_tr_b16 a[156:157], v12 offset:26624
  v_mfma_f32_16x16x32_bf16 v[164:167], a[164:167], a[52:55], v[164:167]
  ds_read_b64_tr_b16 a[158:159], v12 offset:27648
  s_waitcnt lgkmcnt(8)
  v_mfma_f32_16x16x32_bf16 v[168:171], a[168:171], a[40:43], v[168:171]
  ds_read_b64_tr_b16 a[160:161], v7 offset:36864
  v_mfma_f32_16x16x32_bf16 v[172:175], a[168:171], a[52:55], v[172:175]
  ds_read_b64_tr_b16 a[162:163], v7 offset:38912
  buffer_load_dwordx4 a[68:71], v2, s[8:11], s94 offen offset:1024
  v_mfma_f32_16x16x32_bf16 v[176:179], a[172:175], a[40:43], v[176:179]
  ds_read_b64_tr_b16 a[164:165], v8 offset:36864
  v_mfma_f32_16x16x32_bf16 v[180:183], a[172:175], a[52:55], v[180:183]
  ds_read_b64_tr_b16 a[166:167], v8 offset:38912
  s_waitcnt lgkmcnt(8)
  v_mfma_f32_16x16x32_bf16 v[224:227], a[144:147], a[16:19], v[224:227]
  ds_read_b64_tr_b16 a[168:169], v9 offset:36864
  v_mfma_f32_16x16x32_bf16 v[228:231], a[144:147], a[28:31], v[228:231]
  ds_read_b64_tr_b16 a[170:171], v9 offset:38912
  v_mfma_f32_16x16x32_bf16 v[232:235], a[148:151], a[16:19], v[232:235]
  ds_read_b64_tr_b16 a[172:173], v10 offset:36864
  buffer_load_dwordx4 a[72:75], v2, s[8:11], s94 offen offset:2048
  v_mfma_f32_16x16x32_bf16 v[236:239], a[148:151], a[28:31], v[236:239]
  ds_read_b64_tr_b16 a[174:175], v10 offset:38912
  s_waitcnt lgkmcnt(8)
  v_mfma_f32_16x16x32_bf16 v[224:227], a[152:155], a[40:43], v[224:227]
  ds_read_b64_tr_b16 a[144:145], v7 offset:40960
  v_mfma_f32_16x16x32_bf16 v[228:231], a[152:155], a[52:55], v[228:231]
  ds_read_b64_tr_b16 a[146:147], v7 offset:43008
  v_mfma_f32_16x16x32_bf16 v[232:235], a[156:159], a[40:43], v[232:235]
  ds_read_b64_tr_b16 a[148:149], v8 offset:40960
  buffer_load_dwordx4 a[76:79], v2, s[8:11], s94 offen offset:3072
  v_mfma_f32_16x16x32_bf16 v[236:239], a[156:159], a[52:55], v[236:239]
  ds_read_b64_tr_b16 a[150:151], v8 offset:43008
  s_waitcnt vmcnt(46) lgkmcnt(8)
  v_mfma_f32_16x16x32_bf16 v[152:155], a[160:163], a[20:23], v[152:155]
  ds_read_b64_tr_b16 a[152:153], v9 offset:40960
  s_waitcnt vmcnt(41)
  v_mfma_f32_16x16x32_bf16 v[156:159], a[160:163], a[32:35], v[156:159]
  ds_read_b64_tr_b16 a[154:155], v9 offset:43008
  v_mfma_f32_16x16x32_bf16 v[160:163], a[164:167], a[20:23], v[160:163]
  ds_read_b64_tr_b16 a[156:157], v10 offset:40960
  v_mfma_f32_16x16x32_bf16 v[164:167], a[164:167], a[32:35], v[164:167]
  ds_read_b64_tr_b16 a[158:159], v10 offset:43008
  s_add_u32 s94, s80, 16384
  buffer_load_dwordx4 a[80:83], v2, s[8:11], s94 offen offset:0
  s_waitcnt lgkmcnt(8)
  v_mfma_f32_16x16x32_bf16 v[168:171], a[168:171], a[20:23], v[168:171]
  s_waitcnt vmcnt(25)
  s_barrier
  ds_read_b64_tr_b16 a[160:161], v11 offset:36864
  v_mfma_f32_16x16x32_bf16 v[172:175], a[168:171], a[32:35], v[172:175]
  ds_read_b64_tr_b16 a[162:163], v11 offset:37888
  v_mfma_f32_16x16x32_bf16 v[176:179], a[172:175], a[20:23], v[176:179]
  ds_read_b64_tr_b16 a[164:165], v12 offset:36864
  v_mfma_f32_16x16x32_bf16 v[180:183], a[172:175], a[32:35], v[180:183]
  ds_read_b64_tr_b16 a[166:167], v12 offset:37888
  buffer_load_dwordx4 a[84:87], v2, s[8:11], s94 offen offset:1024
  s_waitcnt vmcnt(36) lgkmcnt(8)
  v_mfma_f32_16x16x32_bf16 v[152:155], a[144:147], a[44:47], v[152:155]
  ds_read_b64_tr_b16 a[168:169], v11 offset:38912
  s_waitcnt vmcnt(25)
  v_mfma_f32_16x16x32_bf16 v[156:159], a[144:147], a[56:59], v[156:159]
  ds_read_b64_tr_b16 a[170:171], v11 offset:39936
  v_mfma_f32_16x16x32_bf16 v[160:163], a[148:151], a[44:47], v[160:163]
  ds_read_b64_tr_b16 a[172:173], v12 offset:38912
  v_mfma_f32_16x16x32_bf16 v[164:167], a[148:151], a[56:59], v[164:167]
  ds_read_b64_tr_b16 a[174:175], v12 offset:39936
  s_waitcnt lgkmcnt(8)
  v_mfma_f32_16x16x32_bf16 v[168:171], a[152:155], a[44:47], v[168:171]
  ds_read_b64_tr_b16 a[144:145], v7 offset:49152
  s_add_u32 s94, s81, 12288
  buffer_load_dwordx4 a[88:91], v2, s[8:11], s94 offen offset:0
  v_mfma_f32_16x16x32_bf16 v[172:175], a[152:155], a[56:59], v[172:175]
  ds_read_b64_tr_b16 a[146:147], v7 offset:51200
  v_mfma_f32_16x16x32_bf16 v[176:179], a[156:159], a[44:47], v[176:179]
  ds_read_b64_tr_b16 a[148:149], v8 offset:49152
  v_mfma_f32_16x16x32_bf16 v[180:183], a[156:159], a[56:59], v[180:183]
  ds_read_b64_tr_b16 a[150:151], v8 offset:51200
  s_waitcnt lgkmcnt(8)
  v_mfma_f32_16x16x32_bf16 v[224:227], a[160:163], a[20:23], v[224:227]
  ds_read_b64_tr_b16 a[152:153], v9 offset:49152
  buffer_load_dwordx4 a[92:95], v2, s[8:11], s94 offen offset:1024
  v_mfma_f32_16x16x32_bf16 v[228:231], a[160:163], a[32:35], v[228:231]
  ds_read_b64_tr_b16 a[154:155], v9 offset:51200
  s_waitcnt vmcnt(60)
  v_mfma_f32_16x16x32_bf16 v[232:235], a[164:167], a[20:23], v[232:235]
  ds_read_b64_tr_b16 a[156:157], v10 offset:49152
  v_lshlrev_b32 v92, 16, v100
  v_mfma_f32_16x16x32_bf16 v[236:239], a[164:167], a[32:35], v[236:239]
  ds_read_b64_tr_b16 a[158:159], v10 offset:51200
  s_waitcnt lgkmcnt(8)
  v_mfma_f32_16x16x32_bf16 v[224:227], a[168:171], a[44:47], v[224:227]
  ds_read_b64_tr_b16 a[160:161], v7 offset:53248
  v_and_b32 v93, 0xffff0000, v100
  v_mfma_f32_16x16x32_bf16 v[228:231], a[168:171], a[56:59], v[228:231]
  ds_read_b64_tr_b16 a[162:163], v7 offset:55296
  buffer_load_dwordx4 a[96:99], v2, s[8:11], s94 offen offset:2048
  v_mfma_f32_16x16x32_bf16 v[232:235], a[172:175], a[44:47], v[232:235]
  ds_read_b64_tr_b16 a[164:165], v8 offset:53248
  v_lshlrev_b32 v94, 16, v101
  v_mfma_f32_16x16x32_bf16 v[236:239], a[172:175], a[56:59], v[236:239]
  ds_read_b64_tr_b16 a[166:167], v8 offset:55296
  s_waitcnt vmcnt(50) lgkmcnt(8)
  v_mfma_f32_16x16x32_bf16 v[152:155], a[144:147], a[24:27], v[152:155]
  ds_read_b64_tr_b16 a[168:169], v9 offset:53248
  v_and_b32 v95, 0xffff0000, v101
  s_waitcnt vmcnt(45)
  v_mfma_f32_16x16x32_bf16 v[156:159], a[144:147], a[36:39], v[156:159]
  ds_read_b64_tr_b16 a[170:171], v9 offset:55296
  buffer_load_dwordx4 a[100:103], v2, s[8:11], s94 offen offset:3072
  v_mfma_f32_16x16x32_bf16 v[160:163], a[148:151], a[24:27], v[160:163]
  ds_read_b64_tr_b16 a[172:173], v10 offset:53248
  v_add_f32 v92, v92, v136
  v_mfma_f32_16x16x32_bf16 v[164:167], a[148:151], a[36:39], v[164:167]
  ds_read_b64_tr_b16 a[174:175], v10 offset:55296
  s_waitcnt lgkmcnt(8)
  v_mfma_f32_16x16x32_bf16 v[168:171], a[152:155], a[24:27], v[168:171]
  ds_read_b64_tr_b16 a[144:145], v11 offset:49152
  v_add_f32 v93, v93, v136
  v_mfma_f32_16x16x32_bf16 v[172:175], a[152:155], a[36:39], v[172:175]
  ds_read_b64_tr_b16 a[146:147], v11 offset:50176
  v_add_f32 v94, v94, v136
  v_mfma_f32_16x16x32_bf16 v[176:179], a[156:159], a[24:27], v[176:179]
  ds_read_b64_tr_b16 a[148:149], v12 offset:49152
  s_add_u32 s94, s81, 16384
  buffer_load_dwordx4 a[104:107], v2, s[8:11], s94 offen offset:0
  v_mfma_f32_16x16x32_bf16 v[180:183], a[156:159], a[36:39], v[180:183]
  ds_read_b64_tr_b16 a[150:151], v12 offset:50176
  s_waitcnt vmcnt(39) lgkmcnt(8)
  v_mfma_f32_16x16x32_bf16 v[152:155], a[160:163], a[48:51], v[152:155]
  ds_read_b64_tr_b16 a[152:153], v11 offset:51200
  v_add_f32 v95, v95, v136
  s_waitcnt vmcnt(29)
  v_mfma_f32_16x16x32_bf16 v[156:159], a[160:163], a[60:63], v[156:159]
  ds_read_b64_tr_b16 a[154:155], v11 offset:52224
  v_lshlrev_b32 v104, 16, v120
  v_mfma_f32_16x16x32_bf16 v[160:163], a[164:167], a[48:51], v[160:163]
  ds_read_b64_tr_b16 a[156:157], v12 offset:51200
  buffer_load_dwordx4 a[108:111], v2, s[8:11], s94 offen offset:1024
  v_mfma_f32_16x16x32_bf16 v[164:167], a[164:167], a[60:63], v[164:167]
  ds_read_b64_tr_b16 a[158:159], v12 offset:52224
  s_waitcnt lgkmcnt(8)
  v_mfma_f32_16x16x32_bf16 v[168:171], a[168:171], a[48:51], v[168:171]
  ds_read_b64_tr_b16 a[160:161], v7 offset:61440
  v_and_b32 v105, 0xffff0000, v120
  v_mfma_f32_16x16x32_bf16 v[172:175], a[168:171], a[60:63], v[172:175]
  ds_read_b64_tr_b16 a[162:163], v7 offset:63488
  v_lshlrev_b32 v106, 16, v121
  v_mfma_f32_16x16x32_bf16 v[176:179], a[172:175], a[48:51], v[176:179]
  ds_read_b64_tr_b16 a[164:165], v8 offset:61440
  buffer_load_dword v22, v17, s[8:11], s86 offen offset:0 sc1
  v_mfma_f32_16x16x32_bf16 v[180:183], a[172:175], a[60:63], v[180:183]
  ds_read_b64_tr_b16 a[166:167], v8 offset:63488
  s_add_u32 s94, s82, 12288
  buffer_load_dwordx4 a[112:115], v2, s[8:11], s94 offen offset:0
  s_waitcnt lgkmcnt(8)
  v_mfma_f32_16x16x32_bf16 v[224:227], a[144:147], a[24:27], v[224:227]
  ds_read_b64_tr_b16 a[168:169], v9 offset:61440
  v_and_b32 v107, 0xffff0000, v121
  v_mfma_f32_16x16x32_bf16 v[228:231], a[144:147], a[36:39], v[228:231]
  ds_read_b64_tr_b16 a[170:171], v9 offset:63488
  v_add_f32 v104, v104, v18
  v_mfma_f32_16x16x32_bf16 v[232:235], a[148:151], a[24:27], v[232:235]
  ds_read_b64_tr_b16 a[172:173], v10 offset:61440
  v_add_f32 v105, v105, v18
  v_mfma_f32_16x16x32_bf16 v[236:239], a[148:151], a[36:39], v[236:239]
  ds_read_b64_tr_b16 a[174:175], v10 offset:63488
  buffer_load_dwordx4 a[116:119], v2, s[8:11], s94 offen offset:1024
  s_waitcnt lgkmcnt(8)
  v_mfma_f32_16x16x32_bf16 v[224:227], a[152:155], a[48:51], v[224:227]
  v_add_u32 v7, 65536, v7
  ds_read_b64_tr_b16 a[144:145], v7 offset:0
  v_add_f32 v106, v106, v18
  v_mfma_f32_16x16x32_bf16 v[228:231], a[152:155], a[60:63], v[228:231]
  ds_read_b64_tr_b16 a[146:147], v7 offset:2048
  v_add_f32 v107, v107, v18
  v_mfma_f32_16x16x32_bf16 v[232:235], a[156:159], a[48:51], v[232:235]
  v_add_u32 v8, 65536, v8
  ds_read_b64_tr_b16 a[148:149], v8 offset:0
  v_lshlrev_b32 v108, 16, v122
  v_mfma_f32_16x16x32_bf16 v[236:239], a[156:159], a[60:63], v[236:239]
  ds_read_b64_tr_b16 a[150:151], v8 offset:2048
  s_waitcnt vmcnt(14) lgkmcnt(8)
  v_mfma_f32_16x16x32_bf16 v[152:155], a[160:163], a[64:67], v[152:155]
  v_add_u32 v9, 65536, v9
  ds_read_b64_tr_b16 a[152:153], v9 offset:0
  buffer_load_dwordx4 a[120:123], v2, s[8:11], s94 offen offset:2048
  s_waitcnt vmcnt(14)
  v_mfma_f32_16x16x32_bf16 v[156:159], a[160:163], a[68:71], v[156:159]
  ds_read_b64_tr_b16 a[154:155], v9 offset:2048
  v_and_b32 v109, 0xffff0000, v122
  v_mfma_f32_16x16x32_bf16 v[160:163], a[164:167], a[64:67], v[160:163]
  v_add_u32 v10, 65536, v10
  ds_read_b64_tr_b16 a[156:157], v10 offset:0
  v_lshlrev_b32 v110, 16, v123
  v_mfma_f32_16x16x32_bf16 v[164:167], a[164:167], a[68:71], v[164:167]
  ds_read_b64_tr_b16 a[158:159], v10 offset:2048
  s_waitcnt lgkmcnt(8)
  v_mfma_f32_16x16x32_bf16 v[168:171], a[168:171], a[64:67], v[168:171]
  ds_read_b64_tr_b16 a[160:161], v7 offset:4096
  buffer_load_dwordx4 a[124:127], v2, s[8:11], s94 offen offset:3072
  v_mfma_f32_16x16x32_bf16 v[172:175], a[168:171], a[68:71], v[172:175]
  ds_read_b64_tr_b16 a[162:163], v7 offset:6144
  v_and_b32 v111, 0xffff0000, v123
  v_mfma_f32_16x16x32_bf16 v[176:179], a[172:175], a[64:67], v[176:179]
  ds_read_b64_tr_b16 a[164:165], v8 offset:4096
  v_add_f32 v108, v108, v18
  v_mfma_f32_16x16x32_bf16 v[180:183], a[172:175], a[68:71], v[180:183]
  ds_read_b64_tr_b16 a[166:167], v8 offset:6144
  s_waitcnt vmcnt(14) lgkmcnt(8)
  v_mfma_f32_16x16x32_bf16 v[152:155], a[144:147], a[72:75], v[152:155]
  ds_read_b64_tr_b16 a[168:169], v9 offset:4096
  v_add_f32 v109, v109, v18
  s_waitcnt vmcnt(13)
  v_mfma_f32_16x16x32_bf16 v[156:159], a[144:147], a[76:79], v[156:159]
  ds_read_b64_tr_b16 a[170:171], v9 offset:6144
  s_add_u32 s94, s82, 16384
  buffer_load_dwordx4 a[128:131], v2, s[8:11], s94 offen offset:0
  v_mfma_f32_16x16x32_bf16 v[160:163], a[148:151], a[72:75], v[160:163]
  ds_read_b64_tr_b16 a[172:173], v10 offset:4096
  v_add_f32 v110, v110, v18
  v_mfma_f32_16x16x32_bf16 v[164:167], a[148:151], a[76:79], v[164:167]
  ds_read_b64_tr_b16 a[174:175], v10 offset:6144
  s_waitcnt lgkmcnt(8)
  v_mfma_f32_16x16x32_bf16 v[168:171], a[152:155], a[72:75], v[168:171]
  ds_read_b64_tr_b16 a[144:145], v7 offset:8192
  v_add_f32 v111, v111, v18
  v_mfma_f32_16x16x32_bf16 v[172:175], a[152:155], a[76:79], v[172:175]
  ds_read_b64_tr_b16 a[146:147], v7 offset:10240
  buffer_load_dwordx4 a[132:135], v2, s[8:11], s94 offen offset:1024
  v_mfma_f32_16x16x32_bf16 v[176:179], a[156:159], a[72:75], v[176:179]
  ds_read_b64_tr_b16 a[148:149], v8 offset:8192
  v_lshlrev_b32 v112, 16, v124
  v_mfma_f32_16x16x32_bf16 v[180:183], a[156:159], a[76:79], v[180:183]
  ds_read_b64_tr_b16 a[150:151], v8 offset:10240
  s_waitcnt vmcnt(14) lgkmcnt(8)
  v_mfma_f32_16x16x32_bf16 v[152:155], a[160:163], a[80:83], v[152:155]
  ds_read_b64_tr_b16 a[152:153], v9 offset:8192
  v_and_b32 v113, 0xffff0000, v124
  s_waitcnt vmcnt(13)
  v_mfma_f32_16x16x32_bf16 v[156:159], a[160:163], a[84:87], v[156:159]
  ds_read_b64_tr_b16 a[154:155], v9 offset:10240
  s_add_u32 m0, s27, 66560
  s_xor_b32 s46, s45, 53248
  v_mfma_f32_16x16x32_bf16 v[160:163], a[164:167], a[80:83], v[160:163]
  ds_read_b64_tr_b16 a[156:157], v10 offset:8192
  buffer_load_dwordx4 v3, s[8:11], s46 offen lds
  v_mfma_f32_16x16x32_bf16 v[164:167], a[164:167], a[84:87], v[164:167]
  ds_read_b64_tr_b16 a[158:159], v10 offset:10240
  s_waitcnt lgkmcnt(8)
  v_mfma_f32_16x16x32_bf16 v[168:171], a[168:171], a[80:83], v[168:171]
  ds_read_b64_tr_b16 a[160:161], v7 offset:12288
  v_lshlrev_b32 v114, 16, v125
  v_mfma_f32_16x16x32_bf16 v[172:175], a[168:171], a[84:87], v[172:175]
  ds_read_b64_tr_b16 a[162:163], v7 offset:14336
  s_add_u32 m0, s27, 70656
  s_xor_b32 s46, s45, 8192
  v_mfma_f32_16x16x32_bf16 v[176:179], a[172:175], a[80:83], v[176:179]
  ds_read_b64_tr_b16 a[164:165], v8 offset:12288
  buffer_load_dwordx4 v3, s[8:11], s46 offen lds
  v_mfma_f32_16x16x32_bf16 v[180:183], a[172:175], a[84:87], v[180:183]
  ds_read_b64_tr_b16 a[166:167], v8 offset:14336
  s_waitcnt vmcnt(14) lgkmcnt(8)
  v_mfma_f32_16x16x32_bf16 v[152:155], a[144:147], a[88:91], v[152:155]
  ds_read_b64_tr_b16 a[168:169], v9 offset:12288
  v_and_b32 v115, 0xffff0000, v125
  s_waitcnt vmcnt(13)
  v_mfma_f32_16x16x32_bf16 v[156:159], a[144:147], a[92:95], v[156:159]
  ds_read_b64_tr_b16 a[170:171], v9 offset:14336
  v_add_f32 v112, v112, v19
  v_mfma_f32_16x16x32_bf16 v[160:163], a[148:151], a[88:91], v[160:163]
  ds_read_b64_tr_b16 a[172:173], v10 offset:12288
  s_add_u32 m0, s27, 74752
  s_xor_b32 s46, s45, 24576
  v_mfma_f32_16x16x32_bf16 v[164:167], a[148:151], a[92:95], v[164:167]
  ds_read_b64_tr_b16 a[174:175], v10 offset:14336
  buffer_load_dwordx4 v3, s[8:11], s46 offen lds
  s_waitcnt lgkmcnt(8)
  v_mfma_f32_16x16x32_bf16 v[168:171], a[152:155], a[88:91], v[168:171]
  s_waitcnt vmcnt(30)
  s_barrier
  v_add_u32 v7, -131072, v7
  ds_read_b64_tr_b16 a[144:145], v7 offset:0
  v_add_f32 v113, v113, v19
  v_mfma_f32_16x16x32_bf16 v[172:175], a[152:155], a[92:95], v[172:175]
  ds_read_b64_tr_b16 a[146:147], v7 offset:2048
  v_add_f32 v114, v114, v19
  v_mfma_f32_16x16x32_bf16 v[176:179], a[156:159], a[88:91], v[176:179]
  v_add_u32 v8, -131072, v8
  ds_read_b64_tr_b16 a[148:149], v8 offset:0
  s_add_u32 m0, s27, 78848
  s_xor_b32 s46, s45, 40960
  v_mfma_f32_16x16x32_bf16 v[180:183], a[156:159], a[92:95], v[180:183]
  ds_read_b64_tr_b16 a[150:151], v8 offset:2048
  buffer_load_dwordx4 v3, s[8:11], s46 offen lds
  s_waitcnt vmcnt(14) lgkmcnt(8)
  v_mfma_f32_16x16x32_bf16 v[152:155], a[160:163], a[96:99], v[152:155]
  v_add_u32 v9, -131072, v9
  ds_read_b64_tr_b16 a[152:153], v9 offset:0
  v_add_f32 v115, v115, v19
  s_waitcnt vmcnt(13)
  v_mfma_f32_16x16x32_bf16 v[156:159], a[160:163], a[100:103], v[156:159]
  ds_read_b64_tr_b16 a[154:155], v9 offset:2048
  v_lshlrev_b32 v116, 16, v126
  v_mfma_f32_16x16x32_bf16 v[160:163], a[164:167], a[96:99], v[160:163]
  v_add_u32 v10, -131072, v10
  ds_read_b64_tr_b16 a[156:157], v10 offset:0
  v_and_b32 v117, 0xffff0000, v126
  v_mfma_f32_16x16x32_bf16 v[164:167], a[164:167], a[100:103], v[164:167]
  ds_read_b64_tr_b16 a[158:159], v10 offset:2048
  s_add_u32 m0, s27, 82944
  s_xor_b32 s46, s45, 57344
  s_waitcnt lgkmcnt(8)
  v_mfma_f32_16x16x32_bf16 v[168:171], a[168:171], a[96:99], v[168:171]
  ds_read_b64_tr_b16 a[160:161], v7 offset:4096
  buffer_load_dwordx4 v3, s[8:11], s46 offen lds
  v_mfma_f32_16x16x32_bf16 v[172:175], a[168:171], a[100:103], v[172:175]
  ds_read_b64_tr_b16 a[162:163], v7 offset:6144
  v_lshlrev_b32 v118, 16, v127
  v_mfma_f32_16x16x32_bf16 v[176:179], a[172:175], a[96:99], v[176:179]
  ds_read_b64_tr_b16 a[164:165], v8 offset:4096
  v_and_b32 v119, 0xffff0000, v127
  v_mfma_f32_16x16x32_bf16 v[180:183], a[172:175], a[100:103], v[180:183]
  ds_read_b64_tr_b16 a[166:167], v8 offset:6144
  s_add_u32 m0, s27, 87040
  s_xor_b32 s46, s45, 12288
  s_waitcnt vmcnt(13) lgkmcnt(8)
  v_mfma_f32_16x16x32_bf16 v[152:155], a[144:147], a[104:107], v[152:155]
  ds_read_b64_tr_b16 a[168:169], v9 offset:4096
  buffer_load_dwordx4 v3, s[8:11], s46 offen lds
  s_waitcnt vmcnt(13)
  v_mfma_f32_16x16x32_bf16 v[156:159], a[144:147], a[108:111], v[156:159]
  ds_read_b64_tr_b16 a[170:171], v9 offset:6144
  v_add_f32 v116, v116, v19
  v_mfma_f32_16x16x32_bf16 v[160:163], a[148:151], a[104:107], v[160:163]
  ds_read_b64_tr_b16 a[172:173], v10 offset:4096
  v_add_f32 v117, v117, v19
  v_mfma_f32_16x16x32_bf16 v[164:167], a[148:151], a[108:111], v[164:167]
  ds_read_b64_tr_b16 a[174:175], v10 offset:6144
  s_waitcnt lgkmcnt(8)
  v_mfma_f32_16x16x32_bf16 v[168:171], a[152:155], a[104:107], v[168:171]
  ds_read_b64_tr_b16 a[144:145], v7 offset:8192
  s_add_u32 m0, s27, 91136
  s_xor_b32 s46, s45, 28672
  v_mfma_f32_16x16x32_bf16 v[172:175], a[152:155], a[108:111], v[172:175]
  ds_read_b64_tr_b16 a[146:147], v7 offset:10240
  buffer_load_dwordx4 v3, s[8:11], s46 offen lds
  v_mfma_f32_16x16x32_bf16 v[176:179], a[156:159], a[104:107], v[176:179]
  ds_read_b64_tr_b16 a[148:149], v8 offset:8192
  v_add_f32 v118, v118, v19
  v_mfma_f32_16x16x32_bf16 v[180:183], a[156:159], a[108:111], v[180:183]
  ds_read_b64_tr_b16 a[150:151], v8 offset:10240
  s_waitcnt vmcnt(12) lgkmcnt(8)
  v_mfma_f32_16x16x32_bf16 v[152:155], a[160:163], a[112:115], v[152:155]
  ds_read_b64_tr_b16 a[152:153], v9 offset:8192
  s_add_u32 m0, s27, 95232
  s_xor_b32 s46, s45, 45056
  s_waitcnt vmcnt(11)
  v_mfma_f32_16x16x32_bf16 v[156:159], a[160:163], a[116:119], v[156:159]
  ds_read_b64_tr_b16 a[154:155], v9 offset:10240
  buffer_load_dwordx4 v3, s[8:11], s46 offen lds
  v_mfma_f32_16x16x32_bf16 v[160:163], a[164:167], a[112:115], v[160:163]
  ds_read_b64_tr_b16 a[156:157], v10 offset:8192
k4_part_w9:
  s_cbranch_execz k4_part_wr
  v_add_f32 v119, v119, v19
  v_mfma_f32_16x16x32_bf16 v[164:167], a[164:167], a[116:119], v[164:167]
  ds_read_b64_tr_b16 a[158:159], v10 offset:10240
  s_waitcnt lgkmcnt(8)
  v_mfma_f32_16x16x32_bf16 v[168:171], a[168:171], a[112:115], v[168:171]
  ds_read_b64_tr_b16 a[160:161], v7 offset:12288
  v_mfma_f32_16x16x32_bf16 v[172:175], a[168:171], a[116:119], v[172:175]
  ds_read_b64_tr_b16 a[162:163], v7 offset:14336
  s_add_u32 m0, s27, 99328
  s_xor_b32 s46, s45, 61440
  v_mfma_f32_16x16x32_bf16 v[176:179], a[172:175], a[112:115], v[176:179]
  ds_read_b64_tr_b16 a[164:165], v8 offset:12288
  buffer_load_dwordx4 v3, s[8:11], s46 offen lds
  v_mfma_f32_16x16x32_bf16 v[180:183], a[172:175], a[116:119], v[180:183]
  ds_read_b64_tr_b16 a[166:167], v8 offset:14336
  s_waitcnt vmcnt(12) lgkmcnt(8)
  v_mfma_f32_16x16x32_bf16 v[152:155], a[144:147], a[120:123], v[152:155]
  ds_read_b64_tr_b16 a[168:169], v9 offset:12288
  s_waitcnt vmcnt(11)
  v_mfma_f32_16x16x32_bf16 v[156:159], a[144:147], a[124:127], v[156:159]
  ds_read_b64_tr_b16 a[170:171], v9 offset:14336
  s_add_u32 m0, s27, 103424
  v_mfma_f32_16x16x32_bf16 v[160:163], a[148:151], a[120:123], v[160:163]
  ds_read_b64_tr_b16 a[172:173], v10 offset:12288
  buffer_load_dwordx4 v3, s[8:11], s0 offen lds
  v_mfma_f32_16x16x32_bf16 v[164:167], a[148:151], a[124:127], v[164:167]
  ds_read_b64_tr_b16 a[174:175], v10 offset:14336
  s_waitcnt lgkmcnt(8)
  v_mfma_f32_16x16x32_bf16 v[168:171], a[152:155], a[120:123], v[168:171]
  v_add_u32 v11, -57344, v11
  ds_read_b64_tr_b16 a[144:145], v11 offset:0
  s_waitcnt vmcnt(16)
  v_cmp_eq_u32 vcc, 0, v22
  v_mfma_f32_16x16x32_bf16 v[172:175], a[152:155], a[124:127], v[172:175]
  ds_read_b64_tr_b16 a[146:147], v11 offset:1024
  s_cbranch_vccz k4_part_bk0
k4_part_sl0:
  s_sleep 1
  buffer_load_dword v22, v17, s[8:11], s86 offen offset:0 sc1
  s_sub_u32 s87, s87, 1
  s_max_i32 s87, s87, 0
  s_waitcnt vmcnt(0)
  s_cbranch_scc0 k4_part_bk0
  v_cmp_eq_u32 vcc, 0, v22
  s_cbranch_vccnz k4_part_sl0
k4_part_bk0:
  v_mfma_f32_16x16x32_bf16 v[176:179], a[156:159], a[120:123], v[176:179]
  v_add_u32 v12, -57344, v12
  ds_read_b64_tr_b16 a[148:149], v12 offset:0
  v_mfma_f32_16x16x32_bf16 v[180:183], a[156:159], a[124:127], v[180:183]
  ds_read_b64_tr_b16 a[150:151], v12 offset:1024
  buffer_load_dwordx4 v[32:35], v14, s[8:11], s89 offen sc1
  s_add_u32 s89, s89, 49152
  s_waitcnt vmcnt(12) lgkmcnt(8)
  v_mfma_f32_16x16x32_bf16 v[152:155], a[160:163], a[128:131], v[152:155]
  ds_read_b64_tr_b16 a[152:153], v11 offset:2048
  s_waitcnt vmcnt(11)
  v_mfma_f32_16x16x32_bf16 v[156:159], a[160:163], a[132:135], v[156:159]
  ds_read_b64_tr_b16 a[154:155], v11 offset:3072
  v_mfma_f32_16x16x32_bf16 v[160:163], a[164:167], a[128:131], v[160:163]
  ds_read_b64_tr_b16 a[156:157], v12 offset:2048
  v_cvt_pk_bf16_f32 v152, v152, v153
  v_mfma_f32_16x16x32_bf16 v[164:167], a[164:167], a[132:135], v[164:167]
  ds_read_b64_tr_b16 a[158:159], v12 offset:3072
  buffer_load_dwordx4 v[48:51], v14, s[8:11], s89 offen sc1
  s_add_u32 s89, s89, 49152
  s_waitcnt lgkmcnt(8)
  v_mfma_f32_16x16x32_bf16 v[168:171], a[168:171], a[128:131], v[168:171]
  ds_read_b64_tr_b16 a[160:161], v11 offset:4096
  v_cvt_pk_bf16_f32 v153, v154, v155
  v_mfma_f32_16x16x32_bf16 v[172:175], a[168:171], a[132:135], v[172:175]
  ds_read_b64_tr_b16 a[162:163], v11 offset:5120
  v_cvt_pk_bf16_f32 v154, v160, v161
  v_mfma_f32_16x16x32_bf16 v[176:179], a[172:175], a[128:131], v[176:179]
  ds_read_b64_tr_b16 a[164:165], v12 offset:4096
  v_cvt_pk_bf16_f32 v155, v162, v163
  v_mfma_f32_16x16x32_bf16 v[180:183], a[172:175], a[132:135], v[180:183]
  ds_read_b64_tr_b16 a[166:167], v12 offset:5120
  v_cvt_pk_bf16_f32 v156, v156, v157
  s_waitcnt lgkmcnt(8)
  v_mfma_f32_16x16x32_bf16 v[224:227], a[144:147], a[64:67], v[224:227]
  ds_read_b64_tr_b16 a[168:169], v11 offset:6144
  buffer_load_dwordx4 v[64:67], v14, s[8:11], s89 offen sc1
  s_add_u32 s89, s89, 49152
  v_mfma_f32_16x16x32_bf16 v[228:231], a[144:147], a[68:71], v[228:231]
  ds_read_b64_tr_b16 a[170:171], v11 offset:7168
  v_cvt_pk_bf16_f32 v157, v158, v159
  v_mfma_f32_16x16x32_bf16 v[232:235], a[148:151], a[64:67], v[232:235]
  ds_read_b64_tr_b16 a[172:173], v12 offset:6144
  v_cvt_pk_bf16_f32 v158, v164, v165
  v_mfma_f32_16x16x32_bf16 v[236:239], a[148:151], a[68:71], v[236:239]
  ds_read_b64_tr_b16 a[174:175], v12 offset:7168
  v_cvt_pk_bf16_f32 v159, v166, v167
  s_waitcnt lgkmcnt(8)
  v_mfma_f32_16x16x32_bf16 v[224:227], a[152:155], a[72:75], v[224:227]
  ds_read_b64_tr_b16 a[144:145], v11 offset:8192
  buffer_store_dwordx4 v[152:155], v2, s[8:11], s49 offen offset:0 sc1
  v_mfma_f32_16x16x32_bf16 v[228:231], a[152:155], a[76:79], v[228:231]
  ds_read_b64_tr_b16 a[146:147], v11 offset:9216
  v_cvt_pk_bf16_f32 v168, v168, v169
  v_mfma_f32_16x16x32_bf16 v[232:235], a[156:159], a[72:75], v[232:235]
  ds_read_b64_tr_b16 a[148:149], v12 offset:8192
  v_cvt_pk_bf16_f32 v169, v170, v171
  v_mfma_f32_16x16x32_bf16 v[236:239], a[156:159], a[76:79], v[236:239]
  ds_read_b64_tr_b16 a[150:151], v12 offset:9216
  v_cvt_pk_bf16_f32 v170, v176, v177
  s_waitcnt lgkmcnt(8)
  v_mfma_f32_16x16x32_bf16 v[224:227], a[160:163], a[88:91], v[224:227]
  ds_read_b64_tr_b16 a[152:153], v11 offset:10240
  v_cvt_pk_bf16_f32 v171, v178, v179
  v_mfma_f32_16x16x32_bf16 v[228:231], a[160:163], a[92:95], v[228:231]
  ds_read_b64_tr_b16 a[154:155], v11 offset:11264
  buffer_store_dwordx4 v[156:159], v2, s[8:11], s49 offen offset:1024 sc1
  v_mfma_f32_16x16x32_bf16 v[232:235], a[164:167], a[88:91], v[232:235]
  ds_read_b64_tr_b16 a[156:157], v12 offset:10240
  v_cvt_pk_bf16_f32 v172, v172, v173
  v_mfma_f32_16x16x32_bf16 v[236:239], a[164:167], a[92:95], v[236:239]
  ds_read_b64_tr_b16 a[158:159], v12 offset:11264
  v_cvt_pk_bf16_f32 v173, v174, v175
  s_waitcnt lgkmcnt(8)
  v_mfma_f32_16x16x32_bf16 v[224:227], a[168:171], a[96:99], v[224:227]
  ds_read_b64_tr_b16 a[160:161], v11 offset:12288
  v_cvt_pk_bf16_f32 v174, v180, v181
  v_mfma_f32_16x16x32_bf16 v[228:231], a[168:171], a[100:103], v[228:231]
  ds_read_b64_tr_b16 a[162:163], v11 offset:13312
  buffer_store_dwordx4 v[168:171], v2, s[8:11], s49 offen offset:2048 sc1
  v_mfma_f32_16x16x32_bf16 v[232:235], a[172:175], a[96:99], v[232:235]
  ds_read_b64_tr_b16 a[164:165], v12 offset:12288
  v_cvt_pk_bf16_f32 v175, v182, v183
  v_mfma_f32_16x16x32_bf16 v[236:239], a[172:175], a[100:103], v[236:239]
  ds_read_b64_tr_b16 a[166:167], v12 offset:13312
  s_waitcnt lgkmcnt(8)
  v_mfma_f32_16x16x32_bf16 v[224:227], a[144:147], a[112:115], v[224:227]
  ds_read_b64_tr_b16 a[168:169], v11 offset:14336
  v_mfma_f32_16x16x32_bf16 v[228:231], a[144:147], a[116:119], v[228:231]
  ds_read_b64_tr_b16 a[170:171], v11 offset:15360
  v_mfma_f32_16x16x32_bf16 v[232:235], a[148:151], a[112:115], v[232:235]
  ds_read_b64_tr_b16 a[172:173], v12 offset:14336
  buffer_store_dwordx4 v[172:175], v2, s[8:11], s49 offen offset:3072 sc1
  s_add_u32 s49, s49, 4096
  v_mfma_f32_16x16x32_bf16 v[236:239], a[148:151], a[116:119], v[236:239]
  ds_read_b64_tr_b16 a[174:175], v12 offset:15360
  s_waitcnt lgkmcnt(8)
  v_mfma_f32_16x16x32_bf16 v[224:227], a[152:155], a[120:123], v[224:227]
  ds_read_b64_tr_b16 a[144:145], v11 offset:16384
  v_mfma_f32_16x16x32_bf16 v[228:231], a[152:155], a[124:127], v[228:231]
  ds_read_b64_tr_b16 a[146:147], v11 offset:17408
  v_mfma_f32_16x16x32_bf16 v[232:235], a[156:159], a[120:123], v[232:235]
  ds_read_b64_tr_b16 a[148:149], v12 offset:16384
  buffer_load_dwordx4 v[80:83], v14, s[8:11], s89 offen sc1
  v_mfma_f32_16x16x32_bf16 v[236:239], a[156:159], a[124:127], v[236:239]
  ds_read_b64_tr_b16 a[150:151], v12 offset:17408
  s_waitcnt lgkmcnt(8)
  v_mfma_f32_16x16x32_bf16 v[224:227], a[160:163], v[216:219], v[224:227]
  ds_read_b64_tr_b16 a[152:153], v11 offset:18432
  v_mfma_f32_16x16x32_bf16 v[228:231], a[160:163], v[220:223], v[228:231]
  ds_read_b64_tr_b16 a[154:155], v11 offset:19456
  v_mfma_f32_16x16x32_bf16 v[232:235], a[164:167], v[216:219], v[232:235]
  ds_read_b64_tr_b16 a[156:157], v12 offset:18432
  s_add_u32 m0, s27, 107520
  v_mfma_f32_16x16x32_bf16 v[236:239], a[164:167], v[220:223], v[236:239]
  ds_read_b64_tr_b16 a[158:159], v12 offset:19456
  buffer_load_dwordx4 v3, s[8:11], s1 offen lds
  s_waitcnt lgkmcnt(8)
  v_mfma_f32_16x16x32_bf16 v[224:227], a[168:171], a[80:83], v[224:227]
  s_waitcnt vmcnt(17)
  s_barrier
  ds_read_b64_tr_b16 a[160:161], v11 offset:20480
  v_mfma_f32_16x16x32_bf16 v[228:231], a[168:171], a[84:87], v[228:231]
  ds_read_b64_tr_b16 a[162:163], v11 offset:21504
  v_mfma_f32_16x16x32_bf16 v[232:235], a[172:175], a[80:83], v[232:235]
  ds_read_b64_tr_b16 a[164:165], v12 offset:20480
  v_mfma_f32_16x16x32_bf16 v[236:239], a[172:175], a[84:87], v[236:239]
  ds_read_b64_tr_b16 a[166:167], v12 offset:21504
  s_waitcnt lgkmcnt(8)
  v_mfma_f32_16x16x32_bf16 v[224:227], a[144:147], a[104:107], v[224:227]
  ds_read_b64_tr_b16 a[168:169], v11 offset:22528
  v_mfma_f32_16x16x32_bf16 v[228:231], a[144:147], a[108:111], v[228:231]
  ds_read_b64_tr_b16 a[170:171], v11 offset:23552
  v_mfma_f32_16x16x32_bf16 v[232:235], a[148:151], a[104:107], v[232:235]
  ds_read_b64_tr_b16 a[172:173], v12 offset:22528
  v_mfma_f32_16x16x32_bf16 v[236:239], a[148:151], a[108:111], v[236:239]
  ds_read_b64_tr_b16 a[174:175], v12 offset:23552
  s_waitcnt lgkmcnt(8)
  v_mfma_f32_16x16x32_bf16 v[224:227], a[152:155], a[128:131], v[224:227]
  ds_read_b64_tr_b16 a[144:145], v11 offset:24576
  v_mfma_f32_16x16x32_bf16 v[228:231], a[152:155], a[132:135], v[228:231]
  ds_read_b64_tr_b16 a[146:147], v11 offset:25600
  v_mfma_f32_16x16x32_bf16 v[232:235], a[156:159], a[128:131], v[232:235]
  ds_read_b64_tr_b16 a[148:149], v12 offset:24576
  v_cvt_pk_bf16_f32 v224, v224, v225
  v_mfma_f32_16x16x32_bf16 v[236:239], a[156:159], a[132:135], v[236:239]
  ds_read_b64_tr_b16 a[150:151], v12 offset:25600
  v_cvt_pk_bf16_f32 v225, v226, v227
  s_waitcnt lgkmcnt(8)
  v_mfma_f32_16x16x32_bf16 v[240:243], a[160:163], v[184:187], 0
  ds_read_b64_tr_b16 a[152:153], v11 offset:26624
  v_cvt_pk_bf16_f32 v226, v232, v233
  v_mfma_f32_16x16x32_bf16 v[244:247], a[160:163], v[188:191], 0
  ds_read_b64_tr_b16 a[154:155], v11 offset:27648
  v_cvt_pk_bf16_f32 v227, v234, v235
  v_mfma_f32_16x16x32_bf16 v[248:251], a[164:167], v[184:187], 0
  ds_read_b64_tr_b16 a[156:157], v12 offset:26624
  v_cvt_pk_bf16_f32 v228, v228, v229
  v_mfma_f32_16x16x32_bf16 v[252:255], a[164:167], v[188:191], 0
  ds_read_b64_tr_b16 a[158:159], v12 offset:27648
  v_cvt_pk_bf16_f32 v229, v230, v231
  s_waitcnt lgkmcnt(8)
  v_mfma_f32_16x16x32_bf16 v[240:243], a[168:171], v[192:195], v[240:243]
  ds_read_b64_tr_b16 a[160:161], v11 offset:28672
  v_cvt_pk_bf16_f32 v230, v236, v237
  v_mfma_f32_16x16x32_bf16 v[244:247], a[168:171], v[196:199], v[244:247]
  ds_read_b64_tr_b16 a[162:163], v11 offset:29696
  buffer_store_dwordx4 v[224:227], v2, s[8:11], s49 offen offset:0 sc1
  v_mfma_f32_16x16x32_bf16 v[248:251], a[172:175], v[192:195], v[248:251]
  ds_read_b64_tr_b16 a[164:165], v12 offset:28672
  v_cvt_pk_bf16_f32 v231, v238, v239
  v_mfma_f32_16x16x32_bf16 v[252:255], a[172:175], v[196:199], v[252:255]
  ds_read_b64_tr_b16 a[166:167], v12 offset:29696
  s_waitcnt lgkmcnt(8)
  v_mfma_f32_16x16x32_bf16 v[240:243], a[144:147], a[176:179], v[240:243]
  ds_read_b64_tr_b16 a[168:169], v11 offset:30720
  v_mfma_f32_16x16x32_bf16 v[244:247], a[144:147], a[188:191], v[244:247]
  ds_read_b64_tr_b16 a[170:171], v11 offset:31744
  buffer_store_dwordx4 v[228:231], v2, s[8:11], s49 offen offset:1024 sc1
  v_mfma_f32_16x16x32_bf16 v[248:251], a[148:151], a[176:179], v[248:251]
  ds_read_b64_tr_b16 a[172:173], v12 offset:30720
  v_mfma_f32_16x16x32_bf16 v[252:255], a[148:151], a[188:191], v[252:255]
  ds_read_b64_tr_b16 a[174:175], v12 offset:31744
  s_waitcnt lgkmcnt(8)
  v_mfma_f32_16x16x32_bf16 v[240:243], a[152:155], a[200:203], v[240:243]
  ds_read_b64_tr_b16 a[144:145], v11 offset:32768
  v_mfma_f32_16x16x32_bf16 v[244:247], a[152:155], a[212:215], v[244:247]
  ds_read_b64_tr_b16 a[146:147], v11 offset:33792
  v_mfma_f32_16x16x32_bf16 v[248:251], a[156:159], a[200:203], v[248:251]
  ds_read_b64_tr_b16 a[148:149], v12 offset:32768
  v_mfma_f32_16x16x32_bf16 v[252:255], a[156:159], a[212:215], v[252:255]
  ds_read_b64_tr_b16 a[150:151], v12 offset:33792
  s_waitcnt lgkmcnt(8)
  v_mfma_f32_16x16x32_bf16 v[240:243], a[160:163], a[180:183], v[240:243]
  ds_read_b64_tr_b16 a[152:153], v11 offset:34816
  v_mfma_f32_16x16x32_bf16 v[244:247], a[160:163], a[192:195], v[244:247]
  ds_read_b64_tr_b16 a[154:155], v11 offset:35840
  v_mfma_f32_16x16x32_bf16 v[248:251], a[164:167], a[180:183], v[248:251]
  ds_read_b64_tr_b16 a[156:157], v12 offset:34816
  v_mfma_f32_16x16x32_bf16 v[252:255], a[164:167], a[192:195], v[252:255]
  ds_read_b64_tr_b16 a[158:159], v12 offset:35840
  s_waitcnt lgkmcnt(8)
  v_mfma_f32_16x16x32_bf16 v[240:243], a[168:171], a[204:207], v[240:243]
  ds_read_b64_tr_b16 a[160:161], v11 offset:36864
  v_mfma_f32_16x16x32_bf16 v[244:247], a[168:171], a[216:219], v[244:247]
  ds_read_b64_tr_b16 a[162:163], v11 offset:37888
  v_mfma_f32_16x16x32_bf16 v[248:251], a[172:175], a[204:207], v[248:251]
  ds_read_b64_tr_b16 a[164:165], v12 offset:36864
  v_mfma_f32_16x16x32_bf16 v[252:255], a[172:175], a[216:219], v[252:255]
  ds_read_b64_tr_b16 a[166:167], v12 offset:37888
  s_waitcnt lgkmcnt(8)
  v_mfma_f32_16x16x32_bf16 v[240:243], a[144:147], a[184:187], v[240:243]
  ds_read_b64_tr_b16 a[168:169], v11 offset:38912
  v_mfma_f32_16x16x32_bf16 v[244:247], a[144:147], a[196:199], v[244:247]
  ds_read_b64_tr_b16 a[170:171], v11 offset:39936
  v_mfma_f32_16x16x32_bf16 v[248:251], a[148:151], a[184:187], v[248:251]
  ds_read_b64_tr_b16 a[172:173], v12 offset:38912
  v_mfma_f32_16x16x32_bf16 v[252:255], a[148:151], a[196:199], v[252:255]
  ds_read_b64_tr_b16 a[174:175], v12 offset:39936
  s_waitcnt lgkmcnt(8)
  v_mfma_f32_16x16x32_bf16 v[240:243], a[152:155], a[208:211], v[240:243]
  ds_read_b64_tr_b16 a[144:145], v11 offset:40960
  v_mfma_f32_16x16x32_bf16 v[244:247], a[152:155], a[220:223], v[244:247]
  ds_read_b64_tr_b16 a[146:147], v11 offset:41984
  v_mfma_f32_16x16x32_bf16 v[248:251], a[156:159], a[208:211], v[248:251]
  ds_read_b64_tr_b16 a[148:149], v12 offset:40960
  v_mfma_f32_16x16x32_bf16 v[252:255], a[156:159], a[220:223], v[252:255]
  ds_read_b64_tr_b16 a[150:151], v12 offset:41984
  s_waitcnt lgkmcnt(8)
  v_mfma_f32_16x16x32_bf16 v[240:243], a[160:163], v[200:203], v[240:243]
  ds_read_b64_tr_b16 a[152:153], v11 offset:43008
  v_mfma_f32_16x16x32_bf16 v[244:247], a[160:163], v[204:207], v[244:247]
  ds_read_b64_tr_b16 a[154:155], v11 offset:44032
  v_mfma_f32_16x16x32_bf16 v[248:251], a[164:167], v[200:203], v[248:251]
  ds_read_b64_tr_b16 a[156:157], v12 offset:43008
  v_mfma_f32_16x16x32_bf16 v[252:255], a[164:167], v[204:207], v[252:255]
  ds_read_b64_tr_b16 a[158:159], v12 offset:44032
  s_waitcnt lgkmcnt(8)
  v_mfma_f32_16x16x32_bf16 v[240:243], a[168:171], v[208:211], v[240:243]
  ds_read_b64_tr_b16 a[160:161], v11 offset:45056
  v_mfma_f32_16x16x32_bf16 v[244:247], a[168:171], v[212:215], v[244:247]
  ds_read_b64_tr_b16 a[162:163], v11 offset:46080
  v_mfma_f32_16x16x32_bf16 v[248:251], a[172:175], v[208:211], v[248:251]
  ds_read_b64_tr_b16 a[164:165], v12 offset:45056
  v_mfma_f32_16x16x32_bf16 v[252:255], a[172:175], v[212:215], v[252:255]
  ds_read_b64_tr_b16 a[166:167], v12 offset:46080
  s_waitcnt lgkmcnt(8)
  v_mfma_f32_16x16x32_bf16 v[240:243], a[144:147], a[224:227], v[240:243]
  ds_read_b64_tr_b16 a[168:169], v11 offset:47104
  v_mfma_f32_16x16x32_bf16 v[244:247], a[144:147], a[236:239], v[244:247]
  ds_read_b64_tr_b16 a[170:171], v11 offset:48128
  v_mfma_f32_16x16x32_bf16 v[248:251], a[148:151], a[224:227], v[248:251]
  ds_read_b64_tr_b16 a[172:173], v12 offset:47104
  v_mfma_f32_16x16x32_bf16 v[252:255], a[148:151], a[236:239], v[252:255]
  ds_read_b64_tr_b16 a[174:175], v12 offset:48128
  s_waitcnt lgkmcnt(8)
  v_mfma_f32_16x16x32_bf16 v[240:243], a[152:155], a[248:251], v[240:243]
  ds_read_b64_tr_b16 a[144:145], v11 offset:49152
  v_mfma_f32_16x16x32_bf16 v[244:247], a[152:155], a[4:7], v[244:247]
  ds_read_b64_tr_b16 a[146:147], v11 offset:50176
  v_mfma_f32_16x16x32_bf16 v[248:251], a[156:159], a[248:251], v[248:251]
  ds_read_b64_tr_b16 a[148:149], v12 offset:49152
  v_mfma_f32_16x16x32_bf16 v[252:255], a[156:159], a[4:7], v[252:255]
  ds_read_b64_tr_b16 a[150:151], v12 offset:50176
  s_waitcnt lgkmcnt(8)
  v_mfma_f32_16x16x32_bf16 v[240:243], a[160:163], a[228:231], v[240:243]
  ds_read_b64_tr_b16 a[152:153], v11 offset:51200
  v_mfma_f32_16x16x32_bf16 v[244:247], a[160:163], a[240:243], v[244:247]
  ds_read_b64_tr_b16 a[154:155], v11 offset:52224
  v_mfma_f32_16x16x32_bf16 v[248:251], a[164:167], a[228:231], v[248:251]
  ds_read_b64_tr_b16 a[156:157], v12 offset:51200
  v_mfma_f32_16x16x32_bf16 v[252:255], a[164:167], a[240:243], v[252:255]
  ds_read_b64_tr_b16 a[158:159], v12 offset:52224
  s_waitcnt lgkmcnt(8)
  v_mfma_f32_16x16x32_bf16 v[240:243], a[168:171], a[252:255], v[240:243]
  ds_read_b64_tr_b16 a[160:161], v11 offset:53248
  v_mfma_f32_16x16x32_bf16 v[244:247], a[168:171], a[8:11], v[244:247]
  ds_read_b64_tr_b16 a[162:163], v11 offset:54272
  v_mfma_f32_16x16x32_bf16 v[248:251], a[172:175], a[252:255], v[248:251]
  ds_read_b64_tr_b16 a[164:165], v12 offset:53248
  s_waitcnt vmcnt(0)
  s_mov_b64 exec, 1
  buffer_store_dword v7, off, s[8:11], s85 offset:256 sc1
  s_mov_b64 exec, -1
  v_mfma_f32_16x16x32_bf16 v[252:255], a[172:175], a[8:11], v[252:255]
  ds_read_b64_tr_b16 a[166:167], v12 offset:54272
  s_waitcnt lgkmcnt(8)
  v_mfma_f32_16x16x32_bf16 v[240:243], a[144:147], a[232:235], v[240:243]
  ds_read_b64_tr_b16 a[168:169], v11 offset:55296
  v_mfma_f32_16x16x32_bf16 v[244:247], a[144:147], a[244:247], v[244:247]
  ds_read_b64_tr_b16 a[170:171], v11 offset:56320
  v_mfma_f32_16x16x32_bf16 v[248:251], a[148:151], a[232:235], v[248:251]
  ds_read_b64_tr_b16 a[172:173], v12 offset:55296
  v_mfma_f32_16x16x32_bf16 v[252:255], a[148:151], a[244:247], v[252:255]
  ds_read_b64_tr_b16 a[174:175], v12 offset:56320
  s_waitcnt lgkmcnt(8)
  v_mfma_f32_16x16x32_bf16 v[240:243], a[152:155], a[0:3], v[240:243]
  s_waitcnt vmcnt(3)
  s_barrier
  ds_read_b64_tr_b16 a[144:145], v11 offset:57344
  v_mfma_f32_16x16x32_bf16 v[244:247], a[152:155], a[12:15], v[244:247]
  ds_read_b64_tr_b16 a[146:147], v11 offset:58368
  v_mfma_f32_16x16x32_bf16 v[248:251], a[156:159], a[0:3], v[248:251]
  ds_read_b64_tr_b16 a[148:149], v12 offset:57344
  s_waitcnt vmcnt(11)
  v_mfma_f32_16x16x32_bf16 v[88:91], v[96:99], v[32:35], 0
  v_mfma_f32_16x16x32_bf16 v[252:255], a[156:159], a[12:15], v[252:255]
  ds_read_b64_tr_b16 a[150:151], v12 offset:58368
  s_waitcnt lgkmcnt(8)
  v_mfma_f32_16x16x32_bf16 v[240:243], a[160:163], v[24:27], v[240:243]
  ds_read_b64_tr_b16 a[152:153], v11 offset:59392
  s_waitcnt vmcnt(10)
  v_mfma_f32_16x16x32_bf16 v[88:91], v[96:99], v[48:51], v[88:91]
  v_mfma_f32_16x16x32_bf16 v[244:247], a[160:163], v[28:31], v[244:247]
  ds_read_b64_tr_b16 a[154:155], v11 offset:60416
  v_mfma_f32_16x16x32_bf16 v[248:251], a[164:167], v[24:27], v[248:251]
  ds_read_b64_tr_b16 a[156:157], v12 offset:59392
  s_waitcnt vmcnt(9)
  v_mfma_f32_16x16x32_bf16 v[88:91], v[96:99], v[64:67], v[88:91]
  v_mfma_f32_16x16x32_bf16 v[252:255], a[164:167], v[28:31], v[252:255]
  ds_read_b64_tr_b16 a[158:159], v12 offset:60416
  s_waitcnt lgkmcnt(8)
  v_mfma_f32_16x16x32_bf16 v[240:243], a[168:171], v[40:43], v[240:243]
  ds_read_b64_tr_b16 a[160:161], v11 offset:61440
  s_waitcnt vmcnt(4)
  v_mfma_f32_16x16x32_bf16 v[88:91], v[96:99], v[80:83], v[88:91]
  v_mfma_f32_16x16x32_bf16 v[244:247], a[168:171], v[44:47], v[244:247]
  ds_read_b64_tr_b16 a[162:163], v11 offset:62464
  v_mfma_f32_16x16x32_bf16 v[248:251], a[172:175], v[40:43], v[248:251]
  ds_read_b64_tr_b16 a[164:165], v12 offset:61440
  v_mfma_f32_16x16x32_bf16 v[252:255], a[172:175], v[44:47], v[252:255]
  ds_read_b64_tr_b16 a[166:167], v12 offset:62464
  s_waitcnt lgkmcnt(8)
  v_mfma_f32_16x16x32_bf16 v[240:243], a[144:147], a[16:19], v[240:243]
  ds_read_b64_tr_b16 a[168:169], v11 offset:63488
  v_mfma_f32_16x16x32_bf16 v[244:247], a[144:147], a[28:31], v[244:247]
  ds_read_b64_tr_b16 a[170:171], v11 offset:64512
  v_mfma_f32_16x16x32_bf16 v[248:251], a[148:151], a[16:19], v[248:251]
  ds_read_b64_tr_b16 a[172:173], v12 offset:63488
  v_mfma_f32_16x16x32_bf16 v[252:255], a[148:151], a[28:31], v[252:255]
  ds_read_b64_tr_b16 a[174:175], v12 offset:64512
  s_waitcnt lgkmcnt(8)
  v_mfma_f32_16x16x32_bf16 v[240:243], a[152:155], a[40:43], v[240:243]
  v_add_u32 v11, 65536, v11
  ds_read_b64_tr_b16 a[144:145], v11 offset:0
  v_mfma_f32_16x16x32_bf16 v[244:247], a[152:155], a[52:55], v[244:247]
  ds_read_b64_tr_b16 a[146:147], v11 offset:1024
  v_mfma_f32_16x16x32_bf16 v[248:251], a[156:159], a[40:43], v[248:251]
  v_add_u32 v12, 65536, v12
  ds_read_b64_tr_b16 a[148:149], v12 offset:0
  v_mfma_f32_16x16x32_bf16 v[252:255], a[156:159], a[52:55], v[252:255]
  ds_read_b64_tr_b16 a[150:151], v12 offset:1024
  s_waitcnt lgkmcnt(8)
  v_mfma_f32_16x16x32_bf16 v[240:243], a[160:163], a[20:23], v[240:243]
  ds_read_b64_tr_b16 a[152:153], v11 offset:2048
  v_mfma_f32_16x16x32_bf16 v[244:247], a[160:163], a[32:35], v[244:247]
  ds_read_b64_tr_b16 a[154:155], v11 offset:3072
  v_mfma_f32_16x16x32_bf16 v[248:251], a[164:167], a[20:23], v[248:251]
  ds_read_b64_tr_b16 a[156:157], v12 offset:2048
  v_mfma_f32_16x16x32_bf16 v[252:255], a[164:167], a[32:35], v[252:255]
  ds_read_b64_tr_b16 a[158:159], v12 offset:3072
  s_waitcnt lgkmcnt(8)
  v_mfma_f32_16x16x32_bf16 v[240:243], a[168:171], a[44:47], v[240:243]
  ds_read_b64_tr_b16 a[160:161], v11 offset:4096
  v_mfma_f32_16x16x32_bf16 v[244:247], a[168:171], a[56:59], v[244:247]
  ds_read_b64_tr_b16 a[162:163], v11 offset:5120
  v_mfma_f32_16x16x32_bf16 v[248:251], a[172:175], a[44:47], v[248:251]
  ds_read_b64_tr_b16 a[164:165], v12 offset:4096
  v_fmac_f32 v92, v88, v103
  v_mfma_f32_16x16x32_bf16 v[252:255], a[172:175], a[56:59], v[252:255]
  ds_read_b64_tr_b16 a[166:167], v12 offset:5120
  s_waitcnt lgkmcnt(8)
  v_mfma_f32_16x16x32_bf16 v[240:243], a[144:147], a[24:27], v[240:243]
  ds_read_b64_tr_b16 a[168:169], v11 offset:6144
  v_fmac_f32 v93, v89, v103
  v_mfma_f32_16x16x32_bf16 v[244:247], a[144:147], a[36:39], v[244:247]
  ds_read_b64_tr_b16 a[170:171], v11 offset:7168
  v_mfma_f32_16x16x32_bf16 v[248:251], a[148:151], a[24:27], v[248:251]
  ds_read_b64_tr_b16 a[172:173], v12 offset:6144
  v_fmac_f32 v94, v90, v103
  v_mfma_f32_16x16x32_bf16 v[252:255], a[148:151], a[36:39], v[252:255]
  ds_read_b64_tr_b16 a[174:175], v12 offset:7168
  s_waitcnt lgkmcnt(8)
  v_mfma_f32_16x16x32_bf16 v[240:243], a[152:155], a[48:51], v[240:243]
  ds_read_b64_tr_b16 a[144:145], v11 offset:8192
  v_fmac_f32 v95, v91, v103
  v_mfma_f32_16x16x32_bf16 v[244:247], a[152:155], a[60:63], v[244:247]
  ds_read_b64_tr_b16 a[146:147], v11 offset:9216
  v_mfma_f32_16x16x32_bf16 v[248:251], a[156:159], a[48:51], v[248:251]
  ds_read_b64_tr_b16 a[148:149], v12 offset:8192
  v_cvt_pk_bf16_f32 v92, v92, v93
  v_mfma_f32_16x16x32_bf16 v[252:255], a[156:159], a[60:63], v[252:255]
  ds_read_b64_tr_b16 a[150:151], v12 offset:9216
  s_waitcnt lgkmcnt(8)
  v_mfma_f32_16x16x32_bf16 v[240:243], a[160:163], v[56:59], v[240:243]
  ds_read_b64_tr_b16 a[152:153], v11 offset:10240
  v_cvt_pk_bf16_f32 v93, v94, v95
  v_mfma_f32_16x16x32_bf16 v[244:247], a[160:163], v[60:63], v[244:247]
  ds_read_b64_tr_b16 a[154:155], v11 offset:11264
  v_mfma_f32_16x16x32_bf16 v[248:251], a[164:167], v[56:59], v[248:251]
  ds_read_b64_tr_b16 a[156:157], v12 offset:10240
  s_mov_b32 exec_lo, 0xffff
  s_mov_b32 exec_hi, 0xffff
  buffer_store_dwordx2 v[92:93], v15, s[76:79], s96 offen offset:1024
  s_mov_b64 exec, -1
  v_mfma_f32_16x16x32_bf16 v[252:255], a[164:167], v[60:63], v[252:255]
  ds_read_b64_tr_b16 a[158:159], v12 offset:11264
  buffer_load_dword v22, v13, s[8:11], s97 offen offset:256 sc1
  s_waitcnt lgkmcnt(8)
  v_mfma_f32_16x16x32_bf16 v[240:243], a[168:171], v[72:75], v[240:243]
  ds_read_b64_tr_b16 a[160:161], v11 offset:12288
  s_mov_b32 s96, s95
  v_mfma_f32_16x16x32_bf16 v[244:247], a[168:171], v[76:79], v[244:247]
  ds_read_b64_tr_b16 a[162:163], v11 offset:13312
  v_mfma_f32_16x16x32_bf16 v[248:251], a[172:175], v[72:75], v[248:251]
  ds_read_b64_tr_b16 a[164:165], v12 offset:12288
  s_add_u32 s95, s95, 18432
  v_mfma_f32_16x16x32_bf16 v[252:255], a[172:175], v[76:79], v[252:255]
  ds_read_b64_tr_b16 a[166:167], v12 offset:13312
  s_waitcnt lgkmcnt(8)
  v_mfma_f32_16x16x32_bf16 v[240:243], a[144:147], a[64:67], v[240:243]
  ds_read_b64_tr_b16 a[168:169], v11 offset:14336
  v_mfma_f32_16x16x32_bf16 v[244:247], a[144:147], a[68:71], v[244:247]
  ds_read_b64_tr_b16 a[170:171], v11 offset:15360
  v_mfma_f32_16x16x32_bf16 v[248:251], a[148:151], a[64:67], v[248:251]
  ds_read_b64_tr_b16 a[172:173], v12 offset:14336
  v_mfma_f32_16x16x32_bf16 v[252:255], a[148:151], a[68:71], v[252:255]
  ds_read_b64_tr_b16 a[174:175], v12 offset:15360
  s_waitcnt lgkmcnt(8)
  v_mfma_f32_16x16x32_bf16 v[240:243], a[152:155], a[72:75], v[240:243]
  ds_read_b64_tr_b16 a[144:145], v11 offset:16384
  v_mfma_f32_16x16x32_bf16 v[244:247], a[152:155], a[76:79], v[244:247]
  ds_read_b64_tr_b16 a[146:147], v11 offset:17408
  v_mfma_f32_16x16x32_bf16 v[248:251], a[156:159], a[72:75], v[248:251]
  ds_read_b64_tr_b16 a[148:149], v12 offset:16384
  v_mfma_f32_16x16x32_bf16 v[252:255], a[156:159], a[76:79], v[252:255]
  ds_read_b64_tr_b16 a[150:151], v12 offset:17408
  s_waitcnt lgkmcnt(8)
  v_mfma_f32_16x16x32_bf16 v[240:243], a[160:163], a[88:91], v[240:243]
  ds_read_b64_tr_b16 a[152:153], v11 offset:18432
  v_mfma_f32_16x16x32_bf16 v[244:247], a[160:163], a[92:95], v[244:247]
  ds_read_b64_tr_b16 a[154:155], v11 offset:19456
  v_mfma_f32_16x16x32_bf16 v[248:251], a[164:167], a[88:91], v[248:251]
  ds_read_b64_tr_b16 a[156:157], v12 offset:18432
  v_mfma_f32_16x16x32_bf16 v[252:255], a[164:167], a[92:95], v[252:255]
  ds_read_b64_tr_b16 a[158:159], v12 offset:19456
  s_waitcnt lgkmcnt(8)
  v_mfma_f32_16x16x32_bf16 v[240:243], a[168:171], a[96:99], v[240:243]
  ds_read_b64_tr_b16 a[160:161], v11 offset:20480
  v_mfma_f32_16x16x32_bf16 v[244:247], a[168:171], a[100:103], v[244:247]
  ds_read_b64_tr_b16 a[162:163], v11 offset:21504
  v_mfma_f32_16x16x32_bf16 v[248:251], a[172:175], a[96:99], v[248:251]
  ds_read_b64_tr_b16 a[164:165], v12 offset:20480
  v_mfma_f32_16x16x32_bf16 v[252:255], a[172:175], a[100:103], v[252:255]
  ds_read_b64_tr_b16 a[166:167], v12 offset:21504
  s_waitcnt lgkmcnt(8)
  v_mfma_f32_16x16x32_bf16 v[240:243], a[144:147], a[112:115], v[240:243]
  ds_read_b64_tr_b16 a[168:169], v11 offset:22528
  v_mfma_f32_16x16x32_bf16 v[244:247], a[144:147], a[116:119], v[244:247]
  ds_read_b64_tr_b16 a[170:171], v11 offset:23552
  v_mfma_f32_16x16x32_bf16 v[248:251], a[148:151], a[112:115], v[248:251]
  ds_read_b64_tr_b16 a[172:173], v12 offset:22528
  v_mfma_f32_16x16x32_bf16 v[252:255], a[148:151], a[116:119], v[252:255]
  ds_read_b64_tr_b16 a[174:175], v12 offset:23552
  s_waitcnt lgkmcnt(8)
  v_mfma_f32_16x16x32_bf16 v[240:243], a[152:155], a[120:123], v[240:243]
  ds_read_b64_tr_b16 a[144:145], v11 offset:24576
  v_mfma_f32_16x16x32_bf16 v[244:247], a[152:155], a[124:127], v[244:247]
  ds_read_b64_tr_b16 a[146:147], v11 offset:25600
  v_mfma_f32_16x16x32_bf16 v[248:251], a[156:159], a[120:123], v[248:251]
  ds_read_b64_tr_b16 a[148:149], v12 offset:24576
  v_mfma_f32_16x16x32_bf16 v[252:255], a[156:159], a[124:127], v[252:255]
  ds_read_b64_tr_b16 a[150:151], v12 offset:25600
  s_waitcnt lgkmcnt(8)
  v_mfma_f32_16x16x32_bf16 v[240:243], a[160:163], v[216:219], v[240:243]
  ds_read_b64_tr_b16 a[152:153], v11 offset:26624
  v_mfma_f32_16x16x32_bf16 v[244:247], a[160:163], v[220:223], v[244:247]
  ds_read_b64_tr_b16 a[154:155], v11 offset:27648
  v_mfma_f32_16x16x32_bf16 v[248:251], a[164:167], v[216:219], v[248:251]
  ds_read_b64_tr_b16 a[156:157], v12 offset:26624
  v_mfma_f32_16x16x32_bf16 v[252:255], a[164:167], v[220:223], v[252:255]
  ds_read_b64_tr_b16 a[158:159], v12 offset:27648
  s_waitcnt lgkmcnt(8)
  v_mfma_f32_16x16x32_bf16 v[240:243], a[168:171], a[80:83], v[240:243]
  v_mfma_f32_16x16x32_bf16 v[244:247], a[168:171], a[84:87], v[244:247]
  v_mfma_f32_16x16x32_bf16 v[248:251], a[172:175], a[80:83], v[248:251]
  v_mfma_f32_16x16x32_bf16 v[252:255], a[172:175], a[84:87], v[252:255]
  s_waitcnt lgkmcnt(4)
  v_mfma_f32_16x16x32_bf16 v[240:243], a[144:147], a[104:107], v[240:243]
  v_mfma_f32_16x16x32_bf16 v[244:247], a[144:147], a[108:111], v[244:247]
  v_mfma_f32_16x16x32_bf16 v[248:251], a[148:151], a[104:107], v[248:251]
  v_mfma_f32_16x16x32_bf16 v[252:255], a[148:151], a[108:111], v[252:255]
  s_waitcnt lgkmcnt(0)
  v_mfma_f32_16x16x32_bf16 v[240:243], a[152:155], a[128:131], v[240:243]
  v_mfma_f32_16x16x32_bf16 v[244:247], a[152:155], a[132:135], v[244:247]
  v_mfma_f32_16x16x32_bf16 v[248:251], a[156:159], a[128:131], v[248:251]
  v_mfma_f32_16x16x32_bf16 v[252:255], a[156:159], a[132:135], v[252:255]
  s_waitcnt vmcnt(0)
  v_cmp_eq_u32 vcc, 0, v22
  s_cbranch_vccz k4_part_bk2
k4_part_sl2:
  s_sleep 1
  buffer_load_dword v22, v13, s[8:11], s97 offen offset:256 sc1
  s_sub_u32 s87, s87, 1
  s_max_i32 s87, s87, 0
  s_waitcnt vmcnt(0)
  s_cbranch_scc0 k4_part_bk2
  v_cmp_eq_u32 vcc, 0, v22
  s_cbranch_vccnz k4_part_sl2
k4_part_bk2:
  buffer_load_dwordx4 v[160:163], v2, s[8:11], s34 offen offset:0 sc1
  buffer_load_dwordx4 v[164:167], v2, s[8:11], s34 offen offset:1024 sc1
  buffer_load_dwordx4 v[168:171], v2, s[8:11], s88 offen offset:0 sc1
  buffer_load_dwordx4 v[172:175], v2, s[8:11], s88 offen offset:1024 sc1
  buffer_load_dwordx4 v[152:155], v2, s[8:11], s31 offen offset:0 sc1
k4_part_w10:
  s_cbranch_execz k4_part_wr
  buffer_load_dwordx4 v[156:159], v2, s[8:11], s31 offen offset:1024 sc1
  s_waitcnt vmcnt(5)
  v_mfma_f32_16x16x32_bf16 v[240:243], v[130:133], v[160:163], v[240:243]
  v_mfma_f32_16x16x32_bf16 v[248:251], v[128:131], v[160:163], v[248:251]
  s_waitcnt vmcnt(4)
  v_mfma_f32_16x16x32_bf16 v[244:247], v[130:133], v[164:167], v[244:247]
  v_mfma_f32_16x16x32_bf16 v[252:255], v[128:131], v[164:167], v[252:255]
  s_waitcnt vmcnt(3)
  v_mfma_f32_16x16x32_bf16 v[240:243], v[130:133], v[168:171], v[240:243]
  v_mfma_f32_16x16x32_bf16 v[248:251], v[128:131], v[168:171], v[248:251]
  s_waitcnt vmcnt(2)
  v_mfma_f32_16x16x32_bf16 v[244:247], v[130:133], v[172:175], v[244:247]
  v_mfma_f32_16x16x32_bf16 v[252:255], v[128:131], v[172:175], v[252:255]
  s_waitcnt vmcnt(1)
  v_mfma_f32_16x16x32_bf16 v[240:243], v[130:133], v[152:155], v[240:243]
  v_mfma_f32_16x16x32_bf16 v[248:251], v[128:131], v[152:155], v[248:251]
  s_waitcnt vmcnt(0)
  v_mfma_f32_16x16x32_bf16 v[244:247], v[130:133], v[156:159], v[244:247]
  v_mfma_f32_16x16x32_bf16 v[252:255], v[128:131], v[156:159], v[252:255]
  s_nop 7
  v_fmac_f32 v104, v240, v20
  v_fmac_f32 v105, v241, v20
  v_fmac_f32 v106, v242, v20
  v_fmac_f32 v107, v243, v20
  v_fmac_f32 v108, v248, v20
  v_fmac_f32 v109, v249, v20
  v_fmac_f32 v110, v250, v20
  v_fmac_f32 v111, v251, v20
  v_cvt_pk_bf16_f32 v104, v104, v105
  v_cvt_pk_bf16_f32 v105, v106, v107
  v_cvt_pk_bf16_f32 v106, v108, v109
  v_cvt_pk_bf16_f32 v107, v110, v111
  v_fmac_f32 v112, v244, v21
  v_fmac_f32 v113, v245, v21
  v_fmac_f32 v114, v246, v21
  v_fmac_f32 v115, v247, v21
  v_fmac_f32 v116, v252, v21
  v_fmac_f32 v117, v253, v21
  v_fmac_f32 v118, v254, v21
  v_fmac_f32 v119, v255, v21
  v_permlane16_swap_b32 v104, v106
  v_permlane16_swap_b32 v105, v107
  buffer_store_dwordx4 v[104:107], v102, s[76:79], s96 offen
  v_cvt_pk_bf16_f32 v112, v112, v113
  v_cvt_pk_bf16_f32 v113, v114, v115
  v_cvt_pk_bf16_f32 v114, v116, v117
  v_cvt_pk_bf16_f32 v115, v118, v119
  s_nop 1
  v_permlane16_swap_b32 v112, v114
  v_permlane16_swap_b32 v113, v115
  buffer_store_dwordx4 v[112:115], v102, s[76:79], s95 offen
k4_part_end:
  s_endpgm
code_end:
.section .rodata,"a"
.p2align 6
.amdhsa_kernel k1_kernel
  .amdhsa_next_free_vgpr 512
  .amdhsa_next_free_sgpr 102
  .amdhsa_accum_offset 256
  .amdhsa_group_segment_fixed_size 0
  .amdhsa_kernarg_size 80
  .amdhsa_user_sgpr_count 2
  .amdhsa_user_sgpr_kernarg_segment_ptr 1
  .amdhsa_system_sgpr_workgroup_id_x 1
  .amdhsa_float_denorm_mode_32 3
  .amdhsa_float_denorm_mode_16_64 3
.end_amdhsa_kernel
```
